```python
import torch

def _softmax(x, axis=-1):
    return torch.softmax(x, dim=axis)

def _gelu(x):
    return torch.nn.functional.gelu(x, approximate='tanh')

def _silu(x):
    return torch.nn.functional.silu(x)

def _sigmoid(x):
    return torch.sigmoid(x)

def _layernorm(x, axis=-1, eps=1e-05):
    m = x.mean(dim=axis, keepdim=True)
    v = x.var(dim=axis, keepdim=True, unbiased=False)
    return (x - m) / torch.sqrt(v + eps)

def _scatter_add(tgt, idx, src, axis=0):
    return tgt.clone().index_add_(axis, idx, src)

def _segment_sum(src, seg, n):
    out = torch.zeros((n,) + src.shape[1:], dtype=src.dtype)
    return out.index_add_(0, seg, src)

def _pad(x, pw):
    flat = tuple((v for pair in reversed(pw) for v in pair))
    return torch.nn.functional.pad(x, flat)
kernel_name = 'interleave_layers__memory_aug_recurrent_mem_tr__dense_activation_silu__prompt'

def setup_inputs():

    _w = lambda a: (lambda t: t.to(torch.bfloat16) if t.is_floating_point() else t)(torch.as_tensor(a))

    def _A_setup():
        B, S, Dm = (1, 2048, 448)
        H, Dh = (16, 256)
        M, seg = (8, 32)
        seg = min(seg, S)
        S = S // seg * seg
        return {'x': _w((lambda *s: torch.randn(*s, dtype=torch.bfloat16) * 0.05)(B, S, Dm)), 'mem0': _w((lambda *s: torch.randn(*s, dtype=torch.bfloat16) * 0.2)(B, M, Dm)), 'Wq': _w((lambda *s: torch.randn(*s, dtype=torch.bfloat16) * 1.6)(Dm, H, Dh) * Dm ** (-0.5)), 'Wk': _w((lambda *s: torch.randn(*s, dtype=torch.bfloat16) * 1.6)(Dm, H, Dh) * Dm ** (-0.5)), 'Wv': _w((lambda *s: torch.randn(*s, dtype=torch.bfloat16) * 0.2)(Dm, H, Dh) * Dm ** (-0.5)), 'Wo': _w((lambda *s: torch.randn(*s, dtype=torch.bfloat16) * 0.2)(H, Dh, Dm) * (H * Dh) ** (-0.5)), 'seg_len': seg}
    _A_in = _A_setup()

    def _B_setup():
        B, S, D, F = (1, 2048, 448, 1792)
        return {'x': _w((lambda *s: torch.randn(*s, dtype=torch.bfloat16) * 0.05)(B, S, D)), 'w1': _w((lambda *s: torch.randn(*s, dtype=torch.bfloat16) * 0.4)(D, F) * D ** (-0.5)), 'w2': _w((lambda *s: torch.randn(*s, dtype=torch.bfloat16) * 0.1)(F, D) * F ** (-0.5))}
    _B_in = _B_setup()
    return {'A_x': _A_in['x'], 'A_mem0': _A_in['mem0'], 'A_Wq': _A_in['Wq'], 'A_Wk': _A_in['Wk'], 'A_Wv': _A_in['Wv'], 'A_Wo': _A_in['Wo'], 'A_seg_len': _A_in['seg_len'], 'B_x': _B_in['x'], 'B_w1': _B_in['w1'], 'B_w2': _B_in['w2']}

def reference(A_x, A_mem0, A_Wq, A_Wk, A_Wv, A_Wo, A_seg_len, B_x, B_w1, B_w2):

    def _A_ref(x, mem0, Wq, Wk, Wv, Wo, seg_len):
        B, S, Dm = x.shape
        H, Dh = (Wq.shape[1], Wq.shape[2])
        M = mem0.shape[1]
        scale = Dh ** (-0.5)
        n_seg = S // seg_len
        L = M + seg_len
        idx = torch.arange(L)
        mask = (idx[:, None] < M) | (idx[:, None] >= idx[None, :])
        mem = mem0
        outs = []
        for s in range(n_seg):
            xs = x[:, s * seg_len:(s + 1) * seg_len, :].clone()
            h = torch.concatenate([mem, xs], axis=1)
            q = torch.einsum('btd,dhe->bhte', h, Wq)
            k = torch.einsum('btd,dhe->bhte', h, Wk)
            v = torch.einsum('btd,dhe->bhte', h, Wv)
            scores = torch.einsum('bhqe,bhke->bhqk', q, k) * scale
            scores = torch.where(mask[None, None], scores, -1000000000.0)
            p = _softmax(scores, axis=-1)
            o = torch.einsum('bhqk,bhke->bhqe', p, v)
            o = torch.einsum('bhte,hed->btd', o, Wo)
            mem = o[:, :M, :].clone()
            outs.append(o[:, M:, :])
        return torch.concatenate(outs, axis=1)

    def _B_ref(x, w1, w2):
        h = torch.einsum('bsd,df->bsf', x, w1)
        h = _silu(h)
        out = torch.einsum('bsf,fd->bsd', h, w2)
        return out
    x = A_x
    x = x + _A_ref(_layernorm(x, axis=-1), A_mem0, A_Wq, A_Wk, A_Wv, A_Wo, A_seg_len)
    x = x + _B_ref(_layernorm(x, axis=-1), B_w1, B_w2)
    x = x + _A_ref(_layernorm(x, axis=-1), A_mem0, A_Wq, A_Wk, A_Wv, A_Wo, A_seg_len)
    x = x + _B_ref(_layernorm(x, axis=-1), B_w1, B_w2)
    return x
```

```asm
; @launch grid=(256,1,1) block=(256,1,1) lds=163840
.amdgcn_target "amdgcn-amd-amdhsa--gfx950"
.text
.globl interleave_layers__memory_aug_recurrent_mem_tr__dense_activation_silu__prompt_kernel
.p2align 8
.type interleave_layers__memory_aug_recurrent_mem_tr__dense_activation_silu__prompt_kernel,@function
interleave_layers__memory_aug_recurrent_mem_tr__dense_activation_silu__prompt_kernel:
    s_cmp_ge_u32 s2, 256
    s_cbranch_scc1 main_exit
    s_load_dwordx2 s[4:5], s[0:1], 96
    v_lshrrev_b32 v1, 6, v0
    s_and_b32 s8, s2, 1
    s_lshr_b32 s9, s2, 3
    v_readfirstlane_b32 s10, v1
    s_mov_b32 s6, 268435456
    s_mov_b32 s7, 0x20000
    s_mov_b32 s13, 8388608
    s_mov_b32 s12, 0
    s_mov_b32 s11, 0
    s_bfe_u32 s14, s2, 0x20001
    s_waitcnt lgkmcnt(0)
    s_load_dwordx2 s[16:17], s[0:1], 0
    s_mov_b32 s18, 1835008
    s_mov_b32 s19, 0x20000
    s_load_dwordx2 s[20:21], s[0:1], 8
    s_mov_b32 s22, 7168
    s_mov_b32 s23, 0x20000
    s_load_dwordx2 s[32:33], s[0:1], 88
    s_mov_b32 s34, 256
    s_mov_b32 s35, 0x20000
    s_load_dwordx2 s[36:37], s[0:1], 16
    s_load_dwordx2 s[38:39], s[0:1], 24
    s_load_dwordx2 s[40:41], s[0:1], 32
    s_load_dwordx2 s[42:43], s[0:1], 40
    v_and_b32 v1, 63, v0
    v_and_b32 v2, 15, v0
    v_lshrrev_b32 v3, 4, v1
    s_and_b32 s45, s2, 7
    s_lshl_b32 s45, s45, 5
    s_lshr_b32 s44, s2, 3
    s_add_u32 s44, s44, s45
    s_sub_u32 s44, s44, 32
    s_and_b32 s44, s44, 0xff
    s_mul_i32 s46, s44, 293
    s_lshr_b32 s46, s46, 11
    s_mul_i32 s47, s46, 7
    s_sub_u32 s47, s44, s47
    s_bfe_u32 s48, s46, 0x10004
    s_and_b32 s46, s46, 15
    s_getreg_b32 s15, hwreg(HW_REG_XCC_ID)
    s_and_b32 s15, s15, 15
    s_add_u32 s15, s15, 1
    s_lshl_b32 s55, s2, 7
    s_add_u32 s55, s55, 176128
    v_mov_b32 v6, 1073741824
    v_cmp_eq_u32 vcc, 0, v0
    s_nop 1
    v_cndmask_b32 v4, v6, 0, vcc
    v_mov_b32 v5, s15
    v_lshrrev_b32 v11, 5, v1
    v_add_u32 v11, 0, v11
    v_and_b32 v12, 3, v11
    v_lshl_add_u32 v12, s10, 2, v12
    v_and_b32 v13, 31, v1
    v_xor_b32 v13, v13, v12
    v_lshl_add_u32 v11, s10, 3, v11
    v_lshlrev_b32 v11, 13, v11
    v_lshl_add_u32 v7, v13, 4, v11
    v_lshrrev_b32 v11, 5, v1
    v_add_u32 v11, 2, v11
    v_and_b32 v12, 3, v11
    v_lshl_add_u32 v12, s10, 2, v12
    v_and_b32 v13, 31, v1
    v_xor_b32 v13, v13, v12
    v_lshl_add_u32 v11, s10, 3, v11
    v_lshlrev_b32 v11, 13, v11
    v_lshl_add_u32 v8, v13, 4, v11
    v_lshrrev_b32 v11, 5, v1
    v_add_u32 v11, 4, v11
    v_and_b32 v12, 3, v11
    v_lshl_add_u32 v12, s10, 2, v12
    v_and_b32 v13, 31, v1
    v_xor_b32 v13, v13, v12
    v_lshl_add_u32 v11, s10, 3, v11
    v_lshlrev_b32 v11, 13, v11
    v_lshl_add_u32 v9, v13, 4, v11
    v_lshrrev_b32 v11, 5, v1
    v_add_u32 v11, 6, v11
    v_and_b32 v12, 3, v11
    v_lshl_add_u32 v12, s10, 2, v12
    v_and_b32 v13, 31, v1
    v_xor_b32 v13, v13, v12
    v_lshl_add_u32 v11, s10, 3, v11
    v_lshlrev_b32 v11, 13, v11
    v_lshl_add_u32 v10, v13, 4, v11
    s_waitcnt lgkmcnt(0)
    v_mov_b32 v15, 0
    v_mov_b32 v14, 0
    s_and_b32 s45, s2, 7
    s_cmp_eq_u32 s45, 0
    s_cbranch_scc1 k0_norm
    s_cmp_eq_u32 s48, 0
    s_cselect_b64 s[24:25], s[36:37], s[40:41]
    s_cselect_b64 s[28:29], s[38:39], s[42:43]
    s_mov_b32 s26, 3670016
    s_mov_b32 s27, 0x20000
    s_mov_b32 s30, 3670016
    s_mov_b32 s31, 0x20000
    s_lshl_b32 s49, s46, 9
    s_lshl_b32 s50, s10, 12
    s_cmp_lg_u32 s48, 0
    s_cbranch_scc1 k0_resB
    s_lshl_b32 s51, s47, 19
    s_add_u32 s51, s51, s49
    s_add_u32 m0, s50, 0
    s_nop 0
    buffer_load_dwordx4 v7, s[28:31], s51 offen lds
    s_add_u32 m0, s50, 1024
    s_nop 0
    buffer_load_dwordx4 v8, s[28:31], s51 offen lds
    s_add_u32 m0, s50, 2048
    s_nop 0
    buffer_load_dwordx4 v9, s[28:31], s51 offen lds
    s_add_u32 m0, s50, 3072
    s_nop 0
    buffer_load_dwordx4 v10, s[28:31], s51 offen lds
    s_add_u32 s51, s51, 262144
    s_add_u32 m0, s50, 16384
    s_nop 0
    buffer_load_dwordx4 v7, s[28:31], s51 offen lds
    s_add_u32 m0, s50, 17408
    s_nop 0
    buffer_load_dwordx4 v8, s[28:31], s51 offen lds
    s_add_u32 m0, s50, 18432
    s_nop 0
    buffer_load_dwordx4 v9, s[28:31], s51 offen lds
    s_add_u32 m0, s50, 19456
    s_nop 0
    buffer_load_dwordx4 v10, s[28:31], s51 offen lds
    s_add_u32 s51, s51, 262144
    s_branch k0_resd
k0_resB:
    v_lshrrev_b32 v11, 3, v1
    v_mul_u32_u24 v11, 896, v11
    v_and_b32 v12, 7, v1
    v_lshl_add_u32 v11, v12, 4, v11
    s_mul_i32 s51, s46, 229376
    s_lshl_b32 s45, s47, 7
    s_add_u32 s51, s51, s45
    s_mul_i32 s45, s10, 57344
    s_add_u32 s51, s51, s45
    s_lshl_b32 s45, s10, 13
    s_add_u32 m0, s45, 0
    s_nop 0
    buffer_load_dwordx4 v11, s[28:31], s51 offen lds
    s_add_u32 s51, s51, 7168
    s_add_u32 m0, s45, 1024
    s_nop 0
    buffer_load_dwordx4 v11, s[28:31], s51 offen lds
    s_add_u32 s51, s51, 7168
    s_add_u32 m0, s45, 2048
    s_nop 0
    buffer_load_dwordx4 v11, s[28:31], s51 offen lds
    s_add_u32 s51, s51, 7168
    s_add_u32 m0, s45, 3072
    s_nop 0
    buffer_load_dwordx4 v11, s[28:31], s51 offen lds
    s_add_u32 s51, s51, 7168
    s_add_u32 m0, s45, 4096
    s_nop 0
    buffer_load_dwordx4 v11, s[28:31], s51 offen lds
    s_add_u32 s51, s51, 7168
    s_add_u32 m0, s45, 5120
    s_nop 0
    buffer_load_dwordx4 v11, s[28:31], s51 offen lds
    s_add_u32 s51, s51, 7168
    s_add_u32 m0, s45, 6144
    s_nop 0
    buffer_load_dwordx4 v11, s[28:31], s51 offen lds
    s_add_u32 s51, s51, 7168
    s_add_u32 m0, s45, 7168
    s_nop 0
    buffer_load_dwordx4 v11, s[28:31], s51 offen lds
    s_add_u32 s51, s51, 7168
k0_resd:
    v_lshrrev_b32 v12, 2, v0
    v_lshl_add_u32 v12, s47, 6, v12
    v_lshlrev_b32 v12, 13, v12
    v_and_b32 v13, 3, v0
    v_lshl_add_u32 v12, v13, 7, v12
    buffer_load_dword v13, v12, s[24:27], s49 offen
    s_add_u32 m0, s50, 32768
    s_nop 0
    buffer_load_dwordx4 v7, s[24:27], s49 offen lds
    s_add_u32 m0, s50, 33792
    s_nop 0
    buffer_load_dwordx4 v8, s[24:27], s49 offen lds
    s_add_u32 m0, s50, 34816
    s_nop 0
    buffer_load_dwordx4 v9, s[24:27], s49 offen lds
    s_add_u32 m0, s50, 35840
    s_nop 0
    buffer_load_dwordx4 v10, s[24:27], s49 offen lds
    s_add_u32 s49, s49, 262144
    s_add_u32 m0, s50, 49152
    s_nop 0
    buffer_load_dwordx4 v7, s[24:27], s49 offen lds
    s_add_u32 m0, s50, 50176
    s_nop 0
    buffer_load_dwordx4 v8, s[24:27], s49 offen lds
    s_add_u32 m0, s50, 51200
    s_nop 0
    buffer_load_dwordx4 v9, s[24:27], s49 offen lds
    s_add_u32 m0, s50, 52224
    s_nop 0
    buffer_load_dwordx4 v10, s[24:27], s49 offen lds
    s_add_u32 s49, s49, 262144
    s_add_u32 m0, s50, 65536
    s_nop 0
    buffer_load_dwordx4 v7, s[24:27], s49 offen lds
    s_add_u32 m0, s50, 66560
    s_nop 0
    buffer_load_dwordx4 v8, s[24:27], s49 offen lds
    s_add_u32 m0, s50, 67584
    s_nop 0
    buffer_load_dwordx4 v9, s[24:27], s49 offen lds
    s_add_u32 m0, s50, 68608
    s_nop 0
    buffer_load_dwordx4 v10, s[24:27], s49 offen lds
    s_add_u32 s49, s49, 262144
    s_add_u32 m0, s50, 81920
    s_nop 0
    buffer_load_dwordx4 v7, s[24:27], s49 offen lds
    s_add_u32 m0, s50, 82944
    s_nop 0
    buffer_load_dwordx4 v8, s[24:27], s49 offen lds
    s_add_u32 m0, s50, 83968
    s_nop 0
    buffer_load_dwordx4 v9, s[24:27], s49 offen lds
    s_add_u32 m0, s50, 84992
    s_nop 0
    buffer_load_dwordx4 v10, s[24:27], s49 offen lds
    s_add_u32 s49, s49, 262144
    s_add_u32 m0, s50, 98304
    s_nop 0
    buffer_load_dwordx4 v7, s[24:27], s49 offen lds
    s_add_u32 m0, s50, 99328
    s_nop 0
    buffer_load_dwordx4 v8, s[24:27], s49 offen lds
    s_add_u32 m0, s50, 100352
    s_nop 0
    buffer_load_dwordx4 v9, s[24:27], s49 offen lds
    s_add_u32 m0, s50, 101376
    s_nop 0
    buffer_load_dwordx4 v10, s[24:27], s49 offen lds
    s_add_u32 s49, s49, 262144
    s_add_u32 m0, s50, 114688
    s_nop 0
    buffer_load_dwordx4 v7, s[24:27], s49 offen lds
    s_add_u32 m0, s50, 115712
    s_nop 0
    buffer_load_dwordx4 v8, s[24:27], s49 offen lds
    s_add_u32 m0, s50, 116736
    s_nop 0
    buffer_load_dwordx4 v9, s[24:27], s49 offen lds
    s_add_u32 m0, s50, 117760
    s_nop 0
    buffer_load_dwordx4 v10, s[24:27], s49 offen lds
    s_add_u32 s49, s49, 262144
    v_lshrrev_b32 v11, 2, v2
    v_lshlrev_b32 v11, 3, v11
    v_and_b32 v12, 3, v2
    v_add_u32 v11, v11, v12
    v_lshlrev_b32 v11, 9, v11
    v_add_u32 v12, 0, v3
    v_xor_b32 v12, v12, v2
    v_lshl_add_u32 v80, v12, 4, v11
    v_add_u32 v12, 4, v3
    v_xor_b32 v12, v12, v2
    v_lshl_add_u32 v81, v12, 4, v11
    v_add_u32 v12, 8, v3
    v_xor_b32 v12, v12, v2
    v_lshl_add_u32 v82, v12, 4, v11
    v_add_u32 v12, 12, v3
    v_xor_b32 v12, v12, v2
    v_lshl_add_u32 v83, v12, 4, v11
    s_and_b32 s54, s10, 1
    s_lshr_b32 s45, s10, 1
    s_lshl_b32 s45, s45, 10
    v_lshl_add_u32 v84, v1, 4, s45
    s_waitcnt vmcnt(16)
    s_barrier
    s_lshl_b32 s44, s47, 1
    s_add_u32 s44, s44, s54
    s_lshl_b32 s44, s44, 1
    s_cmp_lg_u32 s48, 0
    s_cbranch_scc1 k0_rdB
    s_mul_i32 s52, s46, 28
    s_add_u32 s52, s52, s44
    s_mul_i32 s52, s52, 14336
    s_add_u32 s52, s52, 5189632
    s_add_u32 s53, s52, 14336
    v_mov_b32 v85, 0x3db8aa3b
    s_lshl_b32 s45, s54, 14
    v_add_u32 v12, s45, v80
    ds_read_b128 v[16:19], v12 offset:0
    ds_read_b128 v[48:51], v12 offset:2048
    v_add_u32 v12, s45, v81
    ds_read_b128 v[20:23], v12 offset:0
    ds_read_b128 v[52:55], v12 offset:2048
    v_add_u32 v12, s45, v82
    ds_read_b128 v[24:27], v12 offset:0
    ds_read_b128 v[56:59], v12 offset:2048
    v_add_u32 v12, s45, v83
    ds_read_b128 v[28:31], v12 offset:0
    ds_read_b128 v[60:63], v12 offset:2048
    v_add_u32 v12, s45, v80
    ds_read_b128 v[32:35], v12 offset:256
    ds_read_b128 v[64:67], v12 offset:2304
    v_add_u32 v12, s45, v81
    ds_read_b128 v[36:39], v12 offset:256
    ds_read_b128 v[68:71], v12 offset:2304
    v_add_u32 v12, s45, v82
    ds_read_b128 v[40:43], v12 offset:256
    ds_read_b128 v[72:75], v12 offset:2304
    v_add_u32 v12, s45, v83
    ds_read_b128 v[44:47], v12 offset:256
    ds_read_b128 v[76:79], v12 offset:2304
    s_branch k0_rdd
k0_rdB:
    s_lshl_b32 s52, s44, 4
    s_add_u32 s52, s52, s46
    s_mul_i32 s52, s52, 14336
    s_add_u32 s52, s52, 11612160
    s_add_u32 s53, s52, 229376
    v_mov_b32 v85, 1.0
    v_lshrrev_b32 v12, 2, v2
    v_lshl_add_u32 v12, v3, 3, v12
    v_lshlrev_b32 v12, 7, v12
    v_and_b32 v13, 3, v2
    v_lshl_add_u32 v12, v13, 3, v12
    v_lshl_add_u32 v12, s54, 6, v12
    ds_read_b64_tr_b16 v[16:17], v12 offset:0
    ds_read_b64_tr_b16 v[18:19], v12 offset:512
    ds_read_b64_tr_b16 v[48:49], v12 offset:32
    ds_read_b64_tr_b16 v[50:51], v12 offset:544
    ds_read_b64_tr_b16 v[20:21], v12 offset:4096
    ds_read_b64_tr_b16 v[22:23], v12 offset:4608
    ds_read_b64_tr_b16 v[52:53], v12 offset:4128
    ds_read_b64_tr_b16 v[54:55], v12 offset:4640
    ds_read_b64_tr_b16 v[24:25], v12 offset:8192
    ds_read_b64_tr_b16 v[26:27], v12 offset:8704
    ds_read_b64_tr_b16 v[56:57], v12 offset:8224
    ds_read_b64_tr_b16 v[58:59], v12 offset:8736
    ds_read_b64_tr_b16 v[28:29], v12 offset:12288
    ds_read_b64_tr_b16 v[30:31], v12 offset:12800
    ds_read_b64_tr_b16 v[60:61], v12 offset:12320
    ds_read_b64_tr_b16 v[62:63], v12 offset:12832
    ds_read_b64_tr_b16 v[32:33], v12 offset:16384
    ds_read_b64_tr_b16 v[34:35], v12 offset:16896
    ds_read_b64_tr_b16 v[64:65], v12 offset:16416
    ds_read_b64_tr_b16 v[66:67], v12 offset:16928
    ds_read_b64_tr_b16 v[36:37], v12 offset:20480
    ds_read_b64_tr_b16 v[38:39], v12 offset:20992
    ds_read_b64_tr_b16 v[68:69], v12 offset:20512
    ds_read_b64_tr_b16 v[70:71], v12 offset:21024
    ds_read_b64_tr_b16 v[40:41], v12 offset:24576
    ds_read_b64_tr_b16 v[42:43], v12 offset:25088
    ds_read_b64_tr_b16 v[72:73], v12 offset:24608
    ds_read_b64_tr_b16 v[74:75], v12 offset:25120
    ds_read_b64_tr_b16 v[44:45], v12 offset:28672
    ds_read_b64_tr_b16 v[46:47], v12 offset:29184
    ds_read_b64_tr_b16 v[76:77], v12 offset:28704
    ds_read_b64_tr_b16 v[78:79], v12 offset:29216
k0_rdd:
    s_waitcnt lgkmcnt(0)
    s_lshr_b32 s45, s10, 1
    s_lshl_b32 s45, s45, 14
    v_add_u32 v80, s45, v80
    v_add_u32 v81, s45, v81
    v_add_u32 v82, s45, v82
    v_add_u32 v83, s45, v83
    v_add_u32 v142, 32768, v80
    v_add_u32 v143, 32768, v81
    v_add_u32 v144, 32768, v82
    v_add_u32 v145, 32768, v83
    ds_read_b128 v[86:89], v142 offset:0
    ds_read_b128 v[90:93], v142 offset:2048
    ds_read_b128 v[94:97], v143 offset:0
    ds_read_b128 v[98:101], v143 offset:2048
    ds_read_b128 v[102:105], v144 offset:0
    ds_read_b128 v[106:109], v144 offset:2048
    s_waitcnt lgkmcnt(5)
    v_mfma_f32_16x16x32_bf16 v[110:113], v[86:89], v[16:19], 0
    v_mfma_f32_16x16x32_bf16 v[118:121], v[86:89], v[48:51], 0
    ds_read_b128 v[86:89], v145 offset:0
    s_waitcnt lgkmcnt(5)
    v_mfma_f32_16x16x32_bf16 v[114:117], v[90:93], v[16:19], 0
    v_mfma_f32_16x16x32_bf16 v[122:125], v[90:93], v[48:51], 0
    ds_read_b128 v[90:93], v145 offset:2048
    s_waitcnt lgkmcnt(5)
    v_mfma_f32_16x16x32_bf16 v[110:113], v[94:97], v[20:23], v[110:113]
    v_mfma_f32_16x16x32_bf16 v[118:121], v[94:97], v[52:55], v[118:121]
    ds_read_b128 v[94:97], v142 offset:256
    s_waitcnt lgkmcnt(5)
    v_mfma_f32_16x16x32_bf16 v[114:117], v[98:101], v[20:23], v[114:117]
    v_mfma_f32_16x16x32_bf16 v[122:125], v[98:101], v[52:55], v[122:125]
    ds_read_b128 v[98:101], v142 offset:2304
    s_waitcnt lgkmcnt(5)
    v_mfma_f32_16x16x32_bf16 v[110:113], v[102:105], v[24:27], v[110:113]
    v_mfma_f32_16x16x32_bf16 v[118:121], v[102:105], v[56:59], v[118:121]
    ds_read_b128 v[102:105], v143 offset:256
    s_waitcnt lgkmcnt(5)
    v_mfma_f32_16x16x32_bf16 v[114:117], v[106:109], v[24:27], v[114:117]
    v_mfma_f32_16x16x32_bf16 v[122:125], v[106:109], v[56:59], v[122:125]
    ds_read_b128 v[106:109], v143 offset:2304
    s_waitcnt lgkmcnt(5)
    v_mfma_f32_16x16x32_bf16 v[110:113], v[86:89], v[28:31], v[110:113]
    v_mfma_f32_16x16x32_bf16 v[118:121], v[86:89], v[60:63], v[118:121]
    ds_read_b128 v[86:89], v144 offset:256
    s_waitcnt lgkmcnt(5)
    v_mfma_f32_16x16x32_bf16 v[114:117], v[90:93], v[28:31], v[114:117]
    v_mfma_f32_16x16x32_bf16 v[122:125], v[90:93], v[60:63], v[122:125]
    ds_read_b128 v[90:93], v144 offset:2304
    s_waitcnt lgkmcnt(5)
    v_mfma_f32_16x16x32_bf16 v[110:113], v[94:97], v[32:35], v[110:113]
    v_mfma_f32_16x16x32_bf16 v[118:121], v[94:97], v[64:67], v[118:121]
    ds_read_b128 v[94:97], v145 offset:256
    s_waitcnt lgkmcnt(5)
    v_mfma_f32_16x16x32_bf16 v[114:117], v[98:101], v[32:35], v[114:117]
    v_mfma_f32_16x16x32_bf16 v[122:125], v[98:101], v[64:67], v[122:125]
    ds_read_b128 v[98:101], v145 offset:2304
    s_waitcnt lgkmcnt(5)
    v_mfma_f32_16x16x32_bf16 v[110:113], v[102:105], v[36:39], v[110:113]
    v_mfma_f32_16x16x32_bf16 v[118:121], v[102:105], v[68:71], v[118:121]
    s_waitcnt lgkmcnt(4)
    v_mfma_f32_16x16x32_bf16 v[114:117], v[106:109], v[36:39], v[114:117]
    v_mfma_f32_16x16x32_bf16 v[122:125], v[106:109], v[68:71], v[122:125]
    s_waitcnt lgkmcnt(3)
    v_mfma_f32_16x16x32_bf16 v[110:113], v[86:89], v[40:43], v[110:113]
    v_mfma_f32_16x16x32_bf16 v[118:121], v[86:89], v[72:75], v[118:121]
    s_waitcnt lgkmcnt(2)
    v_mfma_f32_16x16x32_bf16 v[114:117], v[90:93], v[40:43], v[114:117]
    v_mfma_f32_16x16x32_bf16 v[122:125], v[90:93], v[72:75], v[122:125]
    s_waitcnt lgkmcnt(1)
    v_mfma_f32_16x16x32_bf16 v[110:113], v[94:97], v[44:47], v[110:113]
    v_mfma_f32_16x16x32_bf16 v[118:121], v[94:97], v[76:79], v[118:121]
    s_waitcnt lgkmcnt(0)
    v_mfma_f32_16x16x32_bf16 v[114:117], v[98:101], v[44:47], v[114:117]
    v_mfma_f32_16x16x32_bf16 v[122:125], v[98:101], v[76:79], v[122:125]
    s_waitcnt vmcnt(8)
    s_barrier
    s_add_u32 m0, s50, 32768
    s_nop 0
    buffer_load_dwordx4 v7, s[24:27], s49 offen lds
    s_add_u32 m0, s50, 33792
    s_nop 0
    buffer_load_dwordx4 v8, s[24:27], s49 offen lds
    s_add_u32 m0, s50, 34816
    s_nop 0
    buffer_load_dwordx4 v9, s[24:27], s49 offen lds
    s_add_u32 m0, s50, 35840
    s_nop 0
    buffer_load_dwordx4 v10, s[24:27], s49 offen lds
    s_add_u32 s49, s49, 262144
    s_add_u32 m0, s50, 49152
    s_nop 0
    buffer_load_dwordx4 v7, s[24:27], s49 offen lds
    s_add_u32 m0, s50, 50176
    s_nop 0
    buffer_load_dwordx4 v8, s[24:27], s49 offen lds
    s_add_u32 m0, s50, 51200
    s_nop 0
    buffer_load_dwordx4 v9, s[24:27], s49 offen lds
    s_add_u32 m0, s50, 52224
    s_nop 0
    buffer_load_dwordx4 v10, s[24:27], s49 offen lds
    s_add_u32 s49, s49, 262144
    buffer_load_dword v14, v15, s[32:35], 0 offen offset:252 sc1
    v_add_u32 v142, 65536, v80
    v_add_u32 v143, 65536, v81
    v_add_u32 v144, 65536, v82
    v_add_u32 v145, 65536, v83
    ds_read_b128 v[86:89], v142 offset:0
    v_mul_f32 v110, v110, v85
    v_mul_f32 v111, v111, v85
    v_mul_f32 v112, v112, v85
    v_mul_f32 v113, v113, v85
    ds_read_b128 v[90:93], v142 offset:2048
    v_mul_f32 v118, v118, v85
    v_mul_f32 v119, v119, v85
    v_mul_f32 v114, v114, v85
    v_mul_f32 v115, v115, v85
    ds_read_b128 v[94:97], v143 offset:0
    v_mul_f32 v116, v116, v85
    v_mul_f32 v117, v117, v85
    v_cvt_pk_bf16_f32 v110, v110, v111
    v_mul_f32 v120, v120, v85
    ds_read_b128 v[98:101], v143 offset:2048
    v_mul_f32 v121, v121, v85
    v_cvt_pk_bf16_f32 v111, v112, v113
    v_mul_f32 v122, v122, v85
    v_mul_f32 v123, v123, v85
    ds_read_b128 v[102:105], v144 offset:0
    v_mul_f32 v124, v124, v85
    v_mul_f32 v125, v125, v85
    v_cvt_pk_bf16_f32 v118, v118, v119
    v_cvt_pk_bf16_f32 v112, v114, v115
    ds_read_b128 v[106:109], v144 offset:2048
    v_cvt_pk_bf16_f32 v113, v116, v117
    v_cvt_pk_bf16_f32 v119, v120, v121
    v_cvt_pk_bf16_f32 v120, v122, v123
    s_waitcnt lgkmcnt(5)
    v_mfma_f32_16x16x32_bf16 v[126:129], v[86:89], v[16:19], 0
    v_cvt_pk_bf16_f32 v121, v124, v125
    buffer_store_dwordx4 v[110:113], v84, s[4:7], s52 offen offset:0 sc1
    v_mfma_f32_16x16x32_bf16 v[134:137], v[86:89], v[48:51], 0
    ds_read_b128 v[86:89], v145 offset:0
    buffer_store_dwordx4 v[118:121], v84, s[4:7], s53 offen offset:0 sc1
    s_waitcnt lgkmcnt(5)
    v_mfma_f32_16x16x32_bf16 v[130:133], v[90:93], v[16:19], 0
    v_mfma_f32_16x16x32_bf16 v[138:141], v[90:93], v[48:51], 0
    ds_read_b128 v[90:93], v145 offset:2048
    s_waitcnt lgkmcnt(5)
    v_mfma_f32_16x16x32_bf16 v[126:129], v[94:97], v[20:23], v[126:129]
    v_mfma_f32_16x16x32_bf16 v[134:137], v[94:97], v[52:55], v[134:137]
    ds_read_b128 v[94:97], v142 offset:256
    s_waitcnt lgkmcnt(5)
    v_mfma_f32_16x16x32_bf16 v[130:133], v[98:101], v[20:23], v[130:133]
    v_mfma_f32_16x16x32_bf16 v[138:141], v[98:101], v[52:55], v[138:141]
    ds_read_b128 v[98:101], v142 offset:2304
    s_waitcnt lgkmcnt(5)
    v_mfma_f32_16x16x32_bf16 v[126:129], v[102:105], v[24:27], v[126:129]
    v_mfma_f32_16x16x32_bf16 v[134:137], v[102:105], v[56:59], v[134:137]
    ds_read_b128 v[102:105], v143 offset:256
    s_waitcnt lgkmcnt(5)
    v_mfma_f32_16x16x32_bf16 v[130:133], v[106:109], v[24:27], v[130:133]
    v_mfma_f32_16x16x32_bf16 v[138:141], v[106:109], v[56:59], v[138:141]
    ds_read_b128 v[106:109], v143 offset:2304
    s_waitcnt lgkmcnt(5)
    v_mfma_f32_16x16x32_bf16 v[126:129], v[86:89], v[28:31], v[126:129]
    v_mfma_f32_16x16x32_bf16 v[134:137], v[86:89], v[60:63], v[134:137]
    ds_read_b128 v[86:89], v144 offset:256
    s_waitcnt lgkmcnt(5)
    v_mfma_f32_16x16x32_bf16 v[130:133], v[90:93], v[28:31], v[130:133]
    v_mfma_f32_16x16x32_bf16 v[138:141], v[90:93], v[60:63], v[138:141]
    ds_read_b128 v[90:93], v144 offset:2304
    s_waitcnt lgkmcnt(5)
    v_mfma_f32_16x16x32_bf16 v[126:129], v[94:97], v[32:35], v[126:129]
    v_mfma_f32_16x16x32_bf16 v[134:137], v[94:97], v[64:67], v[134:137]
    ds_read_b128 v[94:97], v145 offset:256
    s_waitcnt lgkmcnt(5)
    v_mfma_f32_16x16x32_bf16 v[130:133], v[98:101], v[32:35], v[130:133]
    v_mfma_f32_16x16x32_bf16 v[138:141], v[98:101], v[64:67], v[138:141]
    ds_read_b128 v[98:101], v145 offset:2304
    s_waitcnt lgkmcnt(5)
    v_mfma_f32_16x16x32_bf16 v[126:129], v[102:105], v[36:39], v[126:129]
    v_mfma_f32_16x16x32_bf16 v[134:137], v[102:105], v[68:71], v[134:137]
    s_waitcnt lgkmcnt(4)
    v_mfma_f32_16x16x32_bf16 v[130:133], v[106:109], v[36:39], v[130:133]
    v_mfma_f32_16x16x32_bf16 v[138:141], v[106:109], v[68:71], v[138:141]
    s_waitcnt lgkmcnt(3)
    v_mfma_f32_16x16x32_bf16 v[126:129], v[86:89], v[40:43], v[126:129]
    v_mfma_f32_16x16x32_bf16 v[134:137], v[86:89], v[72:75], v[134:137]
    s_waitcnt lgkmcnt(2)
    v_mfma_f32_16x16x32_bf16 v[130:133], v[90:93], v[40:43], v[130:133]
    v_mfma_f32_16x16x32_bf16 v[138:141], v[90:93], v[72:75], v[138:141]
    s_waitcnt lgkmcnt(1)
    v_mfma_f32_16x16x32_bf16 v[126:129], v[94:97], v[44:47], v[126:129]
    v_mfma_f32_16x16x32_bf16 v[134:137], v[94:97], v[76:79], v[134:137]
    s_waitcnt lgkmcnt(0)
    v_mfma_f32_16x16x32_bf16 v[130:133], v[98:101], v[44:47], v[130:133]
    v_mfma_f32_16x16x32_bf16 v[138:141], v[98:101], v[76:79], v[138:141]
    s_waitcnt vmcnt(0)
    s_barrier
    v_cmp_eq_u32 vcc, 0, v14
    s_cbranch_vccz k0_zoka
k0_zwa:
    buffer_load_dword v14, v15, s[32:35], 0 offen offset:252 sc1
    s_waitcnt vmcnt(0)
    v_cmp_eq_u32 vcc, 0, v14
    s_cbranch_vccz k0_zoka
    s_sleep 2
    s_sub_u32 s13, s13, 1
    s_cbranch_scc0 k0_zwa
    s_mov_b32 s13, 0
k0_zoka:
    v_mov_b32 v11, 1
    buffer_store_dword v11, v4, s[4:7], s55 offen offset:8 sc1
    s_add_u32 m0, s50, 65536
    s_nop 0
    buffer_load_dwordx4 v7, s[24:27], s49 offen lds
    s_add_u32 m0, s50, 66560
    s_nop 0
    buffer_load_dwordx4 v8, s[24:27], s49 offen lds
    s_add_u32 m0, s50, 67584
    s_nop 0
    buffer_load_dwordx4 v9, s[24:27], s49 offen lds
    s_add_u32 m0, s50, 68608
    s_nop 0
    buffer_load_dwordx4 v10, s[24:27], s49 offen lds
    s_add_u32 s49, s49, 262144
    s_add_u32 m0, s50, 81920
    s_nop 0
    buffer_load_dwordx4 v7, s[24:27], s49 offen lds
    s_add_u32 m0, s50, 82944
    s_nop 0
    buffer_load_dwordx4 v8, s[24:27], s49 offen lds
    s_add_u32 m0, s50, 83968
    s_nop 0
    buffer_load_dwordx4 v9, s[24:27], s49 offen lds
    s_add_u32 m0, s50, 84992
    s_nop 0
    buffer_load_dwordx4 v10, s[24:27], s49 offen lds
    s_add_u32 s49, s49, 262144
    v_add_u32 v142, 98304, v80
    v_add_u32 v143, 98304, v81
    v_add_u32 v144, 98304, v82
    v_add_u32 v145, 98304, v83
    ds_read_b128 v[86:89], v142 offset:0
    v_mul_f32 v126, v126, v85
    v_mul_f32 v127, v127, v85
    v_mul_f32 v128, v128, v85
    v_mul_f32 v129, v129, v85
    ds_read_b128 v[90:93], v142 offset:2048
    v_mul_f32 v134, v134, v85
    v_mul_f32 v135, v135, v85
    v_mul_f32 v130, v130, v85
    v_mul_f32 v131, v131, v85
    ds_read_b128 v[94:97], v143 offset:0
    v_mul_f32 v132, v132, v85
    v_mul_f32 v133, v133, v85
    v_cvt_pk_bf16_f32 v126, v126, v127
    v_mul_f32 v136, v136, v85
    ds_read_b128 v[98:101], v143 offset:2048
    v_mul_f32 v137, v137, v85
    v_cvt_pk_bf16_f32 v127, v128, v129
    v_mul_f32 v138, v138, v85
    v_mul_f32 v139, v139, v85
    ds_read_b128 v[102:105], v144 offset:0
    v_mul_f32 v140, v140, v85
    v_mul_f32 v141, v141, v85
    v_cvt_pk_bf16_f32 v134, v134, v135
    v_cvt_pk_bf16_f32 v128, v130, v131
    ds_read_b128 v[106:109], v144 offset:2048
    v_cvt_pk_bf16_f32 v129, v132, v133
    v_cvt_pk_bf16_f32 v135, v136, v137
    v_cvt_pk_bf16_f32 v136, v138, v139
    s_waitcnt lgkmcnt(5)
    v_mfma_f32_16x16x32_bf16 v[110:113], v[86:89], v[16:19], 0
    v_cvt_pk_bf16_f32 v137, v140, v141
    buffer_store_dwordx4 v[126:129], v84, s[4:7], s52 offen offset:2048 sc1
    v_mfma_f32_16x16x32_bf16 v[118:121], v[86:89], v[48:51], 0
    ds_read_b128 v[86:89], v145 offset:0
    buffer_store_dwordx4 v[134:137], v84, s[4:7], s53 offen offset:2048 sc1
    s_add_u32 s52, s52, 4096
    s_waitcnt lgkmcnt(5)
    v_mfma_f32_16x16x32_bf16 v[114:117], v[90:93], v[16:19], 0
    s_add_u32 s53, s53, 4096
    v_mfma_f32_16x16x32_bf16 v[122:125], v[90:93], v[48:51], 0
    ds_read_b128 v[90:93], v145 offset:2048
    s_waitcnt lgkmcnt(5)
    v_mfma_f32_16x16x32_bf16 v[110:113], v[94:97], v[20:23], v[110:113]
    v_mfma_f32_16x16x32_bf16 v[118:121], v[94:97], v[52:55], v[118:121]
    ds_read_b128 v[94:97], v142 offset:256
    s_waitcnt lgkmcnt(5)
    v_mfma_f32_16x16x32_bf16 v[114:117], v[98:101], v[20:23], v[114:117]
    v_mfma_f32_16x16x32_bf16 v[122:125], v[98:101], v[52:55], v[122:125]
    ds_read_b128 v[98:101], v142 offset:2304
    s_waitcnt lgkmcnt(5)
    v_mfma_f32_16x16x32_bf16 v[110:113], v[102:105], v[24:27], v[110:113]
    v_mfma_f32_16x16x32_bf16 v[118:121], v[102:105], v[56:59], v[118:121]
    ds_read_b128 v[102:105], v143 offset:256
    s_waitcnt lgkmcnt(5)
    v_mfma_f32_16x16x32_bf16 v[114:117], v[106:109], v[24:27], v[114:117]
    v_mfma_f32_16x16x32_bf16 v[122:125], v[106:109], v[56:59], v[122:125]
    ds_read_b128 v[106:109], v143 offset:2304
    s_waitcnt lgkmcnt(5)
    v_mfma_f32_16x16x32_bf16 v[110:113], v[86:89], v[28:31], v[110:113]
    v_mfma_f32_16x16x32_bf16 v[118:121], v[86:89], v[60:63], v[118:121]
    ds_read_b128 v[86:89], v144 offset:256
    s_waitcnt lgkmcnt(5)
    v_mfma_f32_16x16x32_bf16 v[114:117], v[90:93], v[28:31], v[114:117]
    v_mfma_f32_16x16x32_bf16 v[122:125], v[90:93], v[60:63], v[122:125]
    ds_read_b128 v[90:93], v144 offset:2304
    s_waitcnt lgkmcnt(5)
    v_mfma_f32_16x16x32_bf16 v[110:113], v[94:97], v[32:35], v[110:113]
    v_mfma_f32_16x16x32_bf16 v[118:121], v[94:97], v[64:67], v[118:121]
    ds_read_b128 v[94:97], v145 offset:256
    s_waitcnt lgkmcnt(5)
    v_mfma_f32_16x16x32_bf16 v[114:117], v[98:101], v[32:35], v[114:117]
    v_mfma_f32_16x16x32_bf16 v[122:125], v[98:101], v[64:67], v[122:125]
    ds_read_b128 v[98:101], v145 offset:2304
    s_waitcnt lgkmcnt(5)
    v_mfma_f32_16x16x32_bf16 v[110:113], v[102:105], v[36:39], v[110:113]
    v_mfma_f32_16x16x32_bf16 v[118:121], v[102:105], v[68:71], v[118:121]
    s_waitcnt lgkmcnt(4)
    v_mfma_f32_16x16x32_bf16 v[114:117], v[106:109], v[36:39], v[114:117]
    v_mfma_f32_16x16x32_bf16 v[122:125], v[106:109], v[68:71], v[122:125]
    s_waitcnt lgkmcnt(3)
    v_mfma_f32_16x16x32_bf16 v[110:113], v[86:89], v[40:43], v[110:113]
    v_mfma_f32_16x16x32_bf16 v[118:121], v[86:89], v[72:75], v[118:121]
    s_waitcnt lgkmcnt(2)
    v_mfma_f32_16x16x32_bf16 v[114:117], v[90:93], v[40:43], v[114:117]
    v_mfma_f32_16x16x32_bf16 v[122:125], v[90:93], v[72:75], v[122:125]
    s_waitcnt lgkmcnt(1)
    v_mfma_f32_16x16x32_bf16 v[110:113], v[94:97], v[44:47], v[110:113]
    v_mfma_f32_16x16x32_bf16 v[118:121], v[94:97], v[76:79], v[118:121]
    s_waitcnt lgkmcnt(0)
    v_mfma_f32_16x16x32_bf16 v[114:117], v[98:101], v[44:47], v[114:117]
    v_mfma_f32_16x16x32_bf16 v[122:125], v[98:101], v[76:79], v[122:125]
    s_waitcnt vmcnt(0)
    s_barrier
    v_mov_b32 v11, 2
    buffer_store_dword v11, v4, s[4:7], s55 offen offset:8 sc1
    s_add_u32 m0, s50, 98304
    s_nop 0
    buffer_load_dwordx4 v7, s[24:27], s49 offen lds
    s_add_u32 m0, s50, 99328
    s_nop 0
    buffer_load_dwordx4 v8, s[24:27], s49 offen lds
    s_add_u32 m0, s50, 100352
    s_nop 0
    buffer_load_dwordx4 v9, s[24:27], s49 offen lds
    s_add_u32 m0, s50, 101376
    s_nop 0
    buffer_load_dwordx4 v10, s[24:27], s49 offen lds
    s_add_u32 s49, s49, 262144
    s_add_u32 m0, s50, 114688
    s_nop 0
    buffer_load_dwordx4 v7, s[24:27], s49 offen lds
    s_add_u32 m0, s50, 115712
    s_nop 0
    buffer_load_dwordx4 v8, s[24:27], s49 offen lds
    s_add_u32 m0, s50, 116736
    s_nop 0
    buffer_load_dwordx4 v9, s[24:27], s49 offen lds
    s_add_u32 m0, s50, 117760
    s_nop 0
    buffer_load_dwordx4 v10, s[24:27], s49 offen lds
    s_add_u32 s49, s49, 262144
    v_add_u32 v142, 32768, v80
    v_add_u32 v143, 32768, v81
    v_add_u32 v144, 32768, v82
    v_add_u32 v145, 32768, v83
    ds_read_b128 v[86:89], v142 offset:0
    v_mul_f32 v110, v110, v85
    v_mul_f32 v111, v111, v85
    v_mul_f32 v112, v112, v85
    v_mul_f32 v113, v113, v85
    ds_read_b128 v[90:93], v142 offset:2048
    v_mul_f32 v118, v118, v85
    v_mul_f32 v119, v119, v85
    v_mul_f32 v114, v114, v85
    v_mul_f32 v115, v115, v85
    ds_read_b128 v[94:97], v143 offset:0
    v_mul_f32 v116, v116, v85
    v_mul_f32 v117, v117, v85
    v_cvt_pk_bf16_f32 v110, v110, v111
    v_mul_f32 v120, v120, v85
    ds_read_b128 v[98:101], v143 offset:2048
    v_mul_f32 v121, v121, v85
    v_cvt_pk_bf16_f32 v111, v112, v113
    v_mul_f32 v122, v122, v85
    v_mul_f32 v123, v123, v85
    ds_read_b128 v[102:105], v144 offset:0
    v_mul_f32 v124, v124, v85
    v_mul_f32 v125, v125, v85
    v_cvt_pk_bf16_f32 v118, v118, v119
    v_cvt_pk_bf16_f32 v112, v114, v115
    ds_read_b128 v[106:109], v144 offset:2048
    v_cvt_pk_bf16_f32 v113, v116, v117
    v_cvt_pk_bf16_f32 v119, v120, v121
    v_cvt_pk_bf16_f32 v120, v122, v123
    s_waitcnt lgkmcnt(5)
    v_mfma_f32_16x16x32_bf16 v[126:129], v[86:89], v[16:19], 0
    v_cvt_pk_bf16_f32 v121, v124, v125
    buffer_store_dwordx4 v[110:113], v84, s[4:7], s52 offen offset:0 sc1
    v_mfma_f32_16x16x32_bf16 v[134:137], v[86:89], v[48:51], 0
    ds_read_b128 v[86:89], v145 offset:0
    buffer_store_dwordx4 v[118:121], v84, s[4:7], s53 offen offset:0 sc1
    s_waitcnt lgkmcnt(5)
    v_mfma_f32_16x16x32_bf16 v[130:133], v[90:93], v[16:19], 0
    v_mfma_f32_16x16x32_bf16 v[138:141], v[90:93], v[48:51], 0
    ds_read_b128 v[90:93], v145 offset:2048
    s_waitcnt lgkmcnt(5)
    v_mfma_f32_16x16x32_bf16 v[126:129], v[94:97], v[20:23], v[126:129]
    v_mfma_f32_16x16x32_bf16 v[134:137], v[94:97], v[52:55], v[134:137]
    ds_read_b128 v[94:97], v142 offset:256
    s_waitcnt lgkmcnt(5)
    v_mfma_f32_16x16x32_bf16 v[130:133], v[98:101], v[20:23], v[130:133]
    v_mfma_f32_16x16x32_bf16 v[138:141], v[98:101], v[52:55], v[138:141]
    ds_read_b128 v[98:101], v142 offset:2304
    s_waitcnt lgkmcnt(5)
    v_mfma_f32_16x16x32_bf16 v[126:129], v[102:105], v[24:27], v[126:129]
    v_mfma_f32_16x16x32_bf16 v[134:137], v[102:105], v[56:59], v[134:137]
    ds_read_b128 v[102:105], v143 offset:256
    s_waitcnt lgkmcnt(5)
    v_mfma_f32_16x16x32_bf16 v[130:133], v[106:109], v[24:27], v[130:133]
    v_mfma_f32_16x16x32_bf16 v[138:141], v[106:109], v[56:59], v[138:141]
    ds_read_b128 v[106:109], v143 offset:2304
    s_waitcnt lgkmcnt(5)
    v_mfma_f32_16x16x32_bf16 v[126:129], v[86:89], v[28:31], v[126:129]
    v_mfma_f32_16x16x32_bf16 v[134:137], v[86:89], v[60:63], v[134:137]
    ds_read_b128 v[86:89], v144 offset:256
    s_waitcnt lgkmcnt(5)
    v_mfma_f32_16x16x32_bf16 v[130:133], v[90:93], v[28:31], v[130:133]
    v_mfma_f32_16x16x32_bf16 v[138:141], v[90:93], v[60:63], v[138:141]
    ds_read_b128 v[90:93], v144 offset:2304
    s_waitcnt lgkmcnt(5)
    v_mfma_f32_16x16x32_bf16 v[126:129], v[94:97], v[32:35], v[126:129]
    v_mfma_f32_16x16x32_bf16 v[134:137], v[94:97], v[64:67], v[134:137]
    ds_read_b128 v[94:97], v145 offset:256
    s_waitcnt lgkmcnt(5)
    v_mfma_f32_16x16x32_bf16 v[130:133], v[98:101], v[32:35], v[130:133]
    v_mfma_f32_16x16x32_bf16 v[138:141], v[98:101], v[64:67], v[138:141]
    ds_read_b128 v[98:101], v145 offset:2304
    s_waitcnt lgkmcnt(5)
    v_mfma_f32_16x16x32_bf16 v[126:129], v[102:105], v[36:39], v[126:129]
    v_mfma_f32_16x16x32_bf16 v[134:137], v[102:105], v[68:71], v[134:137]
    s_waitcnt lgkmcnt(4)
    v_mfma_f32_16x16x32_bf16 v[130:133], v[106:109], v[36:39], v[130:133]
    v_mfma_f32_16x16x32_bf16 v[138:141], v[106:109], v[68:71], v[138:141]
    s_waitcnt lgkmcnt(3)
    v_mfma_f32_16x16x32_bf16 v[126:129], v[86:89], v[40:43], v[126:129]
    v_mfma_f32_16x16x32_bf16 v[134:137], v[86:89], v[72:75], v[134:137]
    s_waitcnt lgkmcnt(2)
    v_mfma_f32_16x16x32_bf16 v[130:133], v[90:93], v[40:43], v[130:133]
    v_mfma_f32_16x16x32_bf16 v[138:141], v[90:93], v[72:75], v[138:141]
    s_waitcnt lgkmcnt(1)
    v_mfma_f32_16x16x32_bf16 v[126:129], v[94:97], v[44:47], v[126:129]
    v_mfma_f32_16x16x32_bf16 v[134:137], v[94:97], v[76:79], v[134:137]
    s_waitcnt lgkmcnt(0)
    v_mfma_f32_16x16x32_bf16 v[130:133], v[98:101], v[44:47], v[130:133]
    v_mfma_f32_16x16x32_bf16 v[138:141], v[98:101], v[76:79], v[138:141]
    s_waitcnt vmcnt(0)
    s_barrier
    v_mov_b32 v11, 3
    buffer_store_dword v11, v4, s[4:7], s55 offen offset:8 sc1
    s_add_u32 m0, s50, 32768
    s_nop 0
    buffer_load_dwordx4 v7, s[24:27], s49 offen lds
    s_add_u32 m0, s50, 33792
    s_nop 0
    buffer_load_dwordx4 v8, s[24:27], s49 offen lds
    s_add_u32 m0, s50, 34816
    s_nop 0
    buffer_load_dwordx4 v9, s[24:27], s49 offen lds
    s_add_u32 m0, s50, 35840
    s_nop 0
    buffer_load_dwordx4 v10, s[24:27], s49 offen lds
    s_add_u32 s49, s49, 262144
    s_add_u32 m0, s50, 49152
    s_nop 0
    buffer_load_dwordx4 v7, s[24:27], s49 offen lds
    s_add_u32 m0, s50, 50176
    s_nop 0
    buffer_load_dwordx4 v8, s[24:27], s49 offen lds
    s_add_u32 m0, s50, 51200
    s_nop 0
    buffer_load_dwordx4 v9, s[24:27], s49 offen lds
    s_add_u32 m0, s50, 52224
    s_nop 0
    buffer_load_dwordx4 v10, s[24:27], s49 offen lds
    s_add_u32 s49, s49, 262144
    v_add_u32 v142, 65536, v80
    v_add_u32 v143, 65536, v81
    v_add_u32 v144, 65536, v82
    v_add_u32 v145, 65536, v83
    ds_read_b128 v[86:89], v142 offset:0
    v_mul_f32 v126, v126, v85
    v_mul_f32 v127, v127, v85
    v_mul_f32 v128, v128, v85
    v_mul_f32 v129, v129, v85
    ds_read_b128 v[90:93], v142 offset:2048
    v_mul_f32 v134, v134, v85
    v_mul_f32 v135, v135, v85
    v_mul_f32 v130, v130, v85
    v_mul_f32 v131, v131, v85
    ds_read_b128 v[94:97], v143 offset:0
    v_mul_f32 v132, v132, v85
    v_mul_f32 v133, v133, v85
    v_cvt_pk_bf16_f32 v126, v126, v127
    v_mul_f32 v136, v136, v85
    ds_read_b128 v[98:101], v143 offset:2048
    v_mul_f32 v137, v137, v85
    v_cvt_pk_bf16_f32 v127, v128, v129
    v_mul_f32 v138, v138, v85
    v_mul_f32 v139, v139, v85
    ds_read_b128 v[102:105], v144 offset:0
    v_mul_f32 v140, v140, v85
    v_mul_f32 v141, v141, v85
    v_cvt_pk_bf16_f32 v134, v134, v135
    v_cvt_pk_bf16_f32 v128, v130, v131
    ds_read_b128 v[106:109], v144 offset:2048
    v_cvt_pk_bf16_f32 v129, v132, v133
    v_cvt_pk_bf16_f32 v135, v136, v137
    v_cvt_pk_bf16_f32 v136, v138, v139
    s_waitcnt lgkmcnt(5)
    v_mfma_f32_16x16x32_bf16 v[110:113], v[86:89], v[16:19], 0
    v_cvt_pk_bf16_f32 v137, v140, v141
    buffer_store_dwordx4 v[126:129], v84, s[4:7], s52 offen offset:2048 sc1
    v_mfma_f32_16x16x32_bf16 v[118:121], v[86:89], v[48:51], 0
    ds_read_b128 v[86:89], v145 offset:0
    buffer_store_dwordx4 v[134:137], v84, s[4:7], s53 offen offset:2048 sc1
    s_add_u32 s52, s52, 4096
    s_waitcnt lgkmcnt(5)
    v_mfma_f32_16x16x32_bf16 v[114:117], v[90:93], v[16:19], 0
    s_add_u32 s53, s53, 4096
    v_mfma_f32_16x16x32_bf16 v[122:125], v[90:93], v[48:51], 0
    ds_read_b128 v[90:93], v145 offset:2048
    s_waitcnt lgkmcnt(5)
    v_mfma_f32_16x16x32_bf16 v[110:113], v[94:97], v[20:23], v[110:113]
    v_mfma_f32_16x16x32_bf16 v[118:121], v[94:97], v[52:55], v[118:121]
    ds_read_b128 v[94:97], v142 offset:256
    s_waitcnt lgkmcnt(5)
    v_mfma_f32_16x16x32_bf16 v[114:117], v[98:101], v[20:23], v[114:117]
    v_mfma_f32_16x16x32_bf16 v[122:125], v[98:101], v[52:55], v[122:125]
    ds_read_b128 v[98:101], v142 offset:2304
    s_waitcnt lgkmcnt(5)
    v_mfma_f32_16x16x32_bf16 v[110:113], v[102:105], v[24:27], v[110:113]
    v_mfma_f32_16x16x32_bf16 v[118:121], v[102:105], v[56:59], v[118:121]
    ds_read_b128 v[102:105], v143 offset:256
    s_waitcnt lgkmcnt(5)
    v_mfma_f32_16x16x32_bf16 v[114:117], v[106:109], v[24:27], v[114:117]
    v_mfma_f32_16x16x32_bf16 v[122:125], v[106:109], v[56:59], v[122:125]
    ds_read_b128 v[106:109], v143 offset:2304
    s_waitcnt lgkmcnt(5)
    v_mfma_f32_16x16x32_bf16 v[110:113], v[86:89], v[28:31], v[110:113]
    v_mfma_f32_16x16x32_bf16 v[118:121], v[86:89], v[60:63], v[118:121]
    ds_read_b128 v[86:89], v144 offset:256
    s_waitcnt lgkmcnt(5)
    v_mfma_f32_16x16x32_bf16 v[114:117], v[90:93], v[28:31], v[114:117]
    v_mfma_f32_16x16x32_bf16 v[122:125], v[90:93], v[60:63], v[122:125]
    ds_read_b128 v[90:93], v144 offset:2304
    s_waitcnt lgkmcnt(5)
    v_mfma_f32_16x16x32_bf16 v[110:113], v[94:97], v[32:35], v[110:113]
    v_mfma_f32_16x16x32_bf16 v[118:121], v[94:97], v[64:67], v[118:121]
    ds_read_b128 v[94:97], v145 offset:256
    s_waitcnt lgkmcnt(5)
    v_mfma_f32_16x16x32_bf16 v[114:117], v[98:101], v[32:35], v[114:117]
    v_mfma_f32_16x16x32_bf16 v[122:125], v[98:101], v[64:67], v[122:125]
    ds_read_b128 v[98:101], v145 offset:2304
    s_waitcnt lgkmcnt(5)
    v_mfma_f32_16x16x32_bf16 v[110:113], v[102:105], v[36:39], v[110:113]
    v_mfma_f32_16x16x32_bf16 v[118:121], v[102:105], v[68:71], v[118:121]
    s_waitcnt lgkmcnt(4)
    v_mfma_f32_16x16x32_bf16 v[114:117], v[106:109], v[36:39], v[114:117]
    v_mfma_f32_16x16x32_bf16 v[122:125], v[106:109], v[68:71], v[122:125]
    s_waitcnt lgkmcnt(3)
    v_mfma_f32_16x16x32_bf16 v[110:113], v[86:89], v[40:43], v[110:113]
    v_mfma_f32_16x16x32_bf16 v[118:121], v[86:89], v[72:75], v[118:121]
    s_waitcnt lgkmcnt(2)
    v_mfma_f32_16x16x32_bf16 v[114:117], v[90:93], v[40:43], v[114:117]
    v_mfma_f32_16x16x32_bf16 v[122:125], v[90:93], v[72:75], v[122:125]
    s_waitcnt lgkmcnt(1)
    v_mfma_f32_16x16x32_bf16 v[110:113], v[94:97], v[44:47], v[110:113]
    v_mfma_f32_16x16x32_bf16 v[118:121], v[94:97], v[76:79], v[118:121]
    s_waitcnt lgkmcnt(0)
    v_mfma_f32_16x16x32_bf16 v[114:117], v[98:101], v[44:47], v[114:117]
    v_mfma_f32_16x16x32_bf16 v[122:125], v[98:101], v[76:79], v[122:125]
    s_waitcnt vmcnt(0)
    s_barrier
    v_mov_b32 v11, 4
    buffer_store_dword v11, v4, s[4:7], s55 offen offset:8 sc1
    v_add_u32 v142, 98304, v80
    v_add_u32 v143, 98304, v81
    v_add_u32 v144, 98304, v82
    v_add_u32 v145, 98304, v83
    ds_read_b128 v[86:89], v142 offset:0
    v_mul_f32 v110, v110, v85
    v_mul_f32 v111, v111, v85
    v_mul_f32 v112, v112, v85
    v_mul_f32 v113, v113, v85
    ds_read_b128 v[90:93], v142 offset:2048
    v_mul_f32 v118, v118, v85
    v_mul_f32 v119, v119, v85
    v_mul_f32 v114, v114, v85
    v_mul_f32 v115, v115, v85
    ds_read_b128 v[94:97], v143 offset:0
    v_mul_f32 v116, v116, v85
    v_mul_f32 v117, v117, v85
    v_cvt_pk_bf16_f32 v110, v110, v111
    v_mul_f32 v120, v120, v85
    ds_read_b128 v[98:101], v143 offset:2048
    v_mul_f32 v121, v121, v85
    v_cvt_pk_bf16_f32 v111, v112, v113
    v_mul_f32 v122, v122, v85
    v_mul_f32 v123, v123, v85
    ds_read_b128 v[102:105], v144 offset:0
    v_mul_f32 v124, v124, v85
    v_mul_f32 v125, v125, v85
    v_cvt_pk_bf16_f32 v118, v118, v119
    v_cvt_pk_bf16_f32 v112, v114, v115
    ds_read_b128 v[106:109], v144 offset:2048
    v_cvt_pk_bf16_f32 v113, v116, v117
    v_cvt_pk_bf16_f32 v119, v120, v121
    v_cvt_pk_bf16_f32 v120, v122, v123
    s_waitcnt lgkmcnt(5)
    v_mfma_f32_16x16x32_bf16 v[126:129], v[86:89], v[16:19], 0
    v_cvt_pk_bf16_f32 v121, v124, v125
    buffer_store_dwordx4 v[110:113], v84, s[4:7], s52 offen offset:0 sc1
    v_mfma_f32_16x16x32_bf16 v[134:137], v[86:89], v[48:51], 0
    ds_read_b128 v[86:89], v145 offset:0
    buffer_store_dwordx4 v[118:121], v84, s[4:7], s53 offen offset:0 sc1
    s_waitcnt lgkmcnt(5)
    v_mfma_f32_16x16x32_bf16 v[130:133], v[90:93], v[16:19], 0
    v_mfma_f32_16x16x32_bf16 v[138:141], v[90:93], v[48:51], 0
    ds_read_b128 v[90:93], v145 offset:2048
    s_waitcnt lgkmcnt(5)
    v_mfma_f32_16x16x32_bf16 v[126:129], v[94:97], v[20:23], v[126:129]
    v_mfma_f32_16x16x32_bf16 v[134:137], v[94:97], v[52:55], v[134:137]
    ds_read_b128 v[94:97], v142 offset:256
    s_waitcnt lgkmcnt(5)
    v_mfma_f32_16x16x32_bf16 v[130:133], v[98:101], v[20:23], v[130:133]
    v_mfma_f32_16x16x32_bf16 v[138:141], v[98:101], v[52:55], v[138:141]
    ds_read_b128 v[98:101], v142 offset:2304
    s_waitcnt lgkmcnt(5)
    v_mfma_f32_16x16x32_bf16 v[126:129], v[102:105], v[24:27], v[126:129]
    v_mfma_f32_16x16x32_bf16 v[134:137], v[102:105], v[56:59], v[134:137]
    ds_read_b128 v[102:105], v143 offset:256
    s_waitcnt lgkmcnt(5)
    v_mfma_f32_16x16x32_bf16 v[130:133], v[106:109], v[24:27], v[130:133]
    v_mfma_f32_16x16x32_bf16 v[138:141], v[106:109], v[56:59], v[138:141]
    ds_read_b128 v[106:109], v143 offset:2304
    s_waitcnt lgkmcnt(5)
    v_mfma_f32_16x16x32_bf16 v[126:129], v[86:89], v[28:31], v[126:129]
    v_mfma_f32_16x16x32_bf16 v[134:137], v[86:89], v[60:63], v[134:137]
    ds_read_b128 v[86:89], v144 offset:256
    s_waitcnt lgkmcnt(5)
    v_mfma_f32_16x16x32_bf16 v[130:133], v[90:93], v[28:31], v[130:133]
    v_mfma_f32_16x16x32_bf16 v[138:141], v[90:93], v[60:63], v[138:141]
    ds_read_b128 v[90:93], v144 offset:2304
    s_waitcnt lgkmcnt(5)
    v_mfma_f32_16x16x32_bf16 v[126:129], v[94:97], v[32:35], v[126:129]
    v_mfma_f32_16x16x32_bf16 v[134:137], v[94:97], v[64:67], v[134:137]
    ds_read_b128 v[94:97], v145 offset:256
    s_waitcnt lgkmcnt(5)
    v_mfma_f32_16x16x32_bf16 v[130:133], v[98:101], v[32:35], v[130:133]
    v_mfma_f32_16x16x32_bf16 v[138:141], v[98:101], v[64:67], v[138:141]
    ds_read_b128 v[98:101], v145 offset:2304
    s_waitcnt lgkmcnt(5)
    v_mfma_f32_16x16x32_bf16 v[126:129], v[102:105], v[36:39], v[126:129]
    v_mfma_f32_16x16x32_bf16 v[134:137], v[102:105], v[68:71], v[134:137]
    s_waitcnt lgkmcnt(4)
    v_mfma_f32_16x16x32_bf16 v[130:133], v[106:109], v[36:39], v[130:133]
    v_mfma_f32_16x16x32_bf16 v[138:141], v[106:109], v[68:71], v[138:141]
    s_waitcnt lgkmcnt(3)
    v_mfma_f32_16x16x32_bf16 v[126:129], v[86:89], v[40:43], v[126:129]
    v_mfma_f32_16x16x32_bf16 v[134:137], v[86:89], v[72:75], v[134:137]
    s_waitcnt lgkmcnt(2)
    v_mfma_f32_16x16x32_bf16 v[130:133], v[90:93], v[40:43], v[130:133]
    v_mfma_f32_16x16x32_bf16 v[138:141], v[90:93], v[72:75], v[138:141]
    s_waitcnt lgkmcnt(1)
    v_mfma_f32_16x16x32_bf16 v[126:129], v[94:97], v[44:47], v[126:129]
    v_mfma_f32_16x16x32_bf16 v[134:137], v[94:97], v[76:79], v[134:137]
    s_waitcnt lgkmcnt(0)
    v_mfma_f32_16x16x32_bf16 v[130:133], v[98:101], v[44:47], v[130:133]
    v_mfma_f32_16x16x32_bf16 v[138:141], v[98:101], v[76:79], v[138:141]
    s_waitcnt vmcnt(0)
    s_barrier
    v_mov_b32 v11, 5
    buffer_store_dword v11, v4, s[4:7], s55 offen offset:8 sc1
    v_add_u32 v142, 32768, v80
    v_add_u32 v143, 32768, v81
    v_add_u32 v144, 32768, v82
    v_add_u32 v145, 32768, v83
    ds_read_b128 v[86:89], v142 offset:0
    v_mul_f32 v126, v126, v85
    v_mul_f32 v127, v127, v85
    v_mul_f32 v128, v128, v85
    v_mul_f32 v129, v129, v85
    ds_read_b128 v[90:93], v142 offset:2048
    v_mul_f32 v134, v134, v85
    v_mul_f32 v135, v135, v85
    v_mul_f32 v130, v130, v85
    v_mul_f32 v131, v131, v85
    ds_read_b128 v[94:97], v143 offset:0
    v_mul_f32 v132, v132, v85
    v_mul_f32 v133, v133, v85
    v_cvt_pk_bf16_f32 v126, v126, v127
    v_mul_f32 v136, v136, v85
    ds_read_b128 v[98:101], v143 offset:2048
    v_mul_f32 v137, v137, v85
    v_cvt_pk_bf16_f32 v127, v128, v129
    v_mul_f32 v138, v138, v85
    v_mul_f32 v139, v139, v85
    ds_read_b128 v[102:105], v144 offset:0
    v_mul_f32 v140, v140, v85
    v_mul_f32 v141, v141, v85
    v_cvt_pk_bf16_f32 v134, v134, v135
    v_cvt_pk_bf16_f32 v128, v130, v131
    ds_read_b128 v[106:109], v144 offset:2048
    v_cvt_pk_bf16_f32 v129, v132, v133
    v_cvt_pk_bf16_f32 v135, v136, v137
    v_cvt_pk_bf16_f32 v136, v138, v139
    s_waitcnt lgkmcnt(5)
    v_mfma_f32_16x16x32_bf16 v[110:113], v[86:89], v[16:19], 0
    v_cvt_pk_bf16_f32 v137, v140, v141
    buffer_store_dwordx4 v[126:129], v84, s[4:7], s52 offen offset:2048 sc1
    v_mfma_f32_16x16x32_bf16 v[118:121], v[86:89], v[48:51], 0
    ds_read_b128 v[86:89], v145 offset:0
    buffer_store_dwordx4 v[134:137], v84, s[4:7], s53 offen offset:2048 sc1
    s_add_u32 s52, s52, 4096
    s_waitcnt lgkmcnt(5)
    v_mfma_f32_16x16x32_bf16 v[114:117], v[90:93], v[16:19], 0
    s_add_u32 s53, s53, 4096
    v_mfma_f32_16x16x32_bf16 v[122:125], v[90:93], v[48:51], 0
    ds_read_b128 v[90:93], v145 offset:2048
    s_waitcnt lgkmcnt(5)
    v_mfma_f32_16x16x32_bf16 v[110:113], v[94:97], v[20:23], v[110:113]
    v_mfma_f32_16x16x32_bf16 v[118:121], v[94:97], v[52:55], v[118:121]
    ds_read_b128 v[94:97], v142 offset:256
    s_waitcnt lgkmcnt(5)
    v_mfma_f32_16x16x32_bf16 v[114:117], v[98:101], v[20:23], v[114:117]
    v_mfma_f32_16x16x32_bf16 v[122:125], v[98:101], v[52:55], v[122:125]
    ds_read_b128 v[98:101], v142 offset:2304
    s_waitcnt lgkmcnt(5)
    v_mfma_f32_16x16x32_bf16 v[110:113], v[102:105], v[24:27], v[110:113]
    v_mfma_f32_16x16x32_bf16 v[118:121], v[102:105], v[56:59], v[118:121]
    ds_read_b128 v[102:105], v143 offset:256
    s_waitcnt lgkmcnt(5)
    v_mfma_f32_16x16x32_bf16 v[114:117], v[106:109], v[24:27], v[114:117]
    v_mfma_f32_16x16x32_bf16 v[122:125], v[106:109], v[56:59], v[122:125]
    ds_read_b128 v[106:109], v143 offset:2304
    s_waitcnt lgkmcnt(5)
    v_mfma_f32_16x16x32_bf16 v[110:113], v[86:89], v[28:31], v[110:113]
    v_mfma_f32_16x16x32_bf16 v[118:121], v[86:89], v[60:63], v[118:121]
    ds_read_b128 v[86:89], v144 offset:256
    s_waitcnt lgkmcnt(5)
    v_mfma_f32_16x16x32_bf16 v[114:117], v[90:93], v[28:31], v[114:117]
    v_mfma_f32_16x16x32_bf16 v[122:125], v[90:93], v[60:63], v[122:125]
    ds_read_b128 v[90:93], v144 offset:2304
    s_waitcnt lgkmcnt(5)
    v_mfma_f32_16x16x32_bf16 v[110:113], v[94:97], v[32:35], v[110:113]
    v_mfma_f32_16x16x32_bf16 v[118:121], v[94:97], v[64:67], v[118:121]
    ds_read_b128 v[94:97], v145 offset:256
    s_waitcnt lgkmcnt(5)
    v_mfma_f32_16x16x32_bf16 v[114:117], v[98:101], v[32:35], v[114:117]
    v_mfma_f32_16x16x32_bf16 v[122:125], v[98:101], v[64:67], v[122:125]
    ds_read_b128 v[98:101], v145 offset:2304
    s_waitcnt lgkmcnt(5)
    v_mfma_f32_16x16x32_bf16 v[110:113], v[102:105], v[36:39], v[110:113]
    v_mfma_f32_16x16x32_bf16 v[118:121], v[102:105], v[68:71], v[118:121]
    s_waitcnt lgkmcnt(4)
    v_mfma_f32_16x16x32_bf16 v[114:117], v[106:109], v[36:39], v[114:117]
    v_mfma_f32_16x16x32_bf16 v[122:125], v[106:109], v[68:71], v[122:125]
    s_waitcnt lgkmcnt(3)
    v_mfma_f32_16x16x32_bf16 v[110:113], v[86:89], v[40:43], v[110:113]
    v_mfma_f32_16x16x32_bf16 v[118:121], v[86:89], v[72:75], v[118:121]
    s_waitcnt lgkmcnt(2)
    v_mfma_f32_16x16x32_bf16 v[114:117], v[90:93], v[40:43], v[114:117]
    v_mfma_f32_16x16x32_bf16 v[122:125], v[90:93], v[72:75], v[122:125]
    s_waitcnt lgkmcnt(1)
    v_mfma_f32_16x16x32_bf16 v[110:113], v[94:97], v[44:47], v[110:113]
    v_mfma_f32_16x16x32_bf16 v[118:121], v[94:97], v[76:79], v[118:121]
    s_waitcnt lgkmcnt(0)
    v_mfma_f32_16x16x32_bf16 v[114:117], v[98:101], v[44:47], v[114:117]
    v_mfma_f32_16x16x32_bf16 v[122:125], v[98:101], v[76:79], v[122:125]
    s_nop 3
    v_mul_f32 v110, v110, v85
    v_mul_f32 v111, v111, v85
    v_mul_f32 v112, v112, v85
    v_mul_f32 v113, v113, v85
    v_mul_f32 v118, v118, v85
    v_mul_f32 v119, v119, v85
    v_mul_f32 v114, v114, v85
    v_mul_f32 v115, v115, v85
    v_mul_f32 v116, v116, v85
    v_mul_f32 v117, v117, v85
    v_cvt_pk_bf16_f32 v110, v110, v111
    v_mul_f32 v120, v120, v85
    v_mul_f32 v121, v121, v85
    v_cvt_pk_bf16_f32 v111, v112, v113
    v_mul_f32 v122, v122, v85
    v_mul_f32 v123, v123, v85
    v_mul_f32 v124, v124, v85
    v_mul_f32 v125, v125, v85
    v_cvt_pk_bf16_f32 v118, v118, v119
    v_cvt_pk_bf16_f32 v112, v114, v115
    v_cvt_pk_bf16_f32 v113, v116, v117
    v_cvt_pk_bf16_f32 v119, v120, v121
    v_cvt_pk_bf16_f32 v120, v122, v123
    v_cvt_pk_bf16_f32 v121, v124, v125
    buffer_store_dwordx4 v[110:113], v84, s[4:7], s52 offen offset:0 sc1
    buffer_store_dwordx4 v[118:121], v84, s[4:7], s53 offen offset:0 sc1
    s_bitcmp1_b32 s2, 0
    s_cbranch_scc1 k0_clear
    s_waitcnt vmcnt(0)
    s_barrier
    v_mov_b32 v11, 7
    buffer_store_dword v11, v4, s[4:7], s55 offen offset:8 sc1
    buffer_store_dword v5, v4, s[4:7], s55 offen offset:0 sc1
    buffer_store_dword v5, v4, s[4:7], s55 offen offset:4 sc1
    s_branch k0_exit
k0_clear:
    s_waitcnt vmcnt(0)
    s_barrier
    v_mov_b32 v11, 7
    buffer_store_dword v11, v4, s[4:7], s55 offen offset:8 sc1
    buffer_store_dword v5, v4, s[4:7], s55 offen offset:0 sc1
    v_lshrrev_b32 v11, 2, v1
    v_and_b32 v12, 3, v1
    v_lshl_add_u32 v12, s10, 2, v12
    v_mul_u32_u24 v16, 896, v12
    v_lshl_add_u32 v16, v11, 4, v16
    v_lshlrev_b32 v18, 8, v11
    v_lshl_add_u32 v18, v12, 4, v18
    v_cmp_gt_u32 vcc, 8, v11
    s_nop 1
    v_cndmask_b32 v17, v6, v16, vcc
    v_cndmask_b32 v19, v6, v18, vcc
    s_lshr_b32 s44, s2, 1
    s_mul_i32 s44, s44, 14336
    s_add_u32 s56, s44, 22163456
    s_add_u32 s60, s44, 18034688
    buffer_load_dwordx4 v[20:23], v16, s[16:19], s44 offen offset:0
    s_add_u32 s57, s44, 22167552
    s_add_u32 s61, s44, 18038784
    buffer_load_dwordx4 v[24:27], v16, s[16:19], s44 offen offset:256
    s_add_u32 s58, s44, 22171648
    s_add_u32 s62, s44, 18042880
    buffer_load_dwordx4 v[28:31], v16, s[16:19], s44 offen offset:512
    s_add_u32 s59, s44, 22175744
    s_add_u32 s63, s44, 18046976
    buffer_load_dwordx4 v[32:35], v17, s[16:19], s44 offen offset:768
    s_lshr_b32 s45, s2, 1
    s_lshl_b32 s45, s45, 8
    v_add_u32 v36, s45, v0
    s_load_dwordx2 s[24:25], s[0:1], 64
    s_mov_b32 s26, 1605632
    s_mov_b32 s27, 0x20000
    s_load_dwordx2 s[28:29], s[0:1], 72
    s_mov_b32 s30, 1605632
    s_mov_b32 s31, 0x20000
    v_lshlrev_b32 v11, 7, v36
    v_subrev_u32 v12, 2097152, v11
    s_waitcnt lgkmcnt(0)
    buffer_load_dword v13, v11, s[24:27], 0 offen
    buffer_load_dword v13, v12, s[28:31], 0 offen
    s_waitcnt vmcnt(2)
    v_and_b32 v39, 0xffff0000, v20
    v_lshlrev_b32 v38, 16, v20
    v_and_b32 v41, 0xffff0000, v21
    v_lshlrev_b32 v40, 16, v21
    v_mov_b32 v70, v38
    v_mov_b32 v71, v39
    v_mul_f32 v72, v38, v38
    v_mul_f32 v73, v39, v39
    v_and_b32 v43, 0xffff0000, v22
    v_lshlrev_b32 v42, 16, v22
    v_add_f32 v70, v70, v40
    v_add_f32 v71, v71, v41
    v_fmac_f32 v72, v40, v40
    v_fmac_f32 v73, v41, v41
    v_and_b32 v45, 0xffff0000, v23
    v_lshlrev_b32 v44, 16, v23
    v_add_f32 v70, v70, v42
    v_add_f32 v71, v71, v43
    v_fmac_f32 v72, v42, v42
    v_fmac_f32 v73, v43, v43
    v_add_f32 v70, v70, v44
    v_add_f32 v71, v71, v45
    v_and_b32 v47, 0xffff0000, v24
    v_lshlrev_b32 v46, 16, v24
    v_fmac_f32 v72, v44, v44
    v_fmac_f32 v73, v45, v45
    v_and_b32 v49, 0xffff0000, v25
    v_lshlrev_b32 v48, 16, v25
    v_add_f32 v70, v70, v46
    v_add_f32 v71, v71, v47
    v_fmac_f32 v72, v46, v46
    v_fmac_f32 v73, v47, v47
    v_and_b32 v51, 0xffff0000, v26
    v_lshlrev_b32 v50, 16, v26
    v_add_f32 v70, v70, v48
    v_add_f32 v71, v71, v49
    v_fmac_f32 v72, v48, v48
    v_fmac_f32 v73, v49, v49
    v_and_b32 v53, 0xffff0000, v27
    v_lshlrev_b32 v52, 16, v27
    v_add_f32 v70, v70, v50
    v_add_f32 v71, v71, v51
    v_fmac_f32 v72, v50, v50
    v_fmac_f32 v73, v51, v51
    v_add_f32 v70, v70, v52
    v_add_f32 v71, v71, v53
    v_and_b32 v55, 0xffff0000, v28
    v_lshlrev_b32 v54, 16, v28
    v_fmac_f32 v72, v52, v52
    v_fmac_f32 v73, v53, v53
    v_and_b32 v57, 0xffff0000, v29
    v_lshlrev_b32 v56, 16, v29
    v_add_f32 v70, v70, v54
    v_add_f32 v71, v71, v55
    v_fmac_f32 v72, v54, v54
    v_fmac_f32 v73, v55, v55
    v_and_b32 v59, 0xffff0000, v30
    v_lshlrev_b32 v58, 16, v30
    v_add_f32 v70, v70, v56
    v_add_f32 v71, v71, v57
    v_fmac_f32 v72, v56, v56
    v_fmac_f32 v73, v57, v57
    v_and_b32 v61, 0xffff0000, v31
    v_lshlrev_b32 v60, 16, v31
    v_add_f32 v70, v70, v58
    v_add_f32 v71, v71, v59
    v_fmac_f32 v72, v58, v58
    v_fmac_f32 v73, v59, v59
    v_add_f32 v70, v70, v60
    v_add_f32 v71, v71, v61
    v_and_b32 v63, 0xffff0000, v32
    v_lshlrev_b32 v62, 16, v32
    v_fmac_f32 v72, v60, v60
    v_fmac_f32 v73, v61, v61
    v_and_b32 v65, 0xffff0000, v33
    v_lshlrev_b32 v64, 16, v33
    v_add_f32 v70, v70, v62
    v_add_f32 v71, v71, v63
    v_fmac_f32 v72, v62, v62
    v_fmac_f32 v73, v63, v63
    v_and_b32 v67, 0xffff0000, v34
    v_lshlrev_b32 v66, 16, v34
    v_add_f32 v70, v70, v64
    v_add_f32 v71, v71, v65
    v_fmac_f32 v72, v64, v64
    v_fmac_f32 v73, v65, v65
    v_and_b32 v69, 0xffff0000, v35
    v_lshlrev_b32 v68, 16, v35
    v_add_f32 v70, v70, v66
    v_add_f32 v71, v71, v67
    v_fmac_f32 v72, v66, v66
    v_fmac_f32 v73, v67, v67
    v_add_f32 v70, v70, v68
    v_add_f32 v71, v71, v69
    v_fmac_f32 v72, v68, v68
    v_fmac_f32 v73, v69, v69
    v_add_f32 v70, v70, v71
    v_add_f32 v71, v72, v73
    buffer_store_dwordx4 v[20:23], v18, s[4:7], s56 offen sc1
    v_add_f32_dpp v70, v70, v70 row_ror:8 row_mask:0xf bank_mask:0xf
    v_add_f32_dpp v71, v71, v71 row_ror:8 row_mask:0xf bank_mask:0xf
    buffer_store_dwordx4 v[24:27], v18, s[4:7], s57 offen sc1
    v_add_f32_dpp v70, v70, v70 row_ror:4 row_mask:0xf bank_mask:0xf
    v_add_f32_dpp v71, v71, v71 row_ror:4 row_mask:0xf bank_mask:0xf
    v_mov_b32 v72, v70
    v_mov_b32 v73, v71
    buffer_store_dwordx4 v[28:31], v18, s[4:7], s58 offen sc1
    v_permlane16_swap_b32 v70, v72
    v_permlane16_swap_b32 v71, v73
    v_add_f32 v70, v70, v72
    v_add_f32 v71, v71, v73
    v_mov_b32 v72, v70
    v_mov_b32 v73, v71
    buffer_store_dwordx4 v[32:35], v19, s[4:7], s59 offen sc1
    v_permlane32_swap_b32 v70, v72
    v_permlane32_swap_b32 v71, v73
    v_add_f32 v70, v70, v72
    v_add_f32 v71, v71, v73
    v_mul_f32 v70, 0x3b124925, v70
    v_mul_f32 v71, 0x3b124925, v71
    v_sub_f32 v38, v38, v70
    v_fma_f32 v71, -v70, v70, v71
    v_sub_f32 v39, v39, v70
    v_max_f32 v71, 0, v71
    v_sub_f32 v40, v40, v70
    v_add_f32 v71, 0x3727c5ac, v71
    v_sub_f32 v41, v41, v70
    v_rsq_f32 v71, v71
    v_sub_f32 v46, v46, v70
    v_sub_f32 v47, v47, v70
    v_sub_f32 v42, v42, v70
    v_sub_f32 v43, v43, v70
    v_sub_f32 v44, v44, v70
    v_sub_f32 v45, v45, v70
    v_mul_f32 v38, v38, v71
    v_mul_f32 v39, v39, v71
    v_sub_f32 v48, v48, v70
    v_sub_f32 v49, v49, v70
    v_sub_f32 v54, v54, v70
    v_sub_f32 v55, v55, v70
    v_mul_f32 v40, v40, v71
    v_mul_f32 v41, v41, v71
    v_sub_f32 v50, v50, v70
    v_sub_f32 v51, v51, v70
    v_sub_f32 v52, v52, v70
    v_sub_f32 v53, v53, v70
    v_mul_f32 v46, v46, v71
    v_mul_f32 v47, v47, v71
    v_sub_f32 v56, v56, v70
    v_sub_f32 v57, v57, v70
    v_sub_f32 v62, v62, v70
    v_sub_f32 v63, v63, v70
    v_mul_f32 v42, v42, v71
    v_mul_f32 v43, v43, v71
    v_mul_f32 v44, v44, v71
    v_mul_f32 v45, v45, v71
    v_cvt_pk_bf16_f32 v38, v38, v39
    v_mul_f32 v48, v48, v71
    v_mul_f32 v49, v49, v71
    v_sub_f32 v58, v58, v70
    v_sub_f32 v59, v59, v70
    v_sub_f32 v60, v60, v70
    v_sub_f32 v61, v61, v70
    v_mul_f32 v54, v54, v71
    v_mul_f32 v55, v55, v71
    v_sub_f32 v64, v64, v70
    v_sub_f32 v65, v65, v70
    v_cvt_pk_bf16_f32 v39, v40, v41
    v_mul_f32 v50, v50, v71
    v_mul_f32 v51, v51, v71
    v_mul_f32 v52, v52, v71
    v_mul_f32 v53, v53, v71
    v_cvt_pk_bf16_f32 v46, v46, v47
    v_mul_f32 v56, v56, v71
    v_mul_f32 v57, v57, v71
    v_sub_f32 v66, v66, v70
    v_sub_f32 v67, v67, v70
    v_sub_f32 v68, v68, v70
    v_sub_f32 v69, v69, v70
    v_mul_f32 v62, v62, v71
    v_mul_f32 v63, v63, v71
    v_cvt_pk_bf16_f32 v40, v42, v43
    v_cvt_pk_bf16_f32 v41, v44, v45
    v_cvt_pk_bf16_f32 v47, v48, v49
    v_mul_f32 v58, v58, v71
    v_mul_f32 v59, v59, v71
    v_mul_f32 v60, v60, v71
    v_mul_f32 v61, v61, v71
    v_cvt_pk_bf16_f32 v54, v54, v55
    v_mul_f32 v64, v64, v71
    v_mul_f32 v65, v65, v71
    v_cvt_pk_bf16_f32 v48, v50, v51
    v_cvt_pk_bf16_f32 v49, v52, v53
    v_cvt_pk_bf16_f32 v55, v56, v57
    v_mul_f32 v66, v66, v71
    v_mul_f32 v67, v67, v71
    v_mul_f32 v68, v68, v71
    v_mul_f32 v69, v69, v71
    v_cvt_pk_bf16_f32 v62, v62, v63
    buffer_store_dwordx4 v[38:41], v18, s[4:7], s60 offen sc1
    v_cvt_pk_bf16_f32 v56, v58, v59
    v_cvt_pk_bf16_f32 v57, v60, v61
    v_cvt_pk_bf16_f32 v63, v64, v65
    buffer_store_dwordx4 v[46:49], v18, s[4:7], s61 offen sc1
    v_cvt_pk_bf16_f32 v64, v66, v67
    v_cvt_pk_bf16_f32 v65, v68, v69
    buffer_store_dwordx4 v[54:57], v18, s[4:7], s62 offen sc1
    buffer_store_dwordx4 v[62:65], v19, s[4:7], s63 offen sc1
    s_waitcnt vmcnt(0)
    s_barrier
    buffer_store_dword v5, v4, s[4:7], s55 offen offset:4 sc1
    s_branch k0_exit
k0_norm:
    s_cmp_lg_u32 s2, 248
    s_cbranch_scc1 k0_nozero
    v_mov_b32 v16, 0
    v_mov_b32 v17, 0
    v_mov_b32 v18, 0
    v_mov_b32 v19, 0
    v_lshlrev_b32 v20, 4, v0
    s_mov_b32 s45, 176128
    buffer_store_dwordx4 v[16:19], v20, s[4:7], s45 offen sc1
    s_add_u32 s45, s45, 4096
    buffer_store_dwordx4 v[16:19], v20, s[4:7], s45 offen sc1
    s_add_u32 s45, s45, 4096
    buffer_store_dwordx4 v[16:19], v20, s[4:7], s45 offen sc1
    s_add_u32 s45, s45, 4096
    buffer_store_dwordx4 v[16:19], v20, s[4:7], s45 offen sc1
    s_add_u32 s45, s45, 4096
    buffer_store_dwordx4 v[16:19], v20, s[4:7], s45 offen sc1
    s_add_u32 s45, s45, 4096
    buffer_store_dwordx4 v[16:19], v20, s[4:7], s45 offen sc1
    s_add_u32 s45, s45, 4096
    buffer_store_dwordx4 v[16:19], v20, s[4:7], s45 offen sc1
    s_add_u32 s45, s45, 4096
    buffer_store_dwordx4 v[16:19], v20, s[4:7], s45 offen sc1
    s_add_u32 s45, s45, 4096
    s_waitcnt vmcnt(0)
    s_barrier
    v_mov_b32 v20, 1
    buffer_store_dword v20, v16, s[32:35], 0 offen offset:252 sc1
k0_nozero:
    s_lshl_b32 s45, s2, 5
    v_add_lshl_u32 v25, s45, v0, 4
    v_add_u32 v24, 0, v25
    v_subrev_u32 v16, 65536, v24
    v_cmp_gt_u32 vcc, 512, v16
    s_nop 1
    v_cndmask_b32 v16, 0, 1, vcc
    v_mov_b32 v17, v16
    v_mov_b32 v18, v16
    v_mov_b32 v19, v16
    v_cmp_gt_u32 vcc, 176128, v24
    s_nop 1
    v_cndmask_b32 v24, v6, v24, vcc
    buffer_store_dwordx4 v[16:19], v24, s[4:7], 0 offen sc1
    v_add_u32 v24, 131072, v25
    s_nop 0
    v_subrev_u32 v16, 65536, v24
    v_cmp_gt_u32 vcc, 512, v16
    s_nop 1
    v_cndmask_b32 v16, 0, 1, vcc
    v_mov_b32 v17, v16
    v_mov_b32 v18, v16
    v_mov_b32 v19, v16
    v_cmp_gt_u32 vcc, 176128, v24
    s_nop 1
    v_cndmask_b32 v24, v6, v24, vcc
    buffer_store_dwordx4 v[16:19], v24, s[4:7], 0 offen sc1
    v_mov_b32 v20, -1
    v_mov_b32 v21, -1
    v_mov_b32 v22, -1
    v_mov_b32 v23, -1
    v_add_u32 v24, 208896, v25
    v_subrev_u32 v11, 208896, v24
    v_cmp_le_u32 vcc, 7168, v11
    s_nop 1
    v_cndmask_b32 v24, v6, v24, vcc
    buffer_store_dwordx4 v[20:23], v24, s[4:7], 0 offen sc1
    v_add_u32 v24, 339968, v25
    buffer_store_dwordx4 v[20:23], v24, s[4:7], 0 offen sc1
    v_add_u32 v24, 471040, v25
    buffer_store_dwordx4 v[20:23], v24, s[4:7], 0 offen sc1
    v_add_u32 v24, 602112, v25
    v_subrev_u32 v11, 667648, v24
    v_cmp_le_u32 vcc, 7168, v11
    s_nop 1
    v_cndmask_b32 v24, v6, v24, vcc
    buffer_store_dwordx4 v[20:23], v24, s[4:7], 0 offen sc1
    v_add_u32 v24, 733184, v25
    buffer_store_dwordx4 v[20:23], v24, s[4:7], 0 offen sc1
    v_add_u32 v24, 864256, v25
    buffer_store_dwordx4 v[20:23], v24, s[4:7], 0 offen sc1
    v_add_u32 v24, 995328, v25
    buffer_store_dwordx4 v[20:23], v24, s[4:7], 0 offen sc1
    v_add_u32 v24, 1126400, v25
    buffer_store_dwordx4 v[20:23], v24, s[4:7], 0 offen sc1
    v_add_u32 v24, 1257472, v25
    buffer_store_dwordx4 v[20:23], v24, s[4:7], 0 offen sc1
    v_add_u32 v24, 1388544, v25
    buffer_store_dwordx4 v[20:23], v24, s[4:7], 0 offen sc1
    v_add_u32 v24, 1519616, v25
    buffer_store_dwordx4 v[20:23], v24, s[4:7], 0 offen sc1
    v_add_u32 v24, 1650688, v25
    buffer_store_dwordx4 v[20:23], v24, s[4:7], 0 offen sc1
    v_add_u32 v24, 1781760, v25
    buffer_store_dwordx4 v[20:23], v24, s[4:7], 0 offen sc1
    v_add_u32 v24, 1912832, v25
    buffer_store_dwordx4 v[20:23], v24, s[4:7], 0 offen sc1
    v_add_u32 v24, 2043904, v25
    buffer_store_dwordx4 v[20:23], v24, s[4:7], 0 offen sc1
    v_add_u32 v24, 2174976, v25
    buffer_store_dwordx4 v[20:23], v24, s[4:7], 0 offen sc1
    v_add_u32 v24, 2306048, v25
    buffer_store_dwordx4 v[20:23], v24, s[4:7], 0 offen sc1
    v_add_u32 v24, 2437120, v25
    buffer_store_dwordx4 v[20:23], v24, s[4:7], 0 offen sc1
    v_add_u32 v24, 2568192, v25
    buffer_store_dwordx4 v[20:23], v24, s[4:7], 0 offen sc1
    v_add_u32 v24, 2699264, v25
    buffer_store_dwordx4 v[20:23], v24, s[4:7], 0 offen sc1
    v_add_u32 v24, 2830336, v25
    buffer_store_dwordx4 v[20:23], v24, s[4:7], 0 offen sc1
    v_add_u32 v24, 2961408, v25
    buffer_store_dwordx4 v[20:23], v24, s[4:7], 0 offen sc1
    v_add_u32 v24, 3092480, v25
    buffer_store_dwordx4 v[20:23], v24, s[4:7], 0 offen sc1
    v_add_u32 v24, 3223552, v25
    buffer_store_dwordx4 v[20:23], v24, s[4:7], 0 offen sc1
    v_add_u32 v24, 3354624, v25
    buffer_store_dwordx4 v[20:23], v24, s[4:7], 0 offen sc1
    v_add_u32 v24, 3485696, v25
    buffer_store_dwordx4 v[20:23], v24, s[4:7], 0 offen sc1
    v_add_u32 v24, 3616768, v25
    buffer_store_dwordx4 v[20:23], v24, s[4:7], 0 offen sc1
    v_add_u32 v24, 3747840, v25
    buffer_store_dwordx4 v[20:23], v24, s[4:7], 0 offen sc1
    v_add_u32 v24, 3878912, v25
    buffer_store_dwordx4 v[20:23], v24, s[4:7], 0 offen sc1
    v_add_u32 v24, 4009984, v25
    buffer_store_dwordx4 v[20:23], v24, s[4:7], 0 offen sc1
    v_add_u32 v24, 4141056, v25
    buffer_store_dwordx4 v[20:23], v24, s[4:7], 0 offen sc1
    v_add_u32 v24, 4272128, v25
    buffer_store_dwordx4 v[20:23], v24, s[4:7], 0 offen sc1
    v_add_u32 v24, 4403200, v25
    buffer_store_dwordx4 v[20:23], v24, s[4:7], 0 offen sc1
    v_add_u32 v24, 4534272, v25
    buffer_store_dwordx4 v[20:23], v24, s[4:7], 0 offen sc1
    v_add_u32 v24, 4665344, v25
    buffer_store_dwordx4 v[20:23], v24, s[4:7], 0 offen sc1
    v_add_u32 v24, 4796416, v25
    buffer_store_dwordx4 v[20:23], v24, s[4:7], 0 offen sc1
    v_add_u32 v24, 4927488, v25
    buffer_store_dwordx4 v[20:23], v24, s[4:7], 0 offen sc1
    v_add_u32 v24, 5058560, v25
    buffer_store_dwordx4 v[20:23], v24, s[4:7], 0 offen sc1
    s_cmp_lt_u32 s2, 240
    s_cbranch_scc1 k0_nomem
    s_bfe_u32 s45, s2, 0x10003
    s_mul_i32 s45, s45, 458752
    s_add_u32 s45, s45, 208896
    v_lshrrev_b32 v11, 1, v2
    v_mul_u32_u24 v11, 896, v11
    v_lshl_add_u32 v11, v3, 5, v11
    v_and_b32 v12, 1, v2
    v_lshl_add_u32 v11, v12, 2, v11
    s_add_u32 s44, s10, 0
    s_cmp_lt_u32 s44, 7
    s_cselect_b32 s46, 0, 1073741824
    v_lshl_add_u32 v11, s44, 7, v11
    v_add_u32 v11, s46, v11
    s_waitcnt vmcnt(0)
    buffer_load_dword v26, v11, s[20:23], 0 offen offset:0
    buffer_load_dword v27, v11, s[20:23], 0 offen offset:8
    buffer_load_dword v28, v11, s[20:23], 0 offen offset:16
    buffer_load_dword v29, v11, s[20:23], 0 offen offset:24
    v_lshlrev_b32 v12, 4, v1
    v_lshl_add_u32 v12, s44, 10, v12
    v_add_u32 v12, s46, v12
    s_waitcnt vmcnt(0)
    buffer_store_dwordx4 v[26:29], v12, s[4:7], s45 offen sc1
    v_lshrrev_b32 v11, 1, v2
    v_mul_u32_u24 v11, 896, v11
    v_lshl_add_u32 v11, v3, 5, v11
    v_and_b32 v12, 1, v2
    v_lshl_add_u32 v11, v12, 2, v11
    s_add_u32 s44, s10, 4
    s_cmp_lt_u32 s44, 7
    s_cselect_b32 s46, 0, 1073741824
    v_lshl_add_u32 v11, s44, 7, v11
    v_add_u32 v11, s46, v11
    s_waitcnt vmcnt(0)
    buffer_load_dword v26, v11, s[20:23], 0 offen offset:0
    buffer_load_dword v27, v11, s[20:23], 0 offen offset:8
    buffer_load_dword v28, v11, s[20:23], 0 offen offset:16
    buffer_load_dword v29, v11, s[20:23], 0 offen offset:24
    v_lshlrev_b32 v12, 4, v1
    v_lshl_add_u32 v12, s44, 10, v12
    v_add_u32 v12, s46, v12
    s_waitcnt vmcnt(0)
    buffer_store_dwordx4 v[26:29], v12, s[4:7], s45 offen sc1
k0_nomem:
    v_cmp_eq_u32 vcc, 0, v14
    s_cbranch_vccz k0_zokd
k0_zwd:
    buffer_load_dword v14, v15, s[32:35], 0 offen offset:252 sc1
    s_waitcnt vmcnt(0)
    v_cmp_eq_u32 vcc, 0, v14
    s_cbranch_vccz k0_zokd
    s_sleep 2
    s_sub_u32 s13, s13, 1
    s_cbranch_scc0 k0_zwd
    s_mov_b32 s13, 0
k0_zokd:
    s_waitcnt vmcnt(0)
    s_barrier
    buffer_store_dword v5, v4, s[4:7], s55 offen offset:0 sc1
    buffer_store_dword v5, v4, s[4:7], s55 offen offset:4 sc1
k0_exit:
    s_cmp_eq_u32 s14, 2
    s_cbranch_scc1 type2
    s_cmp_lg_u32 s14, 0
    s_cbranch_scc1 type1
    s_cmp_lt_u32 s9, 16
    s_cbranch_scc1 role_S
    s_sub_u32 s9, s9, 16
    s_cmp_lt_u32 s9, 14
    s_cbranch_scc1 role_V
    s_sub_u32 s9, s9, 14
    s_branch role_X
type2:
    s_cmp_lt_u32 s9, 28
    s_cbranch_scc1 role_UB
    s_branch main_exit
type1:
    s_lshr_b32 s11, s14, 1
    s_cmp_lt_u32 s9, 16
    s_cbranch_scc1 role_TA
    s_sub_u32 s9, s9, 16
    s_cmp_lt_u32 s9, 7
    s_cbranch_scc1 role_PV
    s_sub_u32 s9, s9, 7
    s_cmp_lt_u32 s9, 7
    s_cbranch_scc1 role_FFN
    s_sub_u32 s9, s9, 7
    s_branch role_RED
main_exit:
    s_endpgm
.p2align 6
role_S:
    v_and_b32 v1, 63, v0
    v_and_b32 v2, 15, v0
    v_lshrrev_b32 v3, 4, v1
    s_lshl_b32 s16, s10, 1
    s_add_u32 s16, s16, 0
    s_cmp_ge_u32 s16, 7
    s_cselect_b32 m0, 7, 0
    s_sub_u32 s16, s16, m0
    s_lshl_b32 s16, s16, 10
    s_lshl_b32 s17, s10, 1
    s_add_u32 s17, s17, 1
    s_cmp_ge_u32 s17, 7
    s_cselect_b32 m0, 7, 0
    s_sub_u32 s17, s17, m0
    s_lshl_b32 s17, s17, 10
    s_lshl_b32 s18, s10, 1
    s_add_u32 s18, s18, 2
    s_cmp_ge_u32 s18, 7
    s_cselect_b32 m0, 7, 0
    s_sub_u32 s18, s18, m0
    s_lshl_b32 s18, s18, 10
    s_lshl_b32 s19, s10, 1
    s_add_u32 s19, s19, 3
    s_cmp_ge_u32 s19, 7
    s_cselect_b32 m0, 7, 0
    s_sub_u32 s19, s19, m0
    s_lshl_b32 s19, s19, 10
    s_lshl_b32 s20, s10, 1
    s_add_u32 s20, s20, 4
    s_cmp_ge_u32 s20, 7
    s_cselect_b32 m0, 7, 0
    s_sub_u32 s20, s20, m0
    s_lshl_b32 s20, s20, 10
    s_lshl_b32 s21, s10, 1
    s_add_u32 s21, s21, 5
    s_cmp_ge_u32 s21, 7
    s_cselect_b32 m0, 7, 0
    s_sub_u32 s21, s21, m0
    s_lshl_b32 s21, s21, 10
    s_lshl_b32 s22, s10, 1
    s_add_u32 s22, s22, 6
    s_cmp_ge_u32 s22, 7
    s_cselect_b32 m0, 7, 0
    s_sub_u32 s22, s22, m0
    s_lshl_b32 s22, s22, 10
    s_mul_i32 s23, s10, 7
    s_and_b32 s27, s10, 1
    s_add_u32 s25, s23, 1
    s_lshr_b32 s25, s25, 1
    s_lshr_b32 s26, s10, 1
    s_mul_i32 s26, s26, 7
    s_add_u32 s26, s26, 3
    v_lshlrev_b32 v4, 4, v1
    s_mul_i32 s28, s9, 7
    s_cmp_eq_u32 s8, 0
    s_cbranch_scc1 l0_1
    v_lshlrev_b32 v248, 7, v0
    s_mov_b32 s31, 176132
ww_2:
    buffer_load_dword v249, v248, s[4:7], s31 offen sc1
    s_waitcnt vmcnt(0)
    v_cmp_eq_u32 vcc, 0, v249
    s_cbranch_vccz wwok_3
    s_sleep 4
    s_sub_u32 s13, s13, 1
    s_cbranch_scc0 ww_2
    s_mov_b32 s13, 0
wwok_3:
    s_barrier
    v_mov_b32 v248, 0
    s_mov_b32 s30, 66048
ww_4:
    buffer_load_dword v249, v248, s[4:7], s30 offen sc1
    s_waitcnt vmcnt(0)
    v_cmp_eq_u32 vcc, 0, v249
    s_cbranch_vccz wwok_5
    s_sleep 8
    s_sub_u32 s13, s13, 1
    s_cbranch_scc0 ww_4
    s_mov_b32 s13, 0
wwok_5:
l0_1:
    v_and_b32 v248, 63, v0
    v_min_u32 v248, 6, v248
    v_mul_u32_u24 v248, 1, v248
    v_add_u32 v248, s28, v248
    v_add_u32 v248, 32, v248
    v_and_b32 v250, 31, v248
    v_lshrrev_b32 v248, 5, v248
    v_lshl_add_u32 v248, v250, 3, v248
    v_lshlrev_b32 v248, 7, v248
    v_add_u32 v248, 176136, v248
    v_mov_b32 v249, 0
    s_mul_i32 s28, s9, 28
    s_add_u32 s28, s28, s23
    s_mul_i32 s24, s27, 6
    s_sub_u32 s29, s28, s24
    s_add_u32 s29, s29, 6
    s_add_u32 s28, s28, s27
    s_mul_i32 s28, s28, 14336
    s_add_u32 s28, s28, 5189632
    s_mul_i32 s29, s29, 14336
    s_add_u32 s29, s29, 5189632
    s_mul_i32 s24, s10, 14336
    s_cmp_eq_u32 s10, 1
    s_cbranch_scc1 pw_8
    s_cmp_eq_u32 s10, 2
    s_cbranch_scc1 pw_9
    s_cmp_eq_u32 s10, 3
    s_cbranch_scc1 pw_10
pw_7:
    v_cmp_gt_u32 vcc, 1, v249
    s_cbranch_vccz wcok_12
wc_11:
    buffer_load_dword v249, v248, s[4:7], 0 offen sc1
    s_waitcnt vmcnt(0)
    v_cmp_gt_u32 vcc, 1, v249
    s_cbranch_vccz wcok_12
    s_sleep 4
    s_sub_u32 s13, s13, 1
    s_cbranch_scc0 wc_11
    s_mov_b32 s13, 0
wcok_12:
    s_add_u32 s23, s28, 0
    buffer_load_dwordx4 a[0:3], v4, s[4:7], s23 offen
    buffer_load_dwordx4 a[4:7], v4, s[4:7], s23 offen offset:1024
    s_add_u32 s23, s28, 14336
    buffer_load_dwordx4 a[48:51], v4, s[4:7], s23 offen
    buffer_load_dwordx4 a[52:55], v4, s[4:7], s23 offen offset:1024
    s_add_u32 s23, s28, 28672
    buffer_load_dwordx4 a[96:99], v4, s[4:7], s23 offen
    buffer_load_dwordx4 a[100:103], v4, s[4:7], s23 offen offset:1024
    s_add_u32 s23, s28, 43008
    buffer_load_dwordx4 a[144:147], v4, s[4:7], s23 offen
    buffer_load_dwordx4 a[148:151], v4, s[4:7], s23 offen offset:1024
    s_add_u32 s23, s28, 57344
    buffer_load_dwordx4 a[192:195], v4, s[4:7], s23 offen
    buffer_load_dwordx4 a[196:199], v4, s[4:7], s23 offen offset:1024
    s_add_u32 s23, s28, 71680
    buffer_load_dwordx4 a[240:243], v4, s[4:7], s23 offen
    buffer_load_dwordx4 a[244:247], v4, s[4:7], s23 offen offset:1024
    s_add_u32 s23, s29, 0
    buffer_load_dwordx4 v[38:41], v4, s[4:7], s23 offen
    buffer_load_dwordx4 v[42:45], v4, s[4:7], s23 offen offset:1024
    v_cmp_gt_u32 vcc, 2, v249
    s_cbranch_vccz wcok_14
wc_13:
    buffer_load_dword v249, v248, s[4:7], 0 offen sc1
    s_waitcnt vmcnt(0)
    v_cmp_gt_u32 vcc, 2, v249
    s_cbranch_vccz wcok_14
    s_sleep 4
    s_sub_u32 s13, s13, 1
    s_cbranch_scc0 wc_13
    s_mov_b32 s13, 0
wcok_14:
    s_add_u32 s23, s28, 2048
    buffer_load_dwordx4 a[8:11], v4, s[4:7], s23 offen
    buffer_load_dwordx4 a[12:15], v4, s[4:7], s23 offen offset:1024
    s_add_u32 s23, s28, 16384
    buffer_load_dwordx4 a[56:59], v4, s[4:7], s23 offen
    buffer_load_dwordx4 a[60:63], v4, s[4:7], s23 offen offset:1024
    s_add_u32 s23, s28, 30720
    buffer_load_dwordx4 a[104:107], v4, s[4:7], s23 offen
    buffer_load_dwordx4 a[108:111], v4, s[4:7], s23 offen offset:1024
    s_add_u32 s23, s28, 45056
    buffer_load_dwordx4 a[152:155], v4, s[4:7], s23 offen
    buffer_load_dwordx4 a[156:159], v4, s[4:7], s23 offen offset:1024
    s_add_u32 s23, s28, 59392
    buffer_load_dwordx4 a[200:203], v4, s[4:7], s23 offen
    buffer_load_dwordx4 a[204:207], v4, s[4:7], s23 offen offset:1024
    s_add_u32 s23, s28, 73728
    buffer_load_dwordx4 a[248:251], v4, s[4:7], s23 offen
    buffer_load_dwordx4 a[252:255], v4, s[4:7], s23 offen offset:1024
    s_add_u32 s23, s29, 2048
    buffer_load_dwordx4 v[46:49], v4, s[4:7], s23 offen
    buffer_load_dwordx4 v[50:53], v4, s[4:7], s23 offen offset:1024
    v_cmp_gt_u32 vcc, 3, v249
    s_cbranch_vccz wcok_16
wc_15:
    buffer_load_dword v249, v248, s[4:7], 0 offen sc1
    s_waitcnt vmcnt(0)
    v_cmp_gt_u32 vcc, 3, v249
    s_cbranch_vccz wcok_16
    s_sleep 4
    s_sub_u32 s13, s13, 1
    s_cbranch_scc0 wc_15
    s_mov_b32 s13, 0
wcok_16:
    s_add_u32 s23, s28, 4096
    buffer_load_dwordx4 a[16:19], v4, s[4:7], s23 offen
    buffer_load_dwordx4 a[20:23], v4, s[4:7], s23 offen offset:1024
    s_add_u32 s23, s28, 18432
    buffer_load_dwordx4 a[64:67], v4, s[4:7], s23 offen
    buffer_load_dwordx4 a[68:71], v4, s[4:7], s23 offen offset:1024
    s_add_u32 s23, s28, 32768
    buffer_load_dwordx4 a[112:115], v4, s[4:7], s23 offen
    buffer_load_dwordx4 a[116:119], v4, s[4:7], s23 offen offset:1024
    s_add_u32 s23, s28, 47104
    buffer_load_dwordx4 a[160:163], v4, s[4:7], s23 offen
    buffer_load_dwordx4 a[164:167], v4, s[4:7], s23 offen offset:1024
    s_add_u32 s23, s28, 61440
    buffer_load_dwordx4 a[208:211], v4, s[4:7], s23 offen
    buffer_load_dwordx4 a[212:215], v4, s[4:7], s23 offen offset:1024
    s_add_u32 s23, s28, 75776
    buffer_load_dwordx4 v[6:9], v4, s[4:7], s23 offen
    buffer_load_dwordx4 v[10:13], v4, s[4:7], s23 offen offset:1024
    s_add_u32 s23, s29, 4096
    buffer_load_dwordx4 v[54:57], v4, s[4:7], s23 offen
    buffer_load_dwordx4 v[58:61], v4, s[4:7], s23 offen offset:1024
    v_cmp_gt_u32 vcc, 4, v249
    s_cbranch_vccz wcok_18
wc_17:
    buffer_load_dword v249, v248, s[4:7], 0 offen sc1
    s_waitcnt vmcnt(0)
    v_cmp_gt_u32 vcc, 4, v249
    s_cbranch_vccz wcok_18
    s_sleep 4
    s_sub_u32 s13, s13, 1
    s_cbranch_scc0 wc_17
    s_mov_b32 s13, 0
wcok_18:
    s_add_u32 s23, s28, 6144
    buffer_load_dwordx4 a[24:27], v4, s[4:7], s23 offen
    buffer_load_dwordx4 a[28:31], v4, s[4:7], s23 offen offset:1024
    s_add_u32 s23, s28, 20480
    buffer_load_dwordx4 a[72:75], v4, s[4:7], s23 offen
    buffer_load_dwordx4 a[76:79], v4, s[4:7], s23 offen offset:1024
    s_add_u32 s23, s28, 34816
    buffer_load_dwordx4 a[120:123], v4, s[4:7], s23 offen
    buffer_load_dwordx4 a[124:127], v4, s[4:7], s23 offen offset:1024
    s_add_u32 s23, s28, 49152
    buffer_load_dwordx4 a[168:171], v4, s[4:7], s23 offen
    buffer_load_dwordx4 a[172:175], v4, s[4:7], s23 offen offset:1024
    s_add_u32 s23, s28, 63488
    buffer_load_dwordx4 a[216:219], v4, s[4:7], s23 offen
    buffer_load_dwordx4 a[220:223], v4, s[4:7], s23 offen offset:1024
    s_add_u32 s23, s28, 77824
    buffer_load_dwordx4 v[14:17], v4, s[4:7], s23 offen
    buffer_load_dwordx4 v[18:21], v4, s[4:7], s23 offen offset:1024
    s_add_u32 s23, s29, 6144
    buffer_load_dwordx4 v[62:65], v4, s[4:7], s23 offen
    buffer_load_dwordx4 v[66:69], v4, s[4:7], s23 offen offset:1024
    v_cmp_gt_u32 vcc, 5, v249
    s_cbranch_vccz wcok_20
wc_19:
    buffer_load_dword v249, v248, s[4:7], 0 offen sc1
    s_waitcnt vmcnt(0)
    v_cmp_gt_u32 vcc, 5, v249
    s_cbranch_vccz wcok_20
    s_sleep 4
    s_sub_u32 s13, s13, 1
    s_cbranch_scc0 wc_19
    s_mov_b32 s13, 0
wcok_20:
    s_add_u32 s23, s28, 8192
    buffer_load_dwordx4 a[32:35], v4, s[4:7], s23 offen
    buffer_load_dwordx4 a[36:39], v4, s[4:7], s23 offen offset:1024
    s_add_u32 s23, s28, 22528
    buffer_load_dwordx4 a[80:83], v4, s[4:7], s23 offen
    buffer_load_dwordx4 a[84:87], v4, s[4:7], s23 offen offset:1024
    s_add_u32 s23, s28, 36864
    buffer_load_dwordx4 a[128:131], v4, s[4:7], s23 offen
    buffer_load_dwordx4 a[132:135], v4, s[4:7], s23 offen offset:1024
    s_add_u32 s23, s28, 51200
    buffer_load_dwordx4 a[176:179], v4, s[4:7], s23 offen
    buffer_load_dwordx4 a[180:183], v4, s[4:7], s23 offen offset:1024
    s_add_u32 s23, s28, 65536
    buffer_load_dwordx4 a[224:227], v4, s[4:7], s23 offen
    buffer_load_dwordx4 a[228:231], v4, s[4:7], s23 offen offset:1024
    s_add_u32 s23, s28, 79872
    buffer_load_dwordx4 v[22:25], v4, s[4:7], s23 offen
    buffer_load_dwordx4 v[26:29], v4, s[4:7], s23 offen offset:1024
    s_add_u32 s23, s29, 8192
    buffer_load_dwordx4 v[70:73], v4, s[4:7], s23 offen
    buffer_load_dwordx4 v[74:77], v4, s[4:7], s23 offen offset:1024
    v_cmp_gt_u32 vcc, 6, v249
    s_cbranch_vccz wcok_22
wc_21:
    buffer_load_dword v249, v248, s[4:7], 0 offen sc1
    s_waitcnt vmcnt(0)
    v_cmp_gt_u32 vcc, 6, v249
    s_cbranch_vccz wcok_22
    s_sleep 4
    s_sub_u32 s13, s13, 1
    s_cbranch_scc0 wc_21
    s_mov_b32 s13, 0
wcok_22:
    s_add_u32 s23, s28, 10240
    buffer_load_dwordx4 a[40:43], v4, s[4:7], s23 offen
    buffer_load_dwordx4 a[44:47], v4, s[4:7], s23 offen offset:1024
    s_add_u32 s23, s28, 24576
    buffer_load_dwordx4 a[88:91], v4, s[4:7], s23 offen
    buffer_load_dwordx4 a[92:95], v4, s[4:7], s23 offen offset:1024
    s_add_u32 s23, s28, 38912
    buffer_load_dwordx4 a[136:139], v4, s[4:7], s23 offen
    buffer_load_dwordx4 a[140:143], v4, s[4:7], s23 offen offset:1024
    s_add_u32 s23, s28, 53248
    buffer_load_dwordx4 a[184:187], v4, s[4:7], s23 offen
    buffer_load_dwordx4 a[188:191], v4, s[4:7], s23 offen offset:1024
    s_add_u32 s23, s28, 67584
    buffer_load_dwordx4 a[232:235], v4, s[4:7], s23 offen
    buffer_load_dwordx4 a[236:239], v4, s[4:7], s23 offen offset:1024
    s_add_u32 s23, s28, 81920
    buffer_load_dwordx4 v[30:33], v4, s[4:7], s23 offen
    buffer_load_dwordx4 v[34:37], v4, s[4:7], s23 offen offset:1024
    s_add_u32 s23, s29, 10240
    buffer_load_dwordx4 v[78:81], v4, s[4:7], s23 offen
    buffer_load_dwordx4 v[82:85], v4, s[4:7], s23 offen offset:1024
    v_cmp_gt_u32 vcc, 7, v249
    s_cbranch_vccz wcok_24
wc_23:
    buffer_load_dword v249, v248, s[4:7], 0 offen sc1
    s_waitcnt vmcnt(0)
    v_cmp_gt_u32 vcc, 7, v249
    s_cbranch_vccz wcok_24
    s_sleep 4
    s_sub_u32 s13, s13, 1
    s_cbranch_scc0 wc_23
    s_mov_b32 s13, 0
wcok_24:
    s_add_u32 s23, s28, 12288
    s_add_u32 m0, s24, 0
    s_nop 0
    buffer_load_dwordx4 v4, s[4:7], s23 offen lds
    buffer_load_dwordx4 v4, s[4:7], s23 offen offset:1024 lds
    s_add_u32 s23, s28, 26624
    s_add_u32 m0, s24, 2048
    s_nop 0
    buffer_load_dwordx4 v4, s[4:7], s23 offen lds
    buffer_load_dwordx4 v4, s[4:7], s23 offen offset:1024 lds
    s_add_u32 s23, s28, 40960
    s_add_u32 m0, s24, 4096
    s_nop 0
    buffer_load_dwordx4 v4, s[4:7], s23 offen lds
    buffer_load_dwordx4 v4, s[4:7], s23 offen offset:1024 lds
    s_add_u32 s23, s28, 55296
    s_add_u32 m0, s24, 6144
    s_nop 0
    buffer_load_dwordx4 v4, s[4:7], s23 offen lds
    buffer_load_dwordx4 v4, s[4:7], s23 offen offset:1024 lds
    s_add_u32 s23, s28, 69632
    s_add_u32 m0, s24, 8192
    s_nop 0
    buffer_load_dwordx4 v4, s[4:7], s23 offen lds
    buffer_load_dwordx4 v4, s[4:7], s23 offen offset:1024 lds
    s_add_u32 s23, s28, 83968
    s_add_u32 m0, s24, 10240
    s_nop 0
    buffer_load_dwordx4 v4, s[4:7], s23 offen lds
    buffer_load_dwordx4 v4, s[4:7], s23 offen offset:1024 lds
    s_add_u32 s23, s29, 12288
    s_add_u32 m0, s24, 12288
    s_nop 0
    buffer_load_dwordx4 v4, s[4:7], s23 offen lds
    buffer_load_dwordx4 v4, s[4:7], s23 offen offset:1024 lds
    s_branch pwout_6
pw_8:
    v_cmp_gt_u32 vcc, 1, v249
    s_cbranch_vccz wcok_26
wc_25:
    buffer_load_dword v249, v248, s[4:7], 0 offen sc1
    s_waitcnt vmcnt(0)
    v_cmp_gt_u32 vcc, 1, v249
    s_cbranch_vccz wcok_26
    s_sleep 4
    s_sub_u32 s13, s13, 1
    s_cbranch_scc0 wc_25
    s_mov_b32 s13, 0
wcok_26:
    s_add_u32 s23, s28, 0
    buffer_load_dwordx4 a[40:43], v4, s[4:7], s23 offen
    buffer_load_dwordx4 a[44:47], v4, s[4:7], s23 offen offset:1024
    s_add_u32 s23, s28, 14336
    buffer_load_dwordx4 a[88:91], v4, s[4:7], s23 offen
    buffer_load_dwordx4 a[92:95], v4, s[4:7], s23 offen offset:1024
    s_add_u32 s23, s28, 28672
    buffer_load_dwordx4 a[136:139], v4, s[4:7], s23 offen
    buffer_load_dwordx4 a[140:143], v4, s[4:7], s23 offen offset:1024
    s_add_u32 s23, s28, 43008
    buffer_load_dwordx4 a[184:187], v4, s[4:7], s23 offen
    buffer_load_dwordx4 a[188:191], v4, s[4:7], s23 offen offset:1024
    s_add_u32 s23, s28, 57344
    buffer_load_dwordx4 a[232:235], v4, s[4:7], s23 offen
    buffer_load_dwordx4 a[236:239], v4, s[4:7], s23 offen offset:1024
    s_add_u32 s23, s28, 71680
    buffer_load_dwordx4 v[30:33], v4, s[4:7], s23 offen
    buffer_load_dwordx4 v[34:37], v4, s[4:7], s23 offen offset:1024
    s_add_u32 s23, s29, 0
    buffer_load_dwordx4 v[78:81], v4, s[4:7], s23 offen
    buffer_load_dwordx4 v[82:85], v4, s[4:7], s23 offen offset:1024
    v_cmp_gt_u32 vcc, 2, v249
    s_cbranch_vccz wcok_28
wc_27:
    buffer_load_dword v249, v248, s[4:7], 0 offen sc1
    s_waitcnt vmcnt(0)
    v_cmp_gt_u32 vcc, 2, v249
    s_cbranch_vccz wcok_28
    s_sleep 4
    s_sub_u32 s13, s13, 1
    s_cbranch_scc0 wc_27
    s_mov_b32 s13, 0
wcok_28:
    s_add_u32 s23, s28, 2048
    s_add_u32 m0, s24, 0
    s_nop 0
    buffer_load_dwordx4 v4, s[4:7], s23 offen lds
    buffer_load_dwordx4 v4, s[4:7], s23 offen offset:1024 lds
    s_add_u32 s23, s28, 16384
    s_add_u32 m0, s24, 2048
    s_nop 0
    buffer_load_dwordx4 v4, s[4:7], s23 offen lds
    buffer_load_dwordx4 v4, s[4:7], s23 offen offset:1024 lds
    s_add_u32 s23, s28, 30720
    s_add_u32 m0, s24, 4096
    s_nop 0
    buffer_load_dwordx4 v4, s[4:7], s23 offen lds
    buffer_load_dwordx4 v4, s[4:7], s23 offen offset:1024 lds
    s_add_u32 s23, s28, 45056
    s_add_u32 m0, s24, 6144
    s_nop 0
    buffer_load_dwordx4 v4, s[4:7], s23 offen lds
    buffer_load_dwordx4 v4, s[4:7], s23 offen offset:1024 lds
    s_add_u32 s23, s28, 59392
    s_add_u32 m0, s24, 8192
    s_nop 0
    buffer_load_dwordx4 v4, s[4:7], s23 offen lds
    buffer_load_dwordx4 v4, s[4:7], s23 offen offset:1024 lds
    s_add_u32 s23, s28, 73728
    s_add_u32 m0, s24, 10240
    s_nop 0
    buffer_load_dwordx4 v4, s[4:7], s23 offen lds
    buffer_load_dwordx4 v4, s[4:7], s23 offen offset:1024 lds
    s_add_u32 s23, s29, 2048
    s_add_u32 m0, s24, 12288
    s_nop 0
    buffer_load_dwordx4 v4, s[4:7], s23 offen lds
    buffer_load_dwordx4 v4, s[4:7], s23 offen offset:1024 lds
    v_cmp_gt_u32 vcc, 3, v249
    s_cbranch_vccz wcok_30
wc_29:
    buffer_load_dword v249, v248, s[4:7], 0 offen sc1
    s_waitcnt vmcnt(0)
    v_cmp_gt_u32 vcc, 3, v249
    s_cbranch_vccz wcok_30
    s_sleep 4
    s_sub_u32 s13, s13, 1
    s_cbranch_scc0 wc_29
    s_mov_b32 s13, 0
wcok_30:
    s_add_u32 s23, s28, 4096
    buffer_load_dwordx4 a[0:3], v4, s[4:7], s23 offen
    buffer_load_dwordx4 a[4:7], v4, s[4:7], s23 offen offset:1024
    s_add_u32 s23, s28, 18432
    buffer_load_dwordx4 a[48:51], v4, s[4:7], s23 offen
    buffer_load_dwordx4 a[52:55], v4, s[4:7], s23 offen offset:1024
    s_add_u32 s23, s28, 32768
    buffer_load_dwordx4 a[96:99], v4, s[4:7], s23 offen
    buffer_load_dwordx4 a[100:103], v4, s[4:7], s23 offen offset:1024
    s_add_u32 s23, s28, 47104
    buffer_load_dwordx4 a[144:147], v4, s[4:7], s23 offen
    buffer_load_dwordx4 a[148:151], v4, s[4:7], s23 offen offset:1024
    s_add_u32 s23, s28, 61440
    buffer_load_dwordx4 a[192:195], v4, s[4:7], s23 offen
    buffer_load_dwordx4 a[196:199], v4, s[4:7], s23 offen offset:1024
    s_add_u32 s23, s28, 75776
    buffer_load_dwordx4 a[240:243], v4, s[4:7], s23 offen
    buffer_load_dwordx4 a[244:247], v4, s[4:7], s23 offen offset:1024
    s_add_u32 s23, s29, 4096
    buffer_load_dwordx4 v[38:41], v4, s[4:7], s23 offen
    buffer_load_dwordx4 v[42:45], v4, s[4:7], s23 offen offset:1024
    v_cmp_gt_u32 vcc, 4, v249
    s_cbranch_vccz wcok_32
wc_31:
    buffer_load_dword v249, v248, s[4:7], 0 offen sc1
    s_waitcnt vmcnt(0)
    v_cmp_gt_u32 vcc, 4, v249
    s_cbranch_vccz wcok_32
    s_sleep 4
    s_sub_u32 s13, s13, 1
    s_cbranch_scc0 wc_31
    s_mov_b32 s13, 0
wcok_32:
    s_add_u32 s23, s28, 6144
    buffer_load_dwordx4 a[8:11], v4, s[4:7], s23 offen
    buffer_load_dwordx4 a[12:15], v4, s[4:7], s23 offen offset:1024
    s_add_u32 s23, s28, 20480
    buffer_load_dwordx4 a[56:59], v4, s[4:7], s23 offen
    buffer_load_dwordx4 a[60:63], v4, s[4:7], s23 offen offset:1024
    s_add_u32 s23, s28, 34816
    buffer_load_dwordx4 a[104:107], v4, s[4:7], s23 offen
    buffer_load_dwordx4 a[108:111], v4, s[4:7], s23 offen offset:1024
    s_add_u32 s23, s28, 49152
    buffer_load_dwordx4 a[152:155], v4, s[4:7], s23 offen
    buffer_load_dwordx4 a[156:159], v4, s[4:7], s23 offen offset:1024
    s_add_u32 s23, s28, 63488
    buffer_load_dwordx4 a[200:203], v4, s[4:7], s23 offen
    buffer_load_dwordx4 a[204:207], v4, s[4:7], s23 offen offset:1024
    s_add_u32 s23, s28, 77824
    buffer_load_dwordx4 a[248:251], v4, s[4:7], s23 offen
    buffer_load_dwordx4 a[252:255], v4, s[4:7], s23 offen offset:1024
    s_add_u32 s23, s29, 6144
    buffer_load_dwordx4 v[46:49], v4, s[4:7], s23 offen
    buffer_load_dwordx4 v[50:53], v4, s[4:7], s23 offen offset:1024
    v_cmp_gt_u32 vcc, 5, v249
    s_cbranch_vccz wcok_34
wc_33:
    buffer_load_dword v249, v248, s[4:7], 0 offen sc1
    s_waitcnt vmcnt(0)
    v_cmp_gt_u32 vcc, 5, v249
    s_cbranch_vccz wcok_34
    s_sleep 4
    s_sub_u32 s13, s13, 1
    s_cbranch_scc0 wc_33
    s_mov_b32 s13, 0
wcok_34:
    s_add_u32 s23, s28, 8192
    buffer_load_dwordx4 a[16:19], v4, s[4:7], s23 offen
    buffer_load_dwordx4 a[20:23], v4, s[4:7], s23 offen offset:1024
    s_add_u32 s23, s28, 22528
    buffer_load_dwordx4 a[64:67], v4, s[4:7], s23 offen
    buffer_load_dwordx4 a[68:71], v4, s[4:7], s23 offen offset:1024
    s_add_u32 s23, s28, 36864
    buffer_load_dwordx4 a[112:115], v4, s[4:7], s23 offen
    buffer_load_dwordx4 a[116:119], v4, s[4:7], s23 offen offset:1024
    s_add_u32 s23, s28, 51200
    buffer_load_dwordx4 a[160:163], v4, s[4:7], s23 offen
    buffer_load_dwordx4 a[164:167], v4, s[4:7], s23 offen offset:1024
    s_add_u32 s23, s28, 65536
    buffer_load_dwordx4 a[208:211], v4, s[4:7], s23 offen
    buffer_load_dwordx4 a[212:215], v4, s[4:7], s23 offen offset:1024
    s_add_u32 s23, s28, 79872
    buffer_load_dwordx4 v[6:9], v4, s[4:7], s23 offen
    buffer_load_dwordx4 v[10:13], v4, s[4:7], s23 offen offset:1024
    s_add_u32 s23, s29, 8192
    buffer_load_dwordx4 v[54:57], v4, s[4:7], s23 offen
    buffer_load_dwordx4 v[58:61], v4, s[4:7], s23 offen offset:1024
    v_cmp_gt_u32 vcc, 6, v249
    s_cbranch_vccz wcok_36
wc_35:
    buffer_load_dword v249, v248, s[4:7], 0 offen sc1
    s_waitcnt vmcnt(0)
    v_cmp_gt_u32 vcc, 6, v249
    s_cbranch_vccz wcok_36
    s_sleep 4
    s_sub_u32 s13, s13, 1
    s_cbranch_scc0 wc_35
    s_mov_b32 s13, 0
wcok_36:
    s_add_u32 s23, s28, 10240
    buffer_load_dwordx4 a[24:27], v4, s[4:7], s23 offen
    buffer_load_dwordx4 a[28:31], v4, s[4:7], s23 offen offset:1024
    s_add_u32 s23, s28, 24576
    buffer_load_dwordx4 a[72:75], v4, s[4:7], s23 offen
    buffer_load_dwordx4 a[76:79], v4, s[4:7], s23 offen offset:1024
    s_add_u32 s23, s28, 38912
    buffer_load_dwordx4 a[120:123], v4, s[4:7], s23 offen
    buffer_load_dwordx4 a[124:127], v4, s[4:7], s23 offen offset:1024
    s_add_u32 s23, s28, 53248
    buffer_load_dwordx4 a[168:171], v4, s[4:7], s23 offen
    buffer_load_dwordx4 a[172:175], v4, s[4:7], s23 offen offset:1024
    s_add_u32 s23, s28, 67584
    buffer_load_dwordx4 a[216:219], v4, s[4:7], s23 offen
    buffer_load_dwordx4 a[220:223], v4, s[4:7], s23 offen offset:1024
    s_add_u32 s23, s28, 81920
    buffer_load_dwordx4 v[14:17], v4, s[4:7], s23 offen
    buffer_load_dwordx4 v[18:21], v4, s[4:7], s23 offen offset:1024
    s_add_u32 s23, s29, 10240
    buffer_load_dwordx4 v[62:65], v4, s[4:7], s23 offen
    buffer_load_dwordx4 v[66:69], v4, s[4:7], s23 offen offset:1024
    v_cmp_gt_u32 vcc, 7, v249
    s_cbranch_vccz wcok_38
wc_37:
    buffer_load_dword v249, v248, s[4:7], 0 offen sc1
    s_waitcnt vmcnt(0)
    v_cmp_gt_u32 vcc, 7, v249
    s_cbranch_vccz wcok_38
    s_sleep 4
    s_sub_u32 s13, s13, 1
    s_cbranch_scc0 wc_37
    s_mov_b32 s13, 0
wcok_38:
    s_add_u32 s23, s28, 12288
    buffer_load_dwordx4 a[32:35], v4, s[4:7], s23 offen
    buffer_load_dwordx4 a[36:39], v4, s[4:7], s23 offen offset:1024
    s_add_u32 s23, s28, 26624
    buffer_load_dwordx4 a[80:83], v4, s[4:7], s23 offen
    buffer_load_dwordx4 a[84:87], v4, s[4:7], s23 offen offset:1024
    s_add_u32 s23, s28, 40960
    buffer_load_dwordx4 a[128:131], v4, s[4:7], s23 offen
    buffer_load_dwordx4 a[132:135], v4, s[4:7], s23 offen offset:1024
    s_add_u32 s23, s28, 55296
    buffer_load_dwordx4 a[176:179], v4, s[4:7], s23 offen
    buffer_load_dwordx4 a[180:183], v4, s[4:7], s23 offen offset:1024
    s_add_u32 s23, s28, 69632
    buffer_load_dwordx4 a[224:227], v4, s[4:7], s23 offen
    buffer_load_dwordx4 a[228:231], v4, s[4:7], s23 offen offset:1024
    s_add_u32 s23, s28, 83968
    buffer_load_dwordx4 v[22:25], v4, s[4:7], s23 offen
    buffer_load_dwordx4 v[26:29], v4, s[4:7], s23 offen offset:1024
    s_add_u32 s23, s29, 12288
    buffer_load_dwordx4 v[70:73], v4, s[4:7], s23 offen
    buffer_load_dwordx4 v[74:77], v4, s[4:7], s23 offen offset:1024
    s_branch pwout_6
pw_9:
    v_cmp_gt_u32 vcc, 1, v249
    s_cbranch_vccz wcok_40
wc_39:
    buffer_load_dword v249, v248, s[4:7], 0 offen sc1
    s_waitcnt vmcnt(0)
    v_cmp_gt_u32 vcc, 1, v249
    s_cbranch_vccz wcok_40
    s_sleep 4
    s_sub_u32 s13, s13, 1
    s_cbranch_scc0 wc_39
    s_mov_b32 s13, 0
wcok_40:
    s_add_u32 s23, s28, 0
    buffer_load_dwordx4 a[24:27], v4, s[4:7], s23 offen
    buffer_load_dwordx4 a[28:31], v4, s[4:7], s23 offen offset:1024
    s_add_u32 s23, s28, 14336
    buffer_load_dwordx4 a[72:75], v4, s[4:7], s23 offen
    buffer_load_dwordx4 a[76:79], v4, s[4:7], s23 offen offset:1024
    s_add_u32 s23, s28, 28672
    buffer_load_dwordx4 a[120:123], v4, s[4:7], s23 offen
    buffer_load_dwordx4 a[124:127], v4, s[4:7], s23 offen offset:1024
    s_add_u32 s23, s28, 43008
    buffer_load_dwordx4 a[168:171], v4, s[4:7], s23 offen
    buffer_load_dwordx4 a[172:175], v4, s[4:7], s23 offen offset:1024
    s_add_u32 s23, s28, 57344
    buffer_load_dwordx4 a[216:219], v4, s[4:7], s23 offen
    buffer_load_dwordx4 a[220:223], v4, s[4:7], s23 offen offset:1024
    s_add_u32 s23, s28, 71680
    buffer_load_dwordx4 v[14:17], v4, s[4:7], s23 offen
    buffer_load_dwordx4 v[18:21], v4, s[4:7], s23 offen offset:1024
    s_add_u32 s23, s29, 0
    buffer_load_dwordx4 v[62:65], v4, s[4:7], s23 offen
    buffer_load_dwordx4 v[66:69], v4, s[4:7], s23 offen offset:1024
    v_cmp_gt_u32 vcc, 2, v249
    s_cbranch_vccz wcok_42
wc_41:
    buffer_load_dword v249, v248, s[4:7], 0 offen sc1
    s_waitcnt vmcnt(0)
    v_cmp_gt_u32 vcc, 2, v249
    s_cbranch_vccz wcok_42
    s_sleep 4
    s_sub_u32 s13, s13, 1
    s_cbranch_scc0 wc_41
    s_mov_b32 s13, 0
wcok_42:
    s_add_u32 s23, s28, 2048
    buffer_load_dwordx4 a[32:35], v4, s[4:7], s23 offen
    buffer_load_dwordx4 a[36:39], v4, s[4:7], s23 offen offset:1024
    s_add_u32 s23, s28, 16384
    buffer_load_dwordx4 a[80:83], v4, s[4:7], s23 offen
    buffer_load_dwordx4 a[84:87], v4, s[4:7], s23 offen offset:1024
    s_add_u32 s23, s28, 30720
    buffer_load_dwordx4 a[128:131], v4, s[4:7], s23 offen
    buffer_load_dwordx4 a[132:135], v4, s[4:7], s23 offen offset:1024
    s_add_u32 s23, s28, 45056
    buffer_load_dwordx4 a[176:179], v4, s[4:7], s23 offen
    buffer_load_dwordx4 a[180:183], v4, s[4:7], s23 offen offset:1024
    s_add_u32 s23, s28, 59392
    buffer_load_dwordx4 a[224:227], v4, s[4:7], s23 offen
    buffer_load_dwordx4 a[228:231], v4, s[4:7], s23 offen offset:1024
    s_add_u32 s23, s28, 73728
    buffer_load_dwordx4 v[22:25], v4, s[4:7], s23 offen
    buffer_load_dwordx4 v[26:29], v4, s[4:7], s23 offen offset:1024
    s_add_u32 s23, s29, 2048
    buffer_load_dwordx4 v[70:73], v4, s[4:7], s23 offen
    buffer_load_dwordx4 v[74:77], v4, s[4:7], s23 offen offset:1024
    v_cmp_gt_u32 vcc, 3, v249
    s_cbranch_vccz wcok_44
wc_43:
    buffer_load_dword v249, v248, s[4:7], 0 offen sc1
    s_waitcnt vmcnt(0)
    v_cmp_gt_u32 vcc, 3, v249
    s_cbranch_vccz wcok_44
    s_sleep 4
    s_sub_u32 s13, s13, 1
    s_cbranch_scc0 wc_43
    s_mov_b32 s13, 0
wcok_44:
    s_add_u32 s23, s28, 4096
    buffer_load_dwordx4 a[40:43], v4, s[4:7], s23 offen
    buffer_load_dwordx4 a[44:47], v4, s[4:7], s23 offen offset:1024
    s_add_u32 s23, s28, 18432
    buffer_load_dwordx4 a[88:91], v4, s[4:7], s23 offen
    buffer_load_dwordx4 a[92:95], v4, s[4:7], s23 offen offset:1024
    s_add_u32 s23, s28, 32768
    buffer_load_dwordx4 a[136:139], v4, s[4:7], s23 offen
    buffer_load_dwordx4 a[140:143], v4, s[4:7], s23 offen offset:1024
    s_add_u32 s23, s28, 47104
    buffer_load_dwordx4 a[184:187], v4, s[4:7], s23 offen
    buffer_load_dwordx4 a[188:191], v4, s[4:7], s23 offen offset:1024
    s_add_u32 s23, s28, 61440
    buffer_load_dwordx4 a[232:235], v4, s[4:7], s23 offen
    buffer_load_dwordx4 a[236:239], v4, s[4:7], s23 offen offset:1024
    s_add_u32 s23, s28, 75776
    buffer_load_dwordx4 v[30:33], v4, s[4:7], s23 offen
    buffer_load_dwordx4 v[34:37], v4, s[4:7], s23 offen offset:1024
    s_add_u32 s23, s29, 4096
    buffer_load_dwordx4 v[78:81], v4, s[4:7], s23 offen
    buffer_load_dwordx4 v[82:85], v4, s[4:7], s23 offen offset:1024
    v_cmp_gt_u32 vcc, 4, v249
    s_cbranch_vccz wcok_46
wc_45:
    buffer_load_dword v249, v248, s[4:7], 0 offen sc1
    s_waitcnt vmcnt(0)
    v_cmp_gt_u32 vcc, 4, v249
    s_cbranch_vccz wcok_46
    s_sleep 4
    s_sub_u32 s13, s13, 1
    s_cbranch_scc0 wc_45
    s_mov_b32 s13, 0
wcok_46:
    s_add_u32 s23, s28, 6144
    s_add_u32 m0, s24, 0
    s_nop 0
    buffer_load_dwordx4 v4, s[4:7], s23 offen lds
    buffer_load_dwordx4 v4, s[4:7], s23 offen offset:1024 lds
    s_add_u32 s23, s28, 20480
    s_add_u32 m0, s24, 2048
    s_nop 0
    buffer_load_dwordx4 v4, s[4:7], s23 offen lds
    buffer_load_dwordx4 v4, s[4:7], s23 offen offset:1024 lds
    s_add_u32 s23, s28, 34816
    s_add_u32 m0, s24, 4096
    s_nop 0
    buffer_load_dwordx4 v4, s[4:7], s23 offen lds
    buffer_load_dwordx4 v4, s[4:7], s23 offen offset:1024 lds
    s_add_u32 s23, s28, 49152
    s_add_u32 m0, s24, 6144
    s_nop 0
    buffer_load_dwordx4 v4, s[4:7], s23 offen lds
    buffer_load_dwordx4 v4, s[4:7], s23 offen offset:1024 lds
    s_add_u32 s23, s28, 63488
    s_add_u32 m0, s24, 8192
    s_nop 0
    buffer_load_dwordx4 v4, s[4:7], s23 offen lds
    buffer_load_dwordx4 v4, s[4:7], s23 offen offset:1024 lds
    s_add_u32 s23, s28, 77824
    s_add_u32 m0, s24, 10240
    s_nop 0
    buffer_load_dwordx4 v4, s[4:7], s23 offen lds
    buffer_load_dwordx4 v4, s[4:7], s23 offen offset:1024 lds
    s_add_u32 s23, s29, 6144
    s_add_u32 m0, s24, 12288
    s_nop 0
    buffer_load_dwordx4 v4, s[4:7], s23 offen lds
    buffer_load_dwordx4 v4, s[4:7], s23 offen offset:1024 lds
    v_cmp_gt_u32 vcc, 5, v249
    s_cbranch_vccz wcok_48
wc_47:
    buffer_load_dword v249, v248, s[4:7], 0 offen sc1
    s_waitcnt vmcnt(0)
    v_cmp_gt_u32 vcc, 5, v249
    s_cbranch_vccz wcok_48
    s_sleep 4
    s_sub_u32 s13, s13, 1
    s_cbranch_scc0 wc_47
    s_mov_b32 s13, 0
wcok_48:
    s_add_u32 s23, s28, 8192
    buffer_load_dwordx4 a[0:3], v4, s[4:7], s23 offen
    buffer_load_dwordx4 a[4:7], v4, s[4:7], s23 offen offset:1024
    s_add_u32 s23, s28, 22528
    buffer_load_dwordx4 a[48:51], v4, s[4:7], s23 offen
    buffer_load_dwordx4 a[52:55], v4, s[4:7], s23 offen offset:1024
    s_add_u32 s23, s28, 36864
    buffer_load_dwordx4 a[96:99], v4, s[4:7], s23 offen
    buffer_load_dwordx4 a[100:103], v4, s[4:7], s23 offen offset:1024
    s_add_u32 s23, s28, 51200
    buffer_load_dwordx4 a[144:147], v4, s[4:7], s23 offen
    buffer_load_dwordx4 a[148:151], v4, s[4:7], s23 offen offset:1024
    s_add_u32 s23, s28, 65536
    buffer_load_dwordx4 a[192:195], v4, s[4:7], s23 offen
    buffer_load_dwordx4 a[196:199], v4, s[4:7], s23 offen offset:1024
    s_add_u32 s23, s28, 79872
    buffer_load_dwordx4 a[240:243], v4, s[4:7], s23 offen
    buffer_load_dwordx4 a[244:247], v4, s[4:7], s23 offen offset:1024
    s_add_u32 s23, s29, 8192
    buffer_load_dwordx4 v[38:41], v4, s[4:7], s23 offen
    buffer_load_dwordx4 v[42:45], v4, s[4:7], s23 offen offset:1024
    v_cmp_gt_u32 vcc, 6, v249
    s_cbranch_vccz wcok_50
wc_49:
    buffer_load_dword v249, v248, s[4:7], 0 offen sc1
    s_waitcnt vmcnt(0)
    v_cmp_gt_u32 vcc, 6, v249
    s_cbranch_vccz wcok_50
    s_sleep 4
    s_sub_u32 s13, s13, 1
    s_cbranch_scc0 wc_49
    s_mov_b32 s13, 0
wcok_50:
    s_add_u32 s23, s28, 10240
    buffer_load_dwordx4 a[8:11], v4, s[4:7], s23 offen
    buffer_load_dwordx4 a[12:15], v4, s[4:7], s23 offen offset:1024
    s_add_u32 s23, s28, 24576
    buffer_load_dwordx4 a[56:59], v4, s[4:7], s23 offen
    buffer_load_dwordx4 a[60:63], v4, s[4:7], s23 offen offset:1024
    s_add_u32 s23, s28, 38912
    buffer_load_dwordx4 a[104:107], v4, s[4:7], s23 offen
    buffer_load_dwordx4 a[108:111], v4, s[4:7], s23 offen offset:1024
    s_add_u32 s23, s28, 53248
    buffer_load_dwordx4 a[152:155], v4, s[4:7], s23 offen
    buffer_load_dwordx4 a[156:159], v4, s[4:7], s23 offen offset:1024
    s_add_u32 s23, s28, 67584
    buffer_load_dwordx4 a[200:203], v4, s[4:7], s23 offen
    buffer_load_dwordx4 a[204:207], v4, s[4:7], s23 offen offset:1024
    s_add_u32 s23, s28, 81920
    buffer_load_dwordx4 a[248:251], v4, s[4:7], s23 offen
    buffer_load_dwordx4 a[252:255], v4, s[4:7], s23 offen offset:1024
    s_add_u32 s23, s29, 10240
    buffer_load_dwordx4 v[46:49], v4, s[4:7], s23 offen
    buffer_load_dwordx4 v[50:53], v4, s[4:7], s23 offen offset:1024
    v_cmp_gt_u32 vcc, 7, v249
    s_cbranch_vccz wcok_52
wc_51:
    buffer_load_dword v249, v248, s[4:7], 0 offen sc1
    s_waitcnt vmcnt(0)
    v_cmp_gt_u32 vcc, 7, v249
    s_cbranch_vccz wcok_52
    s_sleep 4
    s_sub_u32 s13, s13, 1
    s_cbranch_scc0 wc_51
    s_mov_b32 s13, 0
wcok_52:
    s_add_u32 s23, s28, 12288
    buffer_load_dwordx4 a[16:19], v4, s[4:7], s23 offen
    buffer_load_dwordx4 a[20:23], v4, s[4:7], s23 offen offset:1024
    s_add_u32 s23, s28, 26624
    buffer_load_dwordx4 a[64:67], v4, s[4:7], s23 offen
    buffer_load_dwordx4 a[68:71], v4, s[4:7], s23 offen offset:1024
    s_add_u32 s23, s28, 40960
    buffer_load_dwordx4 a[112:115], v4, s[4:7], s23 offen
    buffer_load_dwordx4 a[116:119], v4, s[4:7], s23 offen offset:1024
    s_add_u32 s23, s28, 55296
    buffer_load_dwordx4 a[160:163], v4, s[4:7], s23 offen
    buffer_load_dwordx4 a[164:167], v4, s[4:7], s23 offen offset:1024
    s_add_u32 s23, s28, 69632
    buffer_load_dwordx4 a[208:211], v4, s[4:7], s23 offen
    buffer_load_dwordx4 a[212:215], v4, s[4:7], s23 offen offset:1024
    s_add_u32 s23, s28, 83968
    buffer_load_dwordx4 v[6:9], v4, s[4:7], s23 offen
    buffer_load_dwordx4 v[10:13], v4, s[4:7], s23 offen offset:1024
    s_add_u32 s23, s29, 12288
    buffer_load_dwordx4 v[54:57], v4, s[4:7], s23 offen
    buffer_load_dwordx4 v[58:61], v4, s[4:7], s23 offen offset:1024
    s_branch pwout_6
pw_10:
    v_cmp_gt_u32 vcc, 1, v249
    s_cbranch_vccz wcok_54
wc_53:
    buffer_load_dword v249, v248, s[4:7], 0 offen sc1
    s_waitcnt vmcnt(0)
    v_cmp_gt_u32 vcc, 1, v249
    s_cbranch_vccz wcok_54
    s_sleep 4
    s_sub_u32 s13, s13, 1
    s_cbranch_scc0 wc_53
    s_mov_b32 s13, 0
wcok_54:
    s_add_u32 s23, s28, 0
    buffer_load_dwordx4 a[8:11], v4, s[4:7], s23 offen
    buffer_load_dwordx4 a[12:15], v4, s[4:7], s23 offen offset:1024
    s_add_u32 s23, s28, 14336
    buffer_load_dwordx4 a[56:59], v4, s[4:7], s23 offen
    buffer_load_dwordx4 a[60:63], v4, s[4:7], s23 offen offset:1024
    s_add_u32 s23, s28, 28672
    buffer_load_dwordx4 a[104:107], v4, s[4:7], s23 offen
    buffer_load_dwordx4 a[108:111], v4, s[4:7], s23 offen offset:1024
    s_add_u32 s23, s28, 43008
    buffer_load_dwordx4 a[152:155], v4, s[4:7], s23 offen
    buffer_load_dwordx4 a[156:159], v4, s[4:7], s23 offen offset:1024
    s_add_u32 s23, s28, 57344
    buffer_load_dwordx4 a[200:203], v4, s[4:7], s23 offen
    buffer_load_dwordx4 a[204:207], v4, s[4:7], s23 offen offset:1024
    s_add_u32 s23, s28, 71680
    buffer_load_dwordx4 a[248:251], v4, s[4:7], s23 offen
    buffer_load_dwordx4 a[252:255], v4, s[4:7], s23 offen offset:1024
    s_add_u32 s23, s29, 0
    buffer_load_dwordx4 v[46:49], v4, s[4:7], s23 offen
    buffer_load_dwordx4 v[50:53], v4, s[4:7], s23 offen offset:1024
    v_cmp_gt_u32 vcc, 2, v249
    s_cbranch_vccz wcok_56
wc_55:
    buffer_load_dword v249, v248, s[4:7], 0 offen sc1
    s_waitcnt vmcnt(0)
    v_cmp_gt_u32 vcc, 2, v249
    s_cbranch_vccz wcok_56
    s_sleep 4
    s_sub_u32 s13, s13, 1
    s_cbranch_scc0 wc_55
    s_mov_b32 s13, 0
wcok_56:
    s_add_u32 s23, s28, 2048
    buffer_load_dwordx4 a[16:19], v4, s[4:7], s23 offen
    buffer_load_dwordx4 a[20:23], v4, s[4:7], s23 offen offset:1024
    s_add_u32 s23, s28, 16384
    buffer_load_dwordx4 a[64:67], v4, s[4:7], s23 offen
    buffer_load_dwordx4 a[68:71], v4, s[4:7], s23 offen offset:1024
    s_add_u32 s23, s28, 30720
    buffer_load_dwordx4 a[112:115], v4, s[4:7], s23 offen
    buffer_load_dwordx4 a[116:119], v4, s[4:7], s23 offen offset:1024
    s_add_u32 s23, s28, 45056
    buffer_load_dwordx4 a[160:163], v4, s[4:7], s23 offen
    buffer_load_dwordx4 a[164:167], v4, s[4:7], s23 offen offset:1024
    s_add_u32 s23, s28, 59392
    buffer_load_dwordx4 a[208:211], v4, s[4:7], s23 offen
    buffer_load_dwordx4 a[212:215], v4, s[4:7], s23 offen offset:1024
    s_add_u32 s23, s28, 73728
    buffer_load_dwordx4 v[6:9], v4, s[4:7], s23 offen
    buffer_load_dwordx4 v[10:13], v4, s[4:7], s23 offen offset:1024
    s_add_u32 s23, s29, 2048
    buffer_load_dwordx4 v[54:57], v4, s[4:7], s23 offen
    buffer_load_dwordx4 v[58:61], v4, s[4:7], s23 offen offset:1024
    v_cmp_gt_u32 vcc, 3, v249
    s_cbranch_vccz wcok_58
wc_57:
    buffer_load_dword v249, v248, s[4:7], 0 offen sc1
    s_waitcnt vmcnt(0)
    v_cmp_gt_u32 vcc, 3, v249
    s_cbranch_vccz wcok_58
    s_sleep 4
    s_sub_u32 s13, s13, 1
    s_cbranch_scc0 wc_57
    s_mov_b32 s13, 0
wcok_58:
    s_add_u32 s23, s28, 4096
    buffer_load_dwordx4 a[24:27], v4, s[4:7], s23 offen
    buffer_load_dwordx4 a[28:31], v4, s[4:7], s23 offen offset:1024
    s_add_u32 s23, s28, 18432
    buffer_load_dwordx4 a[72:75], v4, s[4:7], s23 offen
    buffer_load_dwordx4 a[76:79], v4, s[4:7], s23 offen offset:1024
    s_add_u32 s23, s28, 32768
    buffer_load_dwordx4 a[120:123], v4, s[4:7], s23 offen
    buffer_load_dwordx4 a[124:127], v4, s[4:7], s23 offen offset:1024
    s_add_u32 s23, s28, 47104
    buffer_load_dwordx4 a[168:171], v4, s[4:7], s23 offen
    buffer_load_dwordx4 a[172:175], v4, s[4:7], s23 offen offset:1024
    s_add_u32 s23, s28, 61440
    buffer_load_dwordx4 a[216:219], v4, s[4:7], s23 offen
    buffer_load_dwordx4 a[220:223], v4, s[4:7], s23 offen offset:1024
    s_add_u32 s23, s28, 75776
    buffer_load_dwordx4 v[14:17], v4, s[4:7], s23 offen
    buffer_load_dwordx4 v[18:21], v4, s[4:7], s23 offen offset:1024
    s_add_u32 s23, s29, 4096
    buffer_load_dwordx4 v[62:65], v4, s[4:7], s23 offen
    buffer_load_dwordx4 v[66:69], v4, s[4:7], s23 offen offset:1024
    v_cmp_gt_u32 vcc, 4, v249
    s_cbranch_vccz wcok_60
wc_59:
    buffer_load_dword v249, v248, s[4:7], 0 offen sc1
    s_waitcnt vmcnt(0)
    v_cmp_gt_u32 vcc, 4, v249
    s_cbranch_vccz wcok_60
    s_sleep 4
    s_sub_u32 s13, s13, 1
    s_cbranch_scc0 wc_59
    s_mov_b32 s13, 0
wcok_60:
    s_add_u32 s23, s28, 6144
    buffer_load_dwordx4 a[32:35], v4, s[4:7], s23 offen
    buffer_load_dwordx4 a[36:39], v4, s[4:7], s23 offen offset:1024
    s_add_u32 s23, s28, 20480
    buffer_load_dwordx4 a[80:83], v4, s[4:7], s23 offen
    buffer_load_dwordx4 a[84:87], v4, s[4:7], s23 offen offset:1024
    s_add_u32 s23, s28, 34816
    buffer_load_dwordx4 a[128:131], v4, s[4:7], s23 offen
    buffer_load_dwordx4 a[132:135], v4, s[4:7], s23 offen offset:1024
    s_add_u32 s23, s28, 49152
    buffer_load_dwordx4 a[176:179], v4, s[4:7], s23 offen
    buffer_load_dwordx4 a[180:183], v4, s[4:7], s23 offen offset:1024
    s_add_u32 s23, s28, 63488
    buffer_load_dwordx4 a[224:227], v4, s[4:7], s23 offen
    buffer_load_dwordx4 a[228:231], v4, s[4:7], s23 offen offset:1024
    s_add_u32 s23, s28, 77824
    buffer_load_dwordx4 v[22:25], v4, s[4:7], s23 offen
    buffer_load_dwordx4 v[26:29], v4, s[4:7], s23 offen offset:1024
    s_add_u32 s23, s29, 6144
    buffer_load_dwordx4 v[70:73], v4, s[4:7], s23 offen
    buffer_load_dwordx4 v[74:77], v4, s[4:7], s23 offen offset:1024
    v_cmp_gt_u32 vcc, 5, v249
    s_cbranch_vccz wcok_62
wc_61:
    buffer_load_dword v249, v248, s[4:7], 0 offen sc1
    s_waitcnt vmcnt(0)
    v_cmp_gt_u32 vcc, 5, v249
    s_cbranch_vccz wcok_62
    s_sleep 4
    s_sub_u32 s13, s13, 1
    s_cbranch_scc0 wc_61
    s_mov_b32 s13, 0
wcok_62:
    s_add_u32 s23, s28, 8192
    buffer_load_dwordx4 a[40:43], v4, s[4:7], s23 offen
    buffer_load_dwordx4 a[44:47], v4, s[4:7], s23 offen offset:1024
    s_add_u32 s23, s28, 22528
    buffer_load_dwordx4 a[88:91], v4, s[4:7], s23 offen
    buffer_load_dwordx4 a[92:95], v4, s[4:7], s23 offen offset:1024
    s_add_u32 s23, s28, 36864
    buffer_load_dwordx4 a[136:139], v4, s[4:7], s23 offen
    buffer_load_dwordx4 a[140:143], v4, s[4:7], s23 offen offset:1024
    s_add_u32 s23, s28, 51200
    buffer_load_dwordx4 a[184:187], v4, s[4:7], s23 offen
    buffer_load_dwordx4 a[188:191], v4, s[4:7], s23 offen offset:1024
    s_add_u32 s23, s28, 65536
    buffer_load_dwordx4 a[232:235], v4, s[4:7], s23 offen
    buffer_load_dwordx4 a[236:239], v4, s[4:7], s23 offen offset:1024
    s_add_u32 s23, s28, 79872
    buffer_load_dwordx4 v[30:33], v4, s[4:7], s23 offen
    buffer_load_dwordx4 v[34:37], v4, s[4:7], s23 offen offset:1024
    s_add_u32 s23, s29, 8192
    buffer_load_dwordx4 v[78:81], v4, s[4:7], s23 offen
    buffer_load_dwordx4 v[82:85], v4, s[4:7], s23 offen offset:1024
    v_cmp_gt_u32 vcc, 6, v249
    s_cbranch_vccz wcok_64
wc_63:
    buffer_load_dword v249, v248, s[4:7], 0 offen sc1
    s_waitcnt vmcnt(0)
    v_cmp_gt_u32 vcc, 6, v249
    s_cbranch_vccz wcok_64
    s_sleep 4
    s_sub_u32 s13, s13, 1
    s_cbranch_scc0 wc_63
    s_mov_b32 s13, 0
wcok_64:
    s_add_u32 s23, s28, 10240
    s_add_u32 m0, s24, 0
    s_nop 0
    buffer_load_dwordx4 v4, s[4:7], s23 offen lds
    buffer_load_dwordx4 v4, s[4:7], s23 offen offset:1024 lds
    s_add_u32 s23, s28, 24576
    s_add_u32 m0, s24, 2048
    s_nop 0
    buffer_load_dwordx4 v4, s[4:7], s23 offen lds
    buffer_load_dwordx4 v4, s[4:7], s23 offen offset:1024 lds
    s_add_u32 s23, s28, 38912
    s_add_u32 m0, s24, 4096
    s_nop 0
    buffer_load_dwordx4 v4, s[4:7], s23 offen lds
    buffer_load_dwordx4 v4, s[4:7], s23 offen offset:1024 lds
    s_add_u32 s23, s28, 53248
    s_add_u32 m0, s24, 6144
    s_nop 0
    buffer_load_dwordx4 v4, s[4:7], s23 offen lds
    buffer_load_dwordx4 v4, s[4:7], s23 offen offset:1024 lds
    s_add_u32 s23, s28, 67584
    s_add_u32 m0, s24, 8192
    s_nop 0
    buffer_load_dwordx4 v4, s[4:7], s23 offen lds
    buffer_load_dwordx4 v4, s[4:7], s23 offen offset:1024 lds
    s_add_u32 s23, s28, 81920
    s_add_u32 m0, s24, 10240
    s_nop 0
    buffer_load_dwordx4 v4, s[4:7], s23 offen lds
    buffer_load_dwordx4 v4, s[4:7], s23 offen offset:1024 lds
    s_add_u32 s23, s29, 10240
    s_add_u32 m0, s24, 12288
    s_nop 0
    buffer_load_dwordx4 v4, s[4:7], s23 offen lds
    buffer_load_dwordx4 v4, s[4:7], s23 offen offset:1024 lds
    v_cmp_gt_u32 vcc, 7, v249
    s_cbranch_vccz wcok_66
wc_65:
    buffer_load_dword v249, v248, s[4:7], 0 offen sc1
    s_waitcnt vmcnt(0)
    v_cmp_gt_u32 vcc, 7, v249
    s_cbranch_vccz wcok_66
    s_sleep 4
    s_sub_u32 s13, s13, 1
    s_cbranch_scc0 wc_65
    s_mov_b32 s13, 0
wcok_66:
    s_add_u32 s23, s28, 12288
    buffer_load_dwordx4 a[0:3], v4, s[4:7], s23 offen
    buffer_load_dwordx4 a[4:7], v4, s[4:7], s23 offen offset:1024
    s_add_u32 s23, s28, 26624
    buffer_load_dwordx4 a[48:51], v4, s[4:7], s23 offen
    buffer_load_dwordx4 a[52:55], v4, s[4:7], s23 offen offset:1024
    s_add_u32 s23, s28, 40960
    buffer_load_dwordx4 a[96:99], v4, s[4:7], s23 offen
    buffer_load_dwordx4 a[100:103], v4, s[4:7], s23 offen offset:1024
    s_add_u32 s23, s28, 55296
    buffer_load_dwordx4 a[144:147], v4, s[4:7], s23 offen
    buffer_load_dwordx4 a[148:151], v4, s[4:7], s23 offen offset:1024
    s_add_u32 s23, s28, 69632
    buffer_load_dwordx4 a[192:195], v4, s[4:7], s23 offen
    buffer_load_dwordx4 a[196:199], v4, s[4:7], s23 offen offset:1024
    s_add_u32 s23, s28, 83968
    buffer_load_dwordx4 a[240:243], v4, s[4:7], s23 offen
    buffer_load_dwordx4 a[244:247], v4, s[4:7], s23 offen offset:1024
    s_add_u32 s23, s29, 12288
    buffer_load_dwordx4 v[38:41], v4, s[4:7], s23 offen
    buffer_load_dwordx4 v[42:45], v4, s[4:7], s23 offen offset:1024
pwout_6:
    s_add_u32 s18, s18, 131072
    s_add_u32 s19, s19, 131072
    s_add_u32 s20, s20, 131072
    s_add_u32 s21, s21, 131072
    s_add_u32 s22, s22, 131072
    v_mov_b32 v86, 0x4444
    v_mov_b32 v87, 0xeeee
    v_and_b32 v88, 1, v2
    v_cmp_eq_u32 vcc, 0, v88
    s_nop 1
    v_cndmask_b32 v86, v87, v86, vcc
    s_lshl_b32 s30, s10, 11
    v_add_u32 v87, s30, v4
    v_add_u32 v89, 131072, v87
    s_cmp_eq_u32 s10, 3
    s_cselect_b32 s30, -6, 1
    s_lshl_b32 s30, s30, 10
    v_add_u32 v88, s30, v87
    s_lshl_b32 s30, s8, 7
    s_add_u32 s30, s30, 172032
    v_and_b32 v103, 1, v1
    v_lshl_add_u32 v103, v103, 2, s30
    v_mov_b32 v104, 0
    s_lshl_b32 s30, s8, 13
    s_add_u32 s30, s30, 139264
    s_lshr_b32 s31, s2, 3
    s_lshr_b32 s31, s31, 5
    s_lshl_b32 s31, s31, 8
    s_add_u32 s31, s31, s30
    v_min_u32 v105, 55, v1
    v_lshl_add_u32 v105, v105, 2, s31
    s_cmp_eq_u32 s10, 0
    s_cselect_b32 s31, 0, 1073741824
    v_or_b32 v105, s31, v105
    s_lshl_b32 s30, s8, 13
    s_add_u32 s30, s30, 155648
    s_lshl_b32 s31, s9, 2
    s_add_u32 s31, s31, s30
    s_add_u32 s31, s31, 0
    v_lshl_add_u32 v106, v1, 8, s31
    v_mov_b32 v107, 1073741824
    v_cmp_gt_u32 vcc, 1, v0
    s_nop 1
    v_cndmask_b32 v106, v107, v106, vcc
    v_add_u32 v90, s24, v4
    s_lshl_b32 s30, s10, 13
    s_add_u32 s30, s30, 65536
    v_add_u32 v95, s30, v4
    s_lshl_b32 s23, s27, 3
    v_add_u32 v96, s23, v95
    v_and_b32 v110, 7, v2
    v_lshrrev_b32 v112, 1, v3
    v_lshl_add_u32 v110, v112, 3, v110
    v_lshlrev_b32 v110, 5, v110
    v_and_b32 v112, 1, v3
    v_lshl_add_u32 v110, v112, 3, v110
    s_add_u32 s23, s25, 0
    s_lshl_b32 s23, s23, 9
    s_add_u32 s23, s23, 131072
    v_add_u32 v97, s23, v110
    s_add_u32 s23, s25, 1
    s_lshl_b32 s23, s23, 9
    s_add_u32 s23, s23, 131072
    v_add_u32 v98, s23, v110
    s_add_u32 s23, s25, 2
    s_lshl_b32 s23, s23, 9
    s_add_u32 s23, s23, 131072
    v_add_u32 v99, s23, v110
    s_mov_b32 s23, s26
    s_lshl_b32 s23, s23, 9
    s_add_u32 s23, s23, 131072
    s_lshl_b32 s28, s27, 2
    s_add_u32 s23, s23, s28
    v_add_u32 v100, s23, v110
    v_mov_b32 v111, 1073741824
    v_lshlrev_b32 v112, 1, v3
    v_sub_u32 v110, v2, v112
    v_mov_b32 v112, 0x3f80
    v_mov_b32 v113, 0x3f800000
    v_mov_b32 v108, 0
    v_cmp_eq_u32 vcc, 0, v110
    s_nop 1
    v_cndmask_b32 v108, v108, v112, vcc
    v_cmp_eq_u32 vcc, 1, v110
    s_nop 1
    v_cndmask_b32 v108, v108, v113, vcc
    v_mov_b32 v109, 0
    v_cmp_eq_u32 vcc, 8, v110
    s_nop 1
    v_cndmask_b32 v109, v109, v112, vcc
    v_cmp_eq_u32 vcc, 9, v110
    s_nop 1
    v_cndmask_b32 v109, v109, v113, vcc
    s_mul_i32 s23, s10, 1664
    s_add_u32 s23, s23, 57344
    v_and_b32 v110, 7, v2
    v_mul_u32_u24 v110, 208, v110
    v_lshl_add_u32 v110, v3, 4, v110
    v_add_u32 v91, s23, v110
    v_add_u32 v110, 81920, v91
    v_cmp_gt_u32 vcc, 8, v2
    s_nop 1
    v_cndmask_b32 v91, v110, v91, vcc
    v_and_b32 v112, 31, v1
    v_lshrrev_b32 v113, 5, v1
    s_lshl_b32 s23, s10, 1
    v_add_u32 v113, s23, v113
    v_and_b32 v114, 1, v112
    v_lshlrev_b32 v114, 3, v114
    v_bfe_u32 v115, v112, 3, 1
    v_lshl_add_u32 v114, v115, 2, v114
    v_and_b32 v115, 2, v112
    v_add_u32 v114, v114, v115
    v_bfe_u32 v115, v112, 2, 1
    v_add_u32 v114, v114, v115
    v_cmp_gt_u32 vcc, 16, v112
    s_nop 1
    v_cndmask_b32 v114, v112, v114, vcc
    v_mul_u32_u24 v110, 208, v113
    v_lshl_add_u32 v110, v114, 3, v110
    v_add_u32 v92, 57344, v110
    v_and_b32 v94, 1, v1
    v_lshlrev_b32 v94, 8, v94
    v_bfe_u32 v114, v112, 3, 1
    s_and_b32 s23, s9, 1
    s_lshl_b32 s23, s23, 1
    v_add_u32 v114, s23, v114
    v_lshl_add_u32 v114, v114, 3, v113
    v_bfe_u32 v115, v112, 2, 1
    v_lshl_add_u32 v114, v114, 1, v115
    v_lshlrev_b32 v114, 4, v114
    v_and_b32 v115, 3, v112
    v_lshl_add_u32 v114, v115, 2, v114
    s_bfe_u32 s28, s9, 0x10001
    s_lshl_b32 s29, s28, 10
    v_add_u32 v114, s29, v114
    v_lshl_add_u32 v115, v115, 3, v113
    v_lshlrev_b32 v115, 4, v115
    s_and_b32 s28, s9, 3
    s_lshl_b32 s28, s28, 2
    s_add_u32 s28, s28, 2048
    v_add_u32 v115, s28, v115
    v_cmp_gt_u32 vcc, 16, v112
    s_nop 1
    v_cndmask_b32 v93, v115, v114, vcc
    v_cmp_gt_u32 vcc, 20, v112
    s_nop 1
    v_cndmask_b32 v93, v111, v93, vcc
    s_lshl_b32 s23, s10, 1
    s_add_u32 s23, s23, 0
    s_cmp_eq_u32 s23, s9
    s_cselect_b32 s23, 0, 1073741824
    s_cmp_eq_u32 s9, 7
    s_cselect_b32 s23, 1073741824, s23
    v_add_u32 v101, s23, v87
    s_lshl_b32 s23, s10, 1
    s_add_u32 s23, s23, 1
    s_cmp_eq_u32 s23, s9
    s_cselect_b32 s23, 1024, 1073741824
    s_cmp_eq_u32 s9, 7
    s_cselect_b32 s23, 1073741824, s23
    v_add_u32 v102, s23, v87
    s_mov_b32 s32, 0x000fffff
    s_mov_b32 s33, 0x000fffff
    s_mul_i32 s40, s8, 458752
    s_add_u32 s40, s40, 1126400
    s_mul_i32 s34, s8, 458752
    s_add_u32 s34, s34, 208896
    s_mul_i32 s35, s8, 1835008
    s_add_u32 s35, s35, 18034688
    s_mul_i32 s37, s8, 655360
    s_add_u32 s37, s37, 2043904
    s_lshr_b32 s23, s9, 2
    s_mul_i32 s23, s23, 2560
    s_add_u32 s37, s37, s23
    s_mul_i32 s39, s8, 69632
    s_add_u32 s39, s39, 65536
    v_mov_b32 v111, 0x42800000
    v_lshlrev_b32 v140, 7, v0
    s_mov_b32 s42, 176132
ww_67:
    buffer_load_dword v141, v140, s[4:7], s42 offen sc1
    s_waitcnt vmcnt(0)
    v_cmp_eq_u32 vcc, 0, v141
    s_cbranch_vccz wwok_68
    s_sleep 4
    s_sub_u32 s13, s13, 1
    s_cbranch_scc0 ww_67
    s_mov_b32 s13, 0
wwok_68:
    s_barrier
    v_and_b32 v140, 63, v0
    v_min_u32 v140, 31, v140
    v_lshlrev_b32 v140, 10, v140
    s_and_b32 s42, s2, 7
    s_lshl_b32 s42, s42, 7
    s_add_u32 s42, s42, 176128
    buffer_load_dword v141, v140, s[4:7], s42 offen sc1
    s_waitcnt vmcnt(0)
    v_cmp_ne_u32 vcc, s15, v141
    s_cmp_lg_u64 vcc, 0
    s_cselect_b32 s12, 1, 0
    v_mov_b32 v140, 1073741824
    v_mov_b32 v141, 1
    s_lshl_b32 s23, s2, 8
    v_add_u32 v142, s23, v0
    v_cmp_eq_u32 vcc, 0, v142
    s_nop 1
    v_cndmask_b32 v140, v140, 0, vcc
    s_mov_b32 s23, 66048
    buffer_store_dword v141, v140, s[4:7], s23 offen sc1
    s_lshl_b32 s25, s25, 10
    s_lshl_b32 s26, s26, 10
    buffer_load_dword v2, v94, s[4:7], s39 offen sc1
    s_waitcnt vmcnt(0)
    v_cmp_eq_u32 vcc, 0, v2
    s_cbranch_vccz xnok_70
xnp_69:
    s_sleep 2
    buffer_load_dword v2, v94, s[4:7], s39 offen sc1
    s_waitcnt vmcnt(0)
    v_cmp_eq_u32 vcc, 0, v2
    s_cbranch_vccz xnok_70
    s_sub_u32 s13, s13, 1
    s_cbranch_scc0 xnp_69
    s_mov_b32 s13, 0
xnok_70:
    s_add_u32 s42, s35, s25
    s_add_u32 s43, s35, s26
    s_add_u32 s44, s42, 14336
    s_add_u32 s45, s43, 14336
    s_add_u32 m0, s30, 0
    s_nop 0
    buffer_load_dwordx4 v4, s[4:7], s42 offen sc1 lds
    buffer_load_dwordx4 v4, s[4:7], s42 offen offset:1024 sc1 lds
    buffer_load_dwordx4 v4, s[4:7], s42 offen offset:2048 sc1 lds
    s_add_u32 m0, s30, 3072
    s_nop 0
    buffer_load_dwordx4 v4, s[4:7], s43 offen sc1 lds
    s_add_u32 m0, s30, 4096
    s_nop 0
    buffer_load_dwordx4 v4, s[4:7], s44 offen sc1 lds
    buffer_load_dwordx4 v4, s[4:7], s44 offen offset:1024 sc1 lds
    buffer_load_dwordx4 v4, s[4:7], s44 offen offset:2048 sc1 lds
    s_add_u32 m0, s30, 7168
    s_nop 0
    buffer_load_dwordx4 v4, s[4:7], s45 offen sc1 lds
    s_add_u32 s35, s35, 28672
    s_xor_b32 s30, s30, 0x8000
    buffer_load_dword v3, v93, s[4:7], s37 offen sc1
    s_cmp_lg_u32 s12, 0
    s_cbranch_scc1 far_71
Sloop_72:
    s_add_u32 s38, s37, 10240
    v_mov_b32 v140, 0
    v_mov_b32 v141, 0
    v_mov_b32 v142, 0
    v_mov_b32 v143, 0
    v_mov_b32 v144, 0
    v_mov_b32 v145, 0
    v_mov_b32 v146, 0
    v_mov_b32 v147, 0
    v_mov_b32 v148, 0
    v_mov_b32 v149, 0
    v_mov_b32 v150, 0
    v_mov_b32 v151, 0
    v_mov_b32 v152, 0
    v_mov_b32 v153, 0
    v_mov_b32 v154, 0
    v_mov_b32 v155, 0
    v_mov_b32 v156, 0
    v_mov_b32 v157, 0
    v_mov_b32 v158, 0
    v_mov_b32 v159, 0
    v_mov_b32 v160, 0
    v_mov_b32 v161, 0
    v_mov_b32 v162, 0
    v_mov_b32 v163, 0
    v_mov_b32 v164, 0
    v_mov_b32 v165, 0
    v_mov_b32 v166, 0
    v_mov_b32 v167, 0
    v_mov_b32 v110, 0
    ds_read_b128 v[234:237], v90 offset:0
    ds_read_b128 v[238:241], v90 offset:1024
    ds_read_b128 v[242:245], v90 offset:2048
    ds_read_b128 v[246:249], v90 offset:3072
    s_add_u32 s41, s11, 1
    v_mov_b32 v107, s41
    v_cmp_ge_u32 vcc, s11, v104
    s_and_b32 vcc_lo, vcc_lo, 15
    s_cbranch_scc0 rlok_74
rl_73:
    buffer_load_dword v104, v103, s[4:7], 0 offen sc1
    s_waitcnt vmcnt(0)
    v_cmp_ge_u32 vcc, s11, v104
    s_and_b32 vcc_lo, vcc_lo, 15
    s_cbranch_scc0 rlok_74
    s_sleep 1
    s_sub_u32 s13, s13, 1
    s_cbranch_scc0 rl_73
    s_mov_b32 s13, 0
rlok_74:
    s_add_u32 s42, s35, s25
    s_add_u32 s43, s35, s26
    s_add_u32 s44, s42, 14336
    s_add_u32 s45, s43, 14336
    buffer_load_dword v220, v105, s[4:7], 0 offen sc1
    s_nop 12
    buffer_load_dword v221, v105, s[4:7], 0 offen sc1
    s_nop 12
    s_cmp_lg_u32 s10, 0
    s_cbranch_scc1 hintok_76
hint_75:
    buffer_load_dword v222, v105, s[4:7], 0 offen sc1
    s_waitcnt vmcnt(2)
    v_cmp_gt_u32 vcc, s11, v220
    s_cbranch_vccz hintok_76
    buffer_load_dword v220, v105, s[4:7], 0 offen sc1
    s_waitcnt vmcnt(2)
    v_cmp_gt_u32 vcc, s11, v221
    s_cbranch_vccz hintok_76
    buffer_load_dword v221, v105, s[4:7], 0 offen sc1
    s_waitcnt vmcnt(2)
    v_cmp_gt_u32 vcc, s11, v222
    s_cbranch_vccz hintok_76
    s_sub_u32 s13, s13, 1
    s_cbranch_scc0 hint_75
    s_mov_b32 s13, 0
hintok_76:
    s_nop 4
    s_barrier
    buffer_load_dwordx4 v[112:115], v87, s[4:7], s34 offen sc1
    buffer_load_dwordx4 v[116:119], v88, s[4:7], s34 offen sc1
    s_add_u32 m0, s30, 0
    v_add_u32 v120, s18, v4
    buffer_load_dwordx4 v4, s[4:7], s42 offen sc1 lds
    buffer_load_dwordx4 v4, s[4:7], s42 offen offset:1024 sc1 lds
    buffer_load_dwordx4 v4, s[4:7], s42 offen offset:2048 sc1 lds
    s_add_u32 m0, s30, 3072
    v_add_u32 v124, s19, v4
    buffer_load_dwordx4 v4, s[4:7], s43 offen sc1 lds
    v_add_u32 v128, s20, v4
    v_add_u32 v132, s21, v4
    v_add_u32 v136, s22, v4
    s_waitcnt vmcnt(5)
    v_smfmac_f32_16x16x64_bf16 v[140:143], v[112:115], a[0:7], v86
    ds_write_b128 v89, v[112:115] offset:0
    v_smfmac_f32_16x16x64_bf16 v[144:147], v[112:115], a[48:55], v86
    v_max3_u32 v1, v112, v113, v114
    v_smfmac_f32_16x16x64_bf16 v[148:151], v[112:115], a[96:103], v86
    buffer_store_dwordx4 v[112:115], v101, s[4:7], s40 offen sc1
    v_smfmac_f32_16x16x64_bf16 v[152:155], v[112:115], a[144:151], v86
    v_smfmac_f32_16x16x64_bf16 v[156:159], v[112:115], a[192:199], v86
    s_waitcnt vmcnt(5)
    ds_write_b128 v89, v[116:119] offset:1024
    v_smfmac_f32_16x16x64_bf16 v[160:163], v[112:115], a[240:247], v86
    v_max3_u32 v1, v1, v115, v116
    v_smfmac_f32_16x16x64_bf16 v[164:167], v[112:115], v[38:45], v86
    v_max3_u32 v1, v1, v117, v118
    v_smfmac_f32_16x16x64_bf16 v[140:143], v[116:119], a[8:15], v86
    v_max_u32 v1, v1, v119
    v_smfmac_f32_16x16x64_bf16 v[144:147], v[116:119], a[56:63], v86
    buffer_store_dwordx4 v[116:119], v102, s[4:7], s40 offen sc1
    v_cmp_eq_u32 vcc, -1, v1
    s_cbranch_vccnz bad_77
join_78:
    s_waitcnt lgkmcnt(0)
    s_barrier
    v_smfmac_f32_16x16x64_bf16 v[148:151], v[116:119], a[104:111], v86
    ds_read_b128 v[120:123], v120
    v_smfmac_f32_16x16x64_bf16 v[152:155], v[116:119], a[152:159], v86
    ds_read_b128 v[124:127], v124
    v_smfmac_f32_16x16x64_bf16 v[156:159], v[116:119], a[200:207], v86
    ds_read_b128 v[128:131], v128
    v_smfmac_f32_16x16x64_bf16 v[160:163], v[116:119], a[248:255], v86
    ds_read_b128 v[132:135], v132
    s_add_u32 m0, s30, 4096
    v_smfmac_f32_16x16x64_bf16 v[164:167], v[116:119], v[46:53], v86
    ds_read_b128 v[136:139], v136
    buffer_load_dwordx4 v4, s[4:7], s44 offen sc1 lds
    ds_read_b128 v[192:195], v95 offset:0
    ds_read_b128 v[206:209], v95 offset:4096
    s_waitcnt lgkmcnt(6)
    v_smfmac_f32_16x16x64_bf16 v[140:143], v[120:123], a[16:23], v86
    buffer_load_dwordx4 v4, s[4:7], s44 offen offset:1024 sc1 lds
    s_waitcnt lgkmcnt(5)
    v_smfmac_f32_16x16x64_bf16 v[140:143], v[124:127], a[24:31], v86
    ds_read2_b32 v[220:221], v97 offset0:0 offset1:4
    s_waitcnt lgkmcnt(5)
    v_smfmac_f32_16x16x64_bf16 v[140:143], v[128:131], a[32:39], v86
    ds_read2_b32 v[222:223], v97 offset0:1 offset1:5
    s_waitcnt lgkmcnt(5)
    v_smfmac_f32_16x16x64_bf16 v[140:143], v[132:135], a[40:47], v86
    s_waitcnt lgkmcnt(4)
    v_smfmac_f32_16x16x64_bf16 v[140:143], v[136:139], v[234:241], v86
    ds_read_b128 v[234:237], v90 offset:4096
    buffer_load_dwordx4 v4, s[4:7], s44 offen offset:2048 sc1 lds
    v_smfmac_f32_16x16x64_bf16 v[144:147], v[120:123], a[64:71], v86
    ds_read_b128 v[238:241], v90 offset:5120
    v_smfmac_f32_16x16x64_bf16 v[144:147], v[124:127], a[72:79], v86
    ds_read_b128 v[196:199], v95 offset:1024
    v_smfmac_f32_16x16x64_bf16 v[148:151], v[120:123], a[112:119], v86
    ds_read_b128 v[210:213], v95 offset:5120
    v_add_f32 v140, v140, v141
    v_smfmac_f32_16x16x64_bf16 v[144:147], v[128:131], a[80:87], v86
    ds_read2_b32 v[224:225], v98 offset0:0 offset1:4
    v_add_f32 v142, v142, v143
    v_smfmac_f32_16x16x64_bf16 v[148:151], v[124:127], a[120:127], v86
    ds_read2_b32 v[226:227], v98 offset0:1 offset1:5
    v_cvt_pk_bf16_f32 v140, v140, v142
    v_smfmac_f32_16x16x64_bf16 v[144:147], v[132:135], a[88:95], v86
    ds_read_b128 v[200:203], v95 offset:2048
    s_add_u32 m0, s30, 7168
    v_smfmac_f32_16x16x64_bf16 v[148:151], v[128:131], a[128:135], v86
    ds_read_b128 v[214:217], v95 offset:6144
    buffer_load_dwordx4 v4, s[4:7], s45 offen sc1 lds
    v_smfmac_f32_16x16x64_bf16 v[144:147], v[136:139], v[242:249], v86
    ds_read_b128 v[242:245], v90 offset:6144
    v_xor_b32 v95, 0x8000, v95
    v_smfmac_f32_16x16x64_bf16 v[148:151], v[132:135], a[136:143], v86
    ds_read_b128 v[246:249], v90 offset:7168
    buffer_load_dword v3, v93, s[4:7], s38 offen sc1
    s_waitcnt lgkmcnt(8)
    v_smfmac_f32_16x16x64_bf16 v[148:151], v[136:139], v[234:241], v86
    ds_read_b128 v[234:237], v90 offset:8192
    v_smfmac_f32_16x16x64_bf16 v[152:155], v[120:123], a[160:167], v86
    ds_read_b128 v[238:241], v90 offset:9216
    v_add_f32 v144, v144, v145
    v_smfmac_f32_16x16x64_bf16 v[152:155], v[124:127], a[168:175], v86
    ds_read2_b32 v[228:229], v99 offset0:0 offset1:4
    v_add_f32 v146, v146, v147
    v_smfmac_f32_16x16x64_bf16 v[156:159], v[120:123], a[208:215], v86
    ds_read2_b32 v[230:231], v99 offset0:1 offset1:5
    v_cvt_pk_bf16_f32 v141, v144, v146
    v_smfmac_f32_16x16x64_bf16 v[152:155], v[128:131], a[176:183], v86
    ds_read_b64 v[204:205], v96 offset:3072
    v_add_f32 v148, v148, v149
    v_smfmac_f32_16x16x64_bf16 v[156:159], v[124:127], a[216:223], v86
    ds_read_b64 v[218:219], v96 offset:7168
    v_add_f32 v150, v150, v151
    v_smfmac_f32_16x16x64_bf16 v[152:155], v[132:135], a[184:191], v86
    ds_read2_b32 v[232:233], v100 offset0:0 offset1:4
    v_cvt_pk_bf16_f32 v148, v148, v150
    v_smfmac_f32_16x16x64_bf16 v[156:159], v[128:131], a[224:231], v86
    v_xor_b32 v96, 0x8000, v96
    s_waitcnt lgkmcnt(7)
    v_smfmac_f32_16x16x64_bf16 v[152:155], v[136:139], v[242:249], v86
    ds_read_b128 v[242:245], v90 offset:10240
    v_smfmac_f32_16x16x64_bf16 v[156:159], v[132:135], a[232:239], v86
    ds_read_b128 v[246:249], v90 offset:11264
    s_waitcnt lgkmcnt(7)
    v_smfmac_f32_16x16x64_bf16 v[156:159], v[136:139], v[234:241], v86
    ds_read_b128 v[234:237], v90 offset:12288
    v_smfmac_f32_16x16x64_bf16 v[160:163], v[120:123], v[6:13], v86
    ds_read_b128 v[238:241], v90 offset:13312
    v_smfmac_f32_16x16x64_bf16 v[160:163], v[124:127], v[14:21], v86
    v_add_f32 v152, v152, v153
    v_smfmac_f32_16x16x64_bf16 v[164:167], v[120:123], v[54:61], v86
    v_add_f32 v154, v154, v155
    v_smfmac_f32_16x16x64_bf16 v[160:163], v[128:131], v[22:29], v86
    v_cvt_pk_bf16_f32 v149, v152, v154
    v_smfmac_f32_16x16x64_bf16 v[164:167], v[124:127], v[62:69], v86
    v_add_f32 v156, v156, v157
    v_smfmac_f32_16x16x64_bf16 v[160:163], v[132:135], v[30:37], v86
    v_add_f32 v158, v158, v159
    v_smfmac_f32_16x16x64_bf16 v[164:167], v[128:131], v[70:77], v86
    v_cvt_pk_bf16_f32 v156, v156, v158
    s_waitcnt lgkmcnt(2)
    v_smfmac_f32_16x16x64_bf16 v[160:163], v[136:139], v[242:249], v86
    v_smfmac_f32_16x16x64_bf16 v[164:167], v[132:135], v[78:85], v86
    v_mfma_f32_16x16x16_bf16 v[180:183], v[140:141], v[108:109], 0
    s_waitcnt lgkmcnt(0)
    v_smfmac_f32_16x16x64_bf16 v[164:167], v[136:139], v[234:241], v86
    v_mfma_f32_16x16x16_bf16 v[184:187], v[148:149], v[108:109], 0
    s_nop 2
    v_add_f32 v160, v160, v161
    v_add_f32 v162, v162, v163
    v_cvt_pk_bf16_f32 v140, v180, v181
    v_cvt_pk_bf16_f32 v157, v160, v162
    v_cvt_pk_bf16_f32 v141, v182, v183
    v_add_f32 v164, v164, v165
    v_mfma_f32_16x16x16_bf16 v[188:191], v[156:157], v[108:109], 0
    v_add_f32 v166, v166, v167
    v_mov_b32_dpp v142, v140 row_ror:8 row_mask:0xf bank_mask:0xf
    v_mov_b32_dpp v143, v141 row_ror:8 row_mask:0xf bank_mask:0xf
    v_cvt_pk_bf16_f32 v164, v164, v166
    v_mov_b32 v165, 0
    v_mfma_f32_16x16x32_bf16 v[168:171], v[192:195], v[140:143], 0
    v_cvt_pk_bf16_f32 v148, v184, v185
    v_cvt_pk_bf16_f32 v149, v186, v187
    v_mfma_f32_16x16x32_bf16 v[172:175], v[206:209], v[140:143], 0
    v_mov_b32_dpp v150, v148 row_ror:8 row_mask:0xf bank_mask:0xf
    v_mov_b32_dpp v151, v149 row_ror:8 row_mask:0xf bank_mask:0xf
    v_mfma_f32_16x16x32_bf16 v[176:179], v[220:223], v[140:143], 0
    v_cvt_pk_bf16_f32 v156, v188, v189
    v_cvt_pk_bf16_f32 v157, v190, v191
    v_mfma_f32_16x16x16_bf16 v[180:183], v[164:165], v[108:109], 0
    v_mov_b32_dpp v158, v156 row_ror:8 row_mask:0xf bank_mask:0xf
    v_mov_b32_dpp v159, v157 row_ror:8 row_mask:0xf bank_mask:0xf
    v_mfma_f32_16x16x32_bf16 v[168:171], v[196:199], v[148:151], v[168:171]
    v_mfma_f32_16x16x32_bf16 v[172:175], v[210:213], v[148:151], v[172:175]
    v_mfma_f32_16x16x32_bf16 v[176:179], v[224:227], v[148:151], v[176:179]
    v_mfma_f32_16x16x32_bf16 v[168:171], v[200:203], v[156:159], v[168:171]
    v_mfma_f32_16x16x32_bf16 v[172:175], v[214:217], v[156:159], v[172:175]
    s_nop 0
    v_cvt_pk_bf16_f32 v164, v180, v181
    v_mfma_f32_16x16x32_bf16 v[176:179], v[228:231], v[156:159], v[176:179]
    v_cvt_pk_bf16_f32 v165, v182, v183
    s_nop 1
    v_mfma_f32_16x16x16_bf16 v[168:171], v[204:205], v[164:165], v[168:171]
    v_mfma_f32_16x16x16_bf16 v[172:175], v[218:219], v[164:165], v[172:175]
    v_mfma_f32_16x16x16_bf16 v[176:179], v[232:233], v[164:165], v[176:179]
    s_nop 5
    ds_write_b128 v91, v[168:171] offset:0
    ds_write_b128 v91, v[172:175] offset:64
    ds_write_b128 v91, v[176:179] offset:128
    s_mov_b64 exec, s[32:33]
    s_waitcnt lgkmcnt(0)
    s_barrier
    ds_read_b64 v[140:141], v92 offset:0
    ds_read_b64 v[144:145], v92 offset:1664
    ds_read_b64 v[148:149], v92 offset:3328
    ds_read_b64 v[152:153], v92 offset:4992
    s_waitcnt lgkmcnt(2)
    v_add_f32 v156, v140, v144
    v_add_f32 v157, v141, v145
    s_waitcnt lgkmcnt(0)
    v_add_f32 v160, v148, v152
    v_add_f32 v161, v149, v153
    v_add_f32 v156, v156, v160
    v_add_f32 v157, v157, v161
    v_exp_f32 v164, v156
    v_exp_f32 v165, v157
    buffer_store_dword v107, v106, s[4:7], 0 offen
    v_max_f32 v160, |v156|, |v157|
    v_add_f32 v110, v164, v165
    v_cmp_nle_f32 vcc, v160, v111
    s_mov_b64 exec, -1
Sexp_82:
    v_add_f32_dpp v110, v110, v110 row_ror:8 row_mask:0xf bank_mask:0xf
    s_nop 1
    v_add_f32_dpp v110, v110, v110 row_ror:4 row_mask:0xf bank_mask:0xf
    s_nop 1
    v_add_f32_dpp v110, v110, v110 row_ror:2 row_mask:0xf bank_mask:0xf
    s_nop 1
    v_add_f32_dpp v110, v110, v110 row_ror:1 row_mask:0xf bank_mask:0xf
    v_mov_b32 v161, v110
    s_nop 1
    v_permlane16_swap_b32 v110, v161
    v_add_f32 v110, v110, v161
    s_cbranch_vccnz Smax_81
    v_rcp_f32 v110, v110
    s_nop 0
    v_mul_f32 v164, v164, v110
    v_mul_f32 v165, v165, v110
    v_cvt_pk_bf16_f32 v166, v164, v165
    buffer_store_dword v166, v93, s[4:7], s37 offen
    s_add_u32 s11, s11, 1
    s_mov_b32 s37, s38
    s_add_u32 s34, s34, 7168
    s_add_u32 s40, s40, 7168
    s_cmp_eq_u32 s11, 63
    s_cbranch_scc1 Sdone_83
    s_add_u32 s35, s35, 28672
    s_xor_b32 s30, s30, 0x8000
    s_branch Sloop_72
Sdone_83:
Mpoll_84:
    buffer_load_dwordx4 v[112:115], v87, s[4:7], s34 offen sc1
    buffer_load_dwordx4 v[116:119], v88, s[4:7], s34 offen sc1
Mfirst_86:
    s_waitcnt vmcnt(0)
    v_max3_u32 v1, v112, v113, v114
    v_max3_u32 v1, v1, v115, v116
    v_max3_u32 v1, v1, v117, v118
    v_max_u32 v1, v1, v119
    v_cmp_eq_u32 vcc, -1, v1
    s_cbranch_vccz Mgot_85
    s_sub_u32 s13, s13, 1
    s_cbranch_scc0 Mpoll_84
    s_mov_b32 s13, 0
Mgot_85:
    ds_write_b128 v89, v[112:115]
    ds_write_b128 v89, v[116:119] offset:1024
    buffer_store_dwordx4 v[112:115], v101, s[4:7], s40 offen sc1
    buffer_store_dwordx4 v[116:119], v102, s[4:7], s40 offen sc1
    s_endpgm
.p2align 6
far_71:
Sloop_87:
    s_add_u32 s38, s37, 10240
    v_mov_b32 v140, 0
    v_mov_b32 v141, 0
    v_mov_b32 v142, 0
    v_mov_b32 v143, 0
    v_mov_b32 v144, 0
    v_mov_b32 v145, 0
    v_mov_b32 v146, 0
    v_mov_b32 v147, 0
    v_mov_b32 v148, 0
    v_mov_b32 v149, 0
    v_mov_b32 v150, 0
    v_mov_b32 v151, 0
    v_mov_b32 v152, 0
    v_mov_b32 v153, 0
    v_mov_b32 v154, 0
    v_mov_b32 v155, 0
    v_mov_b32 v156, 0
    v_mov_b32 v157, 0
    v_mov_b32 v158, 0
    v_mov_b32 v159, 0
    v_mov_b32 v160, 0
    v_mov_b32 v161, 0
    v_mov_b32 v162, 0
    v_mov_b32 v163, 0
    v_mov_b32 v164, 0
    v_mov_b32 v165, 0
    v_mov_b32 v166, 0
    v_mov_b32 v167, 0
    v_mov_b32 v110, 0
    ds_read_b128 v[234:237], v90 offset:0
    ds_read_b128 v[238:241], v90 offset:1024
    ds_read_b128 v[242:245], v90 offset:2048
    ds_read_b128 v[246:249], v90 offset:3072
    s_add_u32 s41, s11, 1
    v_mov_b32 v107, s41
    v_cmp_ge_u32 vcc, s11, v104
    s_and_b32 vcc_lo, vcc_lo, 15
    s_cbranch_scc0 rlok_89
rl_88:
    buffer_load_dword v104, v103, s[4:7], 0 offen sc1
    s_waitcnt vmcnt(0)
    v_cmp_ge_u32 vcc, s11, v104
    s_and_b32 vcc_lo, vcc_lo, 15
    s_cbranch_scc0 rlok_89
    s_sleep 1
    s_sub_u32 s13, s13, 1
    s_cbranch_scc0 rl_88
    s_mov_b32 s13, 0
rlok_89:
    s_add_u32 s42, s35, s25
    s_add_u32 s43, s35, s26
    s_add_u32 s44, s42, 14336
    s_add_u32 s45, s43, 14336
    buffer_load_dword v220, v105, s[4:7], 0 offen sc1
    s_nop 12
    buffer_load_dword v221, v105, s[4:7], 0 offen sc1
    s_nop 12
    s_cmp_lg_u32 s10, 0
    s_cbranch_scc1 hintok_91
hint_90:
    buffer_load_dword v222, v105, s[4:7], 0 offen sc1
    s_waitcnt vmcnt(2)
    v_cmp_gt_u32 vcc, s11, v220
    s_cbranch_vccz hintok_91
    buffer_load_dword v220, v105, s[4:7], 0 offen sc1
    s_waitcnt vmcnt(2)
    v_cmp_gt_u32 vcc, s11, v221
    s_cbranch_vccz hintok_91
    buffer_load_dword v221, v105, s[4:7], 0 offen sc1
    s_waitcnt vmcnt(2)
    v_cmp_gt_u32 vcc, s11, v222
    s_cbranch_vccz hintok_91
    s_sub_u32 s13, s13, 1
    s_cbranch_scc0 hint_90
    s_mov_b32 s13, 0
hintok_91:
    s_nop 4
    s_barrier
    buffer_load_dwordx4 v[112:115], v87, s[4:7], s34 offen sc1
    buffer_load_dwordx4 v[116:119], v88, s[4:7], s34 offen sc1
    s_add_u32 m0, s30, 0
    v_add_u32 v120, s18, v4
    buffer_load_dwordx4 v4, s[4:7], s42 offen sc1 lds
    buffer_load_dwordx4 v4, s[4:7], s42 offen offset:1024 sc1 lds
    buffer_load_dwordx4 v4, s[4:7], s42 offen offset:2048 sc1 lds
    s_add_u32 m0, s30, 3072
    v_add_u32 v124, s19, v4
    buffer_load_dwordx4 v4, s[4:7], s43 offen sc1 lds
    v_add_u32 v128, s20, v4
    v_add_u32 v132, s21, v4
    v_add_u32 v136, s22, v4
    s_waitcnt vmcnt(5)
    v_smfmac_f32_16x16x64_bf16 v[140:143], v[112:115], a[0:7], v86
    ds_write_b128 v89, v[112:115] offset:0
    v_smfmac_f32_16x16x64_bf16 v[144:147], v[112:115], a[48:55], v86
    v_max3_u32 v1, v112, v113, v114
    v_smfmac_f32_16x16x64_bf16 v[148:151], v[112:115], a[96:103], v86
    buffer_store_dwordx4 v[112:115], v101, s[4:7], s40 offen sc1
    v_smfmac_f32_16x16x64_bf16 v[152:155], v[112:115], a[144:151], v86
    v_smfmac_f32_16x16x64_bf16 v[156:159], v[112:115], a[192:199], v86
    s_waitcnt vmcnt(5)
    ds_write_b128 v89, v[116:119] offset:1024
    v_smfmac_f32_16x16x64_bf16 v[160:163], v[112:115], a[240:247], v86
    v_max3_u32 v1, v1, v115, v116
    v_smfmac_f32_16x16x64_bf16 v[164:167], v[112:115], v[38:45], v86
    v_max3_u32 v1, v1, v117, v118
    v_smfmac_f32_16x16x64_bf16 v[140:143], v[116:119], a[8:15], v86
    v_max_u32 v1, v1, v119
    v_smfmac_f32_16x16x64_bf16 v[144:147], v[116:119], a[56:63], v86
    buffer_store_dwordx4 v[116:119], v102, s[4:7], s40 offen sc1
    v_cmp_eq_u32 vcc, -1, v1
    s_cbranch_vccnz bad_92
join_93:
    s_waitcnt lgkmcnt(0)
    s_barrier
    v_smfmac_f32_16x16x64_bf16 v[148:151], v[116:119], a[104:111], v86
    ds_read_b128 v[120:123], v120
    v_smfmac_f32_16x16x64_bf16 v[152:155], v[116:119], a[152:159], v86
    ds_read_b128 v[124:127], v124
    v_smfmac_f32_16x16x64_bf16 v[156:159], v[116:119], a[200:207], v86
    ds_read_b128 v[128:131], v128
    v_smfmac_f32_16x16x64_bf16 v[160:163], v[116:119], a[248:255], v86
    ds_read_b128 v[132:135], v132
    s_add_u32 m0, s30, 4096
    v_smfmac_f32_16x16x64_bf16 v[164:167], v[116:119], v[46:53], v86
    ds_read_b128 v[136:139], v136
    buffer_load_dwordx4 v4, s[4:7], s44 offen sc1 lds
    ds_read_b128 v[192:195], v95 offset:0
    ds_read_b128 v[206:209], v95 offset:4096
    s_waitcnt lgkmcnt(6)
    v_smfmac_f32_16x16x64_bf16 v[140:143], v[120:123], a[16:23], v86
    buffer_load_dwordx4 v4, s[4:7], s44 offen offset:1024 sc1 lds
    s_waitcnt lgkmcnt(5)
    v_smfmac_f32_16x16x64_bf16 v[140:143], v[124:127], a[24:31], v86
    ds_read2_b32 v[220:221], v97 offset0:0 offset1:4
    s_waitcnt lgkmcnt(5)
    v_smfmac_f32_16x16x64_bf16 v[140:143], v[128:131], a[32:39], v86
    ds_read2_b32 v[222:223], v97 offset0:1 offset1:5
    s_waitcnt lgkmcnt(5)
    v_smfmac_f32_16x16x64_bf16 v[140:143], v[132:135], a[40:47], v86
    s_waitcnt lgkmcnt(4)
    v_smfmac_f32_16x16x64_bf16 v[140:143], v[136:139], v[234:241], v86
    ds_read_b128 v[234:237], v90 offset:4096
    buffer_load_dwordx4 v4, s[4:7], s44 offen offset:2048 sc1 lds
    v_smfmac_f32_16x16x64_bf16 v[144:147], v[120:123], a[64:71], v86
    ds_read_b128 v[238:241], v90 offset:5120
    v_smfmac_f32_16x16x64_bf16 v[144:147], v[124:127], a[72:79], v86
    ds_read_b128 v[196:199], v95 offset:1024
    v_smfmac_f32_16x16x64_bf16 v[148:151], v[120:123], a[112:119], v86
    ds_read_b128 v[210:213], v95 offset:5120
    v_add_f32 v140, v140, v141
    v_smfmac_f32_16x16x64_bf16 v[144:147], v[128:131], a[80:87], v86
    ds_read2_b32 v[224:225], v98 offset0:0 offset1:4
    v_add_f32 v142, v142, v143
    v_smfmac_f32_16x16x64_bf16 v[148:151], v[124:127], a[120:127], v86
    ds_read2_b32 v[226:227], v98 offset0:1 offset1:5
    v_cvt_pk_bf16_f32 v140, v140, v142
    v_smfmac_f32_16x16x64_bf16 v[144:147], v[132:135], a[88:95], v86
    ds_read_b128 v[200:203], v95 offset:2048
    s_add_u32 m0, s30, 7168
    v_smfmac_f32_16x16x64_bf16 v[148:151], v[128:131], a[128:135], v86
    ds_read_b128 v[214:217], v95 offset:6144
    buffer_load_dwordx4 v4, s[4:7], s45 offen sc1 lds
    v_smfmac_f32_16x16x64_bf16 v[144:147], v[136:139], v[242:249], v86
    ds_read_b128 v[242:245], v90 offset:6144
    v_xor_b32 v95, 0x8000, v95
    v_smfmac_f32_16x16x64_bf16 v[148:151], v[132:135], a[136:143], v86
    ds_read_b128 v[246:249], v90 offset:7168
    buffer_load_dword v3, v93, s[4:7], s38 offen sc1
    s_waitcnt lgkmcnt(8)
    v_smfmac_f32_16x16x64_bf16 v[148:151], v[136:139], v[234:241], v86
    ds_read_b128 v[234:237], v90 offset:8192
    v_smfmac_f32_16x16x64_bf16 v[152:155], v[120:123], a[160:167], v86
    ds_read_b128 v[238:241], v90 offset:9216
    v_add_f32 v144, v144, v145
    v_smfmac_f32_16x16x64_bf16 v[152:155], v[124:127], a[168:175], v86
    ds_read2_b32 v[228:229], v99 offset0:0 offset1:4
    v_add_f32 v146, v146, v147
    v_smfmac_f32_16x16x64_bf16 v[156:159], v[120:123], a[208:215], v86
    ds_read2_b32 v[230:231], v99 offset0:1 offset1:5
    v_cvt_pk_bf16_f32 v141, v144, v146
    v_smfmac_f32_16x16x64_bf16 v[152:155], v[128:131], a[176:183], v86
    ds_read_b64 v[204:205], v96 offset:3072
    v_add_f32 v148, v148, v149
    v_smfmac_f32_16x16x64_bf16 v[156:159], v[124:127], a[216:223], v86
    ds_read_b64 v[218:219], v96 offset:7168
    v_add_f32 v150, v150, v151
    v_smfmac_f32_16x16x64_bf16 v[152:155], v[132:135], a[184:191], v86
    ds_read2_b32 v[232:233], v100 offset0:0 offset1:4
    v_cvt_pk_bf16_f32 v148, v148, v150
    v_smfmac_f32_16x16x64_bf16 v[156:159], v[128:131], a[224:231], v86
    v_xor_b32 v96, 0x8000, v96
    s_waitcnt lgkmcnt(7)
    v_smfmac_f32_16x16x64_bf16 v[152:155], v[136:139], v[242:249], v86
    ds_read_b128 v[242:245], v90 offset:10240
    v_smfmac_f32_16x16x64_bf16 v[156:159], v[132:135], a[232:239], v86
    ds_read_b128 v[246:249], v90 offset:11264
    s_waitcnt lgkmcnt(7)
    v_smfmac_f32_16x16x64_bf16 v[156:159], v[136:139], v[234:241], v86
    ds_read_b128 v[234:237], v90 offset:12288
    v_smfmac_f32_16x16x64_bf16 v[160:163], v[120:123], v[6:13], v86
    ds_read_b128 v[238:241], v90 offset:13312
    v_smfmac_f32_16x16x64_bf16 v[160:163], v[124:127], v[14:21], v86
    v_add_f32 v152, v152, v153
    v_smfmac_f32_16x16x64_bf16 v[164:167], v[120:123], v[54:61], v86
    v_add_f32 v154, v154, v155
    v_smfmac_f32_16x16x64_bf16 v[160:163], v[128:131], v[22:29], v86
    v_cvt_pk_bf16_f32 v149, v152, v154
    v_smfmac_f32_16x16x64_bf16 v[164:167], v[124:127], v[62:69], v86
    v_add_f32 v156, v156, v157
    v_smfmac_f32_16x16x64_bf16 v[160:163], v[132:135], v[30:37], v86
    v_add_f32 v158, v158, v159
    v_smfmac_f32_16x16x64_bf16 v[164:167], v[128:131], v[70:77], v86
    v_cvt_pk_bf16_f32 v156, v156, v158
    s_waitcnt lgkmcnt(2)
    v_smfmac_f32_16x16x64_bf16 v[160:163], v[136:139], v[242:249], v86
    v_smfmac_f32_16x16x64_bf16 v[164:167], v[132:135], v[78:85], v86
    v_mfma_f32_16x16x16_bf16 v[180:183], v[140:141], v[108:109], 0
    s_waitcnt lgkmcnt(0)
    v_smfmac_f32_16x16x64_bf16 v[164:167], v[136:139], v[234:241], v86
    v_mfma_f32_16x16x16_bf16 v[184:187], v[148:149], v[108:109], 0
    s_nop 2
    v_add_f32 v160, v160, v161
    v_add_f32 v162, v162, v163
    v_cvt_pk_bf16_f32 v140, v180, v181
    v_cvt_pk_bf16_f32 v157, v160, v162
    v_cvt_pk_bf16_f32 v141, v182, v183
    v_add_f32 v164, v164, v165
    v_mfma_f32_16x16x16_bf16 v[188:191], v[156:157], v[108:109], 0
    v_add_f32 v166, v166, v167
    v_mov_b32_dpp v142, v140 row_ror:8 row_mask:0xf bank_mask:0xf
    v_mov_b32_dpp v143, v141 row_ror:8 row_mask:0xf bank_mask:0xf
    v_cvt_pk_bf16_f32 v164, v164, v166
    v_mov_b32 v165, 0
    v_mfma_f32_16x16x32_bf16 v[168:171], v[192:195], v[140:143], 0
    v_cvt_pk_bf16_f32 v148, v184, v185
    v_cvt_pk_bf16_f32 v149, v186, v187
    v_mfma_f32_16x16x32_bf16 v[172:175], v[206:209], v[140:143], 0
    v_mov_b32_dpp v150, v148 row_ror:8 row_mask:0xf bank_mask:0xf
    v_mov_b32_dpp v151, v149 row_ror:8 row_mask:0xf bank_mask:0xf
    v_mfma_f32_16x16x32_bf16 v[176:179], v[220:223], v[140:143], 0
    v_cvt_pk_bf16_f32 v156, v188, v189
    v_cvt_pk_bf16_f32 v157, v190, v191
    v_mfma_f32_16x16x16_bf16 v[180:183], v[164:165], v[108:109], 0
    v_mov_b32_dpp v158, v156 row_ror:8 row_mask:0xf bank_mask:0xf
    v_mov_b32_dpp v159, v157 row_ror:8 row_mask:0xf bank_mask:0xf
    v_mfma_f32_16x16x32_bf16 v[168:171], v[196:199], v[148:151], v[168:171]
    v_mfma_f32_16x16x32_bf16 v[172:175], v[210:213], v[148:151], v[172:175]
    v_mfma_f32_16x16x32_bf16 v[176:179], v[224:227], v[148:151], v[176:179]
    v_mfma_f32_16x16x32_bf16 v[168:171], v[200:203], v[156:159], v[168:171]
    v_mfma_f32_16x16x32_bf16 v[172:175], v[214:217], v[156:159], v[172:175]
    s_nop 0
    v_cvt_pk_bf16_f32 v164, v180, v181
    v_mfma_f32_16x16x32_bf16 v[176:179], v[228:231], v[156:159], v[176:179]
    v_cvt_pk_bf16_f32 v165, v182, v183
    s_nop 1
    v_mfma_f32_16x16x16_bf16 v[168:171], v[204:205], v[164:165], v[168:171]
    v_mfma_f32_16x16x16_bf16 v[172:175], v[218:219], v[164:165], v[172:175]
    v_mfma_f32_16x16x16_bf16 v[176:179], v[232:233], v[164:165], v[176:179]
    s_nop 5
    ds_write_b128 v91, v[168:171] offset:0
    ds_write_b128 v91, v[172:175] offset:64
    ds_write_b128 v91, v[176:179] offset:128
    s_mov_b64 exec, s[32:33]
    s_waitcnt lgkmcnt(0)
    s_barrier
    ds_read_b64 v[140:141], v92 offset:0
    ds_read_b64 v[144:145], v92 offset:1664
    ds_read_b64 v[148:149], v92 offset:3328
    ds_read_b64 v[152:153], v92 offset:4992
    s_waitcnt lgkmcnt(2)
    v_add_f32 v156, v140, v144
    v_add_f32 v157, v141, v145
    s_waitcnt lgkmcnt(0)
    v_add_f32 v160, v148, v152
    v_add_f32 v161, v149, v153
    v_add_f32 v156, v156, v160
    v_add_f32 v157, v157, v161
    v_exp_f32 v164, v156
    v_exp_f32 v165, v157
    buffer_store_dword v107, v106, s[4:7], 0 offen sc1
    v_max_f32 v160, |v156|, |v157|
    v_add_f32 v110, v164, v165
    v_cmp_nle_f32 vcc, v160, v111
    s_mov_b64 exec, -1
Sexp_97:
    v_add_f32_dpp v110, v110, v110 row_ror:8 row_mask:0xf bank_mask:0xf
    s_nop 1
    v_add_f32_dpp v110, v110, v110 row_ror:4 row_mask:0xf bank_mask:0xf
    s_nop 1
    v_add_f32_dpp v110, v110, v110 row_ror:2 row_mask:0xf bank_mask:0xf
    s_nop 1
    v_add_f32_dpp v110, v110, v110 row_ror:1 row_mask:0xf bank_mask:0xf
    v_mov_b32 v161, v110
    s_nop 1
    v_permlane16_swap_b32 v110, v161
    v_add_f32 v110, v110, v161
    s_cbranch_vccnz Smax_96
    v_rcp_f32 v110, v110
    s_nop 0
    v_mul_f32 v164, v164, v110
    v_mul_f32 v165, v165, v110
    v_cvt_pk_bf16_f32 v166, v164, v165
    buffer_store_dword v166, v93, s[4:7], s37 offen sc1
    s_add_u32 s11, s11, 1
    s_mov_b32 s37, s38
    s_add_u32 s34, s34, 7168
    s_add_u32 s40, s40, 7168
    s_cmp_eq_u32 s11, 63
    s_cbranch_scc1 Sdone_98
    s_add_u32 s35, s35, 28672
    s_xor_b32 s30, s30, 0x8000
    s_branch Sloop_87
Sdone_98:
Mpoll_99:
    buffer_load_dwordx4 v[112:115], v87, s[4:7], s34 offen sc1
    buffer_load_dwordx4 v[116:119], v88, s[4:7], s34 offen sc1
Mfirst_101:
    s_waitcnt vmcnt(0)
    v_max3_u32 v1, v112, v113, v114
    v_max3_u32 v1, v1, v115, v116
    v_max3_u32 v1, v1, v117, v118
    v_max_u32 v1, v1, v119
    v_cmp_eq_u32 vcc, -1, v1
    s_cbranch_vccz Mgot_100
    s_sub_u32 s13, s13, 1
    s_cbranch_scc0 Mpoll_99
    s_mov_b32 s13, 0
Mgot_100:
    ds_write_b128 v89, v[112:115]
    ds_write_b128 v89, v[116:119] offset:1024
    buffer_store_dwordx4 v[112:115], v101, s[4:7], s40 offen sc1
    buffer_store_dwordx4 v[116:119], v102, s[4:7], s40 offen sc1
    s_endpgm
bad_77:
    s_waitcnt lgkmcnt(0)
again_79:
    buffer_load_dwordx4 v[112:115], v87, s[4:7], s34 offen sc1
    buffer_load_dwordx4 v[116:119], v88, s[4:7], s34 offen sc1
    v_mov_b32 v140, 0
    v_mov_b32 v141, 0
    v_mov_b32 v142, 0
    v_mov_b32 v143, 0
    v_mov_b32 v144, 0
    v_mov_b32 v145, 0
    v_mov_b32 v146, 0
    v_mov_b32 v147, 0
    v_mov_b32 v148, 0
    v_mov_b32 v149, 0
    v_mov_b32 v150, 0
    v_mov_b32 v151, 0
    v_mov_b32 v152, 0
    v_mov_b32 v153, 0
    v_mov_b32 v154, 0
    v_mov_b32 v155, 0
    v_mov_b32 v156, 0
    v_mov_b32 v157, 0
    v_mov_b32 v158, 0
    v_mov_b32 v159, 0
    v_mov_b32 v160, 0
    v_mov_b32 v161, 0
    v_mov_b32 v162, 0
    v_mov_b32 v163, 0
    v_mov_b32 v164, 0
    v_mov_b32 v165, 0
    v_mov_b32 v166, 0
    v_mov_b32 v167, 0
    s_waitcnt vmcnt(0)
    v_max3_u32 v1, v112, v113, v114
    v_max3_u32 v1, v1, v115, v116
    v_max3_u32 v1, v1, v117, v118
    v_max_u32 v1, v1, v119
    v_cmp_eq_u32 vcc, -1, v1
    s_cbranch_vccz just_80
    s_sub_u32 s13, s13, 1
    s_cbranch_scc0 again_79
    s_mov_b32 s13, 0
just_80:
    v_smfmac_f32_16x16x64_bf16 v[140:143], v[112:115], a[0:7], v86
    ds_write_b128 v89, v[112:115] offset:0
    v_smfmac_f32_16x16x64_bf16 v[144:147], v[112:115], a[48:55], v86
    buffer_store_dwordx4 v[112:115], v101, s[4:7], s40 offen sc1
    v_smfmac_f32_16x16x64_bf16 v[148:151], v[112:115], a[96:103], v86
    ds_write_b128 v89, v[116:119] offset:1024
    v_smfmac_f32_16x16x64_bf16 v[152:155], v[112:115], a[144:151], v86
    buffer_store_dwordx4 v[116:119], v102, s[4:7], s40 offen sc1
    v_smfmac_f32_16x16x64_bf16 v[156:159], v[112:115], a[192:199], v86
    v_smfmac_f32_16x16x64_bf16 v[160:163], v[112:115], a[240:247], v86
    v_smfmac_f32_16x16x64_bf16 v[164:167], v[112:115], v[38:45], v86
    v_smfmac_f32_16x16x64_bf16 v[140:143], v[116:119], a[8:15], v86
    v_smfmac_f32_16x16x64_bf16 v[144:147], v[116:119], a[56:63], v86
    s_branch join_78
Smax_81:
    v_mov_b32 v160, 0xff7fffff
    v_mov_b32 v110, 0
    s_mov_b64 vcc, 0
    s_mov_b64 exec, s[32:33]
    v_max_f32 v160, v156, v157
    s_mov_b64 exec, -1
    s_nop 0
    v_max_f32_dpp v160, v160, v160 row_ror:8 row_mask:0xf bank_mask:0xf
    s_nop 1
    v_max_f32_dpp v160, v160, v160 row_ror:4 row_mask:0xf bank_mask:0xf
    s_nop 1
    v_max_f32_dpp v160, v160, v160 row_ror:2 row_mask:0xf bank_mask:0xf
    s_nop 1
    v_max_f32_dpp v160, v160, v160 row_ror:1 row_mask:0xf bank_mask:0xf
    v_mov_b32 v161, v160
    s_nop 1
    v_permlane16_swap_b32 v160, v161
    v_max_f32 v160, v160, v161
    s_mov_b64 exec, s[32:33]
    v_sub_f32 v156, v156, v160
    v_sub_f32 v157, v157, v160
    v_exp_f32 v164, v156
    v_exp_f32 v165, v157
    s_nop 0
    v_add_f32 v110, v164, v165
    s_mov_b64 exec, -1
    s_branch Sexp_82
bad_92:
    s_waitcnt lgkmcnt(0)
again_94:
    buffer_load_dwordx4 v[112:115], v87, s[4:7], s34 offen sc1
    buffer_load_dwordx4 v[116:119], v88, s[4:7], s34 offen sc1
    v_mov_b32 v140, 0
    v_mov_b32 v141, 0
    v_mov_b32 v142, 0
    v_mov_b32 v143, 0
    v_mov_b32 v144, 0
    v_mov_b32 v145, 0
    v_mov_b32 v146, 0
    v_mov_b32 v147, 0
    v_mov_b32 v148, 0
    v_mov_b32 v149, 0
    v_mov_b32 v150, 0
    v_mov_b32 v151, 0
    v_mov_b32 v152, 0
    v_mov_b32 v153, 0
    v_mov_b32 v154, 0
    v_mov_b32 v155, 0
    v_mov_b32 v156, 0
    v_mov_b32 v157, 0
    v_mov_b32 v158, 0
    v_mov_b32 v159, 0
    v_mov_b32 v160, 0
    v_mov_b32 v161, 0
    v_mov_b32 v162, 0
    v_mov_b32 v163, 0
    v_mov_b32 v164, 0
    v_mov_b32 v165, 0
    v_mov_b32 v166, 0
    v_mov_b32 v167, 0
    s_waitcnt vmcnt(0)
    v_max3_u32 v1, v112, v113, v114
    v_max3_u32 v1, v1, v115, v116
    v_max3_u32 v1, v1, v117, v118
    v_max_u32 v1, v1, v119
    v_cmp_eq_u32 vcc, -1, v1
    s_cbranch_vccz just_95
    s_sub_u32 s13, s13, 1
    s_cbranch_scc0 again_94
    s_mov_b32 s13, 0
just_95:
    v_smfmac_f32_16x16x64_bf16 v[140:143], v[112:115], a[0:7], v86
    ds_write_b128 v89, v[112:115] offset:0
    v_smfmac_f32_16x16x64_bf16 v[144:147], v[112:115], a[48:55], v86
    buffer_store_dwordx4 v[112:115], v101, s[4:7], s40 offen sc1
    v_smfmac_f32_16x16x64_bf16 v[148:151], v[112:115], a[96:103], v86
    ds_write_b128 v89, v[116:119] offset:1024
    v_smfmac_f32_16x16x64_bf16 v[152:155], v[112:115], a[144:151], v86
    buffer_store_dwordx4 v[116:119], v102, s[4:7], s40 offen sc1
    v_smfmac_f32_16x16x64_bf16 v[156:159], v[112:115], a[192:199], v86
    v_smfmac_f32_16x16x64_bf16 v[160:163], v[112:115], a[240:247], v86
    v_smfmac_f32_16x16x64_bf16 v[164:167], v[112:115], v[38:45], v86
    v_smfmac_f32_16x16x64_bf16 v[140:143], v[116:119], a[8:15], v86
    v_smfmac_f32_16x16x64_bf16 v[144:147], v[116:119], a[56:63], v86
    s_branch join_93
Smax_96:
    v_mov_b32 v160, 0xff7fffff
    v_mov_b32 v110, 0
    s_mov_b64 vcc, 0
    s_mov_b64 exec, s[32:33]
    v_max_f32 v160, v156, v157
    s_mov_b64 exec, -1
    s_nop 0
    v_max_f32_dpp v160, v160, v160 row_ror:8 row_mask:0xf bank_mask:0xf
    s_nop 1
    v_max_f32_dpp v160, v160, v160 row_ror:4 row_mask:0xf bank_mask:0xf
    s_nop 1
    v_max_f32_dpp v160, v160, v160 row_ror:2 row_mask:0xf bank_mask:0xf
    s_nop 1
    v_max_f32_dpp v160, v160, v160 row_ror:1 row_mask:0xf bank_mask:0xf
    v_mov_b32 v161, v160
    s_nop 1
    v_permlane16_swap_b32 v160, v161
    v_max_f32 v160, v160, v161
    s_mov_b64 exec, s[32:33]
    v_sub_f32 v156, v156, v160
    v_sub_f32 v157, v157, v160
    v_exp_f32 v164, v156
    v_exp_f32 v165, v157
    s_nop 0
    v_add_f32 v110, v164, v165
    s_mov_b64 exec, -1
    s_branch Sexp_97
.p2align 6
role_V:
    v_and_b32 v1, 63, v0
    v_and_b32 v2, 15, v0
    v_lshrrev_b32 v3, 4, v1
    v_lshlrev_b32 v4, 4, v1
    s_lshl_b32 s19, s10, 1
    s_add_u32 s19, s19, 0
    s_cmp_ge_u32 s19, 7
    s_cselect_b32 m0, 7, 0
    s_sub_u32 s19, s19, m0
    s_lshl_b32 s19, s19, 10
    s_lshl_b32 s20, s10, 1
    s_add_u32 s20, s20, 1
    s_cmp_ge_u32 s20, 7
    s_cselect_b32 m0, 7, 0
    s_sub_u32 s20, s20, m0
    s_lshl_b32 s20, s20, 10
    s_lshl_b32 s21, s10, 1
    s_add_u32 s21, s21, 2
    s_cmp_ge_u32 s21, 7
    s_cselect_b32 m0, 7, 0
    s_sub_u32 s21, s21, m0
    s_lshl_b32 s21, s21, 10
    s_lshl_b32 s22, s10, 1
    s_add_u32 s22, s22, 3
    s_cmp_ge_u32 s22, 7
    s_cselect_b32 m0, 7, 0
    s_sub_u32 s22, s22, m0
    s_lshl_b32 s22, s22, 10
    s_lshl_b32 s23, s10, 1
    s_add_u32 s23, s23, 4
    s_cmp_ge_u32 s23, 7
    s_cselect_b32 m0, 7, 0
    s_sub_u32 s23, s23, m0
    s_lshl_b32 s23, s23, 10
    s_lshl_b32 s24, s10, 1
    s_add_u32 s24, s24, 5
    s_cmp_ge_u32 s24, 7
    s_cselect_b32 m0, 7, 0
    s_sub_u32 s24, s24, m0
    s_lshl_b32 s24, s24, 10
    s_lshl_b32 s25, s10, 1
    s_add_u32 s25, s25, 6
    s_cmp_ge_u32 s25, 7
    s_cselect_b32 m0, 7, 0
    s_sub_u32 s25, s25, m0
    s_lshl_b32 s25, s25, 10
    s_lshr_b32 s18, s9, 1
    s_add_u32 s18, s18, 112
    s_cmp_eq_u32 s8, 0
    s_cbranch_scc1 l0_102
    v_lshlrev_b32 v248, 7, v0
    s_mov_b32 s27, 176132
ww_103:
    buffer_load_dword v249, v248, s[4:7], s27 offen sc1
    s_waitcnt vmcnt(0)
    v_cmp_eq_u32 vcc, 0, v249
    s_cbranch_vccz wwok_104
    s_sleep 4
    s_sub_u32 s13, s13, 1
    s_cbranch_scc0 ww_103
    s_mov_b32 s13, 0
wwok_104:
    s_barrier
    v_mov_b32 v248, 0
    s_mov_b32 s26, 66048
ww_105:
    buffer_load_dword v249, v248, s[4:7], s26 offen sc1
    s_waitcnt vmcnt(0)
    v_cmp_eq_u32 vcc, 0, v249
    s_cbranch_vccz wwok_106
    s_sleep 8
    s_sub_u32 s13, s13, 1
    s_cbranch_scc0 ww_105
    s_mov_b32 s13, 0
wwok_106:
l0_102:
    v_and_b32 v248, 63, v0
    v_min_u32 v248, 15, v248
    v_mul_u32_u24 v248, 7, v248
    v_add_u32 v248, s18, v248
    v_add_u32 v248, 32, v248
    v_and_b32 v250, 31, v248
    v_lshrrev_b32 v248, 5, v248
    v_lshl_add_u32 v248, v250, 3, v248
    v_lshlrev_b32 v248, 7, v248
    v_add_u32 v248, 176136, v248
    v_mov_b32 v249, 0
    s_lshl_b32 s17, s10, 15
    s_lshl_b32 s18, s9, 5
    s_lshl_b32 s16, s10, 2
    s_add_u32 s18, s18, s16
    s_mul_i32 s18, s18, 14336
    s_add_u32 s18, s18, 11612160
    s_cmp_eq_u32 s10, 1
    s_cbranch_scc1 pw_109
    s_cmp_eq_u32 s10, 2
    s_cbranch_scc1 pw_110
    s_cmp_eq_u32 s10, 3
    s_cbranch_scc1 pw_111
pw_108:
    v_cmp_gt_u32 vcc, 1, v249
    s_cbranch_vccz wcok_113
wc_112:
    buffer_load_dword v249, v248, s[4:7], 0 offen sc1
    s_waitcnt vmcnt(0)
    v_cmp_gt_u32 vcc, 1, v249
    s_cbranch_vccz wcok_113
    s_sleep 4
    s_sub_u32 s13, s13, 1
    s_cbranch_scc0 wc_112
    s_mov_b32 s13, 0
wcok_113:
    s_add_u32 s16, s18, 0
    buffer_load_dwordx4 a[0:3], v4, s[4:7], s16 offen
    buffer_load_dwordx4 a[4:7], v4, s[4:7], s16 offen offset:1024
    s_add_u32 s16, s18, 14336
    buffer_load_dwordx4 a[40:43], v4, s[4:7], s16 offen
    buffer_load_dwordx4 a[44:47], v4, s[4:7], s16 offen offset:1024
    s_add_u32 s16, s18, 28672
    buffer_load_dwordx4 a[80:83], v4, s[4:7], s16 offen
    buffer_load_dwordx4 a[84:87], v4, s[4:7], s16 offen offset:1024
    s_add_u32 s16, s18, 43008
    buffer_load_dwordx4 a[120:123], v4, s[4:7], s16 offen
    buffer_load_dwordx4 a[124:127], v4, s[4:7], s16 offen offset:1024
    s_add_u32 s16, s18, 229376
    buffer_load_dwordx4 a[160:163], v4, s[4:7], s16 offen
    buffer_load_dwordx4 a[164:167], v4, s[4:7], s16 offen offset:1024
    s_add_u32 s16, s18, 243712
    buffer_load_dwordx4 a[200:203], v4, s[4:7], s16 offen
    buffer_load_dwordx4 a[204:207], v4, s[4:7], s16 offen offset:1024
    s_add_u32 s16, s18, 258048
    buffer_load_dwordx4 a[240:243], v4, s[4:7], s16 offen
    buffer_load_dwordx4 a[244:247], v4, s[4:7], s16 offen offset:1024
    s_add_u32 s16, s18, 272384
    buffer_load_dwordx4 v[30:33], v4, s[4:7], s16 offen
    buffer_load_dwordx4 v[34:37], v4, s[4:7], s16 offen offset:1024
    v_cmp_gt_u32 vcc, 2, v249
    s_cbranch_vccz wcok_115
wc_114:
    buffer_load_dword v249, v248, s[4:7], 0 offen sc1
    s_waitcnt vmcnt(0)
    v_cmp_gt_u32 vcc, 2, v249
    s_cbranch_vccz wcok_115
    s_sleep 4
    s_sub_u32 s13, s13, 1
    s_cbranch_scc0 wc_114
    s_mov_b32 s13, 0
wcok_115:
    s_add_u32 s16, s18, 2048
    buffer_load_dwordx4 a[8:11], v4, s[4:7], s16 offen
    buffer_load_dwordx4 a[12:15], v4, s[4:7], s16 offen offset:1024
    s_add_u32 s16, s18, 16384
    buffer_load_dwordx4 a[48:51], v4, s[4:7], s16 offen
    buffer_load_dwordx4 a[52:55], v4, s[4:7], s16 offen offset:1024
    s_add_u32 s16, s18, 30720
    buffer_load_dwordx4 a[88:91], v4, s[4:7], s16 offen
    buffer_load_dwordx4 a[92:95], v4, s[4:7], s16 offen offset:1024
    s_add_u32 s16, s18, 45056
    buffer_load_dwordx4 a[128:131], v4, s[4:7], s16 offen
    buffer_load_dwordx4 a[132:135], v4, s[4:7], s16 offen offset:1024
    s_add_u32 s16, s18, 231424
    buffer_load_dwordx4 a[168:171], v4, s[4:7], s16 offen
    buffer_load_dwordx4 a[172:175], v4, s[4:7], s16 offen offset:1024
    s_add_u32 s16, s18, 245760
    buffer_load_dwordx4 a[208:211], v4, s[4:7], s16 offen
    buffer_load_dwordx4 a[212:215], v4, s[4:7], s16 offen offset:1024
    s_add_u32 s16, s18, 260096
    buffer_load_dwordx4 a[248:251], v4, s[4:7], s16 offen
    buffer_load_dwordx4 a[252:255], v4, s[4:7], s16 offen offset:1024
    s_add_u32 s16, s18, 274432
    buffer_load_dwordx4 v[38:41], v4, s[4:7], s16 offen
    buffer_load_dwordx4 v[42:45], v4, s[4:7], s16 offen offset:1024
    v_cmp_gt_u32 vcc, 3, v249
    s_cbranch_vccz wcok_117
wc_116:
    buffer_load_dword v249, v248, s[4:7], 0 offen sc1
    s_waitcnt vmcnt(0)
    v_cmp_gt_u32 vcc, 3, v249
    s_cbranch_vccz wcok_117
    s_sleep 4
    s_sub_u32 s13, s13, 1
    s_cbranch_scc0 wc_116
    s_mov_b32 s13, 0
wcok_117:
    s_add_u32 s16, s18, 4096
    buffer_load_dwordx4 a[16:19], v4, s[4:7], s16 offen
    buffer_load_dwordx4 a[20:23], v4, s[4:7], s16 offen offset:1024
    s_add_u32 s16, s18, 18432
    buffer_load_dwordx4 a[56:59], v4, s[4:7], s16 offen
    buffer_load_dwordx4 a[60:63], v4, s[4:7], s16 offen offset:1024
    s_add_u32 s16, s18, 32768
    buffer_load_dwordx4 a[96:99], v4, s[4:7], s16 offen
    buffer_load_dwordx4 a[100:103], v4, s[4:7], s16 offen offset:1024
    s_add_u32 s16, s18, 47104
    buffer_load_dwordx4 a[136:139], v4, s[4:7], s16 offen
    buffer_load_dwordx4 a[140:143], v4, s[4:7], s16 offen offset:1024
    s_add_u32 s16, s18, 233472
    buffer_load_dwordx4 a[176:179], v4, s[4:7], s16 offen
    buffer_load_dwordx4 a[180:183], v4, s[4:7], s16 offen offset:1024
    s_add_u32 s16, s18, 247808
    buffer_load_dwordx4 a[216:219], v4, s[4:7], s16 offen
    buffer_load_dwordx4 a[220:223], v4, s[4:7], s16 offen offset:1024
    s_add_u32 s16, s18, 262144
    buffer_load_dwordx4 v[6:9], v4, s[4:7], s16 offen
    buffer_load_dwordx4 v[10:13], v4, s[4:7], s16 offen offset:1024
    s_add_u32 s16, s18, 276480
    buffer_load_dwordx4 v[46:49], v4, s[4:7], s16 offen
    buffer_load_dwordx4 v[50:53], v4, s[4:7], s16 offen offset:1024
    v_cmp_gt_u32 vcc, 4, v249
    s_cbranch_vccz wcok_119
wc_118:
    buffer_load_dword v249, v248, s[4:7], 0 offen sc1
    s_waitcnt vmcnt(0)
    v_cmp_gt_u32 vcc, 4, v249
    s_cbranch_vccz wcok_119
    s_sleep 4
    s_sub_u32 s13, s13, 1
    s_cbranch_scc0 wc_118
    s_mov_b32 s13, 0
wcok_119:
    s_add_u32 s16, s18, 6144
    buffer_load_dwordx4 a[24:27], v4, s[4:7], s16 offen
    buffer_load_dwordx4 a[28:31], v4, s[4:7], s16 offen offset:1024
    s_add_u32 s16, s18, 20480
    buffer_load_dwordx4 a[64:67], v4, s[4:7], s16 offen
    buffer_load_dwordx4 a[68:71], v4, s[4:7], s16 offen offset:1024
    s_add_u32 s16, s18, 34816
    buffer_load_dwordx4 a[104:107], v4, s[4:7], s16 offen
    buffer_load_dwordx4 a[108:111], v4, s[4:7], s16 offen offset:1024
    s_add_u32 s16, s18, 49152
    buffer_load_dwordx4 a[144:147], v4, s[4:7], s16 offen
    buffer_load_dwordx4 a[148:151], v4, s[4:7], s16 offen offset:1024
    s_add_u32 s16, s18, 235520
    buffer_load_dwordx4 a[184:187], v4, s[4:7], s16 offen
    buffer_load_dwordx4 a[188:191], v4, s[4:7], s16 offen offset:1024
    s_add_u32 s16, s18, 249856
    buffer_load_dwordx4 a[224:227], v4, s[4:7], s16 offen
    buffer_load_dwordx4 a[228:231], v4, s[4:7], s16 offen offset:1024
    s_add_u32 s16, s18, 264192
    buffer_load_dwordx4 v[14:17], v4, s[4:7], s16 offen
    buffer_load_dwordx4 v[18:21], v4, s[4:7], s16 offen offset:1024
    s_add_u32 s16, s18, 278528
    buffer_load_dwordx4 v[54:57], v4, s[4:7], s16 offen
    buffer_load_dwordx4 v[58:61], v4, s[4:7], s16 offen offset:1024
    v_cmp_gt_u32 vcc, 5, v249
    s_cbranch_vccz wcok_121
wc_120:
    buffer_load_dword v249, v248, s[4:7], 0 offen sc1
    s_waitcnt vmcnt(0)
    v_cmp_gt_u32 vcc, 5, v249
    s_cbranch_vccz wcok_121
    s_sleep 4
    s_sub_u32 s13, s13, 1
    s_cbranch_scc0 wc_120
    s_mov_b32 s13, 0
wcok_121:
    s_add_u32 s16, s18, 8192
    buffer_load_dwordx4 a[32:35], v4, s[4:7], s16 offen
    buffer_load_dwordx4 a[36:39], v4, s[4:7], s16 offen offset:1024
    s_add_u32 s16, s18, 22528
    buffer_load_dwordx4 a[72:75], v4, s[4:7], s16 offen
    buffer_load_dwordx4 a[76:79], v4, s[4:7], s16 offen offset:1024
    s_add_u32 s16, s18, 36864
    buffer_load_dwordx4 a[112:115], v4, s[4:7], s16 offen
    buffer_load_dwordx4 a[116:119], v4, s[4:7], s16 offen offset:1024
    s_add_u32 s16, s18, 51200
    buffer_load_dwordx4 a[152:155], v4, s[4:7], s16 offen
    buffer_load_dwordx4 a[156:159], v4, s[4:7], s16 offen offset:1024
    s_add_u32 s16, s18, 237568
    buffer_load_dwordx4 a[192:195], v4, s[4:7], s16 offen
    buffer_load_dwordx4 a[196:199], v4, s[4:7], s16 offen offset:1024
    s_add_u32 s16, s18, 251904
    buffer_load_dwordx4 a[232:235], v4, s[4:7], s16 offen
    buffer_load_dwordx4 a[236:239], v4, s[4:7], s16 offen offset:1024
    s_add_u32 s16, s18, 266240
    buffer_load_dwordx4 v[22:25], v4, s[4:7], s16 offen
    buffer_load_dwordx4 v[26:29], v4, s[4:7], s16 offen offset:1024
    s_add_u32 s16, s18, 280576
    buffer_load_dwordx4 v[62:65], v4, s[4:7], s16 offen
    buffer_load_dwordx4 v[66:69], v4, s[4:7], s16 offen offset:1024
    v_cmp_gt_u32 vcc, 6, v249
    s_cbranch_vccz wcok_123
wc_122:
    buffer_load_dword v249, v248, s[4:7], 0 offen sc1
    s_waitcnt vmcnt(0)
    v_cmp_gt_u32 vcc, 6, v249
    s_cbranch_vccz wcok_123
    s_sleep 4
    s_sub_u32 s13, s13, 1
    s_cbranch_scc0 wc_122
    s_mov_b32 s13, 0
wcok_123:
    s_add_u32 s16, s18, 10240
    s_add_u32 m0, s17, 0
    s_nop 0
    buffer_load_dwordx4 v4, s[4:7], s16 offen lds
    buffer_load_dwordx4 v4, s[4:7], s16 offen offset:1024 lds
    s_add_u32 s16, s18, 24576
    s_add_u32 m0, s17, 4096
    s_nop 0
    buffer_load_dwordx4 v4, s[4:7], s16 offen lds
    buffer_load_dwordx4 v4, s[4:7], s16 offen offset:1024 lds
    s_add_u32 s16, s18, 38912
    s_add_u32 m0, s17, 8192
    s_nop 0
    buffer_load_dwordx4 v4, s[4:7], s16 offen lds
    buffer_load_dwordx4 v4, s[4:7], s16 offen offset:1024 lds
    s_add_u32 s16, s18, 53248
    s_add_u32 m0, s17, 12288
    s_nop 0
    buffer_load_dwordx4 v4, s[4:7], s16 offen lds
    buffer_load_dwordx4 v4, s[4:7], s16 offen offset:1024 lds
    s_add_u32 s16, s18, 239616
    s_add_u32 m0, s17, 16384
    s_nop 0
    buffer_load_dwordx4 v4, s[4:7], s16 offen lds
    buffer_load_dwordx4 v4, s[4:7], s16 offen offset:1024 lds
    s_add_u32 s16, s18, 253952
    s_add_u32 m0, s17, 20480
    s_nop 0
    buffer_load_dwordx4 v4, s[4:7], s16 offen lds
    buffer_load_dwordx4 v4, s[4:7], s16 offen offset:1024 lds
    s_add_u32 s16, s18, 268288
    s_add_u32 m0, s17, 24576
    s_nop 0
    buffer_load_dwordx4 v4, s[4:7], s16 offen lds
    buffer_load_dwordx4 v4, s[4:7], s16 offen offset:1024 lds
    s_add_u32 s16, s18, 282624
    s_add_u32 m0, s17, 28672
    s_nop 0
    buffer_load_dwordx4 v4, s[4:7], s16 offen lds
    buffer_load_dwordx4 v4, s[4:7], s16 offen offset:1024 lds
    v_cmp_gt_u32 vcc, 7, v249
    s_cbranch_vccz wcok_125
wc_124:
    buffer_load_dword v249, v248, s[4:7], 0 offen sc1
    s_waitcnt vmcnt(0)
    v_cmp_gt_u32 vcc, 7, v249
    s_cbranch_vccz wcok_125
    s_sleep 4
    s_sub_u32 s13, s13, 1
    s_cbranch_scc0 wc_124
    s_mov_b32 s13, 0
wcok_125:
    s_add_u32 s16, s18, 12288
    s_add_u32 m0, s17, 2048
    s_nop 0
    buffer_load_dwordx4 v4, s[4:7], s16 offen lds
    buffer_load_dwordx4 v4, s[4:7], s16 offen offset:1024 lds
    s_add_u32 s16, s18, 26624
    s_add_u32 m0, s17, 6144
    s_nop 0
    buffer_load_dwordx4 v4, s[4:7], s16 offen lds
    buffer_load_dwordx4 v4, s[4:7], s16 offen offset:1024 lds
    s_add_u32 s16, s18, 40960
    s_add_u32 m0, s17, 10240
    s_nop 0
    buffer_load_dwordx4 v4, s[4:7], s16 offen lds
    buffer_load_dwordx4 v4, s[4:7], s16 offen offset:1024 lds
    s_add_u32 s16, s18, 55296
    s_add_u32 m0, s17, 14336
    s_nop 0
    buffer_load_dwordx4 v4, s[4:7], s16 offen lds
    buffer_load_dwordx4 v4, s[4:7], s16 offen offset:1024 lds
    s_add_u32 s16, s18, 241664
    s_add_u32 m0, s17, 18432
    s_nop 0
    buffer_load_dwordx4 v4, s[4:7], s16 offen lds
    buffer_load_dwordx4 v4, s[4:7], s16 offen offset:1024 lds
    s_add_u32 s16, s18, 256000
    s_add_u32 m0, s17, 22528
    s_nop 0
    buffer_load_dwordx4 v4, s[4:7], s16 offen lds
    buffer_load_dwordx4 v4, s[4:7], s16 offen offset:1024 lds
    s_add_u32 s16, s18, 270336
    s_add_u32 m0, s17, 26624
    s_nop 0
    buffer_load_dwordx4 v4, s[4:7], s16 offen lds
    buffer_load_dwordx4 v4, s[4:7], s16 offen offset:1024 lds
    s_add_u32 s16, s18, 284672
    s_add_u32 m0, s17, 30720
    s_nop 0
    buffer_load_dwordx4 v4, s[4:7], s16 offen lds
    buffer_load_dwordx4 v4, s[4:7], s16 offen offset:1024 lds
    s_branch pwout_107
pw_109:
    v_cmp_gt_u32 vcc, 1, v249
    s_cbranch_vccz wcok_127
wc_126:
    buffer_load_dword v249, v248, s[4:7], 0 offen sc1
    s_waitcnt vmcnt(0)
    v_cmp_gt_u32 vcc, 1, v249
    s_cbranch_vccz wcok_127
    s_sleep 4
    s_sub_u32 s13, s13, 1
    s_cbranch_scc0 wc_126
    s_mov_b32 s13, 0
wcok_127:
    s_add_u32 s16, s18, 0
    s_add_u32 m0, s17, 0
    s_nop 0
    buffer_load_dwordx4 v4, s[4:7], s16 offen lds
    buffer_load_dwordx4 v4, s[4:7], s16 offen offset:1024 lds
    s_add_u32 s16, s18, 14336
    s_add_u32 m0, s17, 4096
    s_nop 0
    buffer_load_dwordx4 v4, s[4:7], s16 offen lds
    buffer_load_dwordx4 v4, s[4:7], s16 offen offset:1024 lds
    s_add_u32 s16, s18, 28672
    s_add_u32 m0, s17, 8192
    s_nop 0
    buffer_load_dwordx4 v4, s[4:7], s16 offen lds
    buffer_load_dwordx4 v4, s[4:7], s16 offen offset:1024 lds
    s_add_u32 s16, s18, 43008
    s_add_u32 m0, s17, 12288
    s_nop 0
    buffer_load_dwordx4 v4, s[4:7], s16 offen lds
    buffer_load_dwordx4 v4, s[4:7], s16 offen offset:1024 lds
    s_add_u32 s16, s18, 229376
    s_add_u32 m0, s17, 16384
    s_nop 0
    buffer_load_dwordx4 v4, s[4:7], s16 offen lds
    buffer_load_dwordx4 v4, s[4:7], s16 offen offset:1024 lds
    s_add_u32 s16, s18, 243712
    s_add_u32 m0, s17, 20480
    s_nop 0
    buffer_load_dwordx4 v4, s[4:7], s16 offen lds
    buffer_load_dwordx4 v4, s[4:7], s16 offen offset:1024 lds
    s_add_u32 s16, s18, 258048
    s_add_u32 m0, s17, 24576
    s_nop 0
    buffer_load_dwordx4 v4, s[4:7], s16 offen lds
    buffer_load_dwordx4 v4, s[4:7], s16 offen offset:1024 lds
    s_add_u32 s16, s18, 272384
    s_add_u32 m0, s17, 28672
    s_nop 0
    buffer_load_dwordx4 v4, s[4:7], s16 offen lds
    buffer_load_dwordx4 v4, s[4:7], s16 offen offset:1024 lds
    v_cmp_gt_u32 vcc, 2, v249
    s_cbranch_vccz wcok_129
wc_128:
    buffer_load_dword v249, v248, s[4:7], 0 offen sc1
    s_waitcnt vmcnt(0)
    v_cmp_gt_u32 vcc, 2, v249
    s_cbranch_vccz wcok_129
    s_sleep 4
    s_sub_u32 s13, s13, 1
    s_cbranch_scc0 wc_128
    s_mov_b32 s13, 0
wcok_129:
    s_add_u32 s16, s18, 2048
    s_add_u32 m0, s17, 2048
    s_nop 0
    buffer_load_dwordx4 v4, s[4:7], s16 offen lds
    buffer_load_dwordx4 v4, s[4:7], s16 offen offset:1024 lds
    s_add_u32 s16, s18, 16384
    s_add_u32 m0, s17, 6144
    s_nop 0
    buffer_load_dwordx4 v4, s[4:7], s16 offen lds
    buffer_load_dwordx4 v4, s[4:7], s16 offen offset:1024 lds
    s_add_u32 s16, s18, 30720
    s_add_u32 m0, s17, 10240
    s_nop 0
    buffer_load_dwordx4 v4, s[4:7], s16 offen lds
    buffer_load_dwordx4 v4, s[4:7], s16 offen offset:1024 lds
    s_add_u32 s16, s18, 45056
    s_add_u32 m0, s17, 14336
    s_nop 0
    buffer_load_dwordx4 v4, s[4:7], s16 offen lds
    buffer_load_dwordx4 v4, s[4:7], s16 offen offset:1024 lds
    s_add_u32 s16, s18, 231424
    s_add_u32 m0, s17, 18432
    s_nop 0
    buffer_load_dwordx4 v4, s[4:7], s16 offen lds
    buffer_load_dwordx4 v4, s[4:7], s16 offen offset:1024 lds
    s_add_u32 s16, s18, 245760
    s_add_u32 m0, s17, 22528
    s_nop 0
    buffer_load_dwordx4 v4, s[4:7], s16 offen lds
    buffer_load_dwordx4 v4, s[4:7], s16 offen offset:1024 lds
    s_add_u32 s16, s18, 260096
    s_add_u32 m0, s17, 26624
    s_nop 0
    buffer_load_dwordx4 v4, s[4:7], s16 offen lds
    buffer_load_dwordx4 v4, s[4:7], s16 offen offset:1024 lds
    s_add_u32 s16, s18, 274432
    s_add_u32 m0, s17, 30720
    s_nop 0
    buffer_load_dwordx4 v4, s[4:7], s16 offen lds
    buffer_load_dwordx4 v4, s[4:7], s16 offen offset:1024 lds
    v_cmp_gt_u32 vcc, 3, v249
    s_cbranch_vccz wcok_131
wc_130:
    buffer_load_dword v249, v248, s[4:7], 0 offen sc1
    s_waitcnt vmcnt(0)
    v_cmp_gt_u32 vcc, 3, v249
    s_cbranch_vccz wcok_131
    s_sleep 4
    s_sub_u32 s13, s13, 1
    s_cbranch_scc0 wc_130
    s_mov_b32 s13, 0
wcok_131:
    s_add_u32 s16, s18, 4096
    buffer_load_dwordx4 a[0:3], v4, s[4:7], s16 offen
    buffer_load_dwordx4 a[4:7], v4, s[4:7], s16 offen offset:1024
    s_add_u32 s16, s18, 18432
    buffer_load_dwordx4 a[40:43], v4, s[4:7], s16 offen
    buffer_load_dwordx4 a[44:47], v4, s[4:7], s16 offen offset:1024
    s_add_u32 s16, s18, 32768
    buffer_load_dwordx4 a[80:83], v4, s[4:7], s16 offen
    buffer_load_dwordx4 a[84:87], v4, s[4:7], s16 offen offset:1024
    s_add_u32 s16, s18, 47104
    buffer_load_dwordx4 a[120:123], v4, s[4:7], s16 offen
    buffer_load_dwordx4 a[124:127], v4, s[4:7], s16 offen offset:1024
    s_add_u32 s16, s18, 233472
    buffer_load_dwordx4 a[160:163], v4, s[4:7], s16 offen
    buffer_load_dwordx4 a[164:167], v4, s[4:7], s16 offen offset:1024
    s_add_u32 s16, s18, 247808
    buffer_load_dwordx4 a[200:203], v4, s[4:7], s16 offen
    buffer_load_dwordx4 a[204:207], v4, s[4:7], s16 offen offset:1024
    s_add_u32 s16, s18, 262144
    buffer_load_dwordx4 a[240:243], v4, s[4:7], s16 offen
    buffer_load_dwordx4 a[244:247], v4, s[4:7], s16 offen offset:1024
    s_add_u32 s16, s18, 276480
    buffer_load_dwordx4 v[30:33], v4, s[4:7], s16 offen
    buffer_load_dwordx4 v[34:37], v4, s[4:7], s16 offen offset:1024
    v_cmp_gt_u32 vcc, 4, v249
    s_cbranch_vccz wcok_133
wc_132:
    buffer_load_dword v249, v248, s[4:7], 0 offen sc1
    s_waitcnt vmcnt(0)
    v_cmp_gt_u32 vcc, 4, v249
    s_cbranch_vccz wcok_133
    s_sleep 4
    s_sub_u32 s13, s13, 1
    s_cbranch_scc0 wc_132
    s_mov_b32 s13, 0
wcok_133:
    s_add_u32 s16, s18, 6144
    buffer_load_dwordx4 a[8:11], v4, s[4:7], s16 offen
    buffer_load_dwordx4 a[12:15], v4, s[4:7], s16 offen offset:1024
    s_add_u32 s16, s18, 20480
    buffer_load_dwordx4 a[48:51], v4, s[4:7], s16 offen
    buffer_load_dwordx4 a[52:55], v4, s[4:7], s16 offen offset:1024
    s_add_u32 s16, s18, 34816
    buffer_load_dwordx4 a[88:91], v4, s[4:7], s16 offen
    buffer_load_dwordx4 a[92:95], v4, s[4:7], s16 offen offset:1024
    s_add_u32 s16, s18, 49152
    buffer_load_dwordx4 a[128:131], v4, s[4:7], s16 offen
    buffer_load_dwordx4 a[132:135], v4, s[4:7], s16 offen offset:1024
    s_add_u32 s16, s18, 235520
    buffer_load_dwordx4 a[168:171], v4, s[4:7], s16 offen
    buffer_load_dwordx4 a[172:175], v4, s[4:7], s16 offen offset:1024
    s_add_u32 s16, s18, 249856
    buffer_load_dwordx4 a[208:211], v4, s[4:7], s16 offen
    buffer_load_dwordx4 a[212:215], v4, s[4:7], s16 offen offset:1024
    s_add_u32 s16, s18, 264192
    buffer_load_dwordx4 a[248:251], v4, s[4:7], s16 offen
    buffer_load_dwordx4 a[252:255], v4, s[4:7], s16 offen offset:1024
    s_add_u32 s16, s18, 278528
    buffer_load_dwordx4 v[38:41], v4, s[4:7], s16 offen
    buffer_load_dwordx4 v[42:45], v4, s[4:7], s16 offen offset:1024
    v_cmp_gt_u32 vcc, 5, v249
    s_cbranch_vccz wcok_135
wc_134:
    buffer_load_dword v249, v248, s[4:7], 0 offen sc1
    s_waitcnt vmcnt(0)
    v_cmp_gt_u32 vcc, 5, v249
    s_cbranch_vccz wcok_135
    s_sleep 4
    s_sub_u32 s13, s13, 1
    s_cbranch_scc0 wc_134
    s_mov_b32 s13, 0
wcok_135:
    s_add_u32 s16, s18, 8192
    buffer_load_dwordx4 a[16:19], v4, s[4:7], s16 offen
    buffer_load_dwordx4 a[20:23], v4, s[4:7], s16 offen offset:1024
    s_add_u32 s16, s18, 22528
    buffer_load_dwordx4 a[56:59], v4, s[4:7], s16 offen
    buffer_load_dwordx4 a[60:63], v4, s[4:7], s16 offen offset:1024
    s_add_u32 s16, s18, 36864
    buffer_load_dwordx4 a[96:99], v4, s[4:7], s16 offen
    buffer_load_dwordx4 a[100:103], v4, s[4:7], s16 offen offset:1024
    s_add_u32 s16, s18, 51200
    buffer_load_dwordx4 a[136:139], v4, s[4:7], s16 offen
    buffer_load_dwordx4 a[140:143], v4, s[4:7], s16 offen offset:1024
    s_add_u32 s16, s18, 237568
    buffer_load_dwordx4 a[176:179], v4, s[4:7], s16 offen
    buffer_load_dwordx4 a[180:183], v4, s[4:7], s16 offen offset:1024
    s_add_u32 s16, s18, 251904
    buffer_load_dwordx4 a[216:219], v4, s[4:7], s16 offen
    buffer_load_dwordx4 a[220:223], v4, s[4:7], s16 offen offset:1024
    s_add_u32 s16, s18, 266240
    buffer_load_dwordx4 v[6:9], v4, s[4:7], s16 offen
    buffer_load_dwordx4 v[10:13], v4, s[4:7], s16 offen offset:1024
    s_add_u32 s16, s18, 280576
    buffer_load_dwordx4 v[46:49], v4, s[4:7], s16 offen
    buffer_load_dwordx4 v[50:53], v4, s[4:7], s16 offen offset:1024
    v_cmp_gt_u32 vcc, 6, v249
    s_cbranch_vccz wcok_137
wc_136:
    buffer_load_dword v249, v248, s[4:7], 0 offen sc1
    s_waitcnt vmcnt(0)
    v_cmp_gt_u32 vcc, 6, v249
    s_cbranch_vccz wcok_137
    s_sleep 4
    s_sub_u32 s13, s13, 1
    s_cbranch_scc0 wc_136
    s_mov_b32 s13, 0
wcok_137:
    s_add_u32 s16, s18, 10240
    buffer_load_dwordx4 a[24:27], v4, s[4:7], s16 offen
    buffer_load_dwordx4 a[28:31], v4, s[4:7], s16 offen offset:1024
    s_add_u32 s16, s18, 24576
    buffer_load_dwordx4 a[64:67], v4, s[4:7], s16 offen
    buffer_load_dwordx4 a[68:71], v4, s[4:7], s16 offen offset:1024
    s_add_u32 s16, s18, 38912
    buffer_load_dwordx4 a[104:107], v4, s[4:7], s16 offen
    buffer_load_dwordx4 a[108:111], v4, s[4:7], s16 offen offset:1024
    s_add_u32 s16, s18, 53248
    buffer_load_dwordx4 a[144:147], v4, s[4:7], s16 offen
    buffer_load_dwordx4 a[148:151], v4, s[4:7], s16 offen offset:1024
    s_add_u32 s16, s18, 239616
    buffer_load_dwordx4 a[184:187], v4, s[4:7], s16 offen
    buffer_load_dwordx4 a[188:191], v4, s[4:7], s16 offen offset:1024
    s_add_u32 s16, s18, 253952
    buffer_load_dwordx4 a[224:227], v4, s[4:7], s16 offen
    buffer_load_dwordx4 a[228:231], v4, s[4:7], s16 offen offset:1024
    s_add_u32 s16, s18, 268288
    buffer_load_dwordx4 v[14:17], v4, s[4:7], s16 offen
    buffer_load_dwordx4 v[18:21], v4, s[4:7], s16 offen offset:1024
    s_add_u32 s16, s18, 282624
    buffer_load_dwordx4 v[54:57], v4, s[4:7], s16 offen
    buffer_load_dwordx4 v[58:61], v4, s[4:7], s16 offen offset:1024
    v_cmp_gt_u32 vcc, 7, v249
    s_cbranch_vccz wcok_139
wc_138:
    buffer_load_dword v249, v248, s[4:7], 0 offen sc1
    s_waitcnt vmcnt(0)
    v_cmp_gt_u32 vcc, 7, v249
    s_cbranch_vccz wcok_139
    s_sleep 4
    s_sub_u32 s13, s13, 1
    s_cbranch_scc0 wc_138
    s_mov_b32 s13, 0
wcok_139:
    s_add_u32 s16, s18, 12288
    buffer_load_dwordx4 a[32:35], v4, s[4:7], s16 offen
    buffer_load_dwordx4 a[36:39], v4, s[4:7], s16 offen offset:1024
    s_add_u32 s16, s18, 26624
    buffer_load_dwordx4 a[72:75], v4, s[4:7], s16 offen
    buffer_load_dwordx4 a[76:79], v4, s[4:7], s16 offen offset:1024
    s_add_u32 s16, s18, 40960
    buffer_load_dwordx4 a[112:115], v4, s[4:7], s16 offen
    buffer_load_dwordx4 a[116:119], v4, s[4:7], s16 offen offset:1024
    s_add_u32 s16, s18, 55296
    buffer_load_dwordx4 a[152:155], v4, s[4:7], s16 offen
    buffer_load_dwordx4 a[156:159], v4, s[4:7], s16 offen offset:1024
    s_add_u32 s16, s18, 241664
    buffer_load_dwordx4 a[192:195], v4, s[4:7], s16 offen
    buffer_load_dwordx4 a[196:199], v4, s[4:7], s16 offen offset:1024
    s_add_u32 s16, s18, 256000
    buffer_load_dwordx4 a[232:235], v4, s[4:7], s16 offen
    buffer_load_dwordx4 a[236:239], v4, s[4:7], s16 offen offset:1024
    s_add_u32 s16, s18, 270336
    buffer_load_dwordx4 v[22:25], v4, s[4:7], s16 offen
    buffer_load_dwordx4 v[26:29], v4, s[4:7], s16 offen offset:1024
    s_add_u32 s16, s18, 284672
    buffer_load_dwordx4 v[62:65], v4, s[4:7], s16 offen
    buffer_load_dwordx4 v[66:69], v4, s[4:7], s16 offen offset:1024
    s_branch pwout_107
pw_110:
    v_cmp_gt_u32 vcc, 1, v249
    s_cbranch_vccz wcok_141
wc_140:
    buffer_load_dword v249, v248, s[4:7], 0 offen sc1
    s_waitcnt vmcnt(0)
    v_cmp_gt_u32 vcc, 1, v249
    s_cbranch_vccz wcok_141
    s_sleep 4
    s_sub_u32 s13, s13, 1
    s_cbranch_scc0 wc_140
    s_mov_b32 s13, 0
wcok_141:
    s_add_u32 s16, s18, 0
    buffer_load_dwordx4 a[24:27], v4, s[4:7], s16 offen
    buffer_load_dwordx4 a[28:31], v4, s[4:7], s16 offen offset:1024
    s_add_u32 s16, s18, 14336
    buffer_load_dwordx4 a[64:67], v4, s[4:7], s16 offen
    buffer_load_dwordx4 a[68:71], v4, s[4:7], s16 offen offset:1024
    s_add_u32 s16, s18, 28672
    buffer_load_dwordx4 a[104:107], v4, s[4:7], s16 offen
    buffer_load_dwordx4 a[108:111], v4, s[4:7], s16 offen offset:1024
    s_add_u32 s16, s18, 43008
    buffer_load_dwordx4 a[144:147], v4, s[4:7], s16 offen
    buffer_load_dwordx4 a[148:151], v4, s[4:7], s16 offen offset:1024
    s_add_u32 s16, s18, 229376
    buffer_load_dwordx4 a[184:187], v4, s[4:7], s16 offen
    buffer_load_dwordx4 a[188:191], v4, s[4:7], s16 offen offset:1024
    s_add_u32 s16, s18, 243712
    buffer_load_dwordx4 a[224:227], v4, s[4:7], s16 offen
    buffer_load_dwordx4 a[228:231], v4, s[4:7], s16 offen offset:1024
    s_add_u32 s16, s18, 258048
    buffer_load_dwordx4 v[14:17], v4, s[4:7], s16 offen
    buffer_load_dwordx4 v[18:21], v4, s[4:7], s16 offen offset:1024
    s_add_u32 s16, s18, 272384
    buffer_load_dwordx4 v[54:57], v4, s[4:7], s16 offen
    buffer_load_dwordx4 v[58:61], v4, s[4:7], s16 offen offset:1024
    v_cmp_gt_u32 vcc, 2, v249
    s_cbranch_vccz wcok_143
wc_142:
    buffer_load_dword v249, v248, s[4:7], 0 offen sc1
    s_waitcnt vmcnt(0)
    v_cmp_gt_u32 vcc, 2, v249
    s_cbranch_vccz wcok_143
    s_sleep 4
    s_sub_u32 s13, s13, 1
    s_cbranch_scc0 wc_142
    s_mov_b32 s13, 0
wcok_143:
    s_add_u32 s16, s18, 2048
    buffer_load_dwordx4 a[32:35], v4, s[4:7], s16 offen
    buffer_load_dwordx4 a[36:39], v4, s[4:7], s16 offen offset:1024
    s_add_u32 s16, s18, 16384
    buffer_load_dwordx4 a[72:75], v4, s[4:7], s16 offen
    buffer_load_dwordx4 a[76:79], v4, s[4:7], s16 offen offset:1024
    s_add_u32 s16, s18, 30720
    buffer_load_dwordx4 a[112:115], v4, s[4:7], s16 offen
    buffer_load_dwordx4 a[116:119], v4, s[4:7], s16 offen offset:1024
    s_add_u32 s16, s18, 45056
    buffer_load_dwordx4 a[152:155], v4, s[4:7], s16 offen
    buffer_load_dwordx4 a[156:159], v4, s[4:7], s16 offen offset:1024
    s_add_u32 s16, s18, 231424
    buffer_load_dwordx4 a[192:195], v4, s[4:7], s16 offen
    buffer_load_dwordx4 a[196:199], v4, s[4:7], s16 offen offset:1024
    s_add_u32 s16, s18, 245760
    buffer_load_dwordx4 a[232:235], v4, s[4:7], s16 offen
    buffer_load_dwordx4 a[236:239], v4, s[4:7], s16 offen offset:1024
    s_add_u32 s16, s18, 260096
    buffer_load_dwordx4 v[22:25], v4, s[4:7], s16 offen
    buffer_load_dwordx4 v[26:29], v4, s[4:7], s16 offen offset:1024
    s_add_u32 s16, s18, 274432
    buffer_load_dwordx4 v[62:65], v4, s[4:7], s16 offen
    buffer_load_dwordx4 v[66:69], v4, s[4:7], s16 offen offset:1024
    v_cmp_gt_u32 vcc, 3, v249
    s_cbranch_vccz wcok_145
wc_144:
    buffer_load_dword v249, v248, s[4:7], 0 offen sc1
    s_waitcnt vmcnt(0)
    v_cmp_gt_u32 vcc, 3, v249
    s_cbranch_vccz wcok_145
    s_sleep 4
    s_sub_u32 s13, s13, 1
    s_cbranch_scc0 wc_144
    s_mov_b32 s13, 0
wcok_145:
    s_add_u32 s16, s18, 4096
    s_add_u32 m0, s17, 0
    s_nop 0
    buffer_load_dwordx4 v4, s[4:7], s16 offen lds
    buffer_load_dwordx4 v4, s[4:7], s16 offen offset:1024 lds
    s_add_u32 s16, s18, 18432
    s_add_u32 m0, s17, 4096
    s_nop 0
    buffer_load_dwordx4 v4, s[4:7], s16 offen lds
    buffer_load_dwordx4 v4, s[4:7], s16 offen offset:1024 lds
    s_add_u32 s16, s18, 32768
    s_add_u32 m0, s17, 8192
    s_nop 0
    buffer_load_dwordx4 v4, s[4:7], s16 offen lds
    buffer_load_dwordx4 v4, s[4:7], s16 offen offset:1024 lds
    s_add_u32 s16, s18, 47104
    s_add_u32 m0, s17, 12288
    s_nop 0
    buffer_load_dwordx4 v4, s[4:7], s16 offen lds
    buffer_load_dwordx4 v4, s[4:7], s16 offen offset:1024 lds
    s_add_u32 s16, s18, 233472
    s_add_u32 m0, s17, 16384
    s_nop 0
    buffer_load_dwordx4 v4, s[4:7], s16 offen lds
    buffer_load_dwordx4 v4, s[4:7], s16 offen offset:1024 lds
    s_add_u32 s16, s18, 247808
    s_add_u32 m0, s17, 20480
    s_nop 0
    buffer_load_dwordx4 v4, s[4:7], s16 offen lds
    buffer_load_dwordx4 v4, s[4:7], s16 offen offset:1024 lds
    s_add_u32 s16, s18, 262144
    s_add_u32 m0, s17, 24576
    s_nop 0
    buffer_load_dwordx4 v4, s[4:7], s16 offen lds
    buffer_load_dwordx4 v4, s[4:7], s16 offen offset:1024 lds
    s_add_u32 s16, s18, 276480
    s_add_u32 m0, s17, 28672
    s_nop 0
    buffer_load_dwordx4 v4, s[4:7], s16 offen lds
    buffer_load_dwordx4 v4, s[4:7], s16 offen offset:1024 lds
    v_cmp_gt_u32 vcc, 4, v249
    s_cbranch_vccz wcok_147
wc_146:
    buffer_load_dword v249, v248, s[4:7], 0 offen sc1
    s_waitcnt vmcnt(0)
    v_cmp_gt_u32 vcc, 4, v249
    s_cbranch_vccz wcok_147
    s_sleep 4
    s_sub_u32 s13, s13, 1
    s_cbranch_scc0 wc_146
    s_mov_b32 s13, 0
wcok_147:
    s_add_u32 s16, s18, 6144
    s_add_u32 m0, s17, 2048
    s_nop 0
    buffer_load_dwordx4 v4, s[4:7], s16 offen lds
    buffer_load_dwordx4 v4, s[4:7], s16 offen offset:1024 lds
    s_add_u32 s16, s18, 20480
    s_add_u32 m0, s17, 6144
    s_nop 0
    buffer_load_dwordx4 v4, s[4:7], s16 offen lds
    buffer_load_dwordx4 v4, s[4:7], s16 offen offset:1024 lds
    s_add_u32 s16, s18, 34816
    s_add_u32 m0, s17, 10240
    s_nop 0
    buffer_load_dwordx4 v4, s[4:7], s16 offen lds
    buffer_load_dwordx4 v4, s[4:7], s16 offen offset:1024 lds
    s_add_u32 s16, s18, 49152
    s_add_u32 m0, s17, 14336
    s_nop 0
    buffer_load_dwordx4 v4, s[4:7], s16 offen lds
    buffer_load_dwordx4 v4, s[4:7], s16 offen offset:1024 lds
    s_add_u32 s16, s18, 235520
    s_add_u32 m0, s17, 18432
    s_nop 0
    buffer_load_dwordx4 v4, s[4:7], s16 offen lds
    buffer_load_dwordx4 v4, s[4:7], s16 offen offset:1024 lds
    s_add_u32 s16, s18, 249856
    s_add_u32 m0, s17, 22528
    s_nop 0
    buffer_load_dwordx4 v4, s[4:7], s16 offen lds
    buffer_load_dwordx4 v4, s[4:7], s16 offen offset:1024 lds
    s_add_u32 s16, s18, 264192
    s_add_u32 m0, s17, 26624
    s_nop 0
    buffer_load_dwordx4 v4, s[4:7], s16 offen lds
    buffer_load_dwordx4 v4, s[4:7], s16 offen offset:1024 lds
    s_add_u32 s16, s18, 278528
    s_add_u32 m0, s17, 30720
    s_nop 0
    buffer_load_dwordx4 v4, s[4:7], s16 offen lds
    buffer_load_dwordx4 v4, s[4:7], s16 offen offset:1024 lds
    v_cmp_gt_u32 vcc, 5, v249
    s_cbranch_vccz wcok_149
wc_148:
    buffer_load_dword v249, v248, s[4:7], 0 offen sc1
    s_waitcnt vmcnt(0)
    v_cmp_gt_u32 vcc, 5, v249
    s_cbranch_vccz wcok_149
    s_sleep 4
    s_sub_u32 s13, s13, 1
    s_cbranch_scc0 wc_148
    s_mov_b32 s13, 0
wcok_149:
    s_add_u32 s16, s18, 8192
    buffer_load_dwordx4 a[0:3], v4, s[4:7], s16 offen
    buffer_load_dwordx4 a[4:7], v4, s[4:7], s16 offen offset:1024
    s_add_u32 s16, s18, 22528
    buffer_load_dwordx4 a[40:43], v4, s[4:7], s16 offen
    buffer_load_dwordx4 a[44:47], v4, s[4:7], s16 offen offset:1024
    s_add_u32 s16, s18, 36864
    buffer_load_dwordx4 a[80:83], v4, s[4:7], s16 offen
    buffer_load_dwordx4 a[84:87], v4, s[4:7], s16 offen offset:1024
    s_add_u32 s16, s18, 51200
    buffer_load_dwordx4 a[120:123], v4, s[4:7], s16 offen
    buffer_load_dwordx4 a[124:127], v4, s[4:7], s16 offen offset:1024
    s_add_u32 s16, s18, 237568
    buffer_load_dwordx4 a[160:163], v4, s[4:7], s16 offen
    buffer_load_dwordx4 a[164:167], v4, s[4:7], s16 offen offset:1024
    s_add_u32 s16, s18, 251904
    buffer_load_dwordx4 a[200:203], v4, s[4:7], s16 offen
    buffer_load_dwordx4 a[204:207], v4, s[4:7], s16 offen offset:1024
    s_add_u32 s16, s18, 266240
    buffer_load_dwordx4 a[240:243], v4, s[4:7], s16 offen
    buffer_load_dwordx4 a[244:247], v4, s[4:7], s16 offen offset:1024
    s_add_u32 s16, s18, 280576
    buffer_load_dwordx4 v[30:33], v4, s[4:7], s16 offen
    buffer_load_dwordx4 v[34:37], v4, s[4:7], s16 offen offset:1024
    v_cmp_gt_u32 vcc, 6, v249
    s_cbranch_vccz wcok_151
wc_150:
    buffer_load_dword v249, v248, s[4:7], 0 offen sc1
    s_waitcnt vmcnt(0)
    v_cmp_gt_u32 vcc, 6, v249
    s_cbranch_vccz wcok_151
    s_sleep 4
    s_sub_u32 s13, s13, 1
    s_cbranch_scc0 wc_150
    s_mov_b32 s13, 0
wcok_151:
    s_add_u32 s16, s18, 10240
    buffer_load_dwordx4 a[8:11], v4, s[4:7], s16 offen
    buffer_load_dwordx4 a[12:15], v4, s[4:7], s16 offen offset:1024
    s_add_u32 s16, s18, 24576
    buffer_load_dwordx4 a[48:51], v4, s[4:7], s16 offen
    buffer_load_dwordx4 a[52:55], v4, s[4:7], s16 offen offset:1024
    s_add_u32 s16, s18, 38912
    buffer_load_dwordx4 a[88:91], v4, s[4:7], s16 offen
    buffer_load_dwordx4 a[92:95], v4, s[4:7], s16 offen offset:1024
    s_add_u32 s16, s18, 53248
    buffer_load_dwordx4 a[128:131], v4, s[4:7], s16 offen
    buffer_load_dwordx4 a[132:135], v4, s[4:7], s16 offen offset:1024
    s_add_u32 s16, s18, 239616
    buffer_load_dwordx4 a[168:171], v4, s[4:7], s16 offen
    buffer_load_dwordx4 a[172:175], v4, s[4:7], s16 offen offset:1024
    s_add_u32 s16, s18, 253952
    buffer_load_dwordx4 a[208:211], v4, s[4:7], s16 offen
    buffer_load_dwordx4 a[212:215], v4, s[4:7], s16 offen offset:1024
    s_add_u32 s16, s18, 268288
    buffer_load_dwordx4 a[248:251], v4, s[4:7], s16 offen
    buffer_load_dwordx4 a[252:255], v4, s[4:7], s16 offen offset:1024
    s_add_u32 s16, s18, 282624
    buffer_load_dwordx4 v[38:41], v4, s[4:7], s16 offen
    buffer_load_dwordx4 v[42:45], v4, s[4:7], s16 offen offset:1024
    v_cmp_gt_u32 vcc, 7, v249
    s_cbranch_vccz wcok_153
wc_152:
    buffer_load_dword v249, v248, s[4:7], 0 offen sc1
    s_waitcnt vmcnt(0)
    v_cmp_gt_u32 vcc, 7, v249
    s_cbranch_vccz wcok_153
    s_sleep 4
    s_sub_u32 s13, s13, 1
    s_cbranch_scc0 wc_152
    s_mov_b32 s13, 0
wcok_153:
    s_add_u32 s16, s18, 12288
    buffer_load_dwordx4 a[16:19], v4, s[4:7], s16 offen
    buffer_load_dwordx4 a[20:23], v4, s[4:7], s16 offen offset:1024
    s_add_u32 s16, s18, 26624
    buffer_load_dwordx4 a[56:59], v4, s[4:7], s16 offen
    buffer_load_dwordx4 a[60:63], v4, s[4:7], s16 offen offset:1024
    s_add_u32 s16, s18, 40960
    buffer_load_dwordx4 a[96:99], v4, s[4:7], s16 offen
    buffer_load_dwordx4 a[100:103], v4, s[4:7], s16 offen offset:1024
    s_add_u32 s16, s18, 55296
    buffer_load_dwordx4 a[136:139], v4, s[4:7], s16 offen
    buffer_load_dwordx4 a[140:143], v4, s[4:7], s16 offen offset:1024
    s_add_u32 s16, s18, 241664
    buffer_load_dwordx4 a[176:179], v4, s[4:7], s16 offen
    buffer_load_dwordx4 a[180:183], v4, s[4:7], s16 offen offset:1024
    s_add_u32 s16, s18, 256000
    buffer_load_dwordx4 a[216:219], v4, s[4:7], s16 offen
    buffer_load_dwordx4 a[220:223], v4, s[4:7], s16 offen offset:1024
    s_add_u32 s16, s18, 270336
    buffer_load_dwordx4 v[6:9], v4, s[4:7], s16 offen
    buffer_load_dwordx4 v[10:13], v4, s[4:7], s16 offen offset:1024
    s_add_u32 s16, s18, 284672
    buffer_load_dwordx4 v[46:49], v4, s[4:7], s16 offen
    buffer_load_dwordx4 v[50:53], v4, s[4:7], s16 offen offset:1024
    s_branch pwout_107
pw_111:
    v_cmp_gt_u32 vcc, 1, v249
    s_cbranch_vccz wcok_155
wc_154:
    buffer_load_dword v249, v248, s[4:7], 0 offen sc1
    s_waitcnt vmcnt(0)
    v_cmp_gt_u32 vcc, 1, v249
    s_cbranch_vccz wcok_155
    s_sleep 4
    s_sub_u32 s13, s13, 1
    s_cbranch_scc0 wc_154
    s_mov_b32 s13, 0
wcok_155:
    s_add_u32 s16, s18, 0
    buffer_load_dwordx4 a[8:11], v4, s[4:7], s16 offen
    buffer_load_dwordx4 a[12:15], v4, s[4:7], s16 offen offset:1024
    s_add_u32 s16, s18, 14336
    buffer_load_dwordx4 a[48:51], v4, s[4:7], s16 offen
    buffer_load_dwordx4 a[52:55], v4, s[4:7], s16 offen offset:1024
    s_add_u32 s16, s18, 28672
    buffer_load_dwordx4 a[88:91], v4, s[4:7], s16 offen
    buffer_load_dwordx4 a[92:95], v4, s[4:7], s16 offen offset:1024
    s_add_u32 s16, s18, 43008
    buffer_load_dwordx4 a[128:131], v4, s[4:7], s16 offen
    buffer_load_dwordx4 a[132:135], v4, s[4:7], s16 offen offset:1024
    s_add_u32 s16, s18, 229376
    buffer_load_dwordx4 a[168:171], v4, s[4:7], s16 offen
    buffer_load_dwordx4 a[172:175], v4, s[4:7], s16 offen offset:1024
    s_add_u32 s16, s18, 243712
    buffer_load_dwordx4 a[208:211], v4, s[4:7], s16 offen
    buffer_load_dwordx4 a[212:215], v4, s[4:7], s16 offen offset:1024
    s_add_u32 s16, s18, 258048
    buffer_load_dwordx4 a[248:251], v4, s[4:7], s16 offen
    buffer_load_dwordx4 a[252:255], v4, s[4:7], s16 offen offset:1024
    s_add_u32 s16, s18, 272384
    buffer_load_dwordx4 v[38:41], v4, s[4:7], s16 offen
    buffer_load_dwordx4 v[42:45], v4, s[4:7], s16 offen offset:1024
    v_cmp_gt_u32 vcc, 2, v249
    s_cbranch_vccz wcok_157
wc_156:
    buffer_load_dword v249, v248, s[4:7], 0 offen sc1
    s_waitcnt vmcnt(0)
    v_cmp_gt_u32 vcc, 2, v249
    s_cbranch_vccz wcok_157
    s_sleep 4
    s_sub_u32 s13, s13, 1
    s_cbranch_scc0 wc_156
    s_mov_b32 s13, 0
wcok_157:
    s_add_u32 s16, s18, 2048
    buffer_load_dwordx4 a[16:19], v4, s[4:7], s16 offen
    buffer_load_dwordx4 a[20:23], v4, s[4:7], s16 offen offset:1024
    s_add_u32 s16, s18, 16384
    buffer_load_dwordx4 a[56:59], v4, s[4:7], s16 offen
    buffer_load_dwordx4 a[60:63], v4, s[4:7], s16 offen offset:1024
    s_add_u32 s16, s18, 30720
    buffer_load_dwordx4 a[96:99], v4, s[4:7], s16 offen
    buffer_load_dwordx4 a[100:103], v4, s[4:7], s16 offen offset:1024
    s_add_u32 s16, s18, 45056
    buffer_load_dwordx4 a[136:139], v4, s[4:7], s16 offen
    buffer_load_dwordx4 a[140:143], v4, s[4:7], s16 offen offset:1024
    s_add_u32 s16, s18, 231424
    buffer_load_dwordx4 a[176:179], v4, s[4:7], s16 offen
    buffer_load_dwordx4 a[180:183], v4, s[4:7], s16 offen offset:1024
    s_add_u32 s16, s18, 245760
    buffer_load_dwordx4 a[216:219], v4, s[4:7], s16 offen
    buffer_load_dwordx4 a[220:223], v4, s[4:7], s16 offen offset:1024
    s_add_u32 s16, s18, 260096
    buffer_load_dwordx4 v[6:9], v4, s[4:7], s16 offen
    buffer_load_dwordx4 v[10:13], v4, s[4:7], s16 offen offset:1024
    s_add_u32 s16, s18, 274432
    buffer_load_dwordx4 v[46:49], v4, s[4:7], s16 offen
    buffer_load_dwordx4 v[50:53], v4, s[4:7], s16 offen offset:1024
    v_cmp_gt_u32 vcc, 3, v249
    s_cbranch_vccz wcok_159
wc_158:
    buffer_load_dword v249, v248, s[4:7], 0 offen sc1
    s_waitcnt vmcnt(0)
    v_cmp_gt_u32 vcc, 3, v249
    s_cbranch_vccz wcok_159
    s_sleep 4
    s_sub_u32 s13, s13, 1
    s_cbranch_scc0 wc_158
    s_mov_b32 s13, 0
wcok_159:
    s_add_u32 s16, s18, 4096
    buffer_load_dwordx4 a[24:27], v4, s[4:7], s16 offen
    buffer_load_dwordx4 a[28:31], v4, s[4:7], s16 offen offset:1024
    s_add_u32 s16, s18, 18432
    buffer_load_dwordx4 a[64:67], v4, s[4:7], s16 offen
    buffer_load_dwordx4 a[68:71], v4, s[4:7], s16 offen offset:1024
    s_add_u32 s16, s18, 32768
    buffer_load_dwordx4 a[104:107], v4, s[4:7], s16 offen
    buffer_load_dwordx4 a[108:111], v4, s[4:7], s16 offen offset:1024
    s_add_u32 s16, s18, 47104
    buffer_load_dwordx4 a[144:147], v4, s[4:7], s16 offen
    buffer_load_dwordx4 a[148:151], v4, s[4:7], s16 offen offset:1024
    s_add_u32 s16, s18, 233472
    buffer_load_dwordx4 a[184:187], v4, s[4:7], s16 offen
    buffer_load_dwordx4 a[188:191], v4, s[4:7], s16 offen offset:1024
    s_add_u32 s16, s18, 247808
    buffer_load_dwordx4 a[224:227], v4, s[4:7], s16 offen
    buffer_load_dwordx4 a[228:231], v4, s[4:7], s16 offen offset:1024
    s_add_u32 s16, s18, 262144
    buffer_load_dwordx4 v[14:17], v4, s[4:7], s16 offen
    buffer_load_dwordx4 v[18:21], v4, s[4:7], s16 offen offset:1024
    s_add_u32 s16, s18, 276480
    buffer_load_dwordx4 v[54:57], v4, s[4:7], s16 offen
    buffer_load_dwordx4 v[58:61], v4, s[4:7], s16 offen offset:1024
    v_cmp_gt_u32 vcc, 4, v249
    s_cbranch_vccz wcok_161
wc_160:
    buffer_load_dword v249, v248, s[4:7], 0 offen sc1
    s_waitcnt vmcnt(0)
    v_cmp_gt_u32 vcc, 4, v249
    s_cbranch_vccz wcok_161
    s_sleep 4
    s_sub_u32 s13, s13, 1
    s_cbranch_scc0 wc_160
    s_mov_b32 s13, 0
wcok_161:
    s_add_u32 s16, s18, 6144
    buffer_load_dwordx4 a[32:35], v4, s[4:7], s16 offen
    buffer_load_dwordx4 a[36:39], v4, s[4:7], s16 offen offset:1024
    s_add_u32 s16, s18, 20480
    buffer_load_dwordx4 a[72:75], v4, s[4:7], s16 offen
    buffer_load_dwordx4 a[76:79], v4, s[4:7], s16 offen offset:1024
    s_add_u32 s16, s18, 34816
    buffer_load_dwordx4 a[112:115], v4, s[4:7], s16 offen
    buffer_load_dwordx4 a[116:119], v4, s[4:7], s16 offen offset:1024
    s_add_u32 s16, s18, 49152
    buffer_load_dwordx4 a[152:155], v4, s[4:7], s16 offen
    buffer_load_dwordx4 a[156:159], v4, s[4:7], s16 offen offset:1024
    s_add_u32 s16, s18, 235520
    buffer_load_dwordx4 a[192:195], v4, s[4:7], s16 offen
    buffer_load_dwordx4 a[196:199], v4, s[4:7], s16 offen offset:1024
    s_add_u32 s16, s18, 249856
    buffer_load_dwordx4 a[232:235], v4, s[4:7], s16 offen
    buffer_load_dwordx4 a[236:239], v4, s[4:7], s16 offen offset:1024
    s_add_u32 s16, s18, 264192
    buffer_load_dwordx4 v[22:25], v4, s[4:7], s16 offen
    buffer_load_dwordx4 v[26:29], v4, s[4:7], s16 offen offset:1024
    s_add_u32 s16, s18, 278528
    buffer_load_dwordx4 v[62:65], v4, s[4:7], s16 offen
    buffer_load_dwordx4 v[66:69], v4, s[4:7], s16 offen offset:1024
    v_cmp_gt_u32 vcc, 5, v249
    s_cbranch_vccz wcok_163
wc_162:
    buffer_load_dword v249, v248, s[4:7], 0 offen sc1
    s_waitcnt vmcnt(0)
    v_cmp_gt_u32 vcc, 5, v249
    s_cbranch_vccz wcok_163
    s_sleep 4
    s_sub_u32 s13, s13, 1
    s_cbranch_scc0 wc_162
    s_mov_b32 s13, 0
wcok_163:
    s_add_u32 s16, s18, 8192
    s_add_u32 m0, s17, 0
    s_nop 0
    buffer_load_dwordx4 v4, s[4:7], s16 offen lds
    buffer_load_dwordx4 v4, s[4:7], s16 offen offset:1024 lds
    s_add_u32 s16, s18, 22528
    s_add_u32 m0, s17, 4096
    s_nop 0
    buffer_load_dwordx4 v4, s[4:7], s16 offen lds
    buffer_load_dwordx4 v4, s[4:7], s16 offen offset:1024 lds
    s_add_u32 s16, s18, 36864
    s_add_u32 m0, s17, 8192
    s_nop 0
    buffer_load_dwordx4 v4, s[4:7], s16 offen lds
    buffer_load_dwordx4 v4, s[4:7], s16 offen offset:1024 lds
    s_add_u32 s16, s18, 51200
    s_add_u32 m0, s17, 12288
    s_nop 0
    buffer_load_dwordx4 v4, s[4:7], s16 offen lds
    buffer_load_dwordx4 v4, s[4:7], s16 offen offset:1024 lds
    s_add_u32 s16, s18, 237568
    s_add_u32 m0, s17, 16384
    s_nop 0
    buffer_load_dwordx4 v4, s[4:7], s16 offen lds
    buffer_load_dwordx4 v4, s[4:7], s16 offen offset:1024 lds
    s_add_u32 s16, s18, 251904
    s_add_u32 m0, s17, 20480
    s_nop 0
    buffer_load_dwordx4 v4, s[4:7], s16 offen lds
    buffer_load_dwordx4 v4, s[4:7], s16 offen offset:1024 lds
    s_add_u32 s16, s18, 266240
    s_add_u32 m0, s17, 24576
    s_nop 0
    buffer_load_dwordx4 v4, s[4:7], s16 offen lds
    buffer_load_dwordx4 v4, s[4:7], s16 offen offset:1024 lds
    s_add_u32 s16, s18, 280576
    s_add_u32 m0, s17, 28672
    s_nop 0
    buffer_load_dwordx4 v4, s[4:7], s16 offen lds
    buffer_load_dwordx4 v4, s[4:7], s16 offen offset:1024 lds
    v_cmp_gt_u32 vcc, 6, v249
    s_cbranch_vccz wcok_165
wc_164:
    buffer_load_dword v249, v248, s[4:7], 0 offen sc1
    s_waitcnt vmcnt(0)
    v_cmp_gt_u32 vcc, 6, v249
    s_cbranch_vccz wcok_165
    s_sleep 4
    s_sub_u32 s13, s13, 1
    s_cbranch_scc0 wc_164
    s_mov_b32 s13, 0
wcok_165:
    s_add_u32 s16, s18, 10240
    s_add_u32 m0, s17, 2048
    s_nop 0
    buffer_load_dwordx4 v4, s[4:7], s16 offen lds
    buffer_load_dwordx4 v4, s[4:7], s16 offen offset:1024 lds
    s_add_u32 s16, s18, 24576
    s_add_u32 m0, s17, 6144
    s_nop 0
    buffer_load_dwordx4 v4, s[4:7], s16 offen lds
    buffer_load_dwordx4 v4, s[4:7], s16 offen offset:1024 lds
    s_add_u32 s16, s18, 38912
    s_add_u32 m0, s17, 10240
    s_nop 0
    buffer_load_dwordx4 v4, s[4:7], s16 offen lds
    buffer_load_dwordx4 v4, s[4:7], s16 offen offset:1024 lds
    s_add_u32 s16, s18, 53248
    s_add_u32 m0, s17, 14336
    s_nop 0
    buffer_load_dwordx4 v4, s[4:7], s16 offen lds
    buffer_load_dwordx4 v4, s[4:7], s16 offen offset:1024 lds
    s_add_u32 s16, s18, 239616
    s_add_u32 m0, s17, 18432
    s_nop 0
    buffer_load_dwordx4 v4, s[4:7], s16 offen lds
    buffer_load_dwordx4 v4, s[4:7], s16 offen offset:1024 lds
    s_add_u32 s16, s18, 253952
    s_add_u32 m0, s17, 22528
    s_nop 0
    buffer_load_dwordx4 v4, s[4:7], s16 offen lds
    buffer_load_dwordx4 v4, s[4:7], s16 offen offset:1024 lds
    s_add_u32 s16, s18, 268288
    s_add_u32 m0, s17, 26624
    s_nop 0
    buffer_load_dwordx4 v4, s[4:7], s16 offen lds
    buffer_load_dwordx4 v4, s[4:7], s16 offen offset:1024 lds
    s_add_u32 s16, s18, 282624
    s_add_u32 m0, s17, 30720
    s_nop 0
    buffer_load_dwordx4 v4, s[4:7], s16 offen lds
    buffer_load_dwordx4 v4, s[4:7], s16 offen offset:1024 lds
    v_cmp_gt_u32 vcc, 7, v249
    s_cbranch_vccz wcok_167
wc_166:
    buffer_load_dword v249, v248, s[4:7], 0 offen sc1
    s_waitcnt vmcnt(0)
    v_cmp_gt_u32 vcc, 7, v249
    s_cbranch_vccz wcok_167
    s_sleep 4
    s_sub_u32 s13, s13, 1
    s_cbranch_scc0 wc_166
    s_mov_b32 s13, 0
wcok_167:
    s_add_u32 s16, s18, 12288
    buffer_load_dwordx4 a[0:3], v4, s[4:7], s16 offen
    buffer_load_dwordx4 a[4:7], v4, s[4:7], s16 offen offset:1024
    s_add_u32 s16, s18, 26624
    buffer_load_dwordx4 a[40:43], v4, s[4:7], s16 offen
    buffer_load_dwordx4 a[44:47], v4, s[4:7], s16 offen offset:1024
    s_add_u32 s16, s18, 40960
    buffer_load_dwordx4 a[80:83], v4, s[4:7], s16 offen
    buffer_load_dwordx4 a[84:87], v4, s[4:7], s16 offen offset:1024
    s_add_u32 s16, s18, 55296
    buffer_load_dwordx4 a[120:123], v4, s[4:7], s16 offen
    buffer_load_dwordx4 a[124:127], v4, s[4:7], s16 offen offset:1024
    s_add_u32 s16, s18, 241664
    buffer_load_dwordx4 a[160:163], v4, s[4:7], s16 offen
    buffer_load_dwordx4 a[164:167], v4, s[4:7], s16 offen offset:1024
    s_add_u32 s16, s18, 256000
    buffer_load_dwordx4 a[200:203], v4, s[4:7], s16 offen
    buffer_load_dwordx4 a[204:207], v4, s[4:7], s16 offen offset:1024
    s_add_u32 s16, s18, 270336
    buffer_load_dwordx4 a[240:243], v4, s[4:7], s16 offen
    buffer_load_dwordx4 a[244:247], v4, s[4:7], s16 offen offset:1024
    s_add_u32 s16, s18, 284672
    buffer_load_dwordx4 v[30:33], v4, s[4:7], s16 offen
    buffer_load_dwordx4 v[34:37], v4, s[4:7], s16 offen offset:1024
pwout_107:
    s_add_u32 s21, s21, 139264
    s_add_u32 s22, s22, 139264
    s_add_u32 s23, s23, 139264
    s_add_u32 s24, s24, 139264
    s_add_u32 s25, s25, 139264
    v_mov_b32 v70, 0x4444
    v_mov_b32 v71, 0xeeee
    v_and_b32 v72, 1, v2
    v_cmp_eq_u32 vcc, 0, v72
    s_nop 1
    v_cndmask_b32 v70, v71, v70, vcc
    s_lshl_b32 s26, s10, 11
    v_add_u32 v71, s26, v4
    v_add_u32 v73, 139264, v71
    s_cmp_eq_u32 s10, 3
    s_cselect_b32 s26, -6, 1
    s_lshl_b32 s26, s26, 10
    v_add_u32 v72, s26, v71
    s_lshl_b32 s26, s8, 13
    s_add_u32 s26, s26, 139264
    s_lshl_b32 s27, s9, 2
    s_add_u32 s27, s27, s10
    s_lshl_b32 s27, s27, 2
    s_add_u32 s27, s27, s26
    s_add_u32 s27, s27, 0
    v_lshl_add_u32 v74, v1, 8, s27
    v_mov_b32 v75, 1073741824
    v_cmp_gt_u32 vcc, 1, v1
    s_nop 1
    v_cndmask_b32 v74, v75, v74, vcc
    s_lshr_b32 s27, s2, 3
    s_lshr_b32 s27, s27, 5
    s_lshl_b32 s27, s27, 8
    s_add_u32 s27, s27, s26
    v_min_u32 v76, 55, v1
    v_lshl_add_u32 v76, v76, 2, s27
    s_cmp_eq_u32 s10, 0
    s_cselect_b32 s27, 0, 1073741824
    v_or_b32 v76, s27, v76
    s_lshl_b32 s26, s8, 13
    s_add_u32 s26, s26, 155648
    s_lshr_b32 s27, s2, 3
    s_lshr_b32 s27, s27, 5
    s_lshl_b32 s27, s27, 8
    s_add_u32 s27, s27, s26
    v_min_u32 v77, 15, v1
    v_lshl_add_u32 v77, v77, 2, s27
    s_cmp_eq_u32 s10, 0
    s_cselect_b32 s27, 0, 1073741824
    v_or_b32 v77, s27, v77
    s_lshl_b32 s26, s8, 7
    s_add_u32 s26, s26, 172032
    v_and_b32 v83, 3, v1
    v_lshl_add_u32 v83, v83, 2, s26
    v_mov_b32 v84, 0
    v_add_u32 v78, s17, v4
    v_mov_b32 v86, 1073741824
    v_lshrrev_b32 v85, 1, v2
    v_lshl_add_u32 v85, v3, 3, v85
    v_lshlrev_b32 v85, 4, v85
    v_add_u32 v85, 2048, v85
    v_and_b32 v87, 1, v2
    v_cmp_eq_u32 vcc, 0, v87
    s_nop 1
    v_cndmask_b32 v79, v86, v85, vcc
    s_mul_i32 s16, s10, 1280
    s_add_u32 s16, s16, 131072
    v_lshl_add_u32 v80, v1, 2, s16
    v_bfe_u32 v85, v1, 3, 2
    v_mul_u32_u24 v85, 320, v85
    v_and_b32 v87, 3, v1
    v_lshl_add_u32 v85, v87, 4, v85
    v_bfe_u32 v88, v1, 2, 1
    v_lshl_add_u32 v85, v88, 3, v85
    s_lshl_b32 s16, s10, 6
    s_add_u32 s16, s16, 131072
    v_add_u32 v81, s16, v85
    v_bfe_u32 v85, v1, 4, 1
    v_lshlrev_b32 v85, 8, v85
    v_lshl_add_u32 v85, v2, 2, v85
    s_lshl_b32 s16, s9, 3
    s_add_u32 s16, s16, s10
    s_lshl_b32 s16, s16, 6
    v_add_u32 v85, s16, v85
    v_cmp_gt_u32 vcc, 32, v1
    s_nop 1
    v_cndmask_b32 v82, v86, v85, vcc
    s_mul_i32 s26, s8, 458752
    s_add_u32 s26, s26, 208896
    s_mul_i32 s28, s8, 655360
    s_add_u32 s28, s28, 2043904
    s_mul_i32 s29, s8, 7340032
    s_add_u32 s29, s29, 25833472
    s_mul_i32 s31, s8, 917504
    s_add_u32 s31, s31, 3354624
    s_mul_i32 s16, s10, 2560
    s_add_u32 s28, s28, s16
    s_lshl_b32 s16, s9, 15
    s_add_u32 s29, s29, s16
    s_lshl_b32 s16, s10, 12
    s_add_u32 s29, s29, s16
    s_lshl_b32 s16, s9, 13
    s_add_u32 s31, s31, s16
    s_lshl_b32 s16, s10, 10
    s_add_u32 s31, s31, s16
    v_lshlrev_b32 v86, 7, v0
    s_mov_b32 s36, 176132
ww_168:
    buffer_load_dword v87, v86, s[4:7], s36 offen sc1
    s_waitcnt vmcnt(0)
    v_cmp_eq_u32 vcc, 0, v87
    s_cbranch_vccz wwok_169
    s_sleep 4
    s_sub_u32 s13, s13, 1
    s_cbranch_scc0 ww_168
    s_mov_b32 s13, 0
wwok_169:
    s_barrier
    v_and_b32 v86, 63, v0
    v_min_u32 v86, 31, v86
    v_lshlrev_b32 v86, 10, v86
    s_and_b32 s36, s2, 7
    s_lshl_b32 s36, s36, 7
    s_add_u32 s36, s36, 176128
    buffer_load_dword v87, v86, s[4:7], s36 offen sc1
    s_waitcnt vmcnt(0)
    v_cmp_ne_u32 vcc, s15, v87
    s_cmp_lg_u64 vcc, 0
    s_cselect_b32 s12, 1, 0
    v_mov_b32 v114, 0
    v_mov_b32 v115, 0
    v_mov_b32 v116, 0
    v_mov_b32 v117, 0
    v_mov_b32 v118, 0
    v_mov_b32 v119, 0
    v_mov_b32 v120, 0
    v_mov_b32 v121, 0
    v_mov_b32 v122, 0
    v_mov_b32 v123, 0
    v_mov_b32 v124, 0
    v_mov_b32 v125, 0
    v_mov_b32 v126, 0
    v_mov_b32 v127, 0
    v_mov_b32 v128, 0
    v_mov_b32 v129, 0
    v_mov_b32 v130, 0
    v_mov_b32 v131, 0
    v_mov_b32 v132, 0
    v_mov_b32 v133, 0
    v_mov_b32 v134, 0
    v_mov_b32 v135, 0
    v_mov_b32 v136, 0
    v_mov_b32 v137, 0
    v_mov_b32 v138, 0
    v_mov_b32 v139, 0
    v_mov_b32 v140, 0
    v_mov_b32 v141, 0
    v_mov_b32 v142, 0
    v_mov_b32 v143, 0
    v_mov_b32 v144, 0
    v_mov_b32 v145, 0
    s_cmp_lg_u32 s12, 0
    s_cbranch_scc1 far_170
Vloop_171:
    s_add_u32 s27, s26, 7168
    s_add_u32 s34, s11, 1
    v_mov_b32 v75, s34
    v_cmp_ge_u32 vcc, s11, v84
    s_and_b32 vcc_lo, vcc_lo, 15
    s_cbranch_scc0 rlok_174
rl_173:
    buffer_load_dword v84, v83, s[4:7], 0 offen sc1
    s_waitcnt vmcnt(0)
    v_cmp_ge_u32 vcc, s11, v84
    s_and_b32 vcc_lo, vcc_lo, 15
    s_cbranch_scc0 rlok_174
    s_sleep 1
    s_sub_u32 s13, s13, 1
    s_cbranch_scc0 rl_173
    s_mov_b32 s13, 0
rlok_174:
    s_and_b32 s35, s11, 15
    s_mul_i32 s35, s35, 458752
    s_add_u32 s35, s35, s29
    s_add_u32 s30, s35, 16384
    s_sub_u32 s33, s11, 1
    s_and_b32 s33, s33, 7
    s_mul_i32 s33, s33, 114688
    s_add_u32 s33, s33, s31
    s_cmp_eq_u32 s11, 0
    s_cselect_b32 s33, 44380160, s33
    s_add_u32 s32, s33, 4096
    buffer_load_dword v198, v76, s[4:7], 0 offen sc1
    s_nop 4
    buffer_load_dword v199, v76, s[4:7], 0 offen sc1
    s_nop 4
    s_cmp_lg_u32 s10, 0
    s_cbranch_scc1 hintok_176
hint_175:
    buffer_load_dword v200, v76, s[4:7], 0 offen sc1
    s_waitcnt vmcnt(2)
    v_cmp_gt_u32 vcc, s11, v198
    s_cbranch_vccz hintok_176
    buffer_load_dword v198, v76, s[4:7], 0 offen sc1
    s_waitcnt vmcnt(2)
    v_cmp_gt_u32 vcc, s11, v199
    s_cbranch_vccz hintok_176
    buffer_load_dword v199, v76, s[4:7], 0 offen sc1
    s_waitcnt vmcnt(2)
    v_cmp_gt_u32 vcc, s11, v200
    s_cbranch_vccz hintok_176
    s_sub_u32 s13, s13, 1
    s_cbranch_scc0 hint_175
    s_mov_b32 s13, 0
hintok_176:
    s_barrier
    buffer_load_dwordx4 v[86:89], v71, s[4:7], s26 offen sc1
    buffer_load_dwordx4 v[90:93], v72, s[4:7], s26 offen sc1
    v_add_u32 v94, s21, v4
    v_add_u32 v98, s22, v4
    v_add_u32 v102, s23, v4
    v_add_u32 v106, s24, v4
    v_add_u32 v110, s25, v4
    buffer_store_dwordx4 v[178:181], v4, s[4:7], s33 offen sc1
    buffer_store_dwordx4 v[182:185], v4, s[4:7], s32 offen sc1
    buffer_load_dword v231, v82, s[4:7], s27 offen sc1
    buffer_load_dwordx4 v[146:149], v4, s[4:7], s35 offen offset:0 sc1
    s_waitcnt vmcnt(5)
    v_smfmac_f32_16x16x64_bf16 v[114:117], v[86:89], a[0:7], v70
    ds_write_b128 v73, v[86:89] offset:0
    v_smfmac_f32_16x16x64_bf16 v[118:121], v[86:89], a[40:47], v70
    v_max3_u32 v230, v86, v87, v88
    v_smfmac_f32_16x16x64_bf16 v[122:125], v[86:89], a[80:87], v70
    v_smfmac_f32_16x16x64_bf16 v[126:129], v[86:89], a[120:127], v70
    v_smfmac_f32_16x16x64_bf16 v[130:133], v[86:89], a[160:167], v70
    s_waitcnt vmcnt(4)
    ds_write_b128 v73, v[90:93] offset:1024
    v_smfmac_f32_16x16x64_bf16 v[134:137], v[86:89], a[200:207], v70
    v_max3_u32 v230, v230, v89, v90
    v_smfmac_f32_16x16x64_bf16 v[138:141], v[86:89], a[240:247], v70
    v_max3_u32 v230, v230, v91, v92
    v_smfmac_f32_16x16x64_bf16 v[142:145], v[86:89], v[30:37], v70
    v_max_u32 v230, v230, v93
    v_smfmac_f32_16x16x64_bf16 v[114:117], v[90:93], a[8:15], v70
    v_cmp_eq_u32 vcc, -1, v230
    v_smfmac_f32_16x16x64_bf16 v[118:121], v[90:93], a[48:55], v70
    s_cbranch_vccnz bad_177
join_178:
    s_waitcnt lgkmcnt(0)
    s_barrier
    v_smfmac_f32_16x16x64_bf16 v[122:125], v[90:93], a[88:95], v70
    ds_read_b128 v[94:97], v94
    buffer_load_dwordx4 v[150:153], v4, s[4:7], s35 offen offset:1024 sc1
    v_smfmac_f32_16x16x64_bf16 v[126:129], v[90:93], a[128:135], v70
    ds_read_b128 v[98:101], v98
    buffer_load_dwordx4 v[154:157], v4, s[4:7], s35 offen offset:2048 sc1
    v_smfmac_f32_16x16x64_bf16 v[130:133], v[90:93], a[168:175], v70
    ds_read_b128 v[102:105], v102
    v_smfmac_f32_16x16x64_bf16 v[134:137], v[90:93], a[208:215], v70
    ds_read_b128 v[106:109], v106
    buffer_load_dwordx4 v[158:161], v4, s[4:7], s35 offen offset:3072 sc1
    v_smfmac_f32_16x16x64_bf16 v[138:141], v[90:93], a[248:255], v70
    ds_read_b128 v[110:113], v110
    buffer_load_dwordx4 v[162:165], v4, s[4:7], s30 offen offset:0 sc1
    v_smfmac_f32_16x16x64_bf16 v[142:145], v[90:93], v[38:45], v70
    ds_read_b128 v[206:209], v78 offset:0
    buffer_load_dwordx4 v[166:169], v4, s[4:7], s30 offen offset:1024 sc1
    ds_read_b128 v[210:213], v78 offset:1024
    buffer_load_dwordx4 v[170:173], v4, s[4:7], s30 offen offset:2048 sc1
    ds_read_b128 v[214:217], v78 offset:2048
    s_waitcnt lgkmcnt(7)
    v_smfmac_f32_16x16x64_bf16 v[114:117], v[94:97], a[16:23], v70
    ds_read_b128 v[218:221], v78 offset:3072
    buffer_load_dwordx4 v[174:177], v4, s[4:7], s30 offen offset:3072 sc1
    s_waitcnt lgkmcnt(7)
    v_smfmac_f32_16x16x64_bf16 v[114:117], v[98:101], a[24:31], v70
    ds_read_b128 v[222:225], v78 offset:4096
    v_smfmac_f32_16x16x64_bf16 v[118:121], v[94:97], a[56:63], v70
    ds_read_b128 v[226:229], v78 offset:5120
    s_waitcnt lgkmcnt(8)
    v_smfmac_f32_16x16x64_bf16 v[114:117], v[102:105], a[32:39], v70
    v_smfmac_f32_16x16x64_bf16 v[118:121], v[98:101], a[64:71], v70
    v_smfmac_f32_16x16x64_bf16 v[118:121], v[102:105], a[72:79], v70
    v_smfmac_f32_16x16x64_bf16 v[122:125], v[94:97], a[96:103], v70
    s_waitcnt lgkmcnt(4)
    v_smfmac_f32_16x16x64_bf16 v[114:117], v[106:109], v[206:213], v70
    ds_read_b128 v[206:209], v78 offset:6144
    v_smfmac_f32_16x16x64_bf16 v[122:125], v[98:101], a[104:111], v70
    ds_read_b128 v[210:213], v78 offset:7168
    s_waitcnt lgkmcnt(4)
    v_smfmac_f32_16x16x64_bf16 v[114:117], v[110:113], v[214:221], v70
    ds_read_b128 v[214:217], v78 offset:8192
    v_smfmac_f32_16x16x64_bf16 v[126:129], v[94:97], a[136:143], v70
    ds_read_b128 v[218:221], v78 offset:9216
    s_waitcnt lgkmcnt(4)
    v_smfmac_f32_16x16x64_bf16 v[118:121], v[106:109], v[222:229], v70
    ds_read_b128 v[222:225], v78 offset:10240
    v_smfmac_f32_16x16x64_bf16 v[122:125], v[102:105], a[112:119], v70
    ds_read_b128 v[226:229], v78 offset:11264
    v_smfmac_f32_16x16x64_bf16 v[126:129], v[98:101], a[144:151], v70
    v_add_f32 v114, v114, v115
    v_smfmac_f32_16x16x64_bf16 v[126:129], v[102:105], a[152:159], v70
    v_add_f32 v116, v116, v117
    v_smfmac_f32_16x16x64_bf16 v[130:133], v[94:97], a[176:183], v70
    v_cvt_pk_bf16_f32 v178, v114, v116
    v_smfmac_f32_16x16x64_bf16 v[130:133], v[98:101], a[184:191], v70
    s_waitcnt lgkmcnt(4)
    v_smfmac_f32_16x16x64_bf16 v[118:121], v[110:113], v[206:213], v70
    ds_read_b128 v[206:209], v78 offset:12288
    v_smfmac_f32_16x16x64_bf16 v[130:133], v[102:105], a[192:199], v70
    ds_read_b128 v[210:213], v78 offset:13312
    s_waitcnt lgkmcnt(4)
    v_smfmac_f32_16x16x64_bf16 v[122:125], v[106:109], v[214:221], v70
    ds_read_b128 v[214:217], v78 offset:14336
    v_smfmac_f32_16x16x64_bf16 v[134:137], v[94:97], a[216:223], v70
    ds_read_b128 v[218:221], v78 offset:15360
    s_waitcnt lgkmcnt(4)
    v_smfmac_f32_16x16x64_bf16 v[122:125], v[110:113], v[222:229], v70
    ds_read_b128 v[222:225], v78 offset:16384
    v_add_f32 v118, v118, v119
    v_smfmac_f32_16x16x64_bf16 v[134:137], v[98:101], a[224:231], v70
    ds_read_b128 v[226:229], v78 offset:17408
    v_add_f32 v120, v120, v121
    v_smfmac_f32_16x16x64_bf16 v[138:141], v[94:97], v[6:13], v70
    v_cvt_pk_bf16_f32 v179, v118, v120
    v_smfmac_f32_16x16x64_bf16 v[134:137], v[102:105], a[232:239], v70
    v_add_f32 v122, v122, v123
    v_smfmac_f32_16x16x64_bf16 v[138:141], v[98:101], v[14:21], v70
    v_add_f32 v124, v124, v125
    v_smfmac_f32_16x16x64_bf16 v[138:141], v[102:105], v[22:29], v70
    v_cvt_pk_bf16_f32 v180, v122, v124
    s_waitcnt lgkmcnt(4)
    v_smfmac_f32_16x16x64_bf16 v[126:129], v[106:109], v[206:213], v70
    ds_read_b128 v[206:209], v78 offset:18432
    v_smfmac_f32_16x16x64_bf16 v[142:145], v[94:97], v[46:53], v70
    ds_read_b128 v[210:213], v78 offset:19456
    s_waitcnt lgkmcnt(4)
    v_smfmac_f32_16x16x64_bf16 v[126:129], v[110:113], v[214:221], v70
    ds_read_b128 v[214:217], v78 offset:20480
    v_smfmac_f32_16x16x64_bf16 v[142:145], v[98:101], v[54:61], v70
    ds_read_b128 v[218:221], v78 offset:21504
    s_waitcnt lgkmcnt(4)
    v_smfmac_f32_16x16x64_bf16 v[130:133], v[106:109], v[222:229], v70
    ds_read_b128 v[222:225], v78 offset:22528
    v_smfmac_f32_16x16x64_bf16 v[142:145], v[102:105], v[62:69], v70
    ds_read_b128 v[226:229], v78 offset:23552
    v_add_f32 v126, v126, v127
    v_add_f32 v128, v128, v129
    v_cvt_pk_bf16_f32 v181, v126, v128
    s_waitcnt lgkmcnt(4)
    v_smfmac_f32_16x16x64_bf16 v[130:133], v[110:113], v[206:213], v70
    ds_read_b128 v[206:209], v78 offset:24576
    ds_read_b128 v[210:213], v78 offset:25600
    s_waitcnt lgkmcnt(4)
    v_smfmac_f32_16x16x64_bf16 v[134:137], v[106:109], v[214:221], v70
    ds_read_b128 v[214:217], v78 offset:26624
    s_nop 2
    v_add_f32 v130, v130, v131
    v_add_f32 v132, v132, v133
    ds_read_b128 v[218:221], v78 offset:27648
    v_cvt_pk_bf16_f32 v182, v130, v132
    s_waitcnt lgkmcnt(4)
    v_smfmac_f32_16x16x64_bf16 v[134:137], v[110:113], v[222:229], v70
    ds_read_b128 v[222:225], v78 offset:28672
    ds_read_b128 v[226:229], v78 offset:29696
    s_nop 5
    v_add_f32 v134, v134, v135
    v_add_f32 v136, v136, v137
    v_cvt_pk_bf16_f32 v183, v134, v136
    s_waitcnt lgkmcnt(4)
    v_smfmac_f32_16x16x64_bf16 v[138:141], v[106:109], v[206:213], v70
    ds_read_b128 v[206:209], v78 offset:30720
    ds_read_b128 v[210:213], v78 offset:31744
    s_waitcnt lgkmcnt(4)
    v_smfmac_f32_16x16x64_bf16 v[138:141], v[110:113], v[214:221], v70
    s_waitcnt lgkmcnt(2)
    v_smfmac_f32_16x16x64_bf16 v[142:145], v[106:109], v[222:229], v70
    s_nop 5
    v_add_f32 v138, v138, v139
    v_add_f32 v140, v140, v141
    v_cvt_pk_bf16_f32 v184, v138, v140
    s_waitcnt lgkmcnt(0)
    v_smfmac_f32_16x16x64_bf16 v[142:145], v[110:113], v[206:213], v70
    s_nop 7
    v_add_f32 v142, v142, v143
    v_add_f32 v144, v144, v145
    v_cvt_pk_bf16_f32 v185, v142, v144
    s_cmp_eq_u32 s11, 63
    s_cbranch_scc1 Vdone_172
    buffer_load_dword v86, v77, s[4:7], 0 offen sc1
    buffer_load_dword v84, v83, s[4:7], 0 offen sc1
    v_mov_b32 v115, 0
    v_mov_b32 v117, 0
    v_mov_b32 v119, 0
    v_mov_b32 v121, 0
    v_mov_b32 v123, 0
    v_mov_b32 v125, 0
    v_mov_b32 v127, 0
    v_mov_b32 v129, 0
    v_mov_b32 v131, 0
    v_mov_b32 v133, 0
    v_mov_b32 v135, 0
    v_mov_b32 v137, 0
    v_mov_b32 v139, 0
    v_mov_b32 v141, 0
    v_mov_b32 v143, 0
    v_mov_b32 v145, 0
    buffer_load_dword v87, v77, s[4:7], 0 offen sc1
    v_mov_b32 v114, 0
    v_mov_b32 v116, 0
    v_mov_b32 v118, 0
    v_mov_b32 v120, 0
    v_mov_b32 v122, 0
    v_mov_b32 v124, 0
    v_mov_b32 v126, 0
    v_mov_b32 v128, 0
    v_mov_b32 v130, 0
    v_mov_b32 v132, 0
    v_mov_b32 v134, 0
    v_mov_b32 v136, 0
    v_mov_b32 v138, 0
    v_mov_b32 v140, 0
    v_mov_b32 v142, 0
    v_mov_b32 v144, 0
    s_cmp_lg_u32 s10, 0
    s_cbranch_scc1 hintok_182
hint_181:
    buffer_load_dword v88, v77, s[4:7], 0 offen sc1
    s_waitcnt vmcnt(2)
    v_cmp_gt_u32 vcc, s34, v86
    s_cbranch_vccz hintok_182
    buffer_load_dword v86, v77, s[4:7], 0 offen sc1
    s_waitcnt vmcnt(2)
    v_cmp_gt_u32 vcc, s34, v87
    s_cbranch_vccz hintok_182
    buffer_load_dword v87, v77, s[4:7], 0 offen sc1
    s_waitcnt vmcnt(2)
    v_cmp_gt_u32 vcc, s34, v88
    s_cbranch_vccz hintok_182
    s_sub_u32 s13, s13, 1
    s_cbranch_scc0 hint_181
    s_mov_b32 s13, 0
hintok_182:
    s_barrier
Ppoll_183:
    buffer_load_dwordx4 v[194:197], v79, s[4:7], s28 offen sc1
    buffer_load_dwordx4 v[186:189], v4, s[4:7], s28 offen offset:0 sc1
    buffer_load_dwordx4 v[190:193], v4, s[4:7], s28 offen offset:1024 sc1
    s_waitcnt vmcnt(2)
    v_mfma_f32_16x16x32_bf16 v[198:201], v[194:197], v[178:181], 0
    v_max3_u32 v230, v194, v195, v196
    v_mfma_f32_16x16x32_bf16 v[202:205], v[194:197], v[182:185], 0
    s_waitcnt vmcnt(1)
    v_smfmac_f32_16x16x64_bf16 v[198:201], v[186:189], v[146:153], v70
    v_max3_u32 v230, v230, v197, v186
    v_smfmac_f32_16x16x64_bf16 v[202:205], v[186:189], v[162:169], v70
    v_max3_u32 v230, v230, v187, v188
    s_waitcnt vmcnt(0)
    v_smfmac_f32_16x16x64_bf16 v[198:201], v[190:193], v[154:161], v70
    v_max3_u32 v230, v230, v189, v190
    v_smfmac_f32_16x16x64_bf16 v[202:205], v[190:193], v[170:177], v70
    v_max3_u32 v230, v230, v191, v192
    v_max_u32 v230, v230, v193
    v_cmp_eq_u32 vcc, -1, v230
    s_nop 2
    v_add_f32 v198, v198, v199
    v_add_f32 v200, v200, v201
    v_add_f32 v202, v202, v203
    v_add_f32 v204, v204, v205
    ds_write2_b32 v80, v198, v200 offset0:0 offset1:80
    ds_write2_b32 v80, v202, v204 offset0:160 offset1:240
    s_cbranch_vccz Pgot_184
    s_sub_u32 s13, s13, 1
    s_cbranch_scc0 Ppoll_183
    s_mov_b32 s13, 0
Pgot_184:
    buffer_store_dword v75, v74, s[4:7], 0 offen
    s_waitcnt lgkmcnt(0)
    s_barrier
    ds_read_b64 v[98:99], v81 offset:0
    ds_read_b64 v[100:101], v81 offset:1280
    ds_read_b64 v[102:103], v81 offset:2560
    ds_read_b64 v[104:105], v81 offset:3840
    s_waitcnt lgkmcnt(2)
    v_add_f32 v106, v98, v100
    v_add_f32 v107, v99, v101
    s_waitcnt lgkmcnt(0)
    v_add_f32 v110, v102, v104
    v_add_f32 v111, v103, v105
    v_add_f32 v106, v106, v110
    v_add_f32 v107, v107, v111
    v_cvt_pk_bf16_f32 v232, v106, v107
    buffer_store_dword v232, v82, s[4:7], s27 offen
    s_add_u32 s11, s11, 1
    s_mov_b32 s26, s27
    s_add_u32 s28, s28, 10240
    s_branch Vloop_171
Vdone_172:
    v_cmp_ge_u32 vcc, s34, v84
    s_and_b32 vcc_lo, vcc_lo, 3
    s_cbranch_scc0 rlok_186
rl_185:
    buffer_load_dword v84, v83, s[4:7], 0 offen sc1
    s_waitcnt vmcnt(0)
    v_cmp_ge_u32 vcc, s34, v84
    s_and_b32 vcc_lo, vcc_lo, 3
    s_cbranch_scc0 rlok_186
    s_sleep 1
    s_sub_u32 s13, s13, 1
    s_cbranch_scc0 rl_185
    s_mov_b32 s13, 0
rlok_186:
    s_sub_u32 s33, s11, 0
    s_and_b32 s33, s33, 7
    s_mul_i32 s33, s33, 114688
    s_add_u32 s33, s33, s31
    s_add_u32 s32, s33, 4096
    buffer_store_dwordx4 v[178:181], v4, s[4:7], s33 offen sc1
    buffer_store_dwordx4 v[182:185], v4, s[4:7], s32 offen sc1
    s_endpgm
.p2align 6
far_170:
Vloop_187:
    s_add_u32 s27, s26, 7168
    s_add_u32 s34, s11, 1
    v_mov_b32 v75, s34
    v_cmp_ge_u32 vcc, s11, v84
    s_and_b32 vcc_lo, vcc_lo, 15
    s_cbranch_scc0 rlok_190
rl_189:
    buffer_load_dword v84, v83, s[4:7], 0 offen sc1
    s_waitcnt vmcnt(0)
    v_cmp_ge_u32 vcc, s11, v84
    s_and_b32 vcc_lo, vcc_lo, 15
    s_cbranch_scc0 rlok_190
    s_sleep 1
    s_sub_u32 s13, s13, 1
    s_cbranch_scc0 rl_189
    s_mov_b32 s13, 0
rlok_190:
    s_and_b32 s35, s11, 15
    s_mul_i32 s35, s35, 458752
    s_add_u32 s35, s35, s29
    s_add_u32 s30, s35, 16384
    s_sub_u32 s33, s11, 1
    s_and_b32 s33, s33, 7
    s_mul_i32 s33, s33, 114688
    s_add_u32 s33, s33, s31
    s_cmp_eq_u32 s11, 0
    s_cselect_b32 s33, 44380160, s33
    s_add_u32 s32, s33, 4096
    buffer_load_dword v198, v76, s[4:7], 0 offen sc1
    s_nop 4
    buffer_load_dword v199, v76, s[4:7], 0 offen sc1
    s_nop 4
    s_cmp_lg_u32 s10, 0
    s_cbranch_scc1 hintok_192
hint_191:
    buffer_load_dword v200, v76, s[4:7], 0 offen sc1
    s_waitcnt vmcnt(2)
    v_cmp_gt_u32 vcc, s11, v198
    s_cbranch_vccz hintok_192
    buffer_load_dword v198, v76, s[4:7], 0 offen sc1
    s_waitcnt vmcnt(2)
    v_cmp_gt_u32 vcc, s11, v199
    s_cbranch_vccz hintok_192
    buffer_load_dword v199, v76, s[4:7], 0 offen sc1
    s_waitcnt vmcnt(2)
    v_cmp_gt_u32 vcc, s11, v200
    s_cbranch_vccz hintok_192
    s_sub_u32 s13, s13, 1
    s_cbranch_scc0 hint_191
    s_mov_b32 s13, 0
hintok_192:
    s_barrier
    buffer_load_dwordx4 v[86:89], v71, s[4:7], s26 offen sc1
    buffer_load_dwordx4 v[90:93], v72, s[4:7], s26 offen sc1
    v_add_u32 v94, s21, v4
    v_add_u32 v98, s22, v4
    v_add_u32 v102, s23, v4
    v_add_u32 v106, s24, v4
    v_add_u32 v110, s25, v4
    buffer_store_dwordx4 v[178:181], v4, s[4:7], s33 offen sc1
    buffer_store_dwordx4 v[182:185], v4, s[4:7], s32 offen sc1
    buffer_load_dword v231, v82, s[4:7], s27 offen sc1
    buffer_load_dwordx4 v[146:149], v4, s[4:7], s35 offen offset:0 sc1
    s_waitcnt vmcnt(5)
    v_smfmac_f32_16x16x64_bf16 v[114:117], v[86:89], a[0:7], v70
    ds_write_b128 v73, v[86:89] offset:0
    v_smfmac_f32_16x16x64_bf16 v[118:121], v[86:89], a[40:47], v70
    v_max3_u32 v230, v86, v87, v88
    v_smfmac_f32_16x16x64_bf16 v[122:125], v[86:89], a[80:87], v70
    v_smfmac_f32_16x16x64_bf16 v[126:129], v[86:89], a[120:127], v70
    v_smfmac_f32_16x16x64_bf16 v[130:133], v[86:89], a[160:167], v70
    s_waitcnt vmcnt(4)
    ds_write_b128 v73, v[90:93] offset:1024
    v_smfmac_f32_16x16x64_bf16 v[134:137], v[86:89], a[200:207], v70
    v_max3_u32 v230, v230, v89, v90
    v_smfmac_f32_16x16x64_bf16 v[138:141], v[86:89], a[240:247], v70
    v_max3_u32 v230, v230, v91, v92
    v_smfmac_f32_16x16x64_bf16 v[142:145], v[86:89], v[30:37], v70
    v_max_u32 v230, v230, v93
    v_smfmac_f32_16x16x64_bf16 v[114:117], v[90:93], a[8:15], v70
    v_cmp_eq_u32 vcc, -1, v230
    v_smfmac_f32_16x16x64_bf16 v[118:121], v[90:93], a[48:55], v70
    s_cbranch_vccnz bad_193
join_194:
    s_waitcnt lgkmcnt(0)
    s_barrier
    v_smfmac_f32_16x16x64_bf16 v[122:125], v[90:93], a[88:95], v70
    ds_read_b128 v[94:97], v94
    buffer_load_dwordx4 v[150:153], v4, s[4:7], s35 offen offset:1024 sc1
    v_smfmac_f32_16x16x64_bf16 v[126:129], v[90:93], a[128:135], v70
    ds_read_b128 v[98:101], v98
    buffer_load_dwordx4 v[154:157], v4, s[4:7], s35 offen offset:2048 sc1
    v_smfmac_f32_16x16x64_bf16 v[130:133], v[90:93], a[168:175], v70
    ds_read_b128 v[102:105], v102
    v_smfmac_f32_16x16x64_bf16 v[134:137], v[90:93], a[208:215], v70
    ds_read_b128 v[106:109], v106
    buffer_load_dwordx4 v[158:161], v4, s[4:7], s35 offen offset:3072 sc1
    v_smfmac_f32_16x16x64_bf16 v[138:141], v[90:93], a[248:255], v70
    ds_read_b128 v[110:113], v110
    buffer_load_dwordx4 v[162:165], v4, s[4:7], s30 offen offset:0 sc1
    v_smfmac_f32_16x16x64_bf16 v[142:145], v[90:93], v[38:45], v70
    ds_read_b128 v[206:209], v78 offset:0
    buffer_load_dwordx4 v[166:169], v4, s[4:7], s30 offen offset:1024 sc1
    ds_read_b128 v[210:213], v78 offset:1024
    buffer_load_dwordx4 v[170:173], v4, s[4:7], s30 offen offset:2048 sc1
    ds_read_b128 v[214:217], v78 offset:2048
    s_waitcnt lgkmcnt(7)
    v_smfmac_f32_16x16x64_bf16 v[114:117], v[94:97], a[16:23], v70
    ds_read_b128 v[218:221], v78 offset:3072
    buffer_load_dwordx4 v[174:177], v4, s[4:7], s30 offen offset:3072 sc1
    s_waitcnt lgkmcnt(7)
    v_smfmac_f32_16x16x64_bf16 v[114:117], v[98:101], a[24:31], v70
    ds_read_b128 v[222:225], v78 offset:4096
    v_smfmac_f32_16x16x64_bf16 v[118:121], v[94:97], a[56:63], v70
    ds_read_b128 v[226:229], v78 offset:5120
    s_waitcnt lgkmcnt(8)
    v_smfmac_f32_16x16x64_bf16 v[114:117], v[102:105], a[32:39], v70
    v_smfmac_f32_16x16x64_bf16 v[118:121], v[98:101], a[64:71], v70
    v_smfmac_f32_16x16x64_bf16 v[118:121], v[102:105], a[72:79], v70
    v_smfmac_f32_16x16x64_bf16 v[122:125], v[94:97], a[96:103], v70
    s_waitcnt lgkmcnt(4)
    v_smfmac_f32_16x16x64_bf16 v[114:117], v[106:109], v[206:213], v70
    ds_read_b128 v[206:209], v78 offset:6144
    v_smfmac_f32_16x16x64_bf16 v[122:125], v[98:101], a[104:111], v70
    ds_read_b128 v[210:213], v78 offset:7168
    s_waitcnt lgkmcnt(4)
    v_smfmac_f32_16x16x64_bf16 v[114:117], v[110:113], v[214:221], v70
    ds_read_b128 v[214:217], v78 offset:8192
    v_smfmac_f32_16x16x64_bf16 v[126:129], v[94:97], a[136:143], v70
    ds_read_b128 v[218:221], v78 offset:9216
    s_waitcnt lgkmcnt(4)
    v_smfmac_f32_16x16x64_bf16 v[118:121], v[106:109], v[222:229], v70
    ds_read_b128 v[222:225], v78 offset:10240
    v_smfmac_f32_16x16x64_bf16 v[122:125], v[102:105], a[112:119], v70
    ds_read_b128 v[226:229], v78 offset:11264
    v_smfmac_f32_16x16x64_bf16 v[126:129], v[98:101], a[144:151], v70
    v_add_f32 v114, v114, v115
    v_smfmac_f32_16x16x64_bf16 v[126:129], v[102:105], a[152:159], v70
    v_add_f32 v116, v116, v117
    v_smfmac_f32_16x16x64_bf16 v[130:133], v[94:97], a[176:183], v70
    v_cvt_pk_bf16_f32 v178, v114, v116
    v_smfmac_f32_16x16x64_bf16 v[130:133], v[98:101], a[184:191], v70
    s_waitcnt lgkmcnt(4)
    v_smfmac_f32_16x16x64_bf16 v[118:121], v[110:113], v[206:213], v70
    ds_read_b128 v[206:209], v78 offset:12288
    v_smfmac_f32_16x16x64_bf16 v[130:133], v[102:105], a[192:199], v70
    ds_read_b128 v[210:213], v78 offset:13312
    s_waitcnt lgkmcnt(4)
    v_smfmac_f32_16x16x64_bf16 v[122:125], v[106:109], v[214:221], v70
    ds_read_b128 v[214:217], v78 offset:14336
    v_smfmac_f32_16x16x64_bf16 v[134:137], v[94:97], a[216:223], v70
    ds_read_b128 v[218:221], v78 offset:15360
    s_waitcnt lgkmcnt(4)
    v_smfmac_f32_16x16x64_bf16 v[122:125], v[110:113], v[222:229], v70
    ds_read_b128 v[222:225], v78 offset:16384
    v_add_f32 v118, v118, v119
    v_smfmac_f32_16x16x64_bf16 v[134:137], v[98:101], a[224:231], v70
    ds_read_b128 v[226:229], v78 offset:17408
    v_add_f32 v120, v120, v121
    v_smfmac_f32_16x16x64_bf16 v[138:141], v[94:97], v[6:13], v70
    v_cvt_pk_bf16_f32 v179, v118, v120
    v_smfmac_f32_16x16x64_bf16 v[134:137], v[102:105], a[232:239], v70
    v_add_f32 v122, v122, v123
    v_smfmac_f32_16x16x64_bf16 v[138:141], v[98:101], v[14:21], v70
    v_add_f32 v124, v124, v125
    v_smfmac_f32_16x16x64_bf16 v[138:141], v[102:105], v[22:29], v70
    v_cvt_pk_bf16_f32 v180, v122, v124
    s_waitcnt lgkmcnt(4)
    v_smfmac_f32_16x16x64_bf16 v[126:129], v[106:109], v[206:213], v70
    ds_read_b128 v[206:209], v78 offset:18432
    v_smfmac_f32_16x16x64_bf16 v[142:145], v[94:97], v[46:53], v70
    ds_read_b128 v[210:213], v78 offset:19456
    s_waitcnt lgkmcnt(4)
    v_smfmac_f32_16x16x64_bf16 v[126:129], v[110:113], v[214:221], v70
    ds_read_b128 v[214:217], v78 offset:20480
    v_smfmac_f32_16x16x64_bf16 v[142:145], v[98:101], v[54:61], v70
    ds_read_b128 v[218:221], v78 offset:21504
    s_waitcnt lgkmcnt(4)
    v_smfmac_f32_16x16x64_bf16 v[130:133], v[106:109], v[222:229], v70
    ds_read_b128 v[222:225], v78 offset:22528
    v_smfmac_f32_16x16x64_bf16 v[142:145], v[102:105], v[62:69], v70
    ds_read_b128 v[226:229], v78 offset:23552
    v_add_f32 v126, v126, v127
    v_add_f32 v128, v128, v129
    v_cvt_pk_bf16_f32 v181, v126, v128
    s_waitcnt lgkmcnt(4)
    v_smfmac_f32_16x16x64_bf16 v[130:133], v[110:113], v[206:213], v70
    ds_read_b128 v[206:209], v78 offset:24576
    ds_read_b128 v[210:213], v78 offset:25600
    s_waitcnt lgkmcnt(4)
    v_smfmac_f32_16x16x64_bf16 v[134:137], v[106:109], v[214:221], v70
    ds_read_b128 v[214:217], v78 offset:26624
    s_nop 2
    v_add_f32 v130, v130, v131
    v_add_f32 v132, v132, v133
    ds_read_b128 v[218:221], v78 offset:27648
    v_cvt_pk_bf16_f32 v182, v130, v132
    s_waitcnt lgkmcnt(4)
    v_smfmac_f32_16x16x64_bf16 v[134:137], v[110:113], v[222:229], v70
    ds_read_b128 v[222:225], v78 offset:28672
    ds_read_b128 v[226:229], v78 offset:29696
    s_nop 5
    v_add_f32 v134, v134, v135
    v_add_f32 v136, v136, v137
    v_cvt_pk_bf16_f32 v183, v134, v136
    s_waitcnt lgkmcnt(4)
    v_smfmac_f32_16x16x64_bf16 v[138:141], v[106:109], v[206:213], v70
    ds_read_b128 v[206:209], v78 offset:30720
    ds_read_b128 v[210:213], v78 offset:31744
    s_waitcnt lgkmcnt(4)
    v_smfmac_f32_16x16x64_bf16 v[138:141], v[110:113], v[214:221], v70
    s_waitcnt lgkmcnt(2)
    v_smfmac_f32_16x16x64_bf16 v[142:145], v[106:109], v[222:229], v70
    s_nop 5
    v_add_f32 v138, v138, v139
    v_add_f32 v140, v140, v141
    v_cvt_pk_bf16_f32 v184, v138, v140
    s_waitcnt lgkmcnt(0)
    v_smfmac_f32_16x16x64_bf16 v[142:145], v[110:113], v[206:213], v70
    s_nop 7
    v_add_f32 v142, v142, v143
    v_add_f32 v144, v144, v145
    v_cvt_pk_bf16_f32 v185, v142, v144
    s_cmp_eq_u32 s11, 63
    s_cbranch_scc1 Vdone_188
    buffer_load_dword v86, v77, s[4:7], 0 offen sc1
    buffer_load_dword v84, v83, s[4:7], 0 offen sc1
    v_mov_b32 v115, 0
    v_mov_b32 v117, 0
    v_mov_b32 v119, 0
    v_mov_b32 v121, 0
    v_mov_b32 v123, 0
    v_mov_b32 v125, 0
    v_mov_b32 v127, 0
    v_mov_b32 v129, 0
    v_mov_b32 v131, 0
    v_mov_b32 v133, 0
    v_mov_b32 v135, 0
    v_mov_b32 v137, 0
    v_mov_b32 v139, 0
    v_mov_b32 v141, 0
    v_mov_b32 v143, 0
    v_mov_b32 v145, 0
    buffer_load_dword v87, v77, s[4:7], 0 offen sc1
    v_mov_b32 v114, 0
    v_mov_b32 v116, 0
    v_mov_b32 v118, 0
    v_mov_b32 v120, 0
    v_mov_b32 v122, 0
    v_mov_b32 v124, 0
    v_mov_b32 v126, 0
    v_mov_b32 v128, 0
    v_mov_b32 v130, 0
    v_mov_b32 v132, 0
    v_mov_b32 v134, 0
    v_mov_b32 v136, 0
    v_mov_b32 v138, 0
    v_mov_b32 v140, 0
    v_mov_b32 v142, 0
    v_mov_b32 v144, 0
    s_cmp_lg_u32 s10, 0
    s_cbranch_scc1 hintok_198
hint_197:
    buffer_load_dword v88, v77, s[4:7], 0 offen sc1
    s_waitcnt vmcnt(2)
    v_cmp_gt_u32 vcc, s34, v86
    s_cbranch_vccz hintok_198
    buffer_load_dword v86, v77, s[4:7], 0 offen sc1
    s_waitcnt vmcnt(2)
    v_cmp_gt_u32 vcc, s34, v87
    s_cbranch_vccz hintok_198
    buffer_load_dword v87, v77, s[4:7], 0 offen sc1
    s_waitcnt vmcnt(2)
    v_cmp_gt_u32 vcc, s34, v88
    s_cbranch_vccz hintok_198
    s_sub_u32 s13, s13, 1
    s_cbranch_scc0 hint_197
    s_mov_b32 s13, 0
hintok_198:
    s_barrier
Ppoll_199:
    buffer_load_dwordx4 v[194:197], v79, s[4:7], s28 offen sc1
    buffer_load_dwordx4 v[186:189], v4, s[4:7], s28 offen offset:0 sc1
    buffer_load_dwordx4 v[190:193], v4, s[4:7], s28 offen offset:1024 sc1
    s_waitcnt vmcnt(2)
    v_mfma_f32_16x16x32_bf16 v[198:201], v[194:197], v[178:181], 0
    v_max3_u32 v230, v194, v195, v196
    v_mfma_f32_16x16x32_bf16 v[202:205], v[194:197], v[182:185], 0
    s_waitcnt vmcnt(1)
    v_smfmac_f32_16x16x64_bf16 v[198:201], v[186:189], v[146:153], v70
    v_max3_u32 v230, v230, v197, v186
    v_smfmac_f32_16x16x64_bf16 v[202:205], v[186:189], v[162:169], v70
    v_max3_u32 v230, v230, v187, v188
    s_waitcnt vmcnt(0)
    v_smfmac_f32_16x16x64_bf16 v[198:201], v[190:193], v[154:161], v70
    v_max3_u32 v230, v230, v189, v190
    v_smfmac_f32_16x16x64_bf16 v[202:205], v[190:193], v[170:177], v70
    v_max3_u32 v230, v230, v191, v192
    v_max_u32 v230, v230, v193
    v_cmp_eq_u32 vcc, -1, v230
    s_nop 2
    v_add_f32 v198, v198, v199
    v_add_f32 v200, v200, v201
    v_add_f32 v202, v202, v203
    v_add_f32 v204, v204, v205
    ds_write2_b32 v80, v198, v200 offset0:0 offset1:80
    ds_write2_b32 v80, v202, v204 offset0:160 offset1:240
    s_cbranch_vccz Pgot_200
    s_sub_u32 s13, s13, 1
    s_cbranch_scc0 Ppoll_199
    s_mov_b32 s13, 0
Pgot_200:
    buffer_store_dword v75, v74, s[4:7], 0 offen sc1
    s_waitcnt lgkmcnt(0)
    s_barrier
    ds_read_b64 v[98:99], v81 offset:0
    ds_read_b64 v[100:101], v81 offset:1280
    ds_read_b64 v[102:103], v81 offset:2560
    ds_read_b64 v[104:105], v81 offset:3840
    s_waitcnt lgkmcnt(2)
    v_add_f32 v106, v98, v100
    v_add_f32 v107, v99, v101
    s_waitcnt lgkmcnt(0)
    v_add_f32 v110, v102, v104
    v_add_f32 v111, v103, v105
    v_add_f32 v106, v106, v110
    v_add_f32 v107, v107, v111
    v_cvt_pk_bf16_f32 v232, v106, v107
    buffer_store_dword v232, v82, s[4:7], s27 offen sc1
    s_add_u32 s11, s11, 1
    s_mov_b32 s26, s27
    s_add_u32 s28, s28, 10240
    s_branch Vloop_187
Vdone_188:
    v_cmp_ge_u32 vcc, s34, v84
    s_and_b32 vcc_lo, vcc_lo, 3
    s_cbranch_scc0 rlok_202
rl_201:
    buffer_load_dword v84, v83, s[4:7], 0 offen sc1
    s_waitcnt vmcnt(0)
    v_cmp_ge_u32 vcc, s34, v84
    s_and_b32 vcc_lo, vcc_lo, 3
    s_cbranch_scc0 rlok_202
    s_sleep 1
    s_sub_u32 s13, s13, 1
    s_cbranch_scc0 rl_201
    s_mov_b32 s13, 0
rlok_202:
    s_sub_u32 s33, s11, 0
    s_and_b32 s33, s33, 7
    s_mul_i32 s33, s33, 114688
    s_add_u32 s33, s33, s31
    s_add_u32 s32, s33, 4096
    buffer_store_dwordx4 v[178:181], v4, s[4:7], s33 offen sc1
    buffer_store_dwordx4 v[182:185], v4, s[4:7], s32 offen sc1
    s_endpgm
bad_177:
    s_waitcnt lgkmcnt(0)
again_179:
    buffer_load_dwordx4 v[86:89], v71, s[4:7], s26 offen sc1
    buffer_load_dwordx4 v[90:93], v72, s[4:7], s26 offen sc1
    s_nop 1
    v_mov_b32 v114, 0
    v_mov_b32 v115, 0
    v_mov_b32 v116, 0
    v_mov_b32 v117, 0
    v_mov_b32 v118, 0
    v_mov_b32 v119, 0
    v_mov_b32 v120, 0
    v_mov_b32 v121, 0
    v_mov_b32 v122, 0
    v_mov_b32 v123, 0
    v_mov_b32 v124, 0
    v_mov_b32 v125, 0
    v_mov_b32 v126, 0
    v_mov_b32 v127, 0
    v_mov_b32 v128, 0
    v_mov_b32 v129, 0
    v_mov_b32 v130, 0
    v_mov_b32 v131, 0
    v_mov_b32 v132, 0
    v_mov_b32 v133, 0
    v_mov_b32 v134, 0
    v_mov_b32 v135, 0
    v_mov_b32 v136, 0
    v_mov_b32 v137, 0
    v_mov_b32 v138, 0
    v_mov_b32 v139, 0
    v_mov_b32 v140, 0
    v_mov_b32 v141, 0
    v_mov_b32 v142, 0
    v_mov_b32 v143, 0
    v_mov_b32 v144, 0
    v_mov_b32 v145, 0
    s_waitcnt vmcnt(0)
    v_max3_u32 v230, v86, v87, v88
    v_max3_u32 v230, v230, v89, v90
    v_max3_u32 v230, v230, v91, v92
    v_max_u32 v230, v230, v93
    v_cmp_eq_u32 vcc, -1, v230
    s_cbranch_vccz just_180
    s_sub_u32 s13, s13, 1
    s_cbranch_scc0 again_179
    s_mov_b32 s13, 0
just_180:
    v_smfmac_f32_16x16x64_bf16 v[114:117], v[86:89], a[0:7], v70
    ds_write_b128 v73, v[86:89] offset:0
    v_smfmac_f32_16x16x64_bf16 v[118:121], v[86:89], a[40:47], v70
    v_smfmac_f32_16x16x64_bf16 v[122:125], v[86:89], a[80:87], v70
    ds_write_b128 v73, v[90:93] offset:1024
    v_smfmac_f32_16x16x64_bf16 v[126:129], v[86:89], a[120:127], v70
    v_smfmac_f32_16x16x64_bf16 v[130:133], v[86:89], a[160:167], v70
    v_smfmac_f32_16x16x64_bf16 v[134:137], v[86:89], a[200:207], v70
    v_smfmac_f32_16x16x64_bf16 v[138:141], v[86:89], a[240:247], v70
    v_smfmac_f32_16x16x64_bf16 v[142:145], v[86:89], v[30:37], v70
    v_smfmac_f32_16x16x64_bf16 v[114:117], v[90:93], a[8:15], v70
    v_smfmac_f32_16x16x64_bf16 v[118:121], v[90:93], a[48:55], v70
    s_branch join_178
bad_193:
    s_waitcnt lgkmcnt(0)
again_195:
    buffer_load_dwordx4 v[86:89], v71, s[4:7], s26 offen sc1
    buffer_load_dwordx4 v[90:93], v72, s[4:7], s26 offen sc1
    s_nop 1
    v_mov_b32 v114, 0
    v_mov_b32 v115, 0
    v_mov_b32 v116, 0
    v_mov_b32 v117, 0
    v_mov_b32 v118, 0
    v_mov_b32 v119, 0
    v_mov_b32 v120, 0
    v_mov_b32 v121, 0
    v_mov_b32 v122, 0
    v_mov_b32 v123, 0
    v_mov_b32 v124, 0
    v_mov_b32 v125, 0
    v_mov_b32 v126, 0
    v_mov_b32 v127, 0
    v_mov_b32 v128, 0
    v_mov_b32 v129, 0
    v_mov_b32 v130, 0
    v_mov_b32 v131, 0
    v_mov_b32 v132, 0
    v_mov_b32 v133, 0
    v_mov_b32 v134, 0
    v_mov_b32 v135, 0
    v_mov_b32 v136, 0
    v_mov_b32 v137, 0
    v_mov_b32 v138, 0
    v_mov_b32 v139, 0
    v_mov_b32 v140, 0
    v_mov_b32 v141, 0
    v_mov_b32 v142, 0
    v_mov_b32 v143, 0
    v_mov_b32 v144, 0
    v_mov_b32 v145, 0
    s_waitcnt vmcnt(0)
    v_max3_u32 v230, v86, v87, v88
    v_max3_u32 v230, v230, v89, v90
    v_max3_u32 v230, v230, v91, v92
    v_max_u32 v230, v230, v93
    v_cmp_eq_u32 vcc, -1, v230
    s_cbranch_vccz just_196
    s_sub_u32 s13, s13, 1
    s_cbranch_scc0 again_195
    s_mov_b32 s13, 0
just_196:
    v_smfmac_f32_16x16x64_bf16 v[114:117], v[86:89], a[0:7], v70
    ds_write_b128 v73, v[86:89] offset:0
    v_smfmac_f32_16x16x64_bf16 v[118:121], v[86:89], a[40:47], v70
    v_smfmac_f32_16x16x64_bf16 v[122:125], v[86:89], a[80:87], v70
    ds_write_b128 v73, v[90:93] offset:1024
    v_smfmac_f32_16x16x64_bf16 v[126:129], v[86:89], a[120:127], v70
    v_smfmac_f32_16x16x64_bf16 v[130:133], v[86:89], a[160:167], v70
    v_smfmac_f32_16x16x64_bf16 v[134:137], v[86:89], a[200:207], v70
    v_smfmac_f32_16x16x64_bf16 v[138:141], v[86:89], a[240:247], v70
    v_smfmac_f32_16x16x64_bf16 v[142:145], v[86:89], v[30:37], v70
    v_smfmac_f32_16x16x64_bf16 v[114:117], v[90:93], a[8:15], v70
    v_smfmac_f32_16x16x64_bf16 v[118:121], v[90:93], a[48:55], v70
    s_branch join_194
.p2align 6
role_X:
    v_and_b32 v1, 63, v0
    v_and_b32 v2, 15, v0
    v_lshrrev_b32 v3, 4, v1
    s_lshl_b32 s16, s8, 13
    s_add_u32 s16, s16, 139264
    s_add_u32 s17, s9, 30
    s_lshr_b32 s17, s17, 5
    s_lshl_b32 s17, s17, 8
    s_add_u32 s17, s17, s16
    v_min_u32 v4, 55, v1
    v_lshl_add_u32 v4, v4, 2, s17
    s_cmp_eq_u32 s10, 0
    s_cselect_b32 s17, 0, 1073741824
    v_or_b32 v4, s17, v4
    v_lshrrev_b32 v5, 3, v1
    v_min_u32 v5, 6, v5
    s_mul_i32 s16, s9, 7
    v_add_u32 v5, s16, v5
    v_lshlrev_b32 v6, 3, v5
    v_add_u32 v6, s10, v6
    v_and_b32 v7, 1, v1
    v_lshl_add_u32 v6, v7, 2, v6
    v_lshlrev_b32 v6, 8, v6
    v_lshlrev_b32 v7, 8, v7
    v_lshlrev_b32 v5, 15, v5
    v_and_b32 v8, 7, v1
    v_lshl_add_u32 v5, v8, 7, v5
    v_lshl_add_u32 v5, s10, 12, v5
    s_mul_i32 s17, s8, 7340032
    s_add_u32 s17, s17, 25849856
    s_mul_i32 s18, s8, 69632
    s_add_u32 s18, s18, 0
    s_mul_i32 s19, s8, 69632
    s_add_u32 s19, s19, 65536
    s_mul_i32 s20, s8, 69632
    s_add_u32 s20, s20, 66560
    s_add_u32 s19, s19, 4
    s_sub_u32 s20, s20, 36
    s_lshl_b32 s16, s8, 5
    s_add_u32 s16, s16, s9
    s_lshl_b32 s16, s16, 2
    s_add_u32 s16, s16, 172032
    v_mov_b32 v10, s16
    v_mov_b32 v9, 1073741824
    v_cmp_eq_u32 vcc, 0, v0
    s_nop 1
    v_cndmask_b32 v9, v9, v10, vcc
    v_lshlrev_b32 v16, 7, v0
    s_mov_b32 s24, 176132
ww_203:
    buffer_load_dword v17, v16, s[4:7], s24 offen sc1
    s_waitcnt vmcnt(0)
    v_cmp_eq_u32 vcc, 0, v17
    s_cbranch_vccz wwok_204
    s_sleep 4
    s_sub_u32 s13, s13, 1
    s_cbranch_scc0 ww_203
    s_mov_b32 s13, 0
wwok_204:
    s_barrier
    v_and_b32 v16, 63, v0
    v_min_u32 v16, 31, v16
    v_lshlrev_b32 v16, 10, v16
    s_and_b32 s24, s2, 7
    s_lshl_b32 s24, s24, 7
    s_add_u32 s24, s24, 176128
    buffer_load_dword v17, v16, s[4:7], s24 offen sc1
    s_waitcnt vmcnt(0)
    v_cmp_ne_u32 vcc, s15, v17
    s_cmp_lg_u64 vcc, 0
    s_cselect_b32 s12, 1, 0
    s_cmp_lg_u32 s12, 0
    s_cbranch_scc1 far_205
Xloop_206:
    s_cmp_le_u32 s11, 8
    s_cselect_b32 s21, 65536, s20
    s_cmp_ge_u32 s11, 63
    s_cselect_b32 s22, 65536, s19
    s_min_u32 s16, s11, 63
    s_lshl_b32 s16, s16, 2
    s_add_u32 s16, s16, s18
    s_add_u32 s23, s11, 1
    v_mov_b32 v10, s23
Xf_207:
    buffer_load_dword v13, v7, s[4:7], s21 offen sc1
    buffer_load_dword v14, v7, s[4:7], s22 offen sc1
    buffer_load_dword v15, v6, s[4:7], s16 offen sc1
    s_waitcnt vmcnt(0)
    v_min_u32 v8, v13, v14
    v_cmp_eq_u32 vcc, 0, v8
    s_cbranch_vccz Xfok_208
    s_sub_u32 s13, s13, 1
    s_cbranch_scc0 Xf_207
    s_mov_b32 s13, 0
Xfok_208:
    buffer_store_dword v10, v9, s[4:7], 0 offen offset:0
    v_cmp_eq_u32 vcc, 0, v15
    s_cbranch_vccz Xfok_210
Xf_209:
    buffer_load_dword v15, v6, s[4:7], s16 offen sc1
    s_waitcnt vmcnt(0)
    v_cmp_eq_u32 vcc, 0, v15
    s_cbranch_vccz Xfok_210
    s_sub_u32 s13, s13, 1
    s_cbranch_scc0 Xf_209
    s_mov_b32 s13, 0
Xfok_210:
    s_barrier
    buffer_store_dword v10, v9, s[4:7], 0 offen offset:8
    s_sub_u32 s16, s11, 1
    s_cmp_gt_u32 s16, 61
    s_cbranch_scc1 Xn_211
    s_cmp_lg_u32 s10, 0
    s_cbranch_scc1 Xok_213
Xh_212:
    buffer_load_dword v12, v4, s[4:7], 0 offen sc1
    s_waitcnt vmcnt(0)
    v_cmp_gt_u32 vcc, s16, v12
    s_cbranch_vccz Xok_213
    s_sleep 2
    s_sub_u32 s13, s13, 1
    s_cbranch_scc0 Xh_212
    s_mov_b32 s13, 0
Xok_213:
    s_barrier
    s_sleep 6
    s_and_b32 s16, s11, 15
    s_mul_i32 s16, s16, 458752
    s_add_u32 s16, s16, s17
    buffer_load_dword v16, v5, s[4:7], s16 offen offset:3072 sc1
    buffer_load_dword v17, v5, s[4:7], s16 offen offset:2048 sc1
Xn_211:
    s_add_u32 s19, s19, 4
    s_add_u32 s20, s20, 4
    s_add_u32 s11, s11, 1
    s_cmp_le_u32 s11, 64
    s_cbranch_scc1 Xloop_206
    s_endpgm
.p2align 6
far_205:
Xloop_214:
    s_cmp_le_u32 s11, 8
    s_cselect_b32 s21, 65536, s20
    s_cmp_ge_u32 s11, 63
    s_cselect_b32 s22, 65536, s19
    s_min_u32 s16, s11, 63
    s_lshl_b32 s16, s16, 2
    s_add_u32 s16, s16, s18
    s_add_u32 s23, s11, 1
    v_mov_b32 v10, s23
Xf_215:
    buffer_load_dword v13, v7, s[4:7], s21 offen sc1
    buffer_load_dword v14, v7, s[4:7], s22 offen sc1
    buffer_load_dword v15, v6, s[4:7], s16 offen sc1
    s_waitcnt vmcnt(0)
    v_min_u32 v8, v13, v14
    v_cmp_eq_u32 vcc, 0, v8
    s_cbranch_vccz Xfok_216
    s_sub_u32 s13, s13, 1
    s_cbranch_scc0 Xf_215
    s_mov_b32 s13, 0
Xfok_216:
    buffer_store_dword v10, v9, s[4:7], 0 offen offset:0 sc1
    v_cmp_eq_u32 vcc, 0, v15
    s_cbranch_vccz Xfok_218
Xf_217:
    buffer_load_dword v15, v6, s[4:7], s16 offen sc1
    s_waitcnt vmcnt(0)
    v_cmp_eq_u32 vcc, 0, v15
    s_cbranch_vccz Xfok_218
    s_sub_u32 s13, s13, 1
    s_cbranch_scc0 Xf_217
    s_mov_b32 s13, 0
Xfok_218:
    s_barrier
    buffer_store_dword v10, v9, s[4:7], 0 offen offset:8 sc1
    s_sub_u32 s16, s11, 1
    s_cmp_gt_u32 s16, 61
    s_cbranch_scc1 Xn_219
    s_cmp_lg_u32 s10, 0
    s_cbranch_scc1 Xok_221
Xh_220:
    buffer_load_dword v12, v4, s[4:7], 0 offen sc1
    s_waitcnt vmcnt(0)
    v_cmp_gt_u32 vcc, s16, v12
    s_cbranch_vccz Xok_221
    s_sleep 2
    s_sub_u32 s13, s13, 1
    s_cbranch_scc0 Xh_220
    s_mov_b32 s13, 0
Xok_221:
    s_barrier
    s_sleep 6
    s_and_b32 s16, s11, 15
    s_mul_i32 s16, s16, 458752
    s_add_u32 s16, s16, s17
    buffer_load_dword v16, v5, s[4:7], s16 offen offset:3072 sc1
    buffer_load_dword v17, v5, s[4:7], s16 offen offset:2048 sc1
Xn_219:
    s_add_u32 s19, s19, 4
    s_add_u32 s20, s20, 4
    s_add_u32 s11, s11, 1
    s_cmp_le_u32 s11, 64
    s_cbranch_scc1 Xloop_214
    s_endpgm
.p2align 6
role_TA:
    v_and_b32 v1, 63, v0
    v_and_b32 v2, 15, v0
    v_lshrrev_b32 v3, 4, v1
    s_mul_i32 s16, s10, 7
    s_and_b32 s20, s10, 1
    s_add_u32 s18, s16, 1
    s_lshr_b32 s18, s18, 1
    s_lshr_b32 s19, s10, 1
    s_mul_i32 s19, s19, 7
    s_add_u32 s19, s19, 3
    v_lshlrev_b32 v4, 4, v1
    s_mul_i32 s21, s9, 7
    s_cmp_eq_u32 s8, 0
    s_cbranch_scc1 l0_222
    v_lshlrev_b32 v248, 7, v0
    s_mov_b32 s24, 176132
ww_223:
    buffer_load_dword v249, v248, s[4:7], s24 offen sc1
    s_waitcnt vmcnt(0)
    v_cmp_eq_u32 vcc, 0, v249
    s_cbranch_vccz wwok_224
    s_sleep 4
    s_sub_u32 s13, s13, 1
    s_cbranch_scc0 ww_223
    s_mov_b32 s13, 0
wwok_224:
    s_barrier
    v_mov_b32 v248, 0
    s_mov_b32 s23, 66048
ww_225:
    buffer_load_dword v249, v248, s[4:7], s23 offen sc1
    s_waitcnt vmcnt(0)
    v_cmp_eq_u32 vcc, 0, v249
    s_cbranch_vccz wwok_226
    s_sleep 8
    s_sub_u32 s13, s13, 1
    s_cbranch_scc0 ww_225
    s_mov_b32 s13, 0
wwok_226:
l0_222:
    v_and_b32 v248, 63, v0
    v_min_u32 v248, 6, v248
    v_mul_u32_u24 v248, 1, v248
    v_add_u32 v248, s21, v248
    v_add_u32 v248, 32, v248
    v_and_b32 v250, 31, v248
    v_lshrrev_b32 v248, 5, v248
    v_lshl_add_u32 v248, v250, 3, v248
    v_lshlrev_b32 v248, 7, v248
    v_add_u32 v248, 176136, v248
    v_mov_b32 v249, 0
    s_mul_i32 s21, s9, 28
    s_add_u32 s21, s21, s16
    s_mul_i32 s17, s20, 6
    s_sub_u32 s22, s21, s17
    s_add_u32 s22, s22, 6
    s_add_u32 s21, s21, s20
    s_mul_i32 s21, s21, 14336
    s_add_u32 s21, s21, 5189632
    s_mul_i32 s22, s22, 14336
    s_add_u32 s22, s22, 5189632
    s_mul_i32 s17, s10, 14336
    v_cmp_gt_u32 vcc, 1, v249
    s_cbranch_vccz wcok_228
wc_227:
    buffer_load_dword v249, v248, s[4:7], 0 offen sc1
    s_waitcnt vmcnt(0)
    v_cmp_gt_u32 vcc, 1, v249
    s_cbranch_vccz wcok_228
    s_sleep 4
    s_sub_u32 s13, s13, 1
    s_cbranch_scc0 wc_227
    s_mov_b32 s13, 0
wcok_228:
    s_add_u32 s16, s21, 0
    buffer_load_dwordx4 a[0:3], v4, s[4:7], s16 offen
    buffer_load_dwordx4 a[4:7], v4, s[4:7], s16 offen offset:1024
    s_add_u32 s16, s21, 14336
    buffer_load_dwordx4 a[48:51], v4, s[4:7], s16 offen
    buffer_load_dwordx4 a[52:55], v4, s[4:7], s16 offen offset:1024
    s_add_u32 s16, s21, 28672
    buffer_load_dwordx4 a[96:99], v4, s[4:7], s16 offen
    buffer_load_dwordx4 a[100:103], v4, s[4:7], s16 offen offset:1024
    s_add_u32 s16, s21, 43008
    buffer_load_dwordx4 a[144:147], v4, s[4:7], s16 offen
    buffer_load_dwordx4 a[148:151], v4, s[4:7], s16 offen offset:1024
    s_add_u32 s16, s21, 57344
    buffer_load_dwordx4 a[192:195], v4, s[4:7], s16 offen
    buffer_load_dwordx4 a[196:199], v4, s[4:7], s16 offen offset:1024
    s_add_u32 s16, s21, 71680
    buffer_load_dwordx4 a[240:243], v4, s[4:7], s16 offen
    buffer_load_dwordx4 a[244:247], v4, s[4:7], s16 offen offset:1024
    s_add_u32 s16, s22, 0
    buffer_load_dwordx4 v[38:41], v4, s[4:7], s16 offen
    buffer_load_dwordx4 v[42:45], v4, s[4:7], s16 offen offset:1024
    v_cmp_gt_u32 vcc, 2, v249
    s_cbranch_vccz wcok_230
wc_229:
    buffer_load_dword v249, v248, s[4:7], 0 offen sc1
    s_waitcnt vmcnt(0)
    v_cmp_gt_u32 vcc, 2, v249
    s_cbranch_vccz wcok_230
    s_sleep 4
    s_sub_u32 s13, s13, 1
    s_cbranch_scc0 wc_229
    s_mov_b32 s13, 0
wcok_230:
    s_add_u32 s16, s21, 2048
    buffer_load_dwordx4 a[8:11], v4, s[4:7], s16 offen
    buffer_load_dwordx4 a[12:15], v4, s[4:7], s16 offen offset:1024
    s_add_u32 s16, s21, 16384
    buffer_load_dwordx4 a[56:59], v4, s[4:7], s16 offen
    buffer_load_dwordx4 a[60:63], v4, s[4:7], s16 offen offset:1024
    s_add_u32 s16, s21, 30720
    buffer_load_dwordx4 a[104:107], v4, s[4:7], s16 offen
    buffer_load_dwordx4 a[108:111], v4, s[4:7], s16 offen offset:1024
    s_add_u32 s16, s21, 45056
    buffer_load_dwordx4 a[152:155], v4, s[4:7], s16 offen
    buffer_load_dwordx4 a[156:159], v4, s[4:7], s16 offen offset:1024
    s_add_u32 s16, s21, 59392
    buffer_load_dwordx4 a[200:203], v4, s[4:7], s16 offen
    buffer_load_dwordx4 a[204:207], v4, s[4:7], s16 offen offset:1024
    s_add_u32 s16, s21, 73728
    buffer_load_dwordx4 a[248:251], v4, s[4:7], s16 offen
    buffer_load_dwordx4 a[252:255], v4, s[4:7], s16 offen offset:1024
    s_add_u32 s16, s22, 2048
    buffer_load_dwordx4 v[46:49], v4, s[4:7], s16 offen
    buffer_load_dwordx4 v[50:53], v4, s[4:7], s16 offen offset:1024
    v_cmp_gt_u32 vcc, 3, v249
    s_cbranch_vccz wcok_232
wc_231:
    buffer_load_dword v249, v248, s[4:7], 0 offen sc1
    s_waitcnt vmcnt(0)
    v_cmp_gt_u32 vcc, 3, v249
    s_cbranch_vccz wcok_232
    s_sleep 4
    s_sub_u32 s13, s13, 1
    s_cbranch_scc0 wc_231
    s_mov_b32 s13, 0
wcok_232:
    s_add_u32 s16, s21, 4096
    buffer_load_dwordx4 a[16:19], v4, s[4:7], s16 offen
    buffer_load_dwordx4 a[20:23], v4, s[4:7], s16 offen offset:1024
    s_add_u32 s16, s21, 18432
    buffer_load_dwordx4 a[64:67], v4, s[4:7], s16 offen
    buffer_load_dwordx4 a[68:71], v4, s[4:7], s16 offen offset:1024
    s_add_u32 s16, s21, 32768
    buffer_load_dwordx4 a[112:115], v4, s[4:7], s16 offen
    buffer_load_dwordx4 a[116:119], v4, s[4:7], s16 offen offset:1024
    s_add_u32 s16, s21, 47104
    buffer_load_dwordx4 a[160:163], v4, s[4:7], s16 offen
    buffer_load_dwordx4 a[164:167], v4, s[4:7], s16 offen offset:1024
    s_add_u32 s16, s21, 61440
    buffer_load_dwordx4 a[208:211], v4, s[4:7], s16 offen
    buffer_load_dwordx4 a[212:215], v4, s[4:7], s16 offen offset:1024
    s_add_u32 s16, s21, 75776
    buffer_load_dwordx4 v[6:9], v4, s[4:7], s16 offen
    buffer_load_dwordx4 v[10:13], v4, s[4:7], s16 offen offset:1024
    s_add_u32 s16, s22, 4096
    buffer_load_dwordx4 v[54:57], v4, s[4:7], s16 offen
    buffer_load_dwordx4 v[58:61], v4, s[4:7], s16 offen offset:1024
    v_cmp_gt_u32 vcc, 4, v249
    s_cbranch_vccz wcok_234
wc_233:
    buffer_load_dword v249, v248, s[4:7], 0 offen sc1
    s_waitcnt vmcnt(0)
    v_cmp_gt_u32 vcc, 4, v249
    s_cbranch_vccz wcok_234
    s_sleep 4
    s_sub_u32 s13, s13, 1
    s_cbranch_scc0 wc_233
    s_mov_b32 s13, 0
wcok_234:
    s_add_u32 s16, s21, 6144
    buffer_load_dwordx4 a[24:27], v4, s[4:7], s16 offen
    buffer_load_dwordx4 a[28:31], v4, s[4:7], s16 offen offset:1024
    s_add_u32 s16, s21, 20480
    buffer_load_dwordx4 a[72:75], v4, s[4:7], s16 offen
    buffer_load_dwordx4 a[76:79], v4, s[4:7], s16 offen offset:1024
    s_add_u32 s16, s21, 34816
    buffer_load_dwordx4 a[120:123], v4, s[4:7], s16 offen
    buffer_load_dwordx4 a[124:127], v4, s[4:7], s16 offen offset:1024
    s_add_u32 s16, s21, 49152
    buffer_load_dwordx4 a[168:171], v4, s[4:7], s16 offen
    buffer_load_dwordx4 a[172:175], v4, s[4:7], s16 offen offset:1024
    s_add_u32 s16, s21, 63488
    buffer_load_dwordx4 a[216:219], v4, s[4:7], s16 offen
    buffer_load_dwordx4 a[220:223], v4, s[4:7], s16 offen offset:1024
    s_add_u32 s16, s21, 77824
    buffer_load_dwordx4 v[14:17], v4, s[4:7], s16 offen
    buffer_load_dwordx4 v[18:21], v4, s[4:7], s16 offen offset:1024
    s_add_u32 s16, s22, 6144
    buffer_load_dwordx4 v[62:65], v4, s[4:7], s16 offen
    buffer_load_dwordx4 v[66:69], v4, s[4:7], s16 offen offset:1024
    v_cmp_gt_u32 vcc, 5, v249
    s_cbranch_vccz wcok_236
wc_235:
    buffer_load_dword v249, v248, s[4:7], 0 offen sc1
    s_waitcnt vmcnt(0)
    v_cmp_gt_u32 vcc, 5, v249
    s_cbranch_vccz wcok_236
    s_sleep 4
    s_sub_u32 s13, s13, 1
    s_cbranch_scc0 wc_235
    s_mov_b32 s13, 0
wcok_236:
    s_add_u32 s16, s21, 8192
    buffer_load_dwordx4 a[32:35], v4, s[4:7], s16 offen
    buffer_load_dwordx4 a[36:39], v4, s[4:7], s16 offen offset:1024
    s_add_u32 s16, s21, 22528
    buffer_load_dwordx4 a[80:83], v4, s[4:7], s16 offen
    buffer_load_dwordx4 a[84:87], v4, s[4:7], s16 offen offset:1024
    s_add_u32 s16, s21, 36864
    buffer_load_dwordx4 a[128:131], v4, s[4:7], s16 offen
    buffer_load_dwordx4 a[132:135], v4, s[4:7], s16 offen offset:1024
    s_add_u32 s16, s21, 51200
    buffer_load_dwordx4 a[176:179], v4, s[4:7], s16 offen
    buffer_load_dwordx4 a[180:183], v4, s[4:7], s16 offen offset:1024
    s_add_u32 s16, s21, 65536
    buffer_load_dwordx4 a[224:227], v4, s[4:7], s16 offen
    buffer_load_dwordx4 a[228:231], v4, s[4:7], s16 offen offset:1024
    s_add_u32 s16, s21, 79872
    buffer_load_dwordx4 v[22:25], v4, s[4:7], s16 offen
    buffer_load_dwordx4 v[26:29], v4, s[4:7], s16 offen offset:1024
    s_add_u32 s16, s22, 8192
    buffer_load_dwordx4 v[70:73], v4, s[4:7], s16 offen
    buffer_load_dwordx4 v[74:77], v4, s[4:7], s16 offen offset:1024
    v_cmp_gt_u32 vcc, 6, v249
    s_cbranch_vccz wcok_238
wc_237:
    buffer_load_dword v249, v248, s[4:7], 0 offen sc1
    s_waitcnt vmcnt(0)
    v_cmp_gt_u32 vcc, 6, v249
    s_cbranch_vccz wcok_238
    s_sleep 4
    s_sub_u32 s13, s13, 1
    s_cbranch_scc0 wc_237
    s_mov_b32 s13, 0
wcok_238:
    s_add_u32 s16, s21, 10240
    buffer_load_dwordx4 a[40:43], v4, s[4:7], s16 offen
    buffer_load_dwordx4 a[44:47], v4, s[4:7], s16 offen offset:1024
    s_add_u32 s16, s21, 24576
    buffer_load_dwordx4 a[88:91], v4, s[4:7], s16 offen
    buffer_load_dwordx4 a[92:95], v4, s[4:7], s16 offen offset:1024
    s_add_u32 s16, s21, 38912
    buffer_load_dwordx4 a[136:139], v4, s[4:7], s16 offen
    buffer_load_dwordx4 a[140:143], v4, s[4:7], s16 offen offset:1024
    s_add_u32 s16, s21, 53248
    buffer_load_dwordx4 a[184:187], v4, s[4:7], s16 offen
    buffer_load_dwordx4 a[188:191], v4, s[4:7], s16 offen offset:1024
    s_add_u32 s16, s21, 67584
    buffer_load_dwordx4 a[232:235], v4, s[4:7], s16 offen
    buffer_load_dwordx4 a[236:239], v4, s[4:7], s16 offen offset:1024
    s_add_u32 s16, s21, 81920
    buffer_load_dwordx4 v[30:33], v4, s[4:7], s16 offen
    buffer_load_dwordx4 v[34:37], v4, s[4:7], s16 offen offset:1024
    s_add_u32 s16, s22, 10240
    buffer_load_dwordx4 v[78:81], v4, s[4:7], s16 offen
    buffer_load_dwordx4 v[82:85], v4, s[4:7], s16 offen offset:1024
    v_cmp_gt_u32 vcc, 7, v249
    s_cbranch_vccz wcok_240
wc_239:
    buffer_load_dword v249, v248, s[4:7], 0 offen sc1
    s_waitcnt vmcnt(0)
    v_cmp_gt_u32 vcc, 7, v249
    s_cbranch_vccz wcok_240
    s_sleep 4
    s_sub_u32 s13, s13, 1
    s_cbranch_scc0 wc_239
    s_mov_b32 s13, 0
wcok_240:
    s_add_u32 s16, s21, 12288
    s_add_u32 m0, s17, 0
    s_nop 0
    buffer_load_dwordx4 v4, s[4:7], s16 offen lds
    buffer_load_dwordx4 v4, s[4:7], s16 offen offset:1024 lds
    s_add_u32 s16, s21, 26624
    s_add_u32 m0, s17, 2048
    s_nop 0
    buffer_load_dwordx4 v4, s[4:7], s16 offen lds
    buffer_load_dwordx4 v4, s[4:7], s16 offen offset:1024 lds
    s_add_u32 s16, s21, 40960
    s_add_u32 m0, s17, 4096
    s_nop 0
    buffer_load_dwordx4 v4, s[4:7], s16 offen lds
    buffer_load_dwordx4 v4, s[4:7], s16 offen offset:1024 lds
    s_add_u32 s16, s21, 55296
    s_add_u32 m0, s17, 6144
    s_nop 0
    buffer_load_dwordx4 v4, s[4:7], s16 offen lds
    buffer_load_dwordx4 v4, s[4:7], s16 offen offset:1024 lds
    s_add_u32 s16, s21, 69632
    s_add_u32 m0, s17, 8192
    s_nop 0
    buffer_load_dwordx4 v4, s[4:7], s16 offen lds
    buffer_load_dwordx4 v4, s[4:7], s16 offen offset:1024 lds
    s_add_u32 s16, s21, 83968
    s_add_u32 m0, s17, 10240
    s_nop 0
    buffer_load_dwordx4 v4, s[4:7], s16 offen lds
    buffer_load_dwordx4 v4, s[4:7], s16 offen offset:1024 lds
    s_add_u32 s16, s22, 12288
    s_add_u32 m0, s17, 12288
    s_nop 0
    buffer_load_dwordx4 v4, s[4:7], s16 offen lds
    buffer_load_dwordx4 v4, s[4:7], s16 offen offset:1024 lds
    s_lshl_b32 s23, s10, 11
    v_add_u32 v86, s23, v4
    v_add_u32 v88, 131072, v86
    s_cmp_eq_u32 s10, 3
    s_cselect_b32 s23, 1073741824, 1024
    v_add_u32 v87, s23, v86
    v_min_u32 v89, 1, v1
    v_lshlrev_b32 v89, 8, v89
    s_mul_i32 s23, s8, 1835008
    s_add_u32 s23, s23, 18034688
    s_mul_i32 s26, s10, 7168
    s_add_u32 s23, s23, s26
    s_mul_i32 s27, s11, 28672
    s_add_u32 s23, s23, s27
    s_add_u32 s26, s26, 65536
    s_mul_i32 s25, s8, 69632
    s_add_u32 s25, s25, 65536
    s_lshl_b32 s27, s11, 2
    s_add_u32 s25, s25, s27
    s_mov_b32 s28, s11
    s_mov_b32 s27, 1
    v_add_u32 v92, 98304, v4
    s_lshl_b32 s16, s9, 1
    s_add_u32 s16, s16, s20
    s_cmp_lt_u32 s10, 2
    s_cselect_b32 s21, 0, 1073741824
    s_mul_i32 s29, s8, 69632
    s_add_u32 s29, s29, 43008
    s_lshl_b32 s30, s16, 8
    s_add_u32 s29, s29, s30
    s_lshl_b32 s30, s11, 2
    s_add_u32 s29, s29, s30
    v_mov_b32 v106, 1073741824
    v_cmp_eq_u32 vcc, 0, v1
    s_nop 1
    v_cndmask_b32 v107, v106, 0, vcc
    v_or_b32 v107, s21, v107
    v_mov_b32 v108, 1
    v_and_b32 v109, 7, v2
    v_lshrrev_b32 v111, 1, v3
    v_lshl_add_u32 v109, v111, 3, v109
    v_lshlrev_b32 v109, 5, v109
    v_and_b32 v111, 1, v3
    v_lshl_add_u32 v109, v111, 3, v109
    s_add_u32 s16, s18, 0
    s_lshl_b32 s16, s16, 9
    s_add_u32 s16, s16, 131072
    v_add_u32 v93, s16, v109
    s_add_u32 s16, s18, 1
    s_lshl_b32 s16, s16, 9
    s_add_u32 s16, s16, 131072
    v_add_u32 v94, s16, v109
    s_add_u32 s16, s18, 2
    s_lshl_b32 s16, s16, 9
    s_add_u32 s16, s16, 131072
    v_add_u32 v95, s16, v109
    s_mov_b32 s16, s19
    s_lshl_b32 s16, s16, 9
    s_add_u32 s16, s16, 131072
    s_lshl_b32 s21, s20, 2
    s_add_u32 s16, s16, s21
    v_add_u32 v96, s16, v109
    v_add_u32 v97, s17, v4
    s_lshl_b32 s18, s18, 10
    s_lshl_b32 s19, s19, 10
    s_lshl_b32 s16, s20, 3
    s_add_u32 s19, s19, s16
    s_mul_i32 s16, s10, 5120
    s_add_u32 s16, s16, 139264
    v_add_u32 v100, s16, v4
    s_lshl_b32 s16, s20, 10
    s_add_u32 s16, s16, 139264
    v_add_u32 v101, s16, v4
    v_add_u32 v102, 141312, v4
    s_mul_i32 s16, s10, 1280
    s_cmp_lt_u32 s10, 2
    s_cselect_b32 s16, s16, 1073741824
    v_add_u32 v103, s16, v4
    v_lshl_add_u32 v109, v1, 3, s16
    v_mov_b32 v110, 1073741824
    v_cmp_gt_u32 vcc, 32, v1
    s_nop 1
    v_cndmask_b32 v104, v110, v109, vcc
    v_mov_b32 v105, 0xff7fffff
    v_lshl_add_u32 v109, v3, 2, 0
    v_cmp_le_u32 s[30:31], v109, v2
    v_lshl_add_u32 v109, v3, 2, 1
    v_cmp_le_u32 s[32:33], v109, v2
    v_lshl_add_u32 v109, v3, 2, 2
    v_cmp_le_u32 s[34:35], v109, v2
    v_lshl_add_u32 v109, v3, 2, 3
    v_cmp_le_u32 s[36:37], v109, v2
    s_cmp_eq_u32 s20, 1
    s_cselect_b64 s[38:39], -1, 0
    s_mov_b32 s40, -1
    s_mov_b32 s41, 0
    s_mul_i32 s45, s8, 69632
    s_add_u32 s45, s45, 66560
    s_lshl_b32 s16, s11, 2
    s_add_u32 s45, s45, s16
    s_sub_u32 s45, s45, 32
    s_mul_i32 s42, s8, 458752
    s_add_u32 s42, s42, 1126400
    s_mul_i32 s16, s11, 7168
    s_add_u32 s42, s42, s16
    s_mul_i32 s44, s8, 327680
    s_add_u32 s44, s44, 40513536
    s_mul_i32 s16, s9, 2560
    s_add_u32 s44, s44, s16
    v_lshlrev_b32 v110, 7, v0
    s_mov_b32 s47, 176132
ww_241:
    buffer_load_dword v111, v110, s[4:7], s47 offen sc1
    s_waitcnt vmcnt(0)
    v_cmp_eq_u32 vcc, 0, v111
    s_cbranch_vccz wwok_242
    s_sleep 4
    s_sub_u32 s13, s13, 1
    s_cbranch_scc0 ww_241
    s_mov_b32 s13, 0
wwok_242:
    s_barrier
    v_and_b32 v110, 63, v0
    v_min_u32 v110, 31, v110
    v_lshlrev_b32 v110, 10, v110
    s_and_b32 s47, s2, 7
    s_lshl_b32 s47, s47, 7
    s_add_u32 s47, s47, 176128
    buffer_load_dword v111, v110, s[4:7], s47 offen sc1
    s_waitcnt vmcnt(0)
    v_cmp_ne_u32 vcc, s15, v111
    s_cmp_lg_u64 vcc, 0
    s_cselect_b32 s12, 1, 0
    s_cmp_lg_u32 s12, 0
    s_cbranch_scc1 far_243
Aloop_244:
    s_cmp_eq_u32 s27, 0
    s_cbranch_scc1 Tearly_246
    s_waitcnt vmcnt(0)
    buffer_store_dword v108, v106, s[4:7], 0 offen
    v_mov_b32 v106, 1073741824
Tpoll_248:
    buffer_load_dword v90, v89, s[4:7], s25 offen sc1
    s_waitcnt vmcnt(0)
    v_cmp_eq_u32 vcc, 0, v90
    s_cbranch_vccz Tok_249
    s_sleep 1
    s_sub_u32 s13, s13, 1
    s_cbranch_scc0 Tpoll_248
    s_mov_b32 s13, 0
Tok_249:
    s_mov_b32 m0, s26
    s_nop 0
    buffer_load_dwordx4 v4, s[4:7], s23 offen sc1 lds
    buffer_load_dwordx4 v4, s[4:7], s23 offen offset:1024 sc1 lds
    buffer_load_dwordx4 v4, s[4:7], s23 offen offset:2048 sc1 lds
    buffer_load_dwordx4 v4, s[4:7], s23 offen offset:3072 sc1 lds
    s_add_u32 s24, s23, 4096
    s_add_u32 m0, s26, 4096
    s_nop 0
    buffer_load_dwordx4 v4, s[4:7], s24 offen sc1 lds
    buffer_load_dwordx4 v4, s[4:7], s24 offen offset:1024 sc1 lds
    buffer_load_dwordx4 v4, s[4:7], s24 offen offset:2048 sc1 lds
    s_waitcnt vmcnt(0)
    s_branch Tjoin_247
Tearly_246:
    s_waitcnt vmcnt(2)
Tjoin_247:
    s_add_u32 s25, s25, 8
    s_add_u32 s28, s28, 2
    s_add_u32 s23, s23, 57344
    s_xor_b32 s26, s26, 0x8000
    v_xor_b32 v92, 0x8000, v92
    s_barrier
    v_add_u32 v98, s18, v92
    v_add_u32 v99, s19, v92
    s_and_b32 s43, s11, 7
    s_mul_i32 s43, s43, 40960
    s_add_u32 s43, s43, s44
    s_cmp_lt_u32 s11, 8
    s_cselect_b32 s46, 65536, s45
    ds_read_b128 v[166:169], v92 offset:0
    ds_read_b128 v[170:173], v92 offset:14336
    ds_read_b128 v[174:177], v92 offset:1024
    ds_read_b128 v[178:181], v92 offset:15360
    ds_read_b128 v[182:185], v92 offset:2048
    ds_read_b128 v[186:189], v92 offset:16384
    ds_read_b128 v[190:193], v97 offset:0
    s_waitcnt lgkmcnt(6)
    v_mfma_f32_16x16x32_bf16 v[110:113], a[0:3], v[166:169], 0
    ds_read_b128 v[194:197], v97 offset:2048
    s_waitcnt lgkmcnt(6)
    v_mfma_f32_16x16x32_bf16 v[114:117], a[0:3], v[170:173], 0
    ds_read_b128 v[198:201], v97 offset:4096
    v_mfma_f32_16x16x32_bf16 v[118:121], a[48:51], v[166:169], 0
    ds_read_b128 v[202:205], v97 offset:6144
    v_mfma_f32_16x16x32_bf16 v[122:125], a[48:51], v[170:173], 0
    v_mfma_f32_16x16x32_bf16 v[126:129], a[96:99], v[166:169], 0
    v_mfma_f32_16x16x32_bf16 v[130:133], a[96:99], v[170:173], 0
    v_mfma_f32_16x16x32_bf16 v[134:137], a[144:147], v[166:169], 0
    s_waitcnt vmcnt(0)
    buffer_store_dword v108, v106, s[4:7], 0 offen
    v_mfma_f32_16x16x32_bf16 v[138:141], a[144:147], v[170:173], 0
    v_mfma_f32_16x16x32_bf16 v[142:145], a[192:195], v[166:169], 0
    v_mfma_f32_16x16x32_bf16 v[146:149], a[192:195], v[170:173], 0
    v_mfma_f32_16x16x32_bf16 v[150:153], a[240:243], v[166:169], 0
    v_mfma_f32_16x16x32_bf16 v[154:157], a[240:243], v[170:173], 0
    v_mfma_f32_16x16x32_bf16 v[158:161], v[38:41], v[166:169], 0
    ds_read_b128 v[166:169], v92 offset:3072
    v_mfma_f32_16x16x32_bf16 v[162:165], v[38:41], v[170:173], 0
    ds_read_b128 v[170:173], v92 offset:17408
    s_waitcnt lgkmcnt(9)
    v_mfma_f32_16x16x32_bf16 v[110:113], a[4:7], v[174:177], v[110:113]
    s_waitcnt lgkmcnt(8)
    v_mfma_f32_16x16x32_bf16 v[114:117], a[4:7], v[178:181], v[114:117]
    v_mfma_f32_16x16x32_bf16 v[118:121], a[52:55], v[174:177], v[118:121]
    v_mfma_f32_16x16x32_bf16 v[122:125], a[52:55], v[178:181], v[122:125]
    v_mfma_f32_16x16x32_bf16 v[126:129], a[100:103], v[174:177], v[126:129]
    buffer_load_dword v109, v89, s[4:7], s46 offen sc1
    v_mfma_f32_16x16x32_bf16 v[130:133], a[100:103], v[178:181], v[130:133]
    v_mfma_f32_16x16x32_bf16 v[134:137], a[148:151], v[174:177], v[134:137]
    v_mfma_f32_16x16x32_bf16 v[138:141], a[148:151], v[178:181], v[138:141]
    v_mfma_f32_16x16x32_bf16 v[142:145], a[196:199], v[174:177], v[142:145]
    v_mfma_f32_16x16x32_bf16 v[146:149], a[196:199], v[178:181], v[146:149]
    v_mfma_f32_16x16x32_bf16 v[150:153], a[244:247], v[174:177], v[150:153]
    v_mfma_f32_16x16x32_bf16 v[154:157], a[244:247], v[178:181], v[154:157]
    v_mfma_f32_16x16x32_bf16 v[158:161], v[42:45], v[174:177], v[158:161]
    ds_read_b128 v[174:177], v92 offset:4096
    v_mfma_f32_16x16x32_bf16 v[162:165], v[42:45], v[178:181], v[162:165]
    ds_read_b128 v[178:181], v92 offset:18432
    s_waitcnt lgkmcnt(9)
    v_mfma_f32_16x16x32_bf16 v[110:113], a[8:11], v[182:185], v[110:113]
    s_waitcnt lgkmcnt(8)
    v_mfma_f32_16x16x32_bf16 v[114:117], a[8:11], v[186:189], v[114:117]
    v_mfma_f32_16x16x32_bf16 v[118:121], a[56:59], v[182:185], v[118:121]
    v_mfma_f32_16x16x32_bf16 v[122:125], a[56:59], v[186:189], v[122:125]
    v_mfma_f32_16x16x32_bf16 v[126:129], a[104:107], v[182:185], v[126:129]
    v_mfma_f32_16x16x32_bf16 v[130:133], a[104:107], v[186:189], v[130:133]
    v_mfma_f32_16x16x32_bf16 v[134:137], a[152:155], v[182:185], v[134:137]
    v_mfma_f32_16x16x32_bf16 v[138:141], a[152:155], v[186:189], v[138:141]
    v_mfma_f32_16x16x32_bf16 v[142:145], a[200:203], v[182:185], v[142:145]
    v_mfma_f32_16x16x32_bf16 v[146:149], a[200:203], v[186:189], v[146:149]
    v_mfma_f32_16x16x32_bf16 v[150:153], a[248:251], v[182:185], v[150:153]
    v_mfma_f32_16x16x32_bf16 v[154:157], a[248:251], v[186:189], v[154:157]
    v_mfma_f32_16x16x32_bf16 v[158:161], v[46:49], v[182:185], v[158:161]
    ds_read_b128 v[182:185], v92 offset:5120
    v_mfma_f32_16x16x32_bf16 v[162:165], v[46:49], v[186:189], v[162:165]
    ds_read_b128 v[186:189], v92 offset:19456
    s_waitcnt lgkmcnt(5)
    v_mfma_f32_16x16x32_bf16 v[110:113], a[12:15], v[166:169], v[110:113]
    s_waitcnt lgkmcnt(4)
    v_mfma_f32_16x16x32_bf16 v[114:117], a[12:15], v[170:173], v[114:117]
    v_mfma_f32_16x16x32_bf16 v[118:121], a[60:63], v[166:169], v[118:121]
    v_mfma_f32_16x16x32_bf16 v[122:125], a[60:63], v[170:173], v[122:125]
    v_mfma_f32_16x16x32_bf16 v[126:129], a[108:111], v[166:169], v[126:129]
    v_mfma_f32_16x16x32_bf16 v[130:133], a[108:111], v[170:173], v[130:133]
    v_mfma_f32_16x16x32_bf16 v[134:137], a[156:159], v[166:169], v[134:137]
    v_mfma_f32_16x16x32_bf16 v[138:141], a[156:159], v[170:173], v[138:141]
    v_mfma_f32_16x16x32_bf16 v[142:145], a[204:207], v[166:169], v[142:145]
    v_mfma_f32_16x16x32_bf16 v[146:149], a[204:207], v[170:173], v[146:149]
    v_mfma_f32_16x16x32_bf16 v[150:153], a[252:255], v[166:169], v[150:153]
    v_mfma_f32_16x16x32_bf16 v[154:157], a[252:255], v[170:173], v[154:157]
    v_mfma_f32_16x16x32_bf16 v[158:161], v[50:53], v[166:169], v[158:161]
    ds_read_b128 v[166:169], v92 offset:6144
    v_mfma_f32_16x16x32_bf16 v[162:165], v[50:53], v[170:173], v[162:165]
    ds_read_b128 v[170:173], v92 offset:20480
    s_waitcnt lgkmcnt(5)
    v_mfma_f32_16x16x32_bf16 v[110:113], a[16:19], v[174:177], v[110:113]
    s_waitcnt lgkmcnt(4)
    v_mfma_f32_16x16x32_bf16 v[114:117], a[16:19], v[178:181], v[114:117]
    v_mfma_f32_16x16x32_bf16 v[118:121], a[64:67], v[174:177], v[118:121]
    v_mfma_f32_16x16x32_bf16 v[122:125], a[64:67], v[178:181], v[122:125]
    v_mfma_f32_16x16x32_bf16 v[126:129], a[112:115], v[174:177], v[126:129]
    v_mfma_f32_16x16x32_bf16 v[130:133], a[112:115], v[178:181], v[130:133]
    v_mfma_f32_16x16x32_bf16 v[134:137], a[160:163], v[174:177], v[134:137]
    v_mfma_f32_16x16x32_bf16 v[138:141], a[160:163], v[178:181], v[138:141]
    v_mfma_f32_16x16x32_bf16 v[142:145], a[208:211], v[174:177], v[142:145]
    v_mfma_f32_16x16x32_bf16 v[146:149], a[208:211], v[178:181], v[146:149]
    v_mfma_f32_16x16x32_bf16 v[150:153], v[6:9], v[174:177], v[150:153]
    v_mfma_f32_16x16x32_bf16 v[154:157], v[6:9], v[178:181], v[154:157]
    v_mfma_f32_16x16x32_bf16 v[158:161], v[54:57], v[174:177], v[158:161]
    ds_read_b128 v[174:177], v92 offset:7168
    v_mfma_f32_16x16x32_bf16 v[162:165], v[54:57], v[178:181], v[162:165]
    ds_read_b128 v[178:181], v92 offset:21504
    s_waitcnt lgkmcnt(5)
    v_mfma_f32_16x16x32_bf16 v[110:113], a[20:23], v[182:185], v[110:113]
    s_waitcnt lgkmcnt(4)
    v_mfma_f32_16x16x32_bf16 v[114:117], a[20:23], v[186:189], v[114:117]
    v_mfma_f32_16x16x32_bf16 v[118:121], a[68:71], v[182:185], v[118:121]
    v_mfma_f32_16x16x32_bf16 v[122:125], a[68:71], v[186:189], v[122:125]
    v_mfma_f32_16x16x32_bf16 v[126:129], a[116:119], v[182:185], v[126:129]
    v_mfma_f32_16x16x32_bf16 v[130:133], a[116:119], v[186:189], v[130:133]
    v_mfma_f32_16x16x32_bf16 v[134:137], a[164:167], v[182:185], v[134:137]
    v_mfma_f32_16x16x32_bf16 v[138:141], a[164:167], v[186:189], v[138:141]
    v_mfma_f32_16x16x32_bf16 v[142:145], a[212:215], v[182:185], v[142:145]
    v_mfma_f32_16x16x32_bf16 v[146:149], a[212:215], v[186:189], v[146:149]
    v_mfma_f32_16x16x32_bf16 v[150:153], v[10:13], v[182:185], v[150:153]
    v_mfma_f32_16x16x32_bf16 v[154:157], v[10:13], v[186:189], v[154:157]
    v_mfma_f32_16x16x32_bf16 v[158:161], v[58:61], v[182:185], v[158:161]
    ds_read_b128 v[182:185], v92 offset:8192
    v_mfma_f32_16x16x32_bf16 v[162:165], v[58:61], v[186:189], v[162:165]
    ds_read_b128 v[186:189], v92 offset:22528
    s_waitcnt lgkmcnt(5)
    v_mfma_f32_16x16x32_bf16 v[110:113], a[24:27], v[166:169], v[110:113]
    s_waitcnt lgkmcnt(4)
    v_mfma_f32_16x16x32_bf16 v[114:117], a[24:27], v[170:173], v[114:117]
    v_mfma_f32_16x16x32_bf16 v[118:121], a[72:75], v[166:169], v[118:121]
    v_mfma_f32_16x16x32_bf16 v[122:125], a[72:75], v[170:173], v[122:125]
    v_mfma_f32_16x16x32_bf16 v[126:129], a[120:123], v[166:169], v[126:129]
    v_mfma_f32_16x16x32_bf16 v[130:133], a[120:123], v[170:173], v[130:133]
    v_mfma_f32_16x16x32_bf16 v[134:137], a[168:171], v[166:169], v[134:137]
    v_mfma_f32_16x16x32_bf16 v[138:141], a[168:171], v[170:173], v[138:141]
    v_mfma_f32_16x16x32_bf16 v[142:145], a[216:219], v[166:169], v[142:145]
    v_mfma_f32_16x16x32_bf16 v[146:149], a[216:219], v[170:173], v[146:149]
    v_mfma_f32_16x16x32_bf16 v[150:153], v[14:17], v[166:169], v[150:153]
    v_mfma_f32_16x16x32_bf16 v[154:157], v[14:17], v[170:173], v[154:157]
    v_mfma_f32_16x16x32_bf16 v[158:161], v[62:65], v[166:169], v[158:161]
    ds_read_b128 v[166:169], v92 offset:9216
    v_mfma_f32_16x16x32_bf16 v[162:165], v[62:65], v[170:173], v[162:165]
    ds_read_b128 v[170:173], v92 offset:23552
    s_waitcnt lgkmcnt(5)
    v_mfma_f32_16x16x32_bf16 v[110:113], a[28:31], v[174:177], v[110:113]
    s_waitcnt lgkmcnt(4)
    v_mfma_f32_16x16x32_bf16 v[114:117], a[28:31], v[178:181], v[114:117]
    v_mfma_f32_16x16x32_bf16 v[118:121], a[76:79], v[174:177], v[118:121]
    v_mfma_f32_16x16x32_bf16 v[122:125], a[76:79], v[178:181], v[122:125]
    v_mfma_f32_16x16x32_bf16 v[126:129], a[124:127], v[174:177], v[126:129]
    v_mfma_f32_16x16x32_bf16 v[130:133], a[124:127], v[178:181], v[130:133]
    v_mfma_f32_16x16x32_bf16 v[134:137], a[172:175], v[174:177], v[134:137]
    v_mfma_f32_16x16x32_bf16 v[138:141], a[172:175], v[178:181], v[138:141]
    buffer_load_dword v90, v89, s[4:7], s25 offen sc1
    v_mfma_f32_16x16x32_bf16 v[142:145], a[220:223], v[174:177], v[142:145]
    v_mfma_f32_16x16x32_bf16 v[146:149], a[220:223], v[178:181], v[146:149]
    v_mfma_f32_16x16x32_bf16 v[150:153], v[18:21], v[174:177], v[150:153]
    v_mfma_f32_16x16x32_bf16 v[154:157], v[18:21], v[178:181], v[154:157]
    v_mfma_f32_16x16x32_bf16 v[158:161], v[66:69], v[174:177], v[158:161]
    ds_read_b128 v[174:177], v92 offset:10240
    v_mfma_f32_16x16x32_bf16 v[162:165], v[66:69], v[178:181], v[162:165]
    ds_read_b128 v[178:181], v92 offset:24576
    s_waitcnt lgkmcnt(5)
    v_mfma_f32_16x16x32_bf16 v[110:113], a[32:35], v[182:185], v[110:113]
    s_waitcnt lgkmcnt(4)
    v_mfma_f32_16x16x32_bf16 v[114:117], a[32:35], v[186:189], v[114:117]
    v_mfma_f32_16x16x32_bf16 v[118:121], a[80:83], v[182:185], v[118:121]
    v_mfma_f32_16x16x32_bf16 v[122:125], a[80:83], v[186:189], v[122:125]
    v_mfma_f32_16x16x32_bf16 v[126:129], a[128:131], v[182:185], v[126:129]
    v_mfma_f32_16x16x32_bf16 v[130:133], a[128:131], v[186:189], v[130:133]
    v_mfma_f32_16x16x32_bf16 v[134:137], a[176:179], v[182:185], v[134:137]
    v_mfma_f32_16x16x32_bf16 v[138:141], a[176:179], v[186:189], v[138:141]
    v_mfma_f32_16x16x32_bf16 v[142:145], a[224:227], v[182:185], v[142:145]
    v_mfma_f32_16x16x32_bf16 v[146:149], a[224:227], v[186:189], v[146:149]
    v_mfma_f32_16x16x32_bf16 v[150:153], v[22:25], v[182:185], v[150:153]
    v_mfma_f32_16x16x32_bf16 v[154:157], v[22:25], v[186:189], v[154:157]
    v_mfma_f32_16x16x32_bf16 v[158:161], v[70:73], v[182:185], v[158:161]
    ds_read_b128 v[182:185], v92 offset:11264
    v_mfma_f32_16x16x32_bf16 v[162:165], v[70:73], v[186:189], v[162:165]
    ds_read_b128 v[186:189], v92 offset:25600
    s_waitcnt lgkmcnt(5)
    v_mfma_f32_16x16x32_bf16 v[110:113], a[36:39], v[166:169], v[110:113]
    s_waitcnt lgkmcnt(4)
    v_mfma_f32_16x16x32_bf16 v[114:117], a[36:39], v[170:173], v[114:117]
    v_mfma_f32_16x16x32_bf16 v[118:121], a[84:87], v[166:169], v[118:121]
    v_mfma_f32_16x16x32_bf16 v[122:125], a[84:87], v[170:173], v[122:125]
    v_mfma_f32_16x16x32_bf16 v[126:129], a[132:135], v[166:169], v[126:129]
    v_mfma_f32_16x16x32_bf16 v[130:133], a[132:135], v[170:173], v[130:133]
    v_mfma_f32_16x16x32_bf16 v[134:137], a[180:183], v[166:169], v[134:137]
    v_mfma_f32_16x16x32_bf16 v[138:141], a[180:183], v[170:173], v[138:141]
    v_mfma_f32_16x16x32_bf16 v[142:145], a[228:231], v[166:169], v[142:145]
    v_mfma_f32_16x16x32_bf16 v[146:149], a[228:231], v[170:173], v[146:149]
    v_mfma_f32_16x16x32_bf16 v[150:153], v[26:29], v[166:169], v[150:153]
    v_mfma_f32_16x16x32_bf16 v[154:157], v[26:29], v[170:173], v[154:157]
    v_mfma_f32_16x16x32_bf16 v[158:161], v[74:77], v[166:169], v[158:161]
    ds_read_b128 v[166:169], v92 offset:12288
    v_mfma_f32_16x16x32_bf16 v[162:165], v[74:77], v[170:173], v[162:165]
    ds_read_b128 v[170:173], v92 offset:26624
    s_waitcnt lgkmcnt(5)
    v_mfma_f32_16x16x32_bf16 v[110:113], a[40:43], v[174:177], v[110:113]
    s_waitcnt lgkmcnt(4)
    v_mfma_f32_16x16x32_bf16 v[114:117], a[40:43], v[178:181], v[114:117]
    s_waitcnt lgkmcnt(3)
    v_mfma_f32_16x16x32_bf16 v[110:113], a[44:47], v[182:185], v[110:113]
    s_waitcnt lgkmcnt(2)
    v_mfma_f32_16x16x32_bf16 v[114:117], a[44:47], v[186:189], v[114:117]
    v_mfma_f32_16x16x32_bf16 v[118:121], a[88:91], v[174:177], v[118:121]
    v_mfma_f32_16x16x32_bf16 v[122:125], a[88:91], v[178:181], v[122:125]
    s_waitcnt lgkmcnt(1)
    v_mfma_f32_16x16x32_bf16 v[110:113], v[190:193], v[166:169], v[110:113]
    s_waitcnt lgkmcnt(0)
    v_mfma_f32_16x16x32_bf16 v[114:117], v[190:193], v[170:173], v[114:117]
    ds_read_b128 v[190:193], v97 offset:8192
    v_mfma_f32_16x16x32_bf16 v[126:129], a[136:139], v[174:177], v[126:129]
    v_mfma_f32_16x16x32_bf16 v[130:133], a[136:139], v[178:181], v[130:133]
    v_mfma_f32_16x16x32_bf16 v[134:137], a[184:187], v[174:177], v[134:137]
    v_mfma_f32_16x16x32_bf16 v[138:141], a[184:187], v[178:181], v[138:141]
    v_mfma_f32_16x16x32_bf16 v[118:121], a[92:95], v[182:185], v[118:121]
    v_mfma_f32_16x16x32_bf16 v[122:125], a[92:95], v[186:189], v[122:125]
    v_mfma_f32_16x16x32_bf16 v[142:145], a[232:235], v[174:177], v[142:145]
    v_mfma_f32_16x16x32_bf16 v[146:149], a[232:235], v[178:181], v[146:149]
    v_mfma_f32_16x16x32_bf16 v[126:129], a[140:143], v[182:185], v[126:129]
    v_mfma_f32_16x16x32_bf16 v[130:133], a[140:143], v[186:189], v[130:133]
    v_mfma_f32_16x16x32_bf16 v[134:137], a[188:191], v[182:185], v[134:137]
    v_mfma_f32_16x16x32_bf16 v[138:141], a[188:191], v[186:189], v[138:141]
    v_mfma_f32_16x16x32_bf16 v[118:121], v[194:197], v[166:169], v[118:121]
    v_mfma_f32_16x16x32_bf16 v[122:125], v[194:197], v[170:173], v[122:125]
    ds_read_b128 v[194:197], v97 offset:10240
    v_mfma_f32_16x16x32_bf16 v[142:145], a[236:239], v[182:185], v[142:145]
    v_mfma_f32_16x16x32_bf16 v[146:149], a[236:239], v[186:189], v[146:149]
    v_mfma_f32_16x16x32_bf16 v[126:129], v[198:201], v[166:169], v[126:129]
    v_mfma_f32_16x16x32_bf16 v[130:133], v[198:201], v[170:173], v[130:133]
    ds_read_b128 v[198:201], v97 offset:12288
    v_mfma_f32_16x16x32_bf16 v[150:153], v[30:33], v[174:177], v[150:153]
    v_mfma_f32_16x16x32_bf16 v[154:157], v[30:33], v[178:181], v[154:157]
    v_mfma_f32_16x16x32_bf16 v[158:161], v[78:81], v[174:177], v[158:161]
    ds_read_b128 v[174:177], v92 offset:13312
    v_mfma_f32_16x16x32_bf16 v[162:165], v[78:81], v[178:181], v[162:165]
    ds_read_b128 v[178:181], v92 offset:27648
    v_mfma_f32_16x16x32_bf16 v[134:137], v[202:205], v[166:169], v[134:137]
    v_mfma_f32_16x16x32_bf16 v[138:141], v[202:205], v[170:173], v[138:141]
    ds_read_b128 v[202:205], v97 offset:1024
    s_waitcnt vmcnt(0)
    v_cmp_eq_u32 vcc, 0, v90
    s_waitcnt lgkmcnt(5)
    v_mfma_f32_16x16x32_bf16 v[142:145], v[190:193], v[166:169], v[142:145]
    s_cmp_eq_u64 vcc, 0
    s_cselect_b32 s27, 0, 1
    v_mfma_f32_16x16x32_bf16 v[146:149], v[190:193], v[170:173], v[146:149]
    ds_read_b128 v[190:193], v97 offset:3072
    s_cselect_b32 s24, 0, 1073741824
    s_cmp_ge_u32 s28, 64
    v_mfma_f32_16x16x32_bf16 v[150:153], v[34:37], v[182:185], v[150:153]
    s_cselect_b32 s24, 1073741824, s24
    v_add_u32 v91, s24, v4
    v_mfma_f32_16x16x32_bf16 v[154:157], v[34:37], v[186:189], v[154:157]
    s_mov_b32 m0, s26
    s_nop 0
    buffer_load_dwordx4 v91, s[4:7], s23 offen sc1 lds
    v_mfma_f32_16x16x32_bf16 v[158:161], v[82:85], v[182:185], v[158:161]
    v_mfma_f32_16x16x32_bf16 v[162:165], v[82:85], v[186:189], v[162:165]
    s_waitcnt lgkmcnt(5)
    v_mfma_f32_16x16x32_bf16 v[150:153], v[194:197], v[166:169], v[150:153]
    buffer_load_dwordx4 v91, s[4:7], s23 offen offset:1024 sc1 lds
    v_mfma_f32_16x16x32_bf16 v[154:157], v[194:197], v[170:173], v[154:157]
    ds_read_b128 v[194:197], v97 offset:5120
    s_waitcnt lgkmcnt(5)
    v_mfma_f32_16x16x32_bf16 v[158:161], v[198:201], v[166:169], v[158:161]
    ds_read_b64 v[166:167], v99 offset:0
    v_mfma_f32_16x16x32_bf16 v[162:165], v[198:201], v[170:173], v[162:165]
    ds_read_b128 v[198:201], v97 offset:7168
    buffer_load_dwordx4 v91, s[4:7], s23 offen offset:2048 sc1 lds
    s_waitcnt lgkmcnt(4)
    v_mfma_f32_16x16x32_bf16 v[110:113], v[202:205], v[174:177], v[110:113]
    ds_read_b64 v[170:171], v99 offset:14336
    v_mfma_f32_16x16x32_bf16 v[114:117], v[202:205], v[178:181], v[114:117]
    ds_read_b128 v[202:205], v97 offset:9216
    s_waitcnt lgkmcnt(5)
    v_mfma_f32_16x16x32_bf16 v[118:121], v[190:193], v[174:177], v[118:121]
    v_mfma_f32_16x16x32_bf16 v[122:125], v[190:193], v[178:181], v[122:125]
    ds_read_b128 v[190:193], v97 offset:11264
    buffer_load_dwordx4 v91, s[4:7], s23 offen offset:3072 sc1 lds
    v_cvt_pk_bf16_f32 v110, v110, v111
    s_waitcnt lgkmcnt(5)
    v_mfma_f32_16x16x32_bf16 v[126:129], v[194:197], v[174:177], v[126:129]
    v_cvt_pk_bf16_f32 v114, v114, v115
    v_cvt_pk_bf16_f32 v111, v112, v113
    v_mfma_f32_16x16x32_bf16 v[130:133], v[194:197], v[178:181], v[130:133]
    v_cvt_pk_bf16_f32 v115, v116, v117
    ds_read_b128 v[194:197], v97 offset:13312
    v_cvt_pk_bf16_f32 v112, v118, v119
    s_waitcnt lgkmcnt(4)
    v_mfma_f32_16x16x32_bf16 v[134:137], v[198:201], v[174:177], v[134:137]
    v_cvt_pk_bf16_f32 v113, v120, v121
    v_cvt_pk_bf16_f32 v116, v122, v123
    v_mfma_f32_16x16x32_bf16 v[138:141], v[198:201], v[178:181], v[138:141]
    v_cvt_pk_bf16_f32 v117, v124, v125
    ds_read_b128 v[118:121], v98 offset:0
    v_cvt_pk_bf16_f32 v126, v126, v127
    s_waitcnt lgkmcnt(3)
    v_mfma_f32_16x16x32_bf16 v[142:145], v[202:205], v[174:177], v[142:145]
    v_cvt_pk_bf16_f32 v130, v130, v131
    ds_read_b128 v[122:125], v98 offset:14336
    v_cvt_pk_bf16_f32 v127, v128, v129
    v_mfma_f32_16x16x32_bf16 v[146:149], v[202:205], v[178:181], v[146:149]
    v_cvt_pk_bf16_f32 v131, v132, v133
    v_cvt_pk_bf16_f32 v128, v134, v135
    s_waitcnt lgkmcnt(3)
    v_mfma_f32_16x16x32_bf16 v[150:153], v[190:193], v[174:177], v[150:153]
    v_cvt_pk_bf16_f32 v129, v136, v137
    v_cvt_pk_bf16_f32 v132, v138, v139
    v_mfma_f32_16x16x32_bf16 v[154:157], v[190:193], v[178:181], v[154:157]
    v_cvt_pk_bf16_f32 v133, v140, v141
    ds_read_b128 v[134:137], v98 offset:1024
    v_cvt_pk_bf16_f32 v142, v142, v143
    v_cvt_pk_bf16_f32 v146, v146, v147
    s_add_u32 s24, s23, 4096
    s_waitcnt lgkmcnt(3)
    v_mfma_f32_16x16x32_bf16 v[158:161], v[194:197], v[174:177], v[158:161]
    ds_read_b128 v[138:141], v98 offset:15360
    v_cvt_pk_bf16_f32 v143, v144, v145
    v_cvt_pk_bf16_f32 v147, v148, v149
    v_mfma_f32_16x16x32_bf16 v[162:165], v[194:197], v[178:181], v[162:165]
    v_cvt_pk_bf16_f32 v144, v150, v151
    v_cvt_pk_bf16_f32 v145, v152, v153
    s_waitcnt lgkmcnt(3)
    v_mfma_f32_16x16x32_bf16 v[206:209], v[118:121], v[110:113], 0
    v_cvt_pk_bf16_f32 v148, v154, v155
    v_cvt_pk_bf16_f32 v149, v156, v157
    v_mfma_f32_16x16x32_bf16 v[214:217], v[118:121], v[114:117], 0
    ds_read_b128 v[150:153], v98 offset:2048
    v_cvt_pk_bf16_f32 v158, v158, v159
    v_cvt_pk_bf16_f32 v162, v162, v163
    s_waitcnt lgkmcnt(3)
    v_mfma_f32_16x16x32_bf16 v[210:213], v[122:125], v[114:117], 0
    ds_read_b128 v[154:157], v98 offset:16384
    v_cvt_pk_bf16_f32 v159, v160, v161
    v_cvt_pk_bf16_f32 v163, v164, v165
    s_add_u32 m0, s26, 4096
    s_nop 0
    buffer_load_dwordx4 v91, s[4:7], s24 offen sc1 lds
    buffer_load_dwordx4 v91, s[4:7], s24 offen offset:1024 sc1 lds
    buffer_load_dwordx4 v91, s[4:7], s24 offen offset:2048 sc1 lds
    s_waitcnt lgkmcnt(3)
    v_mfma_f32_16x16x32_bf16 v[206:209], v[134:137], v[126:129], v[206:209]
    v_mfma_f32_16x16x32_bf16 v[214:217], v[134:137], v[130:133], v[214:217]
    s_waitcnt lgkmcnt(2)
    v_mfma_f32_16x16x32_bf16 v[210:213], v[138:141], v[130:133], v[210:213]
    s_waitcnt lgkmcnt(1)
    v_mfma_f32_16x16x32_bf16 v[206:209], v[150:153], v[142:145], v[206:209]
    v_mfma_f32_16x16x32_bf16 v[214:217], v[150:153], v[146:149], v[214:217]
    s_waitcnt lgkmcnt(0)
    v_mfma_f32_16x16x32_bf16 v[210:213], v[154:157], v[146:149], v[210:213]
    v_mfma_f32_16x16x16_bf16 v[206:209], v[166:167], v[158:159], v[206:209]
    v_mfma_f32_16x16x16_bf16 v[210:213], v[170:171], v[162:163], v[210:213]
    v_mfma_f32_16x16x16_bf16 v[214:217], v[166:167], v[162:163], v[214:217]
    s_nop 5
    ds_write_b128 v100, v[206:209] offset:0
    ds_write_b128 v100, v[210:213] offset:1024
    ds_write_b128 v100, v[214:217] offset:2048
    v_cmp_eq_u32 vcc, 0, v109
    s_cbranch_vccz dnok_251
dnp_250:
    s_sleep 2
    buffer_load_dword v109, v89, s[4:7], s46 offen sc1
    s_waitcnt vmcnt(0)
    v_cmp_eq_u32 vcc, 0, v109
    s_cbranch_vccz dnok_251
    s_sub_u32 s13, s13, 1
    s_cbranch_scc0 dnp_250
    s_mov_b32 s13, 0
dnok_251:
Mpoll_252:
    buffer_load_dwordx4 v[226:229], v86, s[4:7], s42 offen sc1
    buffer_load_dwordx4 v[230:233], v87, s[4:7], s42 offen sc1
Mfirst_254:
    s_waitcnt vmcnt(0)
    v_max3_u32 v1, v226, v227, v228
    v_max3_u32 v1, v1, v229, v230
    v_max3_u32 v1, v1, v231, v232
    v_max_u32 v1, v1, v233
    v_cmp_eq_u32 vcc, -1, v1
    s_cbranch_vccz Mgot_253
    s_sleep 1
    s_sub_u32 s13, s13, 1
    s_cbranch_scc0 Mpoll_252
    s_mov_b32 s13, 0
Mgot_253:
    ds_write_b128 v88, v[226:229]
    ds_write_b128 v88, v[230:233] offset:1024
    s_waitcnt lgkmcnt(0)
    s_barrier
    ds_read2_b32 v[118:119], v93 offset0:0 offset1:4
    ds_read2_b32 v[120:121], v93 offset0:1 offset1:5
    ds_read2_b32 v[134:135], v94 offset0:0 offset1:4
    ds_read2_b32 v[136:137], v94 offset0:1 offset1:5
    ds_read2_b32 v[150:151], v95 offset0:0 offset1:4
    ds_read2_b32 v[152:153], v95 offset0:1 offset1:5
    ds_read2_b32 v[122:123], v96 offset0:0 offset1:4
    ds_read_b128 v[206:209], v101 offset:0
    s_waitcnt lgkmcnt(6)
    v_mfma_f32_16x16x32_bf16 v[218:221], v[118:121], v[110:113], 0
    ds_read_b128 v[166:169], v101 offset:5120
    v_mfma_f32_16x16x32_bf16 v[222:225], v[118:121], v[114:117], 0
    ds_read_b128 v[170:173], v101 offset:10240
    s_waitcnt lgkmcnt(6)
    v_mfma_f32_16x16x32_bf16 v[218:221], v[134:137], v[126:129], v[218:221]
    ds_read_b128 v[174:177], v101 offset:15360
    v_mfma_f32_16x16x32_bf16 v[222:225], v[134:137], v[130:133], v[222:225]
    ds_read_b128 v[210:213], v102 offset:0
    s_waitcnt lgkmcnt(6)
    v_mfma_f32_16x16x32_bf16 v[218:221], v[150:153], v[142:145], v[218:221]
    ds_read_b128 v[178:181], v102 offset:5120
    v_mfma_f32_16x16x32_bf16 v[222:225], v[150:153], v[146:149], v[222:225]
    ds_read_b128 v[182:185], v102 offset:10240
    s_waitcnt lgkmcnt(7)
    v_mfma_f32_16x16x16_bf16 v[218:221], v[122:123], v[158:159], v[218:221]
    ds_read_b128 v[186:189], v102 offset:15360
    v_mfma_f32_16x16x16_bf16 v[222:225], v[122:123], v[162:163], v[222:225]
    s_waitcnt lgkmcnt(6)
    v_add_f32 v206, v206, v166
    v_add_f32 v207, v207, v167
    v_add_f32 v208, v208, v168
    v_add_f32 v209, v209, v169
    s_nop 0
    ds_write_b128 v100, v[218:221] offset:3072
    s_waitcnt lgkmcnt(5)
    v_add_f32 v170, v170, v174
    v_add_f32 v171, v171, v175
    v_add_f32 v172, v172, v176
    v_add_f32 v173, v173, v177
    v_add_f32 v206, v206, v170
    v_add_f32 v207, v207, v171
    v_add_f32 v208, v208, v172
    ds_write_b128 v100, v[222:225] offset:4096
    s_waitcnt lgkmcnt(4)
    v_add_f32 v210, v210, v178
    v_add_f32 v209, v209, v173
    v_add_f32 v211, v211, v179
    v_add_f32 v212, v212, v180
    v_cndmask_b32 v206, v105, v206, s[30:31]
    v_cndmask_b32 v207, v105, v207, s[32:33]
    v_cndmask_b32 v208, v105, v208, s[34:35]
    v_add_f32 v213, v213, v181
    s_waitcnt lgkmcnt(2)
    v_add_f32 v182, v182, v186
    v_add_f32 v183, v183, v187
    v_add_f32 v184, v184, v188
    v_add_f32 v210, v210, v182
    v_add_f32 v185, v185, v189
    v_add_f32 v211, v211, v183
    v_add_f32 v212, v212, v184
    v_cndmask_b32 v210, v105, v210, s[38:39]
    v_cndmask_b32 v209, v105, v209, s[36:37]
    v_max3_f32 v190, v206, v207, v208
    v_add_f32 v213, v213, v185
    v_cndmask_b32 v211, v105, v211, s[38:39]
    v_cndmask_b32 v212, v105, v212, s[38:39]
    v_max3_f32 v190, v190, v209, v210
    v_cndmask_b32 v213, v105, v213, s[38:39]
    v_max3_f32 v190, v190, v211, v212
    v_max_f32 v190, v190, v213
    s_waitcnt lgkmcnt(0)
    s_barrier
    ds_read_b128 v[214:217], v101 offset:3072
    ds_read_b128 v[166:169], v101 offset:8192
    ds_read_b128 v[170:173], v101 offset:13312
    ds_read_b128 v[174:177], v101 offset:18432
    s_waitcnt lgkmcnt(2)
    v_add_f32 v214, v214, v166
    v_add_f32 v215, v215, v167
    v_add_f32 v216, v216, v168
    v_add_f32 v217, v217, v169
    s_waitcnt lgkmcnt(0)
    v_add_f32 v170, v170, v174
    v_add_f32 v171, v171, v175
    v_add_f32 v172, v172, v176
    v_add_f32 v173, v173, v177
    v_add_f32 v214, v214, v170
    v_add_f32 v215, v215, v171
    v_add_f32 v216, v216, v172
    v_add_f32 v217, v217, v173
    v_cndmask_b32 v214, v105, v214, s[40:41]
    v_cndmask_b32 v215, v105, v215, s[40:41]
    v_cndmask_b32 v216, v105, v216, s[40:41]
    v_cndmask_b32 v217, v105, v217, s[40:41]
    v_max3_f32 v190, v190, v214, v215
    v_max3_f32 v190, v190, v216, v217
    v_mov_b32 v191, v190
    s_nop 1
    v_permlane16_swap_b32 v190, v191
    v_max_f32 v190, v190, v191
    v_mov_b32 v191, v190
    s_nop 1
    v_permlane32_swap_b32 v190, v191
    v_max_f32 v190, v190, v191
    v_sub_f32 v206, v206, v190
    v_sub_f32 v207, v207, v190
    v_sub_f32 v208, v208, v190
    v_sub_f32 v209, v209, v190
    v_sub_f32 v210, v210, v190
    v_sub_f32 v211, v211, v190
    v_sub_f32 v212, v212, v190
    v_sub_f32 v213, v213, v190
    v_sub_f32 v214, v214, v190
    v_sub_f32 v215, v215, v190
    v_sub_f32 v216, v216, v190
    v_sub_f32 v217, v217, v190
    v_exp_f32 v206, v206
    v_exp_f32 v207, v207
    v_exp_f32 v208, v208
    v_exp_f32 v209, v209
    v_exp_f32 v210, v210
    v_exp_f32 v211, v211
    v_exp_f32 v212, v212
    v_exp_f32 v213, v213
    v_exp_f32 v214, v214
    v_exp_f32 v215, v215
    v_exp_f32 v216, v216
    v_exp_f32 v217, v217
    v_add_f32 v194, v206, v207
    v_add_f32 v198, v208, v209
    v_add_f32 v195, v210, v211
    v_add_f32 v199, v212, v213
    v_add_f32 v194, v194, v198
    v_add_f32 v195, v195, v199
    v_add_f32 v196, v214, v215
    v_add_f32 v200, v216, v217
    v_add_f32 v194, v194, v195
    v_add_f32 v196, v196, v200
    v_add_f32 v194, v194, v196
    v_mov_b32 v191, v194
    s_nop 1
    v_permlane16_swap_b32 v194, v191
    v_add_f32 v194, v194, v191
    v_mov_b32 v191, v194
    s_nop 1
    v_permlane32_swap_b32 v194, v191
    v_add_f32 v194, v194, v191
    v_rcp_f32 v194, v194
    s_nop 0
    v_mul_f32 v206, v206, v194
    v_mul_f32 v207, v207, v194
    v_mul_f32 v210, v210, v194
    v_mul_f32 v211, v211, v194
    v_mul_f32 v208, v208, v194
    v_mul_f32 v209, v209, v194
    v_mul_f32 v212, v212, v194
    v_mul_f32 v213, v213, v194
    v_cvt_pk_bf16_f32 v206, v206, v207
    v_cvt_pk_bf16_f32 v210, v210, v211
    v_mul_f32 v214, v214, v194
    v_mul_f32 v215, v215, v194
    v_cvt_pk_bf16_f32 v207, v208, v209
    v_cvt_pk_bf16_f32 v211, v212, v213
    v_mul_f32 v216, v216, v194
    v_mul_f32 v217, v217, v194
    v_cvt_pk_bf16_f32 v214, v214, v215
    v_cndmask_b32 v202, v206, v210, s[38:39]
    v_cndmask_b32 v204, v210, v206, s[38:39]
    v_cndmask_b32 v203, v207, v211, s[38:39]
    v_cndmask_b32 v205, v211, v207, s[38:39]
    v_cvt_pk_bf16_f32 v215, v216, v217
    buffer_store_dwordx4 v[202:205], v103, s[4:7], s43 offen
    buffer_store_dwordx2 v[214:215], v104, s[4:7], s43 offen offset:1024
    v_add_u32 v106, s29, v107
    s_add_u32 s29, s29, 8
    s_add_u32 s11, s11, 2
    s_add_u32 s42, s42, 14336
    s_add_u32 s45, s45, 8
    s_cmp_lt_u32 s11, 64
    s_cbranch_scc1 Aloop_244
    s_waitcnt vmcnt(0)
    buffer_store_dword v108, v106, s[4:7], 0 offen
    v_mov_b32 v106, 1073741824
    s_endpgm
.p2align 6
far_243:
Aloop_255:
    s_cmp_eq_u32 s27, 0
    s_cbranch_scc1 Tearly_257
    s_waitcnt vmcnt(0)
    buffer_store_dword v108, v106, s[4:7], 0 offen sc1
    v_mov_b32 v106, 1073741824
Tpoll_259:
    buffer_load_dword v90, v89, s[4:7], s25 offen sc1
    s_waitcnt vmcnt(0)
    v_cmp_eq_u32 vcc, 0, v90
    s_cbranch_vccz Tok_260
    s_sleep 1
    s_sub_u32 s13, s13, 1
    s_cbranch_scc0 Tpoll_259
    s_mov_b32 s13, 0
Tok_260:
    s_mov_b32 m0, s26
    s_nop 0
    buffer_load_dwordx4 v4, s[4:7], s23 offen sc1 lds
    buffer_load_dwordx4 v4, s[4:7], s23 offen offset:1024 sc1 lds
    buffer_load_dwordx4 v4, s[4:7], s23 offen offset:2048 sc1 lds
    buffer_load_dwordx4 v4, s[4:7], s23 offen offset:3072 sc1 lds
    s_add_u32 s24, s23, 4096
    s_add_u32 m0, s26, 4096
    s_nop 0
    buffer_load_dwordx4 v4, s[4:7], s24 offen sc1 lds
    buffer_load_dwordx4 v4, s[4:7], s24 offen offset:1024 sc1 lds
    buffer_load_dwordx4 v4, s[4:7], s24 offen offset:2048 sc1 lds
    s_waitcnt vmcnt(0)
    s_branch Tjoin_258
Tearly_257:
    s_waitcnt vmcnt(2)
Tjoin_258:
    s_add_u32 s25, s25, 8
    s_add_u32 s28, s28, 2
    s_add_u32 s23, s23, 57344
    s_xor_b32 s26, s26, 0x8000
    v_xor_b32 v92, 0x8000, v92
    s_barrier
    v_add_u32 v98, s18, v92
    v_add_u32 v99, s19, v92
    s_and_b32 s43, s11, 7
    s_mul_i32 s43, s43, 40960
    s_add_u32 s43, s43, s44
    s_cmp_lt_u32 s11, 8
    s_cselect_b32 s46, 65536, s45
    ds_read_b128 v[166:169], v92 offset:0
    ds_read_b128 v[170:173], v92 offset:14336
    ds_read_b128 v[174:177], v92 offset:1024
    ds_read_b128 v[178:181], v92 offset:15360
    ds_read_b128 v[182:185], v92 offset:2048
    ds_read_b128 v[186:189], v92 offset:16384
    ds_read_b128 v[190:193], v97 offset:0
    s_waitcnt lgkmcnt(6)
    v_mfma_f32_16x16x32_bf16 v[110:113], a[0:3], v[166:169], 0
    ds_read_b128 v[194:197], v97 offset:2048
    s_waitcnt lgkmcnt(6)
    v_mfma_f32_16x16x32_bf16 v[114:117], a[0:3], v[170:173], 0
    ds_read_b128 v[198:201], v97 offset:4096
    v_mfma_f32_16x16x32_bf16 v[118:121], a[48:51], v[166:169], 0
    ds_read_b128 v[202:205], v97 offset:6144
    v_mfma_f32_16x16x32_bf16 v[122:125], a[48:51], v[170:173], 0
    v_mfma_f32_16x16x32_bf16 v[126:129], a[96:99], v[166:169], 0
    v_mfma_f32_16x16x32_bf16 v[130:133], a[96:99], v[170:173], 0
    v_mfma_f32_16x16x32_bf16 v[134:137], a[144:147], v[166:169], 0
    s_waitcnt vmcnt(0)
    buffer_store_dword v108, v106, s[4:7], 0 offen sc1
    v_mfma_f32_16x16x32_bf16 v[138:141], a[144:147], v[170:173], 0
    v_mfma_f32_16x16x32_bf16 v[142:145], a[192:195], v[166:169], 0
    v_mfma_f32_16x16x32_bf16 v[146:149], a[192:195], v[170:173], 0
    v_mfma_f32_16x16x32_bf16 v[150:153], a[240:243], v[166:169], 0
    v_mfma_f32_16x16x32_bf16 v[154:157], a[240:243], v[170:173], 0
    v_mfma_f32_16x16x32_bf16 v[158:161], v[38:41], v[166:169], 0
    ds_read_b128 v[166:169], v92 offset:3072
    v_mfma_f32_16x16x32_bf16 v[162:165], v[38:41], v[170:173], 0
    ds_read_b128 v[170:173], v92 offset:17408
    s_waitcnt lgkmcnt(9)
    v_mfma_f32_16x16x32_bf16 v[110:113], a[4:7], v[174:177], v[110:113]
    s_waitcnt lgkmcnt(8)
    v_mfma_f32_16x16x32_bf16 v[114:117], a[4:7], v[178:181], v[114:117]
    v_mfma_f32_16x16x32_bf16 v[118:121], a[52:55], v[174:177], v[118:121]
    v_mfma_f32_16x16x32_bf16 v[122:125], a[52:55], v[178:181], v[122:125]
    v_mfma_f32_16x16x32_bf16 v[126:129], a[100:103], v[174:177], v[126:129]
    buffer_load_dword v109, v89, s[4:7], s46 offen sc1
    v_mfma_f32_16x16x32_bf16 v[130:133], a[100:103], v[178:181], v[130:133]
    v_mfma_f32_16x16x32_bf16 v[134:137], a[148:151], v[174:177], v[134:137]
    v_mfma_f32_16x16x32_bf16 v[138:141], a[148:151], v[178:181], v[138:141]
    v_mfma_f32_16x16x32_bf16 v[142:145], a[196:199], v[174:177], v[142:145]
    v_mfma_f32_16x16x32_bf16 v[146:149], a[196:199], v[178:181], v[146:149]
    v_mfma_f32_16x16x32_bf16 v[150:153], a[244:247], v[174:177], v[150:153]
    v_mfma_f32_16x16x32_bf16 v[154:157], a[244:247], v[178:181], v[154:157]
    v_mfma_f32_16x16x32_bf16 v[158:161], v[42:45], v[174:177], v[158:161]
    ds_read_b128 v[174:177], v92 offset:4096
    v_mfma_f32_16x16x32_bf16 v[162:165], v[42:45], v[178:181], v[162:165]
    ds_read_b128 v[178:181], v92 offset:18432
    s_waitcnt lgkmcnt(9)
    v_mfma_f32_16x16x32_bf16 v[110:113], a[8:11], v[182:185], v[110:113]
    s_waitcnt lgkmcnt(8)
    v_mfma_f32_16x16x32_bf16 v[114:117], a[8:11], v[186:189], v[114:117]
    v_mfma_f32_16x16x32_bf16 v[118:121], a[56:59], v[182:185], v[118:121]
    v_mfma_f32_16x16x32_bf16 v[122:125], a[56:59], v[186:189], v[122:125]
    v_mfma_f32_16x16x32_bf16 v[126:129], a[104:107], v[182:185], v[126:129]
    v_mfma_f32_16x16x32_bf16 v[130:133], a[104:107], v[186:189], v[130:133]
    v_mfma_f32_16x16x32_bf16 v[134:137], a[152:155], v[182:185], v[134:137]
    v_mfma_f32_16x16x32_bf16 v[138:141], a[152:155], v[186:189], v[138:141]
    v_mfma_f32_16x16x32_bf16 v[142:145], a[200:203], v[182:185], v[142:145]
    v_mfma_f32_16x16x32_bf16 v[146:149], a[200:203], v[186:189], v[146:149]
    v_mfma_f32_16x16x32_bf16 v[150:153], a[248:251], v[182:185], v[150:153]
    v_mfma_f32_16x16x32_bf16 v[154:157], a[248:251], v[186:189], v[154:157]
    v_mfma_f32_16x16x32_bf16 v[158:161], v[46:49], v[182:185], v[158:161]
    ds_read_b128 v[182:185], v92 offset:5120
    v_mfma_f32_16x16x32_bf16 v[162:165], v[46:49], v[186:189], v[162:165]
    ds_read_b128 v[186:189], v92 offset:19456
    s_waitcnt lgkmcnt(5)
    v_mfma_f32_16x16x32_bf16 v[110:113], a[12:15], v[166:169], v[110:113]
    s_waitcnt lgkmcnt(4)
    v_mfma_f32_16x16x32_bf16 v[114:117], a[12:15], v[170:173], v[114:117]
    v_mfma_f32_16x16x32_bf16 v[118:121], a[60:63], v[166:169], v[118:121]
    v_mfma_f32_16x16x32_bf16 v[122:125], a[60:63], v[170:173], v[122:125]
    v_mfma_f32_16x16x32_bf16 v[126:129], a[108:111], v[166:169], v[126:129]
    v_mfma_f32_16x16x32_bf16 v[130:133], a[108:111], v[170:173], v[130:133]
    v_mfma_f32_16x16x32_bf16 v[134:137], a[156:159], v[166:169], v[134:137]
    v_mfma_f32_16x16x32_bf16 v[138:141], a[156:159], v[170:173], v[138:141]
    v_mfma_f32_16x16x32_bf16 v[142:145], a[204:207], v[166:169], v[142:145]
    v_mfma_f32_16x16x32_bf16 v[146:149], a[204:207], v[170:173], v[146:149]
    v_mfma_f32_16x16x32_bf16 v[150:153], a[252:255], v[166:169], v[150:153]
    v_mfma_f32_16x16x32_bf16 v[154:157], a[252:255], v[170:173], v[154:157]
    v_mfma_f32_16x16x32_bf16 v[158:161], v[50:53], v[166:169], v[158:161]
    ds_read_b128 v[166:169], v92 offset:6144
    v_mfma_f32_16x16x32_bf16 v[162:165], v[50:53], v[170:173], v[162:165]
    ds_read_b128 v[170:173], v92 offset:20480
    s_waitcnt lgkmcnt(5)
    v_mfma_f32_16x16x32_bf16 v[110:113], a[16:19], v[174:177], v[110:113]
    s_waitcnt lgkmcnt(4)
    v_mfma_f32_16x16x32_bf16 v[114:117], a[16:19], v[178:181], v[114:117]
    v_mfma_f32_16x16x32_bf16 v[118:121], a[64:67], v[174:177], v[118:121]
    v_mfma_f32_16x16x32_bf16 v[122:125], a[64:67], v[178:181], v[122:125]
    v_mfma_f32_16x16x32_bf16 v[126:129], a[112:115], v[174:177], v[126:129]
    v_mfma_f32_16x16x32_bf16 v[130:133], a[112:115], v[178:181], v[130:133]
    v_mfma_f32_16x16x32_bf16 v[134:137], a[160:163], v[174:177], v[134:137]
    v_mfma_f32_16x16x32_bf16 v[138:141], a[160:163], v[178:181], v[138:141]
    v_mfma_f32_16x16x32_bf16 v[142:145], a[208:211], v[174:177], v[142:145]
    v_mfma_f32_16x16x32_bf16 v[146:149], a[208:211], v[178:181], v[146:149]
    v_mfma_f32_16x16x32_bf16 v[150:153], v[6:9], v[174:177], v[150:153]
    v_mfma_f32_16x16x32_bf16 v[154:157], v[6:9], v[178:181], v[154:157]
    v_mfma_f32_16x16x32_bf16 v[158:161], v[54:57], v[174:177], v[158:161]
    ds_read_b128 v[174:177], v92 offset:7168
    v_mfma_f32_16x16x32_bf16 v[162:165], v[54:57], v[178:181], v[162:165]
    ds_read_b128 v[178:181], v92 offset:21504
    s_waitcnt lgkmcnt(5)
    v_mfma_f32_16x16x32_bf16 v[110:113], a[20:23], v[182:185], v[110:113]
    s_waitcnt lgkmcnt(4)
    v_mfma_f32_16x16x32_bf16 v[114:117], a[20:23], v[186:189], v[114:117]
    v_mfma_f32_16x16x32_bf16 v[118:121], a[68:71], v[182:185], v[118:121]
    v_mfma_f32_16x16x32_bf16 v[122:125], a[68:71], v[186:189], v[122:125]
    v_mfma_f32_16x16x32_bf16 v[126:129], a[116:119], v[182:185], v[126:129]
    v_mfma_f32_16x16x32_bf16 v[130:133], a[116:119], v[186:189], v[130:133]
    v_mfma_f32_16x16x32_bf16 v[134:137], a[164:167], v[182:185], v[134:137]
    v_mfma_f32_16x16x32_bf16 v[138:141], a[164:167], v[186:189], v[138:141]
    v_mfma_f32_16x16x32_bf16 v[142:145], a[212:215], v[182:185], v[142:145]
    v_mfma_f32_16x16x32_bf16 v[146:149], a[212:215], v[186:189], v[146:149]
    v_mfma_f32_16x16x32_bf16 v[150:153], v[10:13], v[182:185], v[150:153]
    v_mfma_f32_16x16x32_bf16 v[154:157], v[10:13], v[186:189], v[154:157]
    v_mfma_f32_16x16x32_bf16 v[158:161], v[58:61], v[182:185], v[158:161]
    ds_read_b128 v[182:185], v92 offset:8192
    v_mfma_f32_16x16x32_bf16 v[162:165], v[58:61], v[186:189], v[162:165]
    ds_read_b128 v[186:189], v92 offset:22528
    s_waitcnt lgkmcnt(5)
    v_mfma_f32_16x16x32_bf16 v[110:113], a[24:27], v[166:169], v[110:113]
    s_waitcnt lgkmcnt(4)
    v_mfma_f32_16x16x32_bf16 v[114:117], a[24:27], v[170:173], v[114:117]
    v_mfma_f32_16x16x32_bf16 v[118:121], a[72:75], v[166:169], v[118:121]
    v_mfma_f32_16x16x32_bf16 v[122:125], a[72:75], v[170:173], v[122:125]
    v_mfma_f32_16x16x32_bf16 v[126:129], a[120:123], v[166:169], v[126:129]
    v_mfma_f32_16x16x32_bf16 v[130:133], a[120:123], v[170:173], v[130:133]
    v_mfma_f32_16x16x32_bf16 v[134:137], a[168:171], v[166:169], v[134:137]
    v_mfma_f32_16x16x32_bf16 v[138:141], a[168:171], v[170:173], v[138:141]
    v_mfma_f32_16x16x32_bf16 v[142:145], a[216:219], v[166:169], v[142:145]
    v_mfma_f32_16x16x32_bf16 v[146:149], a[216:219], v[170:173], v[146:149]
    v_mfma_f32_16x16x32_bf16 v[150:153], v[14:17], v[166:169], v[150:153]
    v_mfma_f32_16x16x32_bf16 v[154:157], v[14:17], v[170:173], v[154:157]
    v_mfma_f32_16x16x32_bf16 v[158:161], v[62:65], v[166:169], v[158:161]
    ds_read_b128 v[166:169], v92 offset:9216
    v_mfma_f32_16x16x32_bf16 v[162:165], v[62:65], v[170:173], v[162:165]
    ds_read_b128 v[170:173], v92 offset:23552
    s_waitcnt lgkmcnt(5)
    v_mfma_f32_16x16x32_bf16 v[110:113], a[28:31], v[174:177], v[110:113]
    s_waitcnt lgkmcnt(4)
    v_mfma_f32_16x16x32_bf16 v[114:117], a[28:31], v[178:181], v[114:117]
    v_mfma_f32_16x16x32_bf16 v[118:121], a[76:79], v[174:177], v[118:121]
    v_mfma_f32_16x16x32_bf16 v[122:125], a[76:79], v[178:181], v[122:125]
    v_mfma_f32_16x16x32_bf16 v[126:129], a[124:127], v[174:177], v[126:129]
    v_mfma_f32_16x16x32_bf16 v[130:133], a[124:127], v[178:181], v[130:133]
    v_mfma_f32_16x16x32_bf16 v[134:137], a[172:175], v[174:177], v[134:137]
    v_mfma_f32_16x16x32_bf16 v[138:141], a[172:175], v[178:181], v[138:141]
    buffer_load_dword v90, v89, s[4:7], s25 offen sc1
    v_mfma_f32_16x16x32_bf16 v[142:145], a[220:223], v[174:177], v[142:145]
    v_mfma_f32_16x16x32_bf16 v[146:149], a[220:223], v[178:181], v[146:149]
    v_mfma_f32_16x16x32_bf16 v[150:153], v[18:21], v[174:177], v[150:153]
    v_mfma_f32_16x16x32_bf16 v[154:157], v[18:21], v[178:181], v[154:157]
    v_mfma_f32_16x16x32_bf16 v[158:161], v[66:69], v[174:177], v[158:161]
    ds_read_b128 v[174:177], v92 offset:10240
    v_mfma_f32_16x16x32_bf16 v[162:165], v[66:69], v[178:181], v[162:165]
    ds_read_b128 v[178:181], v92 offset:24576
    s_waitcnt lgkmcnt(5)
    v_mfma_f32_16x16x32_bf16 v[110:113], a[32:35], v[182:185], v[110:113]
    s_waitcnt lgkmcnt(4)
    v_mfma_f32_16x16x32_bf16 v[114:117], a[32:35], v[186:189], v[114:117]
    v_mfma_f32_16x16x32_bf16 v[118:121], a[80:83], v[182:185], v[118:121]
    v_mfma_f32_16x16x32_bf16 v[122:125], a[80:83], v[186:189], v[122:125]
    v_mfma_f32_16x16x32_bf16 v[126:129], a[128:131], v[182:185], v[126:129]
    v_mfma_f32_16x16x32_bf16 v[130:133], a[128:131], v[186:189], v[130:133]
    v_mfma_f32_16x16x32_bf16 v[134:137], a[176:179], v[182:185], v[134:137]
    v_mfma_f32_16x16x32_bf16 v[138:141], a[176:179], v[186:189], v[138:141]
    v_mfma_f32_16x16x32_bf16 v[142:145], a[224:227], v[182:185], v[142:145]
    v_mfma_f32_16x16x32_bf16 v[146:149], a[224:227], v[186:189], v[146:149]
    v_mfma_f32_16x16x32_bf16 v[150:153], v[22:25], v[182:185], v[150:153]
    v_mfma_f32_16x16x32_bf16 v[154:157], v[22:25], v[186:189], v[154:157]
    v_mfma_f32_16x16x32_bf16 v[158:161], v[70:73], v[182:185], v[158:161]
    ds_read_b128 v[182:185], v92 offset:11264
    v_mfma_f32_16x16x32_bf16 v[162:165], v[70:73], v[186:189], v[162:165]
    ds_read_b128 v[186:189], v92 offset:25600
    s_waitcnt lgkmcnt(5)
    v_mfma_f32_16x16x32_bf16 v[110:113], a[36:39], v[166:169], v[110:113]
    s_waitcnt lgkmcnt(4)
    v_mfma_f32_16x16x32_bf16 v[114:117], a[36:39], v[170:173], v[114:117]
    v_mfma_f32_16x16x32_bf16 v[118:121], a[84:87], v[166:169], v[118:121]
    v_mfma_f32_16x16x32_bf16 v[122:125], a[84:87], v[170:173], v[122:125]
    v_mfma_f32_16x16x32_bf16 v[126:129], a[132:135], v[166:169], v[126:129]
    v_mfma_f32_16x16x32_bf16 v[130:133], a[132:135], v[170:173], v[130:133]
    v_mfma_f32_16x16x32_bf16 v[134:137], a[180:183], v[166:169], v[134:137]
    v_mfma_f32_16x16x32_bf16 v[138:141], a[180:183], v[170:173], v[138:141]
    v_mfma_f32_16x16x32_bf16 v[142:145], a[228:231], v[166:169], v[142:145]
    v_mfma_f32_16x16x32_bf16 v[146:149], a[228:231], v[170:173], v[146:149]
    v_mfma_f32_16x16x32_bf16 v[150:153], v[26:29], v[166:169], v[150:153]
    v_mfma_f32_16x16x32_bf16 v[154:157], v[26:29], v[170:173], v[154:157]
    v_mfma_f32_16x16x32_bf16 v[158:161], v[74:77], v[166:169], v[158:161]
    ds_read_b128 v[166:169], v92 offset:12288
    v_mfma_f32_16x16x32_bf16 v[162:165], v[74:77], v[170:173], v[162:165]
    ds_read_b128 v[170:173], v92 offset:26624
    s_waitcnt lgkmcnt(5)
    v_mfma_f32_16x16x32_bf16 v[110:113], a[40:43], v[174:177], v[110:113]
    s_waitcnt lgkmcnt(4)
    v_mfma_f32_16x16x32_bf16 v[114:117], a[40:43], v[178:181], v[114:117]
    s_waitcnt lgkmcnt(3)
    v_mfma_f32_16x16x32_bf16 v[110:113], a[44:47], v[182:185], v[110:113]
    s_waitcnt lgkmcnt(2)
    v_mfma_f32_16x16x32_bf16 v[114:117], a[44:47], v[186:189], v[114:117]
    v_mfma_f32_16x16x32_bf16 v[118:121], a[88:91], v[174:177], v[118:121]
    v_mfma_f32_16x16x32_bf16 v[122:125], a[88:91], v[178:181], v[122:125]
    s_waitcnt lgkmcnt(1)
    v_mfma_f32_16x16x32_bf16 v[110:113], v[190:193], v[166:169], v[110:113]
    s_waitcnt lgkmcnt(0)
    v_mfma_f32_16x16x32_bf16 v[114:117], v[190:193], v[170:173], v[114:117]
    ds_read_b128 v[190:193], v97 offset:8192
    v_mfma_f32_16x16x32_bf16 v[126:129], a[136:139], v[174:177], v[126:129]
    v_mfma_f32_16x16x32_bf16 v[130:133], a[136:139], v[178:181], v[130:133]
    v_mfma_f32_16x16x32_bf16 v[134:137], a[184:187], v[174:177], v[134:137]
    v_mfma_f32_16x16x32_bf16 v[138:141], a[184:187], v[178:181], v[138:141]
    v_mfma_f32_16x16x32_bf16 v[118:121], a[92:95], v[182:185], v[118:121]
    v_mfma_f32_16x16x32_bf16 v[122:125], a[92:95], v[186:189], v[122:125]
    v_mfma_f32_16x16x32_bf16 v[142:145], a[232:235], v[174:177], v[142:145]
    v_mfma_f32_16x16x32_bf16 v[146:149], a[232:235], v[178:181], v[146:149]
    v_mfma_f32_16x16x32_bf16 v[126:129], a[140:143], v[182:185], v[126:129]
    v_mfma_f32_16x16x32_bf16 v[130:133], a[140:143], v[186:189], v[130:133]
    v_mfma_f32_16x16x32_bf16 v[134:137], a[188:191], v[182:185], v[134:137]
    v_mfma_f32_16x16x32_bf16 v[138:141], a[188:191], v[186:189], v[138:141]
    v_mfma_f32_16x16x32_bf16 v[118:121], v[194:197], v[166:169], v[118:121]
    v_mfma_f32_16x16x32_bf16 v[122:125], v[194:197], v[170:173], v[122:125]
    ds_read_b128 v[194:197], v97 offset:10240
    v_mfma_f32_16x16x32_bf16 v[142:145], a[236:239], v[182:185], v[142:145]
    v_mfma_f32_16x16x32_bf16 v[146:149], a[236:239], v[186:189], v[146:149]
    v_mfma_f32_16x16x32_bf16 v[126:129], v[198:201], v[166:169], v[126:129]
    v_mfma_f32_16x16x32_bf16 v[130:133], v[198:201], v[170:173], v[130:133]
    ds_read_b128 v[198:201], v97 offset:12288
    v_mfma_f32_16x16x32_bf16 v[150:153], v[30:33], v[174:177], v[150:153]
    v_mfma_f32_16x16x32_bf16 v[154:157], v[30:33], v[178:181], v[154:157]
    v_mfma_f32_16x16x32_bf16 v[158:161], v[78:81], v[174:177], v[158:161]
    ds_read_b128 v[174:177], v92 offset:13312
    v_mfma_f32_16x16x32_bf16 v[162:165], v[78:81], v[178:181], v[162:165]
    ds_read_b128 v[178:181], v92 offset:27648
    v_mfma_f32_16x16x32_bf16 v[134:137], v[202:205], v[166:169], v[134:137]
    v_mfma_f32_16x16x32_bf16 v[138:141], v[202:205], v[170:173], v[138:141]
    ds_read_b128 v[202:205], v97 offset:1024
    s_waitcnt vmcnt(0)
    v_cmp_eq_u32 vcc, 0, v90
    s_waitcnt lgkmcnt(5)
    v_mfma_f32_16x16x32_bf16 v[142:145], v[190:193], v[166:169], v[142:145]
    s_cmp_eq_u64 vcc, 0
    s_cselect_b32 s27, 0, 1
    v_mfma_f32_16x16x32_bf16 v[146:149], v[190:193], v[170:173], v[146:149]
    ds_read_b128 v[190:193], v97 offset:3072
    s_cselect_b32 s24, 0, 1073741824
    s_cmp_ge_u32 s28, 64
    v_mfma_f32_16x16x32_bf16 v[150:153], v[34:37], v[182:185], v[150:153]
    s_cselect_b32 s24, 1073741824, s24
    v_add_u32 v91, s24, v4
    v_mfma_f32_16x16x32_bf16 v[154:157], v[34:37], v[186:189], v[154:157]
    s_mov_b32 m0, s26
    s_nop 0
    buffer_load_dwordx4 v91, s[4:7], s23 offen sc1 lds
    v_mfma_f32_16x16x32_bf16 v[158:161], v[82:85], v[182:185], v[158:161]
    v_mfma_f32_16x16x32_bf16 v[162:165], v[82:85], v[186:189], v[162:165]
    s_waitcnt lgkmcnt(5)
    v_mfma_f32_16x16x32_bf16 v[150:153], v[194:197], v[166:169], v[150:153]
    buffer_load_dwordx4 v91, s[4:7], s23 offen offset:1024 sc1 lds
    v_mfma_f32_16x16x32_bf16 v[154:157], v[194:197], v[170:173], v[154:157]
    ds_read_b128 v[194:197], v97 offset:5120
    s_waitcnt lgkmcnt(5)
    v_mfma_f32_16x16x32_bf16 v[158:161], v[198:201], v[166:169], v[158:161]
    ds_read_b64 v[166:167], v99 offset:0
    v_mfma_f32_16x16x32_bf16 v[162:165], v[198:201], v[170:173], v[162:165]
    ds_read_b128 v[198:201], v97 offset:7168
    buffer_load_dwordx4 v91, s[4:7], s23 offen offset:2048 sc1 lds
    s_waitcnt lgkmcnt(4)
    v_mfma_f32_16x16x32_bf16 v[110:113], v[202:205], v[174:177], v[110:113]
    ds_read_b64 v[170:171], v99 offset:14336
    v_mfma_f32_16x16x32_bf16 v[114:117], v[202:205], v[178:181], v[114:117]
    ds_read_b128 v[202:205], v97 offset:9216
    s_waitcnt lgkmcnt(5)
    v_mfma_f32_16x16x32_bf16 v[118:121], v[190:193], v[174:177], v[118:121]
    v_mfma_f32_16x16x32_bf16 v[122:125], v[190:193], v[178:181], v[122:125]
    ds_read_b128 v[190:193], v97 offset:11264
    buffer_load_dwordx4 v91, s[4:7], s23 offen offset:3072 sc1 lds
    v_cvt_pk_bf16_f32 v110, v110, v111
    s_waitcnt lgkmcnt(5)
    v_mfma_f32_16x16x32_bf16 v[126:129], v[194:197], v[174:177], v[126:129]
    v_cvt_pk_bf16_f32 v114, v114, v115
    v_cvt_pk_bf16_f32 v111, v112, v113
    v_mfma_f32_16x16x32_bf16 v[130:133], v[194:197], v[178:181], v[130:133]
    v_cvt_pk_bf16_f32 v115, v116, v117
    ds_read_b128 v[194:197], v97 offset:13312
    v_cvt_pk_bf16_f32 v112, v118, v119
    s_waitcnt lgkmcnt(4)
    v_mfma_f32_16x16x32_bf16 v[134:137], v[198:201], v[174:177], v[134:137]
    v_cvt_pk_bf16_f32 v113, v120, v121
    v_cvt_pk_bf16_f32 v116, v122, v123
    v_mfma_f32_16x16x32_bf16 v[138:141], v[198:201], v[178:181], v[138:141]
    v_cvt_pk_bf16_f32 v117, v124, v125
    ds_read_b128 v[118:121], v98 offset:0
    v_cvt_pk_bf16_f32 v126, v126, v127
    s_waitcnt lgkmcnt(3)
    v_mfma_f32_16x16x32_bf16 v[142:145], v[202:205], v[174:177], v[142:145]
    v_cvt_pk_bf16_f32 v130, v130, v131
    ds_read_b128 v[122:125], v98 offset:14336
    v_cvt_pk_bf16_f32 v127, v128, v129
    v_mfma_f32_16x16x32_bf16 v[146:149], v[202:205], v[178:181], v[146:149]
    v_cvt_pk_bf16_f32 v131, v132, v133
    v_cvt_pk_bf16_f32 v128, v134, v135
    s_waitcnt lgkmcnt(3)
    v_mfma_f32_16x16x32_bf16 v[150:153], v[190:193], v[174:177], v[150:153]
    v_cvt_pk_bf16_f32 v129, v136, v137
    v_cvt_pk_bf16_f32 v132, v138, v139
    v_mfma_f32_16x16x32_bf16 v[154:157], v[190:193], v[178:181], v[154:157]
    v_cvt_pk_bf16_f32 v133, v140, v141
    ds_read_b128 v[134:137], v98 offset:1024
    v_cvt_pk_bf16_f32 v142, v142, v143
    v_cvt_pk_bf16_f32 v146, v146, v147
    s_add_u32 s24, s23, 4096
    s_waitcnt lgkmcnt(3)
    v_mfma_f32_16x16x32_bf16 v[158:161], v[194:197], v[174:177], v[158:161]
    ds_read_b128 v[138:141], v98 offset:15360
    v_cvt_pk_bf16_f32 v143, v144, v145
    v_cvt_pk_bf16_f32 v147, v148, v149
    v_mfma_f32_16x16x32_bf16 v[162:165], v[194:197], v[178:181], v[162:165]
    v_cvt_pk_bf16_f32 v144, v150, v151
    v_cvt_pk_bf16_f32 v145, v152, v153
    s_waitcnt lgkmcnt(3)
    v_mfma_f32_16x16x32_bf16 v[206:209], v[118:121], v[110:113], 0
    v_cvt_pk_bf16_f32 v148, v154, v155
    v_cvt_pk_bf16_f32 v149, v156, v157
    v_mfma_f32_16x16x32_bf16 v[214:217], v[118:121], v[114:117], 0
    ds_read_b128 v[150:153], v98 offset:2048
    v_cvt_pk_bf16_f32 v158, v158, v159
    v_cvt_pk_bf16_f32 v162, v162, v163
    s_waitcnt lgkmcnt(3)
    v_mfma_f32_16x16x32_bf16 v[210:213], v[122:125], v[114:117], 0
    ds_read_b128 v[154:157], v98 offset:16384
    v_cvt_pk_bf16_f32 v159, v160, v161
    v_cvt_pk_bf16_f32 v163, v164, v165
    s_add_u32 m0, s26, 4096
    s_nop 0
    buffer_load_dwordx4 v91, s[4:7], s24 offen sc1 lds
    buffer_load_dwordx4 v91, s[4:7], s24 offen offset:1024 sc1 lds
    buffer_load_dwordx4 v91, s[4:7], s24 offen offset:2048 sc1 lds
    s_waitcnt lgkmcnt(3)
    v_mfma_f32_16x16x32_bf16 v[206:209], v[134:137], v[126:129], v[206:209]
    v_mfma_f32_16x16x32_bf16 v[214:217], v[134:137], v[130:133], v[214:217]
    s_waitcnt lgkmcnt(2)
    v_mfma_f32_16x16x32_bf16 v[210:213], v[138:141], v[130:133], v[210:213]
    s_waitcnt lgkmcnt(1)
    v_mfma_f32_16x16x32_bf16 v[206:209], v[150:153], v[142:145], v[206:209]
    v_mfma_f32_16x16x32_bf16 v[214:217], v[150:153], v[146:149], v[214:217]
    s_waitcnt lgkmcnt(0)
    v_mfma_f32_16x16x32_bf16 v[210:213], v[154:157], v[146:149], v[210:213]
    v_mfma_f32_16x16x16_bf16 v[206:209], v[166:167], v[158:159], v[206:209]
    v_mfma_f32_16x16x16_bf16 v[210:213], v[170:171], v[162:163], v[210:213]
    v_mfma_f32_16x16x16_bf16 v[214:217], v[166:167], v[162:163], v[214:217]
    s_nop 5
    ds_write_b128 v100, v[206:209] offset:0
    ds_write_b128 v100, v[210:213] offset:1024
    ds_write_b128 v100, v[214:217] offset:2048
    v_cmp_eq_u32 vcc, 0, v109
    s_cbranch_vccz dnok_262
dnp_261:
    s_sleep 2
    buffer_load_dword v109, v89, s[4:7], s46 offen sc1
    s_waitcnt vmcnt(0)
    v_cmp_eq_u32 vcc, 0, v109
    s_cbranch_vccz dnok_262
    s_sub_u32 s13, s13, 1
    s_cbranch_scc0 dnp_261
    s_mov_b32 s13, 0
dnok_262:
Mpoll_263:
    buffer_load_dwordx4 v[226:229], v86, s[4:7], s42 offen sc1
    buffer_load_dwordx4 v[230:233], v87, s[4:7], s42 offen sc1
Mfirst_265:
    s_waitcnt vmcnt(0)
    v_max3_u32 v1, v226, v227, v228
    v_max3_u32 v1, v1, v229, v230
    v_max3_u32 v1, v1, v231, v232
    v_max_u32 v1, v1, v233
    v_cmp_eq_u32 vcc, -1, v1
    s_cbranch_vccz Mgot_264
    s_sleep 1
    s_sub_u32 s13, s13, 1
    s_cbranch_scc0 Mpoll_263
    s_mov_b32 s13, 0
Mgot_264:
    ds_write_b128 v88, v[226:229]
    ds_write_b128 v88, v[230:233] offset:1024
    s_waitcnt lgkmcnt(0)
    s_barrier
    ds_read2_b32 v[118:119], v93 offset0:0 offset1:4
    ds_read2_b32 v[120:121], v93 offset0:1 offset1:5
    ds_read2_b32 v[134:135], v94 offset0:0 offset1:4
    ds_read2_b32 v[136:137], v94 offset0:1 offset1:5
    ds_read2_b32 v[150:151], v95 offset0:0 offset1:4
    ds_read2_b32 v[152:153], v95 offset0:1 offset1:5
    ds_read2_b32 v[122:123], v96 offset0:0 offset1:4
    ds_read_b128 v[206:209], v101 offset:0
    s_waitcnt lgkmcnt(6)
    v_mfma_f32_16x16x32_bf16 v[218:221], v[118:121], v[110:113], 0
    ds_read_b128 v[166:169], v101 offset:5120
    v_mfma_f32_16x16x32_bf16 v[222:225], v[118:121], v[114:117], 0
    ds_read_b128 v[170:173], v101 offset:10240
    s_waitcnt lgkmcnt(6)
    v_mfma_f32_16x16x32_bf16 v[218:221], v[134:137], v[126:129], v[218:221]
    ds_read_b128 v[174:177], v101 offset:15360
    v_mfma_f32_16x16x32_bf16 v[222:225], v[134:137], v[130:133], v[222:225]
    ds_read_b128 v[210:213], v102 offset:0
    s_waitcnt lgkmcnt(6)
    v_mfma_f32_16x16x32_bf16 v[218:221], v[150:153], v[142:145], v[218:221]
    ds_read_b128 v[178:181], v102 offset:5120
    v_mfma_f32_16x16x32_bf16 v[222:225], v[150:153], v[146:149], v[222:225]
    ds_read_b128 v[182:185], v102 offset:10240
    s_waitcnt lgkmcnt(7)
    v_mfma_f32_16x16x16_bf16 v[218:221], v[122:123], v[158:159], v[218:221]
    ds_read_b128 v[186:189], v102 offset:15360
    v_mfma_f32_16x16x16_bf16 v[222:225], v[122:123], v[162:163], v[222:225]
    s_waitcnt lgkmcnt(6)
    v_add_f32 v206, v206, v166
    v_add_f32 v207, v207, v167
    v_add_f32 v208, v208, v168
    v_add_f32 v209, v209, v169
    s_nop 0
    ds_write_b128 v100, v[218:221] offset:3072
    s_waitcnt lgkmcnt(5)
    v_add_f32 v170, v170, v174
    v_add_f32 v171, v171, v175
    v_add_f32 v172, v172, v176
    v_add_f32 v173, v173, v177
    v_add_f32 v206, v206, v170
    v_add_f32 v207, v207, v171
    v_add_f32 v208, v208, v172
    ds_write_b128 v100, v[222:225] offset:4096
    s_waitcnt lgkmcnt(4)
    v_add_f32 v210, v210, v178
    v_add_f32 v209, v209, v173
    v_add_f32 v211, v211, v179
    v_add_f32 v212, v212, v180
    v_cndmask_b32 v206, v105, v206, s[30:31]
    v_cndmask_b32 v207, v105, v207, s[32:33]
    v_cndmask_b32 v208, v105, v208, s[34:35]
    v_add_f32 v213, v213, v181
    s_waitcnt lgkmcnt(2)
    v_add_f32 v182, v182, v186
    v_add_f32 v183, v183, v187
    v_add_f32 v184, v184, v188
    v_add_f32 v210, v210, v182
    v_add_f32 v185, v185, v189
    v_add_f32 v211, v211, v183
    v_add_f32 v212, v212, v184
    v_cndmask_b32 v210, v105, v210, s[38:39]
    v_cndmask_b32 v209, v105, v209, s[36:37]
    v_max3_f32 v190, v206, v207, v208
    v_add_f32 v213, v213, v185
    v_cndmask_b32 v211, v105, v211, s[38:39]
    v_cndmask_b32 v212, v105, v212, s[38:39]
    v_max3_f32 v190, v190, v209, v210
    v_cndmask_b32 v213, v105, v213, s[38:39]
    v_max3_f32 v190, v190, v211, v212
    v_max_f32 v190, v190, v213
    s_waitcnt lgkmcnt(0)
    s_barrier
    ds_read_b128 v[214:217], v101 offset:3072
    ds_read_b128 v[166:169], v101 offset:8192
    ds_read_b128 v[170:173], v101 offset:13312
    ds_read_b128 v[174:177], v101 offset:18432
    s_waitcnt lgkmcnt(2)
    v_add_f32 v214, v214, v166
    v_add_f32 v215, v215, v167
    v_add_f32 v216, v216, v168
    v_add_f32 v217, v217, v169
    s_waitcnt lgkmcnt(0)
    v_add_f32 v170, v170, v174
    v_add_f32 v171, v171, v175
    v_add_f32 v172, v172, v176
    v_add_f32 v173, v173, v177
    v_add_f32 v214, v214, v170
    v_add_f32 v215, v215, v171
    v_add_f32 v216, v216, v172
    v_add_f32 v217, v217, v173
    v_cndmask_b32 v214, v105, v214, s[40:41]
    v_cndmask_b32 v215, v105, v215, s[40:41]
    v_cndmask_b32 v216, v105, v216, s[40:41]
    v_cndmask_b32 v217, v105, v217, s[40:41]
    v_max3_f32 v190, v190, v214, v215
    v_max3_f32 v190, v190, v216, v217
    v_mov_b32 v191, v190
    s_nop 1
    v_permlane16_swap_b32 v190, v191
    v_max_f32 v190, v190, v191
    v_mov_b32 v191, v190
    s_nop 1
    v_permlane32_swap_b32 v190, v191
    v_max_f32 v190, v190, v191
    v_sub_f32 v206, v206, v190
    v_sub_f32 v207, v207, v190
    v_sub_f32 v208, v208, v190
    v_sub_f32 v209, v209, v190
    v_sub_f32 v210, v210, v190
    v_sub_f32 v211, v211, v190
    v_sub_f32 v212, v212, v190
    v_sub_f32 v213, v213, v190
    v_sub_f32 v214, v214, v190
    v_sub_f32 v215, v215, v190
    v_sub_f32 v216, v216, v190
    v_sub_f32 v217, v217, v190
    v_exp_f32 v206, v206
    v_exp_f32 v207, v207
    v_exp_f32 v208, v208
    v_exp_f32 v209, v209
    v_exp_f32 v210, v210
    v_exp_f32 v211, v211
    v_exp_f32 v212, v212
    v_exp_f32 v213, v213
    v_exp_f32 v214, v214
    v_exp_f32 v215, v215
    v_exp_f32 v216, v216
    v_exp_f32 v217, v217
    v_add_f32 v194, v206, v207
    v_add_f32 v198, v208, v209
    v_add_f32 v195, v210, v211
    v_add_f32 v199, v212, v213
    v_add_f32 v194, v194, v198
    v_add_f32 v195, v195, v199
    v_add_f32 v196, v214, v215
    v_add_f32 v200, v216, v217
    v_add_f32 v194, v194, v195
    v_add_f32 v196, v196, v200
    v_add_f32 v194, v194, v196
    v_mov_b32 v191, v194
    s_nop 1
    v_permlane16_swap_b32 v194, v191
    v_add_f32 v194, v194, v191
    v_mov_b32 v191, v194
    s_nop 1
    v_permlane32_swap_b32 v194, v191
    v_add_f32 v194, v194, v191
    v_rcp_f32 v194, v194
    s_nop 0
    v_mul_f32 v206, v206, v194
    v_mul_f32 v207, v207, v194
    v_mul_f32 v210, v210, v194
    v_mul_f32 v211, v211, v194
    v_mul_f32 v208, v208, v194
    v_mul_f32 v209, v209, v194
    v_mul_f32 v212, v212, v194
    v_mul_f32 v213, v213, v194
    v_cvt_pk_bf16_f32 v206, v206, v207
    v_cvt_pk_bf16_f32 v210, v210, v211
    v_mul_f32 v214, v214, v194
    v_mul_f32 v215, v215, v194
    v_cvt_pk_bf16_f32 v207, v208, v209
    v_cvt_pk_bf16_f32 v211, v212, v213
    v_mul_f32 v216, v216, v194
    v_mul_f32 v217, v217, v194
    v_cvt_pk_bf16_f32 v214, v214, v215
    v_cndmask_b32 v202, v206, v210, s[38:39]
    v_cndmask_b32 v204, v210, v206, s[38:39]
    v_cndmask_b32 v203, v207, v211, s[38:39]
    v_cndmask_b32 v205, v211, v207, s[38:39]
    v_cvt_pk_bf16_f32 v215, v216, v217
    buffer_store_dwordx4 v[202:205], v103, s[4:7], s43 offen sc1
    buffer_store_dwordx2 v[214:215], v104, s[4:7], s43 offen offset:1024 sc1
    v_add_u32 v106, s29, v107
    s_add_u32 s29, s29, 8
    s_add_u32 s11, s11, 2
    s_add_u32 s42, s42, 14336
    s_add_u32 s45, s45, 8
    s_cmp_lt_u32 s11, 64
    s_cbranch_scc1 Aloop_255
    s_waitcnt vmcnt(0)
    buffer_store_dword v108, v106, s[4:7], 0 offen sc1
    v_mov_b32 v106, 1073741824
    s_endpgm
.p2align 6
role_UB:
    v_and_b32 v1, 63, v0
    v_and_b32 v2, 15, v0
    v_lshrrev_b32 v3, 4, v1
    v_lshlrev_b32 v4, 4, v1
    s_lshr_b32 s17, s9, 2
    s_add_u32 s17, s17, 112
    s_cmp_eq_u32 s8, 0
    s_cbranch_scc1 l0_266
    v_lshlrev_b32 v248, 7, v0
    s_mov_b32 s19, 176132
ww_267:
    buffer_load_dword v249, v248, s[4:7], s19 offen sc1
    s_waitcnt vmcnt(0)
    v_cmp_eq_u32 vcc, 0, v249
    s_cbranch_vccz wwok_268
    s_sleep 4
    s_sub_u32 s13, s13, 1
    s_cbranch_scc0 ww_267
    s_mov_b32 s13, 0
wwok_268:
    s_barrier
    v_mov_b32 v248, 0
    s_mov_b32 s18, 66048
ww_269:
    buffer_load_dword v249, v248, s[4:7], s18 offen sc1
    s_waitcnt vmcnt(0)
    v_cmp_eq_u32 vcc, 0, v249
    s_cbranch_vccz wwok_270
    s_sleep 8
    s_sub_u32 s13, s13, 1
    s_cbranch_scc0 ww_269
    s_mov_b32 s13, 0
wwok_270:
l0_266:
    v_and_b32 v248, 63, v0
    v_min_u32 v248, 15, v248
    v_mul_u32_u24 v248, 7, v248
    v_add_u32 v248, s17, v248
    v_add_u32 v248, 32, v248
    v_and_b32 v250, 31, v248
    v_lshrrev_b32 v248, 5, v248
    v_lshl_add_u32 v248, v250, 3, v248
    v_lshlrev_b32 v248, 7, v248
    v_add_u32 v248, 176136, v248
    v_mov_b32 v249, 0
    s_lshl_b32 s17, s9, 4
    s_lshl_b32 s16, s10, 2
    s_add_u32 s17, s17, s16
    s_mul_i32 s17, s17, 14336
    s_add_u32 s17, s17, 11612160
    v_cmp_gt_u32 vcc, 1, v249
    s_cbranch_vccz wcok_272
wc_271:
    buffer_load_dword v249, v248, s[4:7], 0 offen sc1
    s_waitcnt vmcnt(0)
    v_cmp_gt_u32 vcc, 1, v249
    s_cbranch_vccz wcok_272
    s_sleep 4
    s_sub_u32 s13, s13, 1
    s_cbranch_scc0 wc_271
    s_mov_b32 s13, 0
wcok_272:
    s_add_u32 s16, s17, 0
    buffer_load_dwordx4 a[0:3], v4, s[4:7], s16 offen
    buffer_load_dwordx4 a[4:7], v4, s[4:7], s16 offen offset:1024
    s_add_u32 s16, s17, 14336
    buffer_load_dwordx4 a[56:59], v4, s[4:7], s16 offen
    buffer_load_dwordx4 a[60:63], v4, s[4:7], s16 offen offset:1024
    s_add_u32 s16, s17, 28672
    buffer_load_dwordx4 a[112:115], v4, s[4:7], s16 offen
    buffer_load_dwordx4 a[116:119], v4, s[4:7], s16 offen offset:1024
    s_add_u32 s16, s17, 43008
    buffer_load_dwordx4 a[168:171], v4, s[4:7], s16 offen
    buffer_load_dwordx4 a[172:175], v4, s[4:7], s16 offen offset:1024
    v_cmp_gt_u32 vcc, 2, v249
    s_cbranch_vccz wcok_274
wc_273:
    buffer_load_dword v249, v248, s[4:7], 0 offen sc1
    s_waitcnt vmcnt(0)
    v_cmp_gt_u32 vcc, 2, v249
    s_cbranch_vccz wcok_274
    s_sleep 4
    s_sub_u32 s13, s13, 1
    s_cbranch_scc0 wc_273
    s_mov_b32 s13, 0
wcok_274:
    s_add_u32 s16, s17, 2048
    buffer_load_dwordx4 a[8:11], v4, s[4:7], s16 offen
    buffer_load_dwordx4 a[12:15], v4, s[4:7], s16 offen offset:1024
    s_add_u32 s16, s17, 16384
    buffer_load_dwordx4 a[64:67], v4, s[4:7], s16 offen
    buffer_load_dwordx4 a[68:71], v4, s[4:7], s16 offen offset:1024
    s_add_u32 s16, s17, 30720
    buffer_load_dwordx4 a[120:123], v4, s[4:7], s16 offen
    buffer_load_dwordx4 a[124:127], v4, s[4:7], s16 offen offset:1024
    s_add_u32 s16, s17, 45056
    buffer_load_dwordx4 a[176:179], v4, s[4:7], s16 offen
    buffer_load_dwordx4 a[180:183], v4, s[4:7], s16 offen offset:1024
    v_cmp_gt_u32 vcc, 3, v249
    s_cbranch_vccz wcok_276
wc_275:
    buffer_load_dword v249, v248, s[4:7], 0 offen sc1
    s_waitcnt vmcnt(0)
    v_cmp_gt_u32 vcc, 3, v249
    s_cbranch_vccz wcok_276
    s_sleep 4
    s_sub_u32 s13, s13, 1
    s_cbranch_scc0 wc_275
    s_mov_b32 s13, 0
wcok_276:
    s_add_u32 s16, s17, 4096
    buffer_load_dwordx4 a[16:19], v4, s[4:7], s16 offen
    buffer_load_dwordx4 a[20:23], v4, s[4:7], s16 offen offset:1024
    s_add_u32 s16, s17, 18432
    buffer_load_dwordx4 a[72:75], v4, s[4:7], s16 offen
    buffer_load_dwordx4 a[76:79], v4, s[4:7], s16 offen offset:1024
    s_add_u32 s16, s17, 32768
    buffer_load_dwordx4 a[128:131], v4, s[4:7], s16 offen
    buffer_load_dwordx4 a[132:135], v4, s[4:7], s16 offen offset:1024
    s_add_u32 s16, s17, 47104
    buffer_load_dwordx4 a[184:187], v4, s[4:7], s16 offen
    buffer_load_dwordx4 a[188:191], v4, s[4:7], s16 offen offset:1024
    v_cmp_gt_u32 vcc, 4, v249
    s_cbranch_vccz wcok_278
wc_277:
    buffer_load_dword v249, v248, s[4:7], 0 offen sc1
    s_waitcnt vmcnt(0)
    v_cmp_gt_u32 vcc, 4, v249
    s_cbranch_vccz wcok_278
    s_sleep 4
    s_sub_u32 s13, s13, 1
    s_cbranch_scc0 wc_277
    s_mov_b32 s13, 0
wcok_278:
    s_add_u32 s16, s17, 6144
    buffer_load_dwordx4 a[24:27], v4, s[4:7], s16 offen
    buffer_load_dwordx4 a[28:31], v4, s[4:7], s16 offen offset:1024
    s_add_u32 s16, s17, 20480
    buffer_load_dwordx4 a[80:83], v4, s[4:7], s16 offen
    buffer_load_dwordx4 a[84:87], v4, s[4:7], s16 offen offset:1024
    s_add_u32 s16, s17, 34816
    buffer_load_dwordx4 a[136:139], v4, s[4:7], s16 offen
    buffer_load_dwordx4 a[140:143], v4, s[4:7], s16 offen offset:1024
    s_add_u32 s16, s17, 49152
    buffer_load_dwordx4 a[192:195], v4, s[4:7], s16 offen
    buffer_load_dwordx4 a[196:199], v4, s[4:7], s16 offen offset:1024
    v_cmp_gt_u32 vcc, 5, v249
    s_cbranch_vccz wcok_280
wc_279:
    buffer_load_dword v249, v248, s[4:7], 0 offen sc1
    s_waitcnt vmcnt(0)
    v_cmp_gt_u32 vcc, 5, v249
    s_cbranch_vccz wcok_280
    s_sleep 4
    s_sub_u32 s13, s13, 1
    s_cbranch_scc0 wc_279
    s_mov_b32 s13, 0
wcok_280:
    s_add_u32 s16, s17, 8192
    buffer_load_dwordx4 a[32:35], v4, s[4:7], s16 offen
    buffer_load_dwordx4 a[36:39], v4, s[4:7], s16 offen offset:1024
    s_add_u32 s16, s17, 22528
    buffer_load_dwordx4 a[88:91], v4, s[4:7], s16 offen
    buffer_load_dwordx4 a[92:95], v4, s[4:7], s16 offen offset:1024
    s_add_u32 s16, s17, 36864
    buffer_load_dwordx4 a[144:147], v4, s[4:7], s16 offen
    buffer_load_dwordx4 a[148:151], v4, s[4:7], s16 offen offset:1024
    s_add_u32 s16, s17, 51200
    buffer_load_dwordx4 a[200:203], v4, s[4:7], s16 offen
    buffer_load_dwordx4 a[204:207], v4, s[4:7], s16 offen offset:1024
    v_cmp_gt_u32 vcc, 6, v249
    s_cbranch_vccz wcok_282
wc_281:
    buffer_load_dword v249, v248, s[4:7], 0 offen sc1
    s_waitcnt vmcnt(0)
    v_cmp_gt_u32 vcc, 6, v249
    s_cbranch_vccz wcok_282
    s_sleep 4
    s_sub_u32 s13, s13, 1
    s_cbranch_scc0 wc_281
    s_mov_b32 s13, 0
wcok_282:
    s_add_u32 s16, s17, 10240
    buffer_load_dwordx4 a[40:43], v4, s[4:7], s16 offen
    buffer_load_dwordx4 a[44:47], v4, s[4:7], s16 offen offset:1024
    s_add_u32 s16, s17, 24576
    buffer_load_dwordx4 a[96:99], v4, s[4:7], s16 offen
    buffer_load_dwordx4 a[100:103], v4, s[4:7], s16 offen offset:1024
    s_add_u32 s16, s17, 38912
    buffer_load_dwordx4 a[152:155], v4, s[4:7], s16 offen
    buffer_load_dwordx4 a[156:159], v4, s[4:7], s16 offen offset:1024
    s_add_u32 s16, s17, 53248
    buffer_load_dwordx4 a[208:211], v4, s[4:7], s16 offen
    buffer_load_dwordx4 a[212:215], v4, s[4:7], s16 offen offset:1024
    v_cmp_gt_u32 vcc, 7, v249
    s_cbranch_vccz wcok_284
wc_283:
    buffer_load_dword v249, v248, s[4:7], 0 offen sc1
    s_waitcnt vmcnt(0)
    v_cmp_gt_u32 vcc, 7, v249
    s_cbranch_vccz wcok_284
    s_sleep 4
    s_sub_u32 s13, s13, 1
    s_cbranch_scc0 wc_283
    s_mov_b32 s13, 0
wcok_284:
    s_add_u32 s16, s17, 12288
    buffer_load_dwordx4 a[48:51], v4, s[4:7], s16 offen
    buffer_load_dwordx4 a[52:55], v4, s[4:7], s16 offen offset:1024
    s_add_u32 s16, s17, 26624
    buffer_load_dwordx4 a[104:107], v4, s[4:7], s16 offen
    buffer_load_dwordx4 a[108:111], v4, s[4:7], s16 offen offset:1024
    s_add_u32 s16, s17, 40960
    buffer_load_dwordx4 a[160:163], v4, s[4:7], s16 offen
    buffer_load_dwordx4 a[164:167], v4, s[4:7], s16 offen offset:1024
    s_add_u32 s16, s17, 55296
    buffer_load_dwordx4 a[216:219], v4, s[4:7], s16 offen
    buffer_load_dwordx4 a[220:223], v4, s[4:7], s16 offen offset:1024
    v_min_u32 v5, 1, v1
    v_lshlrev_b32 v5, 8, v5
    s_mul_i32 s18, s8, 1835008
    s_add_u32 s18, s18, 18034688
    s_mul_i32 s21, s10, 7168
    s_add_u32 s18, s18, s21
    s_mul_i32 s22, s11, 28672
    s_add_u32 s18, s18, s22
    s_add_u32 s21, s21, 65536
    s_mul_i32 s20, s8, 69632
    s_add_u32 s20, s20, 65536
    s_lshl_b32 s22, s11, 2
    s_add_u32 s20, s20, s22
    s_mov_b32 s23, s11
    s_mov_b32 s22, 1
    v_add_u32 v8, 98304, v4
    s_lshl_b32 s16, s9, 2
    s_add_u32 s16, s16, s10
    s_mul_i32 s24, s8, 69632
    s_add_u32 s24, s24, 0
    s_lshl_b32 s25, s16, 8
    s_add_u32 s24, s24, s25
    s_lshl_b32 s25, s11, 2
    s_add_u32 s24, s24, s25
    v_mov_b32 v9, 1073741824
    v_cmp_eq_u32 vcc, 0, v1
    s_nop 1
    v_cndmask_b32 v10, v9, 0, vcc
    v_mov_b32 v11, 1
    s_mul_i32 s26, s8, 7340032
    s_add_u32 s26, s26, 25833472
    s_lshl_b32 s16, s16, 12
    s_add_u32 s26, s26, s16
    v_add_u32 v12, 704, v5
    v_cmp_gt_u32 vcc, 2, v1
    s_nop 1
    v_cndmask_b32 v12, v12, v5, vcc
    v_lshlrev_b32 v46, 7, v0
    s_mov_b32 s27, 176132
ww_285:
    buffer_load_dword v47, v46, s[4:7], s27 offen sc1
    s_waitcnt vmcnt(0)
    v_cmp_eq_u32 vcc, 0, v47
    s_cbranch_vccz wwok_286
    s_sleep 4
    s_sub_u32 s13, s13, 1
    s_cbranch_scc0 ww_285
    s_mov_b32 s13, 0
wwok_286:
    s_barrier
    v_mov_b32 v6, 0
Uloop_287:
    s_cmp_eq_u32 s22, 0
    s_cbranch_scc1 Tearly_288
    s_waitcnt vmcnt(4)
    v_cmp_eq_u32 vcc, 0, v6
    s_cbranch_vccnz Tslow_292
    s_mov_b32 m0, s21
    s_nop 0
    buffer_load_dwordx4 v4, s[4:7], s18 offen sc1 lds
    buffer_load_dwordx4 v4, s[4:7], s18 offen offset:1024 sc1 lds
    buffer_load_dwordx4 v4, s[4:7], s18 offen offset:2048 sc1 lds
    buffer_load_dwordx4 v4, s[4:7], s18 offen offset:3072 sc1 lds
    s_add_u32 s19, s18, 4096
    s_add_u32 m0, s21, 4096
    s_nop 0
    buffer_load_dwordx4 v4, s[4:7], s19 offen sc1 lds
    buffer_load_dwordx4 v4, s[4:7], s19 offen offset:1024 sc1 lds
    buffer_load_dwordx4 v4, s[4:7], s19 offen offset:2048 sc1 lds
    s_waitcnt vmcnt(7)
    buffer_store_dword v11, v9, s[4:7], 0 offen sc1
    v_mov_b32 v9, 1073741824
    s_waitcnt vmcnt(1)
    s_branch Tjoin_289
Tslow_292:
    s_waitcnt vmcnt(0)
    buffer_store_dword v11, v9, s[4:7], 0 offen sc1
    v_mov_b32 v9, 1073741824
Tpoll_290:
    buffer_load_dword v6, v5, s[4:7], s20 offen sc1
    s_waitcnt vmcnt(0)
    v_cmp_eq_u32 vcc, 0, v6
    s_cbranch_vccz Tok_291
    s_sleep 1
    s_sub_u32 s13, s13, 1
    s_cbranch_scc0 Tpoll_290
    s_mov_b32 s13, 0
Tok_291:
    s_mov_b32 m0, s21
    s_nop 0
    buffer_load_dwordx4 v4, s[4:7], s18 offen sc1 lds
    buffer_load_dwordx4 v4, s[4:7], s18 offen offset:1024 sc1 lds
    buffer_load_dwordx4 v4, s[4:7], s18 offen offset:2048 sc1 lds
    buffer_load_dwordx4 v4, s[4:7], s18 offen offset:3072 sc1 lds
    s_add_u32 s19, s18, 4096
    s_add_u32 m0, s21, 4096
    s_nop 0
    buffer_load_dwordx4 v4, s[4:7], s19 offen sc1 lds
    buffer_load_dwordx4 v4, s[4:7], s19 offen offset:1024 sc1 lds
    buffer_load_dwordx4 v4, s[4:7], s19 offen offset:2048 sc1 lds
    s_waitcnt vmcnt(0)
    s_branch Tjoin_289
Tearly_288:
    s_waitcnt vmcnt(4)
Tjoin_289:
    s_add_u32 s20, s20, 4
    s_add_u32 s23, s23, 1
    s_add_u32 s18, s18, 28672
    s_xor_b32 s21, s21, 0x8000
    v_xor_b32 v8, 0x8000, v8
    s_barrier
    s_and_b32 s25, s11, 15
    s_mul_i32 s25, s25, 458752
    s_add_u32 s25, s25, s26
    s_cmp_lg_u32 s11, 15
    s_cbranch_scc1 Usw_293
    v_mov_b32 v5, v12
Usw_293:
    ds_read_b128 v[46:49], v8 offset:0
    ds_read_b128 v[50:53], v8 offset:14336
    ds_read_b128 v[54:57], v8 offset:1024
    ds_read_b128 v[58:61], v8 offset:15360
    ds_read_b128 v[62:65], v8 offset:2048
    ds_read_b128 v[66:69], v8 offset:16384
    s_waitcnt lgkmcnt(5)
    v_mfma_f32_16x16x32_bf16 v[14:17], v[46:49], a[0:3], 0
    v_mfma_f32_16x16x32_bf16 v[22:25], v[46:49], a[56:59], 0
    v_mfma_f32_16x16x32_bf16 v[30:33], v[46:49], a[112:115], 0
    v_mfma_f32_16x16x32_bf16 v[38:41], v[46:49], a[168:171], 0
    ds_read_b128 v[46:49], v8 offset:3072
    s_waitcnt lgkmcnt(5)
    v_mfma_f32_16x16x32_bf16 v[18:21], v[50:53], a[0:3], 0
    v_mfma_f32_16x16x32_bf16 v[26:29], v[50:53], a[56:59], 0
    v_mfma_f32_16x16x32_bf16 v[34:37], v[50:53], a[112:115], 0
    v_mfma_f32_16x16x32_bf16 v[42:45], v[50:53], a[168:171], 0
    ds_read_b128 v[50:53], v8 offset:17408
    s_waitcnt lgkmcnt(5)
    v_mfma_f32_16x16x32_bf16 v[14:17], v[54:57], a[4:7], v[14:17]
    v_mfma_f32_16x16x32_bf16 v[22:25], v[54:57], a[60:63], v[22:25]
    v_mfma_f32_16x16x32_bf16 v[30:33], v[54:57], a[116:119], v[30:33]
    v_mfma_f32_16x16x32_bf16 v[38:41], v[54:57], a[172:175], v[38:41]
    ds_read_b128 v[54:57], v8 offset:4096
    s_waitcnt lgkmcnt(5)
    v_mfma_f32_16x16x32_bf16 v[18:21], v[58:61], a[4:7], v[18:21]
    v_mfma_f32_16x16x32_bf16 v[26:29], v[58:61], a[60:63], v[26:29]
    v_mfma_f32_16x16x32_bf16 v[34:37], v[58:61], a[116:119], v[34:37]
    v_mfma_f32_16x16x32_bf16 v[42:45], v[58:61], a[172:175], v[42:45]
    ds_read_b128 v[58:61], v8 offset:18432
    s_waitcnt lgkmcnt(5)
    v_mfma_f32_16x16x32_bf16 v[14:17], v[62:65], a[8:11], v[14:17]
    v_mfma_f32_16x16x32_bf16 v[22:25], v[62:65], a[64:67], v[22:25]
    v_mfma_f32_16x16x32_bf16 v[30:33], v[62:65], a[120:123], v[30:33]
    s_waitcnt vmcnt(0)
    buffer_store_dword v11, v9, s[4:7], 0 offen sc1
    v_mfma_f32_16x16x32_bf16 v[38:41], v[62:65], a[176:179], v[38:41]
    ds_read_b128 v[62:65], v8 offset:5120
    s_waitcnt lgkmcnt(5)
    v_mfma_f32_16x16x32_bf16 v[18:21], v[66:69], a[8:11], v[18:21]
    v_mfma_f32_16x16x32_bf16 v[26:29], v[66:69], a[64:67], v[26:29]
    buffer_load_dword v6, v5, s[4:7], s20 offen sc1
    v_mfma_f32_16x16x32_bf16 v[34:37], v[66:69], a[120:123], v[34:37]
    v_mfma_f32_16x16x32_bf16 v[42:45], v[66:69], a[176:179], v[42:45]
    ds_read_b128 v[66:69], v8 offset:19456
    s_waitcnt lgkmcnt(5)
    v_mfma_f32_16x16x32_bf16 v[14:17], v[46:49], a[12:15], v[14:17]
    v_mfma_f32_16x16x32_bf16 v[22:25], v[46:49], a[68:71], v[22:25]
    v_mfma_f32_16x16x32_bf16 v[30:33], v[46:49], a[124:127], v[30:33]
    v_mfma_f32_16x16x32_bf16 v[38:41], v[46:49], a[180:183], v[38:41]
    ds_read_b128 v[46:49], v8 offset:6144
    s_waitcnt lgkmcnt(5)
    v_mfma_f32_16x16x32_bf16 v[18:21], v[50:53], a[12:15], v[18:21]
    v_mfma_f32_16x16x32_bf16 v[26:29], v[50:53], a[68:71], v[26:29]
    v_mfma_f32_16x16x32_bf16 v[34:37], v[50:53], a[124:127], v[34:37]
    v_mfma_f32_16x16x32_bf16 v[42:45], v[50:53], a[180:183], v[42:45]
    ds_read_b128 v[50:53], v8 offset:20480
    s_waitcnt lgkmcnt(5)
    v_mfma_f32_16x16x32_bf16 v[14:17], v[54:57], a[16:19], v[14:17]
    v_mfma_f32_16x16x32_bf16 v[22:25], v[54:57], a[72:75], v[22:25]
    v_mfma_f32_16x16x32_bf16 v[30:33], v[54:57], a[128:131], v[30:33]
    v_mfma_f32_16x16x32_bf16 v[38:41], v[54:57], a[184:187], v[38:41]
    ds_read_b128 v[54:57], v8 offset:7168
    s_waitcnt lgkmcnt(5)
    v_mfma_f32_16x16x32_bf16 v[18:21], v[58:61], a[16:19], v[18:21]
    v_mfma_f32_16x16x32_bf16 v[26:29], v[58:61], a[72:75], v[26:29]
    v_mfma_f32_16x16x32_bf16 v[34:37], v[58:61], a[128:131], v[34:37]
    v_mfma_f32_16x16x32_bf16 v[42:45], v[58:61], a[184:187], v[42:45]
    ds_read_b128 v[58:61], v8 offset:21504
    s_waitcnt lgkmcnt(5)
    v_mfma_f32_16x16x32_bf16 v[14:17], v[62:65], a[20:23], v[14:17]
    v_mfma_f32_16x16x32_bf16 v[22:25], v[62:65], a[76:79], v[22:25]
    v_mfma_f32_16x16x32_bf16 v[30:33], v[62:65], a[132:135], v[30:33]
    v_mfma_f32_16x16x32_bf16 v[38:41], v[62:65], a[188:191], v[38:41]
    ds_read_b128 v[62:65], v8 offset:8192
    s_waitcnt lgkmcnt(5)
    v_mfma_f32_16x16x32_bf16 v[18:21], v[66:69], a[20:23], v[18:21]
    v_mfma_f32_16x16x32_bf16 v[26:29], v[66:69], a[76:79], v[26:29]
    v_mfma_f32_16x16x32_bf16 v[34:37], v[66:69], a[132:135], v[34:37]
    v_mfma_f32_16x16x32_bf16 v[42:45], v[66:69], a[188:191], v[42:45]
    ds_read_b128 v[66:69], v8 offset:22528
    s_waitcnt lgkmcnt(5)
    v_mfma_f32_16x16x32_bf16 v[14:17], v[46:49], a[24:27], v[14:17]
    v_mfma_f32_16x16x32_bf16 v[22:25], v[46:49], a[80:83], v[22:25]
    v_mfma_f32_16x16x32_bf16 v[30:33], v[46:49], a[136:139], v[30:33]
    v_mfma_f32_16x16x32_bf16 v[38:41], v[46:49], a[192:195], v[38:41]
    ds_read_b128 v[46:49], v8 offset:9216
    s_waitcnt lgkmcnt(5)
    v_mfma_f32_16x16x32_bf16 v[18:21], v[50:53], a[24:27], v[18:21]
    v_mfma_f32_16x16x32_bf16 v[26:29], v[50:53], a[80:83], v[26:29]
    v_mfma_f32_16x16x32_bf16 v[34:37], v[50:53], a[136:139], v[34:37]
    v_mfma_f32_16x16x32_bf16 v[42:45], v[50:53], a[192:195], v[42:45]
    ds_read_b128 v[50:53], v8 offset:23552
    s_waitcnt lgkmcnt(5)
    v_mfma_f32_16x16x32_bf16 v[14:17], v[54:57], a[28:31], v[14:17]
    v_mfma_f32_16x16x32_bf16 v[22:25], v[54:57], a[84:87], v[22:25]
    v_mfma_f32_16x16x32_bf16 v[30:33], v[54:57], a[140:143], v[30:33]
    v_mfma_f32_16x16x32_bf16 v[38:41], v[54:57], a[196:199], v[38:41]
    ds_read_b128 v[54:57], v8 offset:10240
    s_waitcnt lgkmcnt(5)
    v_mfma_f32_16x16x32_bf16 v[18:21], v[58:61], a[28:31], v[18:21]
    v_mfma_f32_16x16x32_bf16 v[26:29], v[58:61], a[84:87], v[26:29]
    v_mfma_f32_16x16x32_bf16 v[34:37], v[58:61], a[140:143], v[34:37]
    v_mfma_f32_16x16x32_bf16 v[42:45], v[58:61], a[196:199], v[42:45]
    ds_read_b128 v[58:61], v8 offset:24576
    s_waitcnt lgkmcnt(5)
    v_mfma_f32_16x16x32_bf16 v[14:17], v[62:65], a[32:35], v[14:17]
    v_mfma_f32_16x16x32_bf16 v[22:25], v[62:65], a[88:91], v[22:25]
    v_mfma_f32_16x16x32_bf16 v[30:33], v[62:65], a[144:147], v[30:33]
    v_mfma_f32_16x16x32_bf16 v[38:41], v[62:65], a[200:203], v[38:41]
    ds_read_b128 v[62:65], v8 offset:11264
    s_waitcnt lgkmcnt(5)
    v_mfma_f32_16x16x32_bf16 v[18:21], v[66:69], a[32:35], v[18:21]
    v_mfma_f32_16x16x32_bf16 v[26:29], v[66:69], a[88:91], v[26:29]
    v_mfma_f32_16x16x32_bf16 v[34:37], v[66:69], a[144:147], v[34:37]
    v_mfma_f32_16x16x32_bf16 v[42:45], v[66:69], a[200:203], v[42:45]
    ds_read_b128 v[66:69], v8 offset:25600
    s_waitcnt lgkmcnt(5)
    v_mfma_f32_16x16x32_bf16 v[14:17], v[46:49], a[36:39], v[14:17]
    v_mfma_f32_16x16x32_bf16 v[22:25], v[46:49], a[92:95], v[22:25]
    v_mfma_f32_16x16x32_bf16 v[30:33], v[46:49], a[148:151], v[30:33]
    v_mfma_f32_16x16x32_bf16 v[38:41], v[46:49], a[204:207], v[38:41]
    ds_read_b128 v[46:49], v8 offset:12288
    s_waitcnt lgkmcnt(5)
    v_mfma_f32_16x16x32_bf16 v[18:21], v[50:53], a[36:39], v[18:21]
    v_mfma_f32_16x16x32_bf16 v[26:29], v[50:53], a[92:95], v[26:29]
    v_mfma_f32_16x16x32_bf16 v[34:37], v[50:53], a[148:151], v[34:37]
    s_waitcnt vmcnt(0)
    v_cmp_eq_u32 vcc, 0, v6
    v_mfma_f32_16x16x32_bf16 v[42:45], v[50:53], a[204:207], v[42:45]
    ds_read_b128 v[50:53], v8 offset:26624
    s_cmp_eq_u64 vcc, 0
    s_cselect_b32 s22, 0, 1
    s_waitcnt lgkmcnt(5)
    v_mfma_f32_16x16x32_bf16 v[14:17], v[54:57], a[40:43], v[14:17]
    s_cselect_b32 s19, 0, 1073741824
    s_cmp_ge_u32 s23, 64
    v_mfma_f32_16x16x32_bf16 v[22:25], v[54:57], a[96:99], v[22:25]
    s_cselect_b32 s19, 1073741824, s19
    v_add_u32 v7, s19, v4
    v_mfma_f32_16x16x32_bf16 v[30:33], v[54:57], a[152:155], v[30:33]
    s_mov_b32 m0, s21
    s_nop 0
    buffer_load_dwordx4 v7, s[4:7], s18 offen sc1 lds
    v_mfma_f32_16x16x32_bf16 v[38:41], v[54:57], a[208:211], v[38:41]
    ds_read_b128 v[54:57], v8 offset:13312
    buffer_load_dwordx4 v7, s[4:7], s18 offen offset:1024 sc1 lds
    buffer_load_dwordx4 v7, s[4:7], s18 offen offset:2048 sc1 lds
    s_waitcnt lgkmcnt(5)
    v_mfma_f32_16x16x32_bf16 v[18:21], v[58:61], a[40:43], v[18:21]
    buffer_load_dwordx4 v7, s[4:7], s18 offen offset:3072 sc1 lds
    s_add_u32 s19, s18, 4096
    v_mfma_f32_16x16x32_bf16 v[26:29], v[58:61], a[96:99], v[26:29]
    s_add_u32 m0, s21, 4096
    s_nop 0
    buffer_load_dwordx4 v7, s[4:7], s19 offen sc1 lds
    v_mfma_f32_16x16x32_bf16 v[34:37], v[58:61], a[152:155], v[34:37]
    buffer_load_dwordx4 v7, s[4:7], s19 offen offset:1024 sc1 lds
    buffer_load_dwordx4 v7, s[4:7], s19 offen offset:2048 sc1 lds
    v_mfma_f32_16x16x32_bf16 v[42:45], v[58:61], a[208:211], v[42:45]
    ds_read_b128 v[58:61], v8 offset:27648
    s_waitcnt lgkmcnt(5)
    v_mfma_f32_16x16x32_bf16 v[14:17], v[62:65], a[44:47], v[14:17]
    v_mfma_f32_16x16x32_bf16 v[22:25], v[62:65], a[100:103], v[22:25]
    s_waitcnt lgkmcnt(4)
    v_mfma_f32_16x16x32_bf16 v[18:21], v[66:69], a[44:47], v[18:21]
    v_mfma_f32_16x16x32_bf16 v[30:33], v[62:65], a[156:159], v[30:33]
    v_mfma_f32_16x16x32_bf16 v[26:29], v[66:69], a[100:103], v[26:29]
    v_mfma_f32_16x16x32_bf16 v[38:41], v[62:65], a[212:215], v[38:41]
    v_mfma_f32_16x16x32_bf16 v[34:37], v[66:69], a[156:159], v[34:37]
    s_waitcnt lgkmcnt(3)
    v_mfma_f32_16x16x32_bf16 v[14:17], v[46:49], a[48:51], v[14:17]
    v_mfma_f32_16x16x32_bf16 v[42:45], v[66:69], a[212:215], v[42:45]
    v_mfma_f32_16x16x32_bf16 v[22:25], v[46:49], a[104:107], v[22:25]
    s_waitcnt lgkmcnt(2)
    v_mfma_f32_16x16x32_bf16 v[18:21], v[50:53], a[48:51], v[18:21]
    v_mfma_f32_16x16x32_bf16 v[30:33], v[46:49], a[160:163], v[30:33]
    v_mfma_f32_16x16x32_bf16 v[26:29], v[50:53], a[104:107], v[26:29]
    v_mfma_f32_16x16x32_bf16 v[38:41], v[46:49], a[216:219], v[38:41]
    v_mfma_f32_16x16x32_bf16 v[34:37], v[50:53], a[160:163], v[34:37]
    buffer_load_dword v6, v5, s[4:7], s20 offen sc1
    s_waitcnt lgkmcnt(1)
    v_mfma_f32_16x16x32_bf16 v[14:17], v[54:57], a[52:55], v[14:17]
    v_mfma_f32_16x16x32_bf16 v[42:45], v[50:53], a[216:219], v[42:45]
    v_mfma_f32_16x16x32_bf16 v[22:25], v[54:57], a[108:111], v[22:25]
    s_waitcnt lgkmcnt(0)
    v_mfma_f32_16x16x32_bf16 v[18:21], v[58:61], a[52:55], v[18:21]
    v_mfma_f32_16x16x32_bf16 v[30:33], v[54:57], a[164:167], v[30:33]
    v_mfma_f32_16x16x32_bf16 v[26:29], v[58:61], a[108:111], v[26:29]
    v_mfma_f32_16x16x32_bf16 v[38:41], v[54:57], a[220:223], v[38:41]
    v_mfma_f32_16x16x32_bf16 v[34:37], v[58:61], a[164:167], v[34:37]
    v_cvt_pk_bf16_f32 v14, v14, v15
    v_mfma_f32_16x16x32_bf16 v[42:45], v[58:61], a[220:223], v[42:45]
    v_cvt_pk_bf16_f32 v15, v16, v17
    v_cvt_pk_bf16_f32 v22, v22, v23
    v_cvt_pk_bf16_f32 v16, v18, v19
    v_cvt_pk_bf16_f32 v17, v20, v21
    v_cvt_pk_bf16_f32 v23, v24, v25
    v_cvt_pk_bf16_f32 v30, v30, v31
    v_cvt_pk_bf16_f32 v24, v26, v27
    v_cvt_pk_bf16_f32 v25, v28, v29
    v_cvt_pk_bf16_f32 v31, v32, v33
    v_cvt_pk_bf16_f32 v38, v38, v39
    buffer_store_dwordx4 v[14:17], v4, s[4:7], s25 offen offset:0 sc1
    v_cvt_pk_bf16_f32 v32, v34, v35
    v_cvt_pk_bf16_f32 v33, v36, v37
    v_cvt_pk_bf16_f32 v39, v40, v41
    buffer_store_dwordx4 v[22:25], v4, s[4:7], s25 offen offset:1024 sc1
    v_cvt_pk_bf16_f32 v40, v42, v43
    v_cvt_pk_bf16_f32 v41, v44, v45
    buffer_store_dwordx4 v[30:33], v4, s[4:7], s25 offen offset:2048 sc1
    buffer_store_dwordx4 v[38:41], v4, s[4:7], s25 offen offset:3072 sc1
    v_add_u32 v9, s24, v10
    s_add_u32 s24, s24, 4
    s_add_u32 s11, s11, 1
    s_cmp_lt_u32 s11, 64
    s_cbranch_scc1 Uloop_287
    s_waitcnt vmcnt(0)
    buffer_store_dword v11, v9, s[4:7], 0 offen sc1
    v_mov_b32 v9, 1073741824
    s_endpgm
.p2align 6
role_PV:
    v_and_b32 v1, 63, v0
    v_and_b32 v2, 15, v0
    v_lshrrev_b32 v3, 4, v1
    v_lshlrev_b32 v4, 4, v1
    s_lshl_b32 s17, s9, 2
    s_add_u32 s17, s17, s10
    s_mul_i32 s18, s8, 69632
    s_add_u32 s18, s18, 51200
    s_lshl_b32 s19, s17, 8
    s_add_u32 s18, s18, s19
    s_lshl_b32 s19, s11, 2
    s_add_u32 s18, s18, s19
    v_mov_b32 v15, 1073741824
    v_cmp_eq_u32 vcc, 0, v1
    s_nop 1
    v_cndmask_b32 v16, v15, 0, vcc
    v_mov_b32 v17, 1
    s_lshl_b32 s16, s9, 4
    s_add_u32 s16, s16, s10
    s_add_u32 s16, s16, 0
    v_and_b32 v13, 3, v1
    v_lshl_add_u32 v13, v13, 2, s16
    v_lshlrev_b32 v5, 8, v13
    s_lshl_b32 s16, s10, 3
    s_add_u32 s16, s16, 168
    v_and_b32 v13, 7, v1
    v_add_lshl_u32 v6, v13, s16, 8
    v_lshrrev_b32 v13, 1, v3
    v_lshl_add_u32 v13, v13, 4, v2
    v_lshlrev_b32 v13, 3, v13
    v_and_b32 v14, 1, v3
    v_lshl_add_u32 v7, v14, 2, v13
    s_lshl_b32 s16, s10, 13
    s_add_u32 s16, s16, 0
    v_add_u32 v8, s16, v4
    s_lshl_b32 s16, s10, 11
    s_add_u32 s16, s16, 0
    v_add_u32 v9, s16, v4
    v_and_b32 v13, 1, v3
    v_mul_u32_u24 v13, 14336, v13
    v_lshrrev_b32 v14, 1, v3
    v_lshl_add_u32 v13, v14, 8, v13
    v_lshl_add_u32 v13, v2, 4, v13
    s_lshl_b32 s16, s17, 9
    v_add_u32 v10, s16, v13
    s_mul_i32 s37, s8, 7340032
    s_add_u32 s37, s37, 25833472
    s_lshl_b32 s16, s9, 16
    s_add_u32 s37, s37, s16
    s_lshl_b32 s16, s10, 12
    s_add_u32 s37, s37, s16
    s_mul_i32 s34, s8, 327680
    s_add_u32 s34, s34, 40513536
    s_mul_i32 s16, s10, 10240
    s_add_u32 s34, s34, s16
    s_mul_i32 s36, s8, 917504
    s_add_u32 s36, s36, 3354624
    s_lshl_b32 s16, s9, 14
    s_add_u32 s36, s36, s16
    s_lshl_b32 s16, s10, 10
    s_add_u32 s36, s36, s16
    s_mul_i32 s31, s8, 1835008
    s_add_u32 s31, s31, 22163456
    s_mul_i32 s16, s11, 28672
    s_add_u32 s31, s31, s16
    s_mul_i32 s35, s8, 229376
    s_add_u32 s35, s35, 21704704
    s_mul_i32 s33, s8, 69632
    s_add_u32 s33, s33, 0
    s_lshl_b32 s16, s11, 2
    s_add_u32 s33, s33, s16
    v_mov_b32 v174, -1
    v_mov_b32 v175, -1
    v_mov_b32 v176, -1
    v_mov_b32 v177, -1
    v_mov_b32 v12, 0
    s_mul_i32 s32, s8, 1605632
    s_add_u32 s32, s32, 41168896
    s_mul_i32 s16, s11, 200704
    s_add_u32 s32, s32, s16
    s_mul_i32 s16, s9, 28672
    s_add_u32 s32, s32, s16
    v_lshlrev_b32 v170, 7, v0
    v_mov_b32 v171, 1073741824
    v_cmp_gt_u32 vcc, 28672, v170
    s_nop 1
    v_cndmask_b32 v170, v171, v170, vcc
    buffer_load_dword v172, v170, s[4:7], s32 offen sc1
    v_add_u32 v170, 32768, v170
    s_mul_i32 s32, s8, 1605632
    s_add_u32 s32, s32, 41570304
    s_mul_i32 s16, s11, 200704
    s_add_u32 s32, s32, s16
    s_mul_i32 s16, s9, 28672
    s_add_u32 s32, s32, s16
    v_lshlrev_b32 v170, 7, v0
    v_mov_b32 v171, 1073741824
    v_cmp_gt_u32 vcc, 28672, v170
    s_nop 1
    v_cndmask_b32 v170, v171, v170, vcc
    buffer_load_dword v172, v170, s[4:7], s32 offen sc1
    v_add_u32 v170, 32768, v170
    s_mul_i32 s32, s8, 1605632
    s_add_u32 s32, s32, 41971712
    s_mul_i32 s16, s11, 200704
    s_add_u32 s32, s32, s16
    s_mul_i32 s16, s9, 28672
    s_add_u32 s32, s32, s16
    v_lshlrev_b32 v170, 7, v0
    v_mov_b32 v171, 1073741824
    v_cmp_gt_u32 vcc, 28672, v170
    s_nop 1
    v_cndmask_b32 v170, v171, v170, vcc
    buffer_load_dword v172, v170, s[4:7], s32 offen sc1
    v_add_u32 v170, 32768, v170
    s_mul_i32 s32, s8, 1605632
    s_add_u32 s32, s32, 42373120
    s_mul_i32 s16, s11, 200704
    s_add_u32 s32, s32, s16
    s_mul_i32 s16, s9, 28672
    s_add_u32 s32, s32, s16
    v_lshlrev_b32 v170, 7, v0
    v_mov_b32 v171, 1073741824
    v_cmp_gt_u32 vcc, 28672, v170
    s_nop 1
    v_cndmask_b32 v170, v171, v170, vcc
    buffer_load_dword v172, v170, s[4:7], s32 offen sc1
    v_add_u32 v170, 32768, v170
    v_lshlrev_b32 v170, 7, v0
    s_mov_b32 s38, 176132
ww_294:
    buffer_load_dword v171, v170, s[4:7], s38 offen sc1
    s_waitcnt vmcnt(0)
    v_cmp_eq_u32 vcc, 0, v171
    s_cbranch_vccz wwok_295
    s_sleep 4
    s_sub_u32 s13, s13, 1
    s_cbranch_scc0 ww_294
    s_mov_b32 s13, 0
wwok_295:
    s_barrier
    v_and_b32 v170, 63, v0
    v_min_u32 v170, 31, v170
    v_lshlrev_b32 v170, 10, v170
    s_and_b32 s38, s2, 7
    s_lshl_b32 s38, s38, 7
    s_add_u32 s38, s38, 176128
    buffer_load_dword v171, v170, s[4:7], s38 offen sc1
    s_waitcnt vmcnt(0)
    v_cmp_ne_u32 vcc, s15, v171
    s_cmp_lg_u64 vcc, 0
    s_cselect_b32 s12, 1, 0
    s_cmp_lg_u32 s12, 0
    s_cbranch_scc1 far_296
Ploop_297:
    v_cmp_eq_u32 vcc, 0, v12
    s_cbranch_vccz puok_299
pup_298:
    s_sleep 2
    buffer_load_dword v12, v5, s[4:7], s33 offen sc1
    s_waitcnt vmcnt(0)
    v_cmp_eq_u32 vcc, 0, v12
    s_cbranch_vccz puok_299
    s_sub_u32 s13, s13, 1
    s_cbranch_scc0 pup_298
    s_mov_b32 s13, 0
puok_299:
    s_and_b32 s19, s11, 7
    s_mul_i32 s19, s19, 40960
    s_add_u32 s19, s19, s34
    s_and_b32 s32, s11, 7
    s_mul_i32 s32, s32, 28672
    s_add_u32 s32, s32, s35
    s_and_b32 s27, s11, 7
    s_mul_i32 s27, s27, 114688
    s_add_u32 s27, s27, s36
    s_and_b32 s23, s11, 15
    s_mul_i32 s23, s23, 458752
    s_add_u32 s23, s23, s37
    s_add_u32 s24, s23, 16384
    s_add_u32 s28, s27, 4096
    s_add_u32 s20, s19, 2560
    s_add_u32 s25, s23, 32768
    s_add_u32 s29, s27, 8192
    s_add_u32 s21, s19, 5120
    s_add_u32 s26, s23, 49152
    s_add_u32 s30, s27, 12288
    s_add_u32 s22, s19, 7680
    buffer_load_dwordx4 v[58:61], v4, s[4:7], s23 offen sc1
    buffer_load_dwordx4 v[62:65], v4, s[4:7], s23 offen offset:1024 sc1
    buffer_load_dwordx4 v[66:69], v4, s[4:7], s23 offen offset:2048 sc1
    buffer_load_dwordx4 v[70:73], v4, s[4:7], s23 offen offset:3072 sc1
    buffer_load_dwordx4 v[78:81], v4, s[4:7], s24 offen sc1
    buffer_load_dwordx4 v[82:85], v4, s[4:7], s24 offen offset:1024 sc1
    buffer_load_dwordx4 v[86:89], v4, s[4:7], s24 offen offset:2048 sc1
    buffer_load_dwordx4 v[90:93], v4, s[4:7], s24 offen offset:3072 sc1
    buffer_load_dwordx4 v[98:101], v4, s[4:7], s25 offen sc1
    buffer_load_dwordx4 v[102:105], v4, s[4:7], s25 offen offset:1024 sc1
    buffer_load_dwordx4 v[106:109], v4, s[4:7], s25 offen offset:2048 sc1
    buffer_load_dwordx4 v[110:113], v4, s[4:7], s25 offen offset:3072 sc1
    buffer_load_dwordx4 v[118:121], v4, s[4:7], s26 offen sc1
    buffer_load_dwordx4 v[122:125], v4, s[4:7], s26 offen offset:1024 sc1
    buffer_load_dwordx4 v[126:129], v4, s[4:7], s26 offen offset:2048 sc1
    buffer_load_dwordx4 v[130:133], v4, s[4:7], s26 offen offset:3072 sc1
    buffer_load_dwordx4 v[170:173], v10, s[4:7], s31 offen sc1
    buffer_load_dword v12, v5, s[4:7], s33 offen offset:8 sc1
    buffer_load_dword v11, v6, s[4:7], s33 offen sc1
    s_waitcnt vmcnt(0)
    v_cmp_eq_u32 vcc, 0, v11
    s_cbranch_vccz pxok_301
pxp_300:
    s_sleep 1
    buffer_load_dword v11, v6, s[4:7], s33 offen sc1
    s_waitcnt vmcnt(0)
    v_cmp_eq_u32 vcc, 0, v11
    s_cbranch_vccz pxok_301
    s_sub_u32 s13, s13, 1
    s_cbranch_scc0 pxp_300
    s_mov_b32 s13, 0
pxok_301:
    buffer_load_dwordx4 v[18:21], v4, s[4:7], s19 offen offset:0 sc1
    buffer_load_dwordx4 v[38:41], v4, s[4:7], s19 offen offset:1280 sc1
    buffer_load_dwordx4 v[22:25], v4, s[4:7], s20 offen offset:0 sc1
    buffer_load_dwordx4 v[42:45], v4, s[4:7], s20 offen offset:1280 sc1
    buffer_load_dwordx4 v[26:29], v4, s[4:7], s21 offen offset:0 sc1
    buffer_load_dwordx4 v[46:49], v4, s[4:7], s21 offen offset:1280 sc1
    buffer_load_dwordx4 v[30:33], v4, s[4:7], s22 offen offset:0 sc1
    buffer_load_dwordx4 v[50:53], v4, s[4:7], s22 offen offset:1280 sc1
    buffer_load_dword v34, v7, s[4:7], s19 offen offset:1024 sc1
    buffer_load_dword v35, v7, s[4:7], s20 offen offset:1024 sc1
    buffer_load_dword v36, v7, s[4:7], s21 offen offset:1024 sc1
    buffer_load_dword v37, v7, s[4:7], s22 offen offset:1024 sc1
    buffer_load_dword v54, v7, s[4:7], s19 offen offset:2304 sc1
    buffer_load_dword v55, v7, s[4:7], s20 offen offset:2304 sc1
    buffer_load_dword v56, v7, s[4:7], s21 offen offset:2304 sc1
    buffer_load_dword v57, v7, s[4:7], s22 offen offset:2304 sc1
    buffer_load_dwordx4 v[74:77], v4, s[4:7], s27 offen sc1
    buffer_load_dwordx4 v[94:97], v4, s[4:7], s28 offen sc1
    buffer_load_dwordx4 v[114:117], v4, s[4:7], s29 offen sc1
    buffer_load_dwordx4 v[134:137], v4, s[4:7], s30 offen sc1
    s_waitcnt vmcnt(19)
    v_mfma_f32_16x16x32_bf16 v[138:141], v[58:61], v[18:21], 0
    v_mfma_f32_16x16x32_bf16 v[146:149], v[78:81], v[18:21], 0
    v_mfma_f32_16x16x32_bf16 v[154:157], v[98:101], v[18:21], 0
    v_mfma_f32_16x16x32_bf16 v[162:165], v[118:121], v[18:21], 0
    s_waitcnt vmcnt(18)
    v_mfma_f32_16x16x32_bf16 v[142:145], v[58:61], v[38:41], 0
    v_mfma_f32_16x16x32_bf16 v[150:153], v[78:81], v[38:41], 0
    v_mfma_f32_16x16x32_bf16 v[158:161], v[98:101], v[38:41], 0
    v_mfma_f32_16x16x32_bf16 v[166:169], v[118:121], v[38:41], 0
    s_waitcnt vmcnt(17)
    v_mfma_f32_16x16x32_bf16 v[138:141], v[62:65], v[22:25], v[138:141]
    v_mfma_f32_16x16x32_bf16 v[146:149], v[82:85], v[22:25], v[146:149]
    v_mfma_f32_16x16x32_bf16 v[154:157], v[102:105], v[22:25], v[154:157]
    v_mfma_f32_16x16x32_bf16 v[162:165], v[122:125], v[22:25], v[162:165]
    s_waitcnt vmcnt(16)
    v_mfma_f32_16x16x32_bf16 v[142:145], v[62:65], v[42:45], v[142:145]
    v_mfma_f32_16x16x32_bf16 v[150:153], v[82:85], v[42:45], v[150:153]
    v_mfma_f32_16x16x32_bf16 v[158:161], v[102:105], v[42:45], v[158:161]
    v_mfma_f32_16x16x32_bf16 v[166:169], v[122:125], v[42:45], v[166:169]
    s_waitcnt vmcnt(15)
    v_mfma_f32_16x16x32_bf16 v[138:141], v[66:69], v[26:29], v[138:141]
    v_mfma_f32_16x16x32_bf16 v[146:149], v[86:89], v[26:29], v[146:149]
    v_mfma_f32_16x16x32_bf16 v[154:157], v[106:109], v[26:29], v[154:157]
    v_mfma_f32_16x16x32_bf16 v[162:165], v[126:129], v[26:29], v[162:165]
    s_waitcnt vmcnt(14)
    v_mfma_f32_16x16x32_bf16 v[142:145], v[66:69], v[46:49], v[142:145]
    v_mfma_f32_16x16x32_bf16 v[150:153], v[86:89], v[46:49], v[150:153]
    v_mfma_f32_16x16x32_bf16 v[158:161], v[106:109], v[46:49], v[158:161]
    v_mfma_f32_16x16x32_bf16 v[166:169], v[126:129], v[46:49], v[166:169]
    s_waitcnt vmcnt(13)
    v_mfma_f32_16x16x32_bf16 v[138:141], v[70:73], v[30:33], v[138:141]
    v_mfma_f32_16x16x32_bf16 v[146:149], v[90:93], v[30:33], v[146:149]
    v_mfma_f32_16x16x32_bf16 v[154:157], v[110:113], v[30:33], v[154:157]
    v_mfma_f32_16x16x32_bf16 v[162:165], v[130:133], v[30:33], v[162:165]
    s_waitcnt vmcnt(12)
    v_mfma_f32_16x16x32_bf16 v[142:145], v[70:73], v[50:53], v[142:145]
    v_mfma_f32_16x16x32_bf16 v[150:153], v[90:93], v[50:53], v[150:153]
    v_mfma_f32_16x16x32_bf16 v[158:161], v[110:113], v[50:53], v[158:161]
    v_mfma_f32_16x16x32_bf16 v[166:169], v[130:133], v[50:53], v[166:169]
Yp_302:
    s_waitcnt vmcnt(0)
    v_max3_u32 v13, v74, v75, v76
    v_max3_u32 v13, v13, v77, v94
    v_max3_u32 v13, v13, v95, v96
    v_max3_u32 v13, v13, v97, v114
    v_max3_u32 v13, v13, v115, v116
    v_max3_u32 v13, v13, v117, v134
    v_max3_u32 v13, v13, v135, v136
    v_max_u32 v13, v13, v137
    v_cmp_eq_u32 vcc, -1, v13
    s_cbranch_vccz Yok_303
    s_sleep 1
    buffer_load_dwordx4 v[74:77], v4, s[4:7], s27 offen sc1
    buffer_load_dwordx4 v[94:97], v4, s[4:7], s28 offen sc1
    buffer_load_dwordx4 v[114:117], v4, s[4:7], s29 offen sc1
    buffer_load_dwordx4 v[134:137], v4, s[4:7], s30 offen sc1
    s_sub_u32 s13, s13, 1
    s_cbranch_scc0 Yp_302
    s_mov_b32 s13, 0
    s_waitcnt vmcnt(0)
Yok_303:
    v_mfma_f32_16x16x32_bf16 v[138:141], v[74:77], v[34:37], v[138:141]
    buffer_store_dwordx4 v[174:177], v4, s[4:7], s27 offen sc1
    buffer_store_dwordx4 v[174:177], v4, s[4:7], s28 offen sc1
    v_mfma_f32_16x16x32_bf16 v[142:145], v[74:77], v[54:57], v[142:145]
    buffer_store_dwordx4 v[174:177], v4, s[4:7], s29 offen sc1
    buffer_store_dwordx4 v[174:177], v4, s[4:7], s30 offen sc1
    v_mfma_f32_16x16x32_bf16 v[146:149], v[94:97], v[34:37], v[146:149]
    v_mfma_f32_16x16x32_bf16 v[150:153], v[94:97], v[54:57], v[150:153]
    s_nop 0
    ds_write_b128 v8, v[138:141] offset:0
    v_mfma_f32_16x16x32_bf16 v[154:157], v[114:117], v[34:37], v[154:157]
    v_mfma_f32_16x16x32_bf16 v[158:161], v[114:117], v[54:57], v[158:161]
    ds_write_b128 v8, v[142:145] offset:1024
    v_mfma_f32_16x16x32_bf16 v[162:165], v[134:137], v[34:37], v[162:165]
    v_mfma_f32_16x16x32_bf16 v[166:169], v[134:137], v[54:57], v[166:169]
    ds_write_b128 v8, v[146:149] offset:2048
    ds_write_b128 v8, v[150:153] offset:3072
    s_nop 1
    ds_write_b128 v8, v[154:157] offset:4096
    ds_write_b128 v8, v[158:161] offset:5120
    s_nop 0
    ds_write_b128 v8, v[162:165] offset:6144
    ds_write_b128 v8, v[166:169] offset:7168
    s_waitcnt lgkmcnt(0)
    s_barrier
    ds_read_b128 v[18:21], v9 offset:0
    v_and_b32 v139, 0xffff0000, v170
    v_lshlrev_b32 v138, 16, v170
    v_and_b32 v141, 0xffff0000, v171
    v_lshlrev_b32 v140, 16, v171
    ds_read_b128 v[22:25], v9 offset:8192
    v_and_b32 v143, 0xffff0000, v172
    v_lshlrev_b32 v142, 16, v172
    v_and_b32 v145, 0xffff0000, v173
    v_lshlrev_b32 v144, 16, v173
    ds_read_b128 v[26:29], v9 offset:16384
    ds_read_b128 v[30:33], v9 offset:24576
    ds_read_b128 v[38:41], v9 offset:1024
    ds_read_b128 v[42:45], v9 offset:9216
    ds_read_b128 v[46:49], v9 offset:17408
    ds_read_b128 v[50:53], v9 offset:25600
    s_waitcnt lgkmcnt(6)
    v_add_f32 v18, v18, v22
    v_add_f32 v19, v19, v23
    v_add_f32 v20, v20, v24
    v_add_f32 v21, v21, v25
    s_waitcnt lgkmcnt(4)
    v_add_f32 v26, v26, v30
    v_add_f32 v27, v27, v31
    v_add_f32 v28, v28, v32
    v_add_f32 v29, v29, v33
    v_add_f32 v18, v18, v26
    v_add_f32 v19, v19, v27
    v_add_f32 v20, v20, v28
    v_add_f32 v21, v21, v29
    s_waitcnt lgkmcnt(2)
    v_add_f32 v38, v38, v42
    v_add_f32 v39, v39, v43
    v_add_f32 v40, v40, v44
    v_add_f32 v41, v41, v45
    s_waitcnt lgkmcnt(0)
    v_add_f32 v46, v46, v50
    v_add_f32 v47, v47, v51
    v_add_f32 v48, v48, v52
    v_add_f32 v49, v49, v53
    v_add_f32 v38, v38, v46
    v_add_f32 v39, v39, v47
    v_add_f32 v40, v40, v48
    v_add_f32 v41, v41, v49
    v_permlane16_swap_b32 v18, v38
    v_permlane16_swap_b32 v19, v39
    v_permlane16_swap_b32 v20, v40
    v_permlane16_swap_b32 v21, v41
    v_add_f32 v138, v138, v18
    v_add_f32 v139, v139, v19
    v_add_f32 v140, v140, v20
    v_add_f32 v141, v141, v21
    v_add_f32 v142, v142, v38
    v_add_f32 v143, v143, v39
    v_add_f32 v144, v144, v40
    v_add_f32 v145, v145, v41
    v_cvt_pk_bf16_f32 v146, v138, v139
    v_cvt_pk_bf16_f32 v147, v140, v141
    v_cvt_pk_bf16_f32 v148, v142, v143
    v_cvt_pk_bf16_f32 v149, v144, v145
    buffer_store_dwordx4 v[146:149], v10, s[4:7], s32 offen
    v_add_u32 v15, s18, v16
    s_add_u32 s18, s18, 8
    s_waitcnt vmcnt(0)
    buffer_store_dword v17, v15, s[4:7], 0 offen
    v_mov_b32 v15, 1073741824
    s_barrier
    s_add_u32 s31, s31, 57344
    s_add_u32 s33, s33, 8
    s_add_u32 s11, s11, 2
    s_cmp_lt_u32 s11, 64
    s_cbranch_scc1 Ploop_297
    s_endpgm
.p2align 6
far_296:
Ploop_304:
    v_cmp_eq_u32 vcc, 0, v12
    s_cbranch_vccz puok_306
pup_305:
    s_sleep 2
    buffer_load_dword v12, v5, s[4:7], s33 offen sc1
    s_waitcnt vmcnt(0)
    v_cmp_eq_u32 vcc, 0, v12
    s_cbranch_vccz puok_306
    s_sub_u32 s13, s13, 1
    s_cbranch_scc0 pup_305
    s_mov_b32 s13, 0
puok_306:
    s_and_b32 s19, s11, 7
    s_mul_i32 s19, s19, 40960
    s_add_u32 s19, s19, s34
    s_and_b32 s32, s11, 7
    s_mul_i32 s32, s32, 28672
    s_add_u32 s32, s32, s35
    s_and_b32 s27, s11, 7
    s_mul_i32 s27, s27, 114688
    s_add_u32 s27, s27, s36
    s_and_b32 s23, s11, 15
    s_mul_i32 s23, s23, 458752
    s_add_u32 s23, s23, s37
    s_add_u32 s24, s23, 16384
    s_add_u32 s28, s27, 4096
    s_add_u32 s20, s19, 2560
    s_add_u32 s25, s23, 32768
    s_add_u32 s29, s27, 8192
    s_add_u32 s21, s19, 5120
    s_add_u32 s26, s23, 49152
    s_add_u32 s30, s27, 12288
    s_add_u32 s22, s19, 7680
    buffer_load_dwordx4 v[58:61], v4, s[4:7], s23 offen sc1
    buffer_load_dwordx4 v[62:65], v4, s[4:7], s23 offen offset:1024 sc1
    buffer_load_dwordx4 v[66:69], v4, s[4:7], s23 offen offset:2048 sc1
    buffer_load_dwordx4 v[70:73], v4, s[4:7], s23 offen offset:3072 sc1
    buffer_load_dwordx4 v[78:81], v4, s[4:7], s24 offen sc1
    buffer_load_dwordx4 v[82:85], v4, s[4:7], s24 offen offset:1024 sc1
    buffer_load_dwordx4 v[86:89], v4, s[4:7], s24 offen offset:2048 sc1
    buffer_load_dwordx4 v[90:93], v4, s[4:7], s24 offen offset:3072 sc1
    buffer_load_dwordx4 v[98:101], v4, s[4:7], s25 offen sc1
    buffer_load_dwordx4 v[102:105], v4, s[4:7], s25 offen offset:1024 sc1
    buffer_load_dwordx4 v[106:109], v4, s[4:7], s25 offen offset:2048 sc1
    buffer_load_dwordx4 v[110:113], v4, s[4:7], s25 offen offset:3072 sc1
    buffer_load_dwordx4 v[118:121], v4, s[4:7], s26 offen sc1
    buffer_load_dwordx4 v[122:125], v4, s[4:7], s26 offen offset:1024 sc1
    buffer_load_dwordx4 v[126:129], v4, s[4:7], s26 offen offset:2048 sc1
    buffer_load_dwordx4 v[130:133], v4, s[4:7], s26 offen offset:3072 sc1
    buffer_load_dwordx4 v[170:173], v10, s[4:7], s31 offen sc1
    buffer_load_dword v12, v5, s[4:7], s33 offen offset:8 sc1
    buffer_load_dword v11, v6, s[4:7], s33 offen sc1
    s_waitcnt vmcnt(0)
    v_cmp_eq_u32 vcc, 0, v11
    s_cbranch_vccz pxok_308
pxp_307:
    s_sleep 1
    buffer_load_dword v11, v6, s[4:7], s33 offen sc1
    s_waitcnt vmcnt(0)
    v_cmp_eq_u32 vcc, 0, v11
    s_cbranch_vccz pxok_308
    s_sub_u32 s13, s13, 1
    s_cbranch_scc0 pxp_307
    s_mov_b32 s13, 0
pxok_308:
    buffer_load_dwordx4 v[18:21], v4, s[4:7], s19 offen offset:0 sc1
    buffer_load_dwordx4 v[38:41], v4, s[4:7], s19 offen offset:1280 sc1
    buffer_load_dwordx4 v[22:25], v4, s[4:7], s20 offen offset:0 sc1
    buffer_load_dwordx4 v[42:45], v4, s[4:7], s20 offen offset:1280 sc1
    buffer_load_dwordx4 v[26:29], v4, s[4:7], s21 offen offset:0 sc1
    buffer_load_dwordx4 v[46:49], v4, s[4:7], s21 offen offset:1280 sc1
    buffer_load_dwordx4 v[30:33], v4, s[4:7], s22 offen offset:0 sc1
    buffer_load_dwordx4 v[50:53], v4, s[4:7], s22 offen offset:1280 sc1
    buffer_load_dword v34, v7, s[4:7], s19 offen offset:1024 sc1
    buffer_load_dword v35, v7, s[4:7], s20 offen offset:1024 sc1
    buffer_load_dword v36, v7, s[4:7], s21 offen offset:1024 sc1
    buffer_load_dword v37, v7, s[4:7], s22 offen offset:1024 sc1
    buffer_load_dword v54, v7, s[4:7], s19 offen offset:2304 sc1
    buffer_load_dword v55, v7, s[4:7], s20 offen offset:2304 sc1
    buffer_load_dword v56, v7, s[4:7], s21 offen offset:2304 sc1
    buffer_load_dword v57, v7, s[4:7], s22 offen offset:2304 sc1
    buffer_load_dwordx4 v[74:77], v4, s[4:7], s27 offen sc1
    buffer_load_dwordx4 v[94:97], v4, s[4:7], s28 offen sc1
    buffer_load_dwordx4 v[114:117], v4, s[4:7], s29 offen sc1
    buffer_load_dwordx4 v[134:137], v4, s[4:7], s30 offen sc1
    s_waitcnt vmcnt(19)
    v_mfma_f32_16x16x32_bf16 v[138:141], v[58:61], v[18:21], 0
    v_mfma_f32_16x16x32_bf16 v[146:149], v[78:81], v[18:21], 0
    v_mfma_f32_16x16x32_bf16 v[154:157], v[98:101], v[18:21], 0
    v_mfma_f32_16x16x32_bf16 v[162:165], v[118:121], v[18:21], 0
    s_waitcnt vmcnt(18)
    v_mfma_f32_16x16x32_bf16 v[142:145], v[58:61], v[38:41], 0
    v_mfma_f32_16x16x32_bf16 v[150:153], v[78:81], v[38:41], 0
    v_mfma_f32_16x16x32_bf16 v[158:161], v[98:101], v[38:41], 0
    v_mfma_f32_16x16x32_bf16 v[166:169], v[118:121], v[38:41], 0
    s_waitcnt vmcnt(17)
    v_mfma_f32_16x16x32_bf16 v[138:141], v[62:65], v[22:25], v[138:141]
    v_mfma_f32_16x16x32_bf16 v[146:149], v[82:85], v[22:25], v[146:149]
    v_mfma_f32_16x16x32_bf16 v[154:157], v[102:105], v[22:25], v[154:157]
    v_mfma_f32_16x16x32_bf16 v[162:165], v[122:125], v[22:25], v[162:165]
    s_waitcnt vmcnt(16)
    v_mfma_f32_16x16x32_bf16 v[142:145], v[62:65], v[42:45], v[142:145]
    v_mfma_f32_16x16x32_bf16 v[150:153], v[82:85], v[42:45], v[150:153]
    v_mfma_f32_16x16x32_bf16 v[158:161], v[102:105], v[42:45], v[158:161]
    v_mfma_f32_16x16x32_bf16 v[166:169], v[122:125], v[42:45], v[166:169]
    s_waitcnt vmcnt(15)
    v_mfma_f32_16x16x32_bf16 v[138:141], v[66:69], v[26:29], v[138:141]
    v_mfma_f32_16x16x32_bf16 v[146:149], v[86:89], v[26:29], v[146:149]
    v_mfma_f32_16x16x32_bf16 v[154:157], v[106:109], v[26:29], v[154:157]
    v_mfma_f32_16x16x32_bf16 v[162:165], v[126:129], v[26:29], v[162:165]
    s_waitcnt vmcnt(14)
    v_mfma_f32_16x16x32_bf16 v[142:145], v[66:69], v[46:49], v[142:145]
    v_mfma_f32_16x16x32_bf16 v[150:153], v[86:89], v[46:49], v[150:153]
    v_mfma_f32_16x16x32_bf16 v[158:161], v[106:109], v[46:49], v[158:161]
    v_mfma_f32_16x16x32_bf16 v[166:169], v[126:129], v[46:49], v[166:169]
    s_waitcnt vmcnt(13)
    v_mfma_f32_16x16x32_bf16 v[138:141], v[70:73], v[30:33], v[138:141]
    v_mfma_f32_16x16x32_bf16 v[146:149], v[90:93], v[30:33], v[146:149]
    v_mfma_f32_16x16x32_bf16 v[154:157], v[110:113], v[30:33], v[154:157]
    v_mfma_f32_16x16x32_bf16 v[162:165], v[130:133], v[30:33], v[162:165]
    s_waitcnt vmcnt(12)
    v_mfma_f32_16x16x32_bf16 v[142:145], v[70:73], v[50:53], v[142:145]
    v_mfma_f32_16x16x32_bf16 v[150:153], v[90:93], v[50:53], v[150:153]
    v_mfma_f32_16x16x32_bf16 v[158:161], v[110:113], v[50:53], v[158:161]
    v_mfma_f32_16x16x32_bf16 v[166:169], v[130:133], v[50:53], v[166:169]
Yp_309:
    s_waitcnt vmcnt(0)
    v_max3_u32 v13, v74, v75, v76
    v_max3_u32 v13, v13, v77, v94
    v_max3_u32 v13, v13, v95, v96
    v_max3_u32 v13, v13, v97, v114
    v_max3_u32 v13, v13, v115, v116
    v_max3_u32 v13, v13, v117, v134
    v_max3_u32 v13, v13, v135, v136
    v_max_u32 v13, v13, v137
    v_cmp_eq_u32 vcc, -1, v13
    s_cbranch_vccz Yok_310
    s_sleep 1
    buffer_load_dwordx4 v[74:77], v4, s[4:7], s27 offen sc1
    buffer_load_dwordx4 v[94:97], v4, s[4:7], s28 offen sc1
    buffer_load_dwordx4 v[114:117], v4, s[4:7], s29 offen sc1
    buffer_load_dwordx4 v[134:137], v4, s[4:7], s30 offen sc1
    s_sub_u32 s13, s13, 1
    s_cbranch_scc0 Yp_309
    s_mov_b32 s13, 0
    s_waitcnt vmcnt(0)
Yok_310:
    v_mfma_f32_16x16x32_bf16 v[138:141], v[74:77], v[34:37], v[138:141]
    buffer_store_dwordx4 v[174:177], v4, s[4:7], s27 offen sc1
    buffer_store_dwordx4 v[174:177], v4, s[4:7], s28 offen sc1
    v_mfma_f32_16x16x32_bf16 v[142:145], v[74:77], v[54:57], v[142:145]
    buffer_store_dwordx4 v[174:177], v4, s[4:7], s29 offen sc1
    buffer_store_dwordx4 v[174:177], v4, s[4:7], s30 offen sc1
    v_mfma_f32_16x16x32_bf16 v[146:149], v[94:97], v[34:37], v[146:149]
    v_mfma_f32_16x16x32_bf16 v[150:153], v[94:97], v[54:57], v[150:153]
    s_nop 0
    ds_write_b128 v8, v[138:141] offset:0
    v_mfma_f32_16x16x32_bf16 v[154:157], v[114:117], v[34:37], v[154:157]
    v_mfma_f32_16x16x32_bf16 v[158:161], v[114:117], v[54:57], v[158:161]
    ds_write_b128 v8, v[142:145] offset:1024
    v_mfma_f32_16x16x32_bf16 v[162:165], v[134:137], v[34:37], v[162:165]
    v_mfma_f32_16x16x32_bf16 v[166:169], v[134:137], v[54:57], v[166:169]
    ds_write_b128 v8, v[146:149] offset:2048
    ds_write_b128 v8, v[150:153] offset:3072
    s_nop 1
    ds_write_b128 v8, v[154:157] offset:4096
    ds_write_b128 v8, v[158:161] offset:5120
    s_nop 0
    ds_write_b128 v8, v[162:165] offset:6144
    ds_write_b128 v8, v[166:169] offset:7168
    s_waitcnt lgkmcnt(0)
    s_barrier
    ds_read_b128 v[18:21], v9 offset:0
    v_and_b32 v139, 0xffff0000, v170
    v_lshlrev_b32 v138, 16, v170
    v_and_b32 v141, 0xffff0000, v171
    v_lshlrev_b32 v140, 16, v171
    ds_read_b128 v[22:25], v9 offset:8192
    v_and_b32 v143, 0xffff0000, v172
    v_lshlrev_b32 v142, 16, v172
    v_and_b32 v145, 0xffff0000, v173
    v_lshlrev_b32 v144, 16, v173
    ds_read_b128 v[26:29], v9 offset:16384
    ds_read_b128 v[30:33], v9 offset:24576
    ds_read_b128 v[38:41], v9 offset:1024
    ds_read_b128 v[42:45], v9 offset:9216
    ds_read_b128 v[46:49], v9 offset:17408
    ds_read_b128 v[50:53], v9 offset:25600
    s_waitcnt lgkmcnt(6)
    v_add_f32 v18, v18, v22
    v_add_f32 v19, v19, v23
    v_add_f32 v20, v20, v24
    v_add_f32 v21, v21, v25
    s_waitcnt lgkmcnt(4)
    v_add_f32 v26, v26, v30
    v_add_f32 v27, v27, v31
    v_add_f32 v28, v28, v32
    v_add_f32 v29, v29, v33
    v_add_f32 v18, v18, v26
    v_add_f32 v19, v19, v27
    v_add_f32 v20, v20, v28
    v_add_f32 v21, v21, v29
    s_waitcnt lgkmcnt(2)
    v_add_f32 v38, v38, v42
    v_add_f32 v39, v39, v43
    v_add_f32 v40, v40, v44
    v_add_f32 v41, v41, v45
    s_waitcnt lgkmcnt(0)
    v_add_f32 v46, v46, v50
    v_add_f32 v47, v47, v51
    v_add_f32 v48, v48, v52
    v_add_f32 v49, v49, v53
    v_add_f32 v38, v38, v46
    v_add_f32 v39, v39, v47
    v_add_f32 v40, v40, v48
    v_add_f32 v41, v41, v49
    v_permlane16_swap_b32 v18, v38
    v_permlane16_swap_b32 v19, v39
    v_permlane16_swap_b32 v20, v40
    v_permlane16_swap_b32 v21, v41
    v_add_f32 v138, v138, v18
    v_add_f32 v139, v139, v19
    v_add_f32 v140, v140, v20
    v_add_f32 v141, v141, v21
    v_add_f32 v142, v142, v38
    v_add_f32 v143, v143, v39
    v_add_f32 v144, v144, v40
    v_add_f32 v145, v145, v41
    v_cvt_pk_bf16_f32 v146, v138, v139
    v_cvt_pk_bf16_f32 v147, v140, v141
    v_cvt_pk_bf16_f32 v148, v142, v143
    v_cvt_pk_bf16_f32 v149, v144, v145
    buffer_store_dwordx4 v[146:149], v10, s[4:7], s32 offen sc1
    v_add_u32 v15, s18, v16
    s_add_u32 s18, s18, 8
    s_waitcnt vmcnt(0)
    buffer_store_dword v17, v15, s[4:7], 0 offen sc1
    v_mov_b32 v15, 1073741824
    s_barrier
    s_add_u32 s31, s31, 57344
    s_add_u32 s33, s33, 8
    s_add_u32 s11, s11, 2
    s_cmp_lt_u32 s11, 64
    s_cbranch_scc1 Ploop_304
    s_endpgm
.p2align 6
role_FFN:
    v_and_b32 v1, 63, v0
    v_and_b32 v2, 15, v0
    v_lshrrev_b32 v3, 4, v1
    v_lshlrev_b32 v4, 4, v1
    s_load_dwordx2 s[24:25], s[0:1], 64
    s_mov_b32 s26, 1605632
    s_mov_b32 s27, 0x20000
    s_load_dwordx2 s[28:29], s[0:1], 72
    s_mov_b32 s30, 1605632
    s_mov_b32 s31, 0x20000
    s_mul_i32 s16, s10, 7
    s_and_b32 s20, s10, 1
    s_add_u32 s18, s16, 1
    s_lshr_b32 s18, s18, 1
    s_lshr_b32 s19, s10, 1
    s_mul_i32 s19, s19, 7
    s_add_u32 s19, s19, 3
    s_cmp_eq_u32 s8, 0
    s_cbranch_scc1 l0_311
    v_lshlrev_b32 v248, 7, v0
    s_mov_b32 s33, 176132
ww_312:
    buffer_load_dword v249, v248, s[4:7], s33 offen sc1
    s_waitcnt vmcnt(0)
    v_cmp_eq_u32 vcc, 0, v249
    s_cbranch_vccz wwok_313
    s_sleep 4
    s_sub_u32 s13, s13, 1
    s_cbranch_scc0 ww_312
    s_mov_b32 s13, 0
wwok_313:
    s_barrier
    v_mov_b32 v248, 0
    s_mov_b32 s32, 66048
ww_314:
    buffer_load_dword v249, v248, s[4:7], s32 offen sc1
    s_waitcnt vmcnt(0)
    v_cmp_eq_u32 vcc, 0, v249
    s_cbranch_vccz wwok_315
    s_sleep 8
    s_sub_u32 s13, s13, 1
    s_cbranch_scc0 ww_314
    s_mov_b32 s13, 0
wwok_315:
l0_311:
    v_lshrrev_b32 v115, 5, v1
    v_mul_u32_u24 v115, 3584, v115
    v_and_b32 v121, 31, v1
    v_lshl_add_u32 v115, v121, 4, v115
    v_lshrrev_b32 v120, 2, v2
    v_lshrrev_b32 v121, 1, v3
    v_lshl_add_u32 v120, v121, 3, v120
    v_and_b32 v119, 1, v3
    v_lshlrev_b32 v119, 5, v119
    v_and_b32 v121, 1, v2
    v_lshl_add_u32 v119, v121, 4, v119
    v_bfe_u32 v121, v2, 1, 1
    v_lshl_add_u32 v119, v121, 3, v119
    v_lshrrev_b32 v116, 1, v120
    v_mul_u32_u24 v116, 1056, v116
    v_and_b32 v121, 1, v120
    v_lshl_add_u32 v116, v121, 9, v116
    v_add_u32 v116, v116, v119
    v_lshl_add_u32 v116, s10, 7, v116
    v_mul_u32_u24 v117, 896, v120
    v_add_u32 v117, v117, v119
    s_lshl_b32 s16, s18, 6
    v_add_u32 v117, s16, v117
    v_lshrrev_b32 v120, 2, v2
    v_lshl_add_u32 v120, v3, 3, v120
    v_mul_u32_u24 v118, 896, v120
    v_and_b32 v121, 3, v2
    v_lshl_add_u32 v118, v121, 3, v118
    s_lshl_b32 s16, s19, 6
    s_lshl_b32 s17, s20, 5
    s_add_u32 s16, s16, s17
    v_add_u32 v118, s16, v118
    s_lshl_b32 s21, s9, 9
    s_mul_i32 s16, s10, 57344
    s_add_u32 s21, s21, s16
    s_mul_i32 s33, s10, 8448
    s_mul_i32 s34, s10, 7168
    s_mul_i32 s32, s9, 229376
    s_add_u32 s32, s32, s34
    s_waitcnt lgkmcnt(0)
    s_add_u32 m0, s33, 0
    s_nop 0
    buffer_load_dwordx4 v115, s[24:27], s21 offen lds
    s_add_u32 s21, s21, 7168
    s_add_u32 m0, s33, 1056
    s_nop 0
    buffer_load_dwordx4 v115, s[24:27], s21 offen lds
    s_add_u32 s21, s21, 7168
    s_add_u32 m0, s33, 2112
    s_nop 0
    buffer_load_dwordx4 v115, s[24:27], s21 offen lds
    s_add_u32 s21, s21, 7168
    s_add_u32 m0, s33, 3168
    s_nop 0
    buffer_load_dwordx4 v115, s[24:27], s21 offen lds
    s_add_u32 s21, s21, 7168
    s_add_u32 m0, s33, 4224
    s_nop 0
    buffer_load_dwordx4 v115, s[24:27], s21 offen lds
    s_add_u32 s21, s21, 7168
    s_add_u32 m0, s33, 5280
    s_nop 0
    buffer_load_dwordx4 v115, s[24:27], s21 offen lds
    s_add_u32 s21, s21, 7168
    s_add_u32 m0, s33, 6336
    s_nop 0
    buffer_load_dwordx4 v115, s[24:27], s21 offen lds
    s_add_u32 s21, s21, 7168
    s_add_u32 m0, s33, 7392
    s_nop 0
    buffer_load_dwordx4 v115, s[24:27], s21 offen lds
    s_add_u32 s21, s21, 7168
    s_add_u32 s21, s21, 172032
    s_add_u32 m0, s33, 33792
    s_nop 0
    buffer_load_dwordx4 v115, s[24:27], s21 offen lds
    s_add_u32 s21, s21, 7168
    s_add_u32 m0, s33, 34848
    s_nop 0
    buffer_load_dwordx4 v115, s[24:27], s21 offen lds
    s_add_u32 s21, s21, 7168
    s_add_u32 m0, s33, 35904
    s_nop 0
    buffer_load_dwordx4 v115, s[24:27], s21 offen lds
    s_add_u32 s21, s21, 7168
    s_add_u32 m0, s33, 36960
    s_nop 0
    buffer_load_dwordx4 v115, s[24:27], s21 offen lds
    s_add_u32 s21, s21, 7168
    s_add_u32 m0, s33, 38016
    s_nop 0
    buffer_load_dwordx4 v115, s[24:27], s21 offen lds
    s_add_u32 s21, s21, 7168
    s_add_u32 m0, s33, 39072
    s_nop 0
    buffer_load_dwordx4 v115, s[24:27], s21 offen lds
    s_add_u32 s21, s21, 7168
    s_add_u32 m0, s33, 40128
    s_nop 0
    buffer_load_dwordx4 v115, s[24:27], s21 offen lds
    s_add_u32 s21, s21, 7168
    s_add_u32 m0, s33, 41184
    s_nop 0
    buffer_load_dwordx4 v115, s[24:27], s21 offen lds
    s_add_u32 s21, s21, 7168
    s_add_u32 s21, s21, 172032
    s_add_u32 m0, s33, 67584
    s_nop 0
    buffer_load_dwordx4 v115, s[24:27], s21 offen lds
    s_add_u32 s21, s21, 7168
    s_add_u32 m0, s33, 68640
    s_nop 0
    buffer_load_dwordx4 v115, s[24:27], s21 offen lds
    s_add_u32 s21, s21, 7168
    s_add_u32 m0, s33, 69696
    s_nop 0
    buffer_load_dwordx4 v115, s[24:27], s21 offen lds
    s_add_u32 s21, s21, 7168
    s_add_u32 m0, s33, 70752
    s_nop 0
    buffer_load_dwordx4 v115, s[24:27], s21 offen lds
    s_add_u32 s21, s21, 7168
    s_add_u32 m0, s33, 71808
    s_nop 0
    buffer_load_dwordx4 v115, s[24:27], s21 offen lds
    s_add_u32 s21, s21, 7168
    s_add_u32 m0, s33, 72864
    s_nop 0
    buffer_load_dwordx4 v115, s[24:27], s21 offen lds
    s_add_u32 s21, s21, 7168
    s_add_u32 m0, s33, 73920
    s_nop 0
    buffer_load_dwordx4 v115, s[24:27], s21 offen lds
    s_add_u32 s21, s21, 7168
    s_add_u32 m0, s33, 74976
    s_nop 0
    buffer_load_dwordx4 v115, s[24:27], s21 offen lds
    s_add_u32 s21, s21, 7168
    s_add_u32 s21, s21, 172032
    s_waitcnt vmcnt(16) lgkmcnt(0)
    s_barrier
    s_add_u32 m0, s33, 101376
    s_nop 0
    buffer_load_dwordx4 v115, s[24:27], s21 offen lds
    s_add_u32 s21, s21, 7168
    s_add_u32 m0, s33, 102432
    s_nop 0
    buffer_load_dwordx4 v115, s[24:27], s21 offen lds
    s_add_u32 s21, s21, 7168
    s_add_u32 m0, s33, 103488
    s_nop 0
    buffer_load_dwordx4 v115, s[24:27], s21 offen lds
    s_add_u32 s21, s21, 7168
    s_add_u32 m0, s33, 104544
    s_nop 0
    buffer_load_dwordx4 v115, s[24:27], s21 offen lds
    s_add_u32 s21, s21, 7168
    s_add_u32 m0, s33, 105600
    s_nop 0
    buffer_load_dwordx4 v115, s[24:27], s21 offen lds
    s_add_u32 s21, s21, 7168
    s_add_u32 m0, s33, 106656
    s_nop 0
    buffer_load_dwordx4 v115, s[24:27], s21 offen lds
    s_add_u32 s21, s21, 7168
    s_add_u32 m0, s33, 107712
    s_nop 0
    buffer_load_dwordx4 v115, s[24:27], s21 offen lds
    s_add_u32 s21, s21, 7168
    s_add_u32 m0, s33, 108768
    s_nop 0
    buffer_load_dwordx4 v115, s[24:27], s21 offen lds
    s_add_u32 s21, s21, 7168
    s_add_u32 s21, s21, 172032
    v_add_u32 v119, 0, v116
    ds_read_b64_tr_b16 a[0:1], v119 offset:0
    ds_read_b64_tr_b16 a[2:3], v119 offset:2112
    ds_read_b64_tr_b16 a[112:113], v119 offset:64
    ds_read_b64_tr_b16 a[114:115], v119 offset:2176
    ds_read_b64_tr_b16 a[4:5], v119 offset:8448
    ds_read_b64_tr_b16 a[6:7], v119 offset:10560
    ds_read_b64_tr_b16 a[116:117], v119 offset:8512
    ds_read_b64_tr_b16 a[118:119], v119 offset:10624
    ds_read_b64_tr_b16 a[8:9], v119 offset:16896
    ds_read_b64_tr_b16 a[10:11], v119 offset:19008
    ds_read_b64_tr_b16 a[120:121], v119 offset:16960
    ds_read_b64_tr_b16 a[122:123], v119 offset:19072
    ds_read_b64_tr_b16 a[12:13], v119 offset:25344
    ds_read_b64_tr_b16 a[14:15], v119 offset:27456
    ds_read_b64_tr_b16 a[124:125], v119 offset:25408
    ds_read_b64_tr_b16 a[126:127], v119 offset:27520
    s_waitcnt vmcnt(16) lgkmcnt(0)
    s_barrier
    s_add_u32 m0, s33, 0
    s_nop 0
    buffer_load_dwordx4 v115, s[24:27], s21 offen lds
    s_add_u32 s21, s21, 7168
    s_add_u32 m0, s33, 1056
    s_nop 0
    buffer_load_dwordx4 v115, s[24:27], s21 offen lds
    s_add_u32 s21, s21, 7168
    s_add_u32 m0, s33, 2112
    s_nop 0
    buffer_load_dwordx4 v115, s[24:27], s21 offen lds
    s_add_u32 s21, s21, 7168
    s_add_u32 m0, s33, 3168
    s_nop 0
    buffer_load_dwordx4 v115, s[24:27], s21 offen lds
    s_add_u32 s21, s21, 7168
    s_add_u32 m0, s33, 4224
    s_nop 0
    buffer_load_dwordx4 v115, s[24:27], s21 offen lds
    s_add_u32 s21, s21, 7168
    s_add_u32 m0, s33, 5280
    s_nop 0
    buffer_load_dwordx4 v115, s[24:27], s21 offen lds
    s_add_u32 s21, s21, 7168
    s_add_u32 m0, s33, 6336
    s_nop 0
    buffer_load_dwordx4 v115, s[24:27], s21 offen lds
    s_add_u32 s21, s21, 7168
    s_add_u32 m0, s33, 7392
    s_nop 0
    buffer_load_dwordx4 v115, s[24:27], s21 offen lds
    s_add_u32 s21, s21, 7168
    s_add_u32 s21, s21, 172032
    v_add_u32 v119, 33792, v116
    ds_read_b64_tr_b16 a[16:17], v119 offset:0
    ds_read_b64_tr_b16 a[18:19], v119 offset:2112
    ds_read_b64_tr_b16 a[128:129], v119 offset:64
    ds_read_b64_tr_b16 a[130:131], v119 offset:2176
    ds_read_b64_tr_b16 a[20:21], v119 offset:8448
    ds_read_b64_tr_b16 a[22:23], v119 offset:10560
    ds_read_b64_tr_b16 a[132:133], v119 offset:8512
    ds_read_b64_tr_b16 a[134:135], v119 offset:10624
    ds_read_b64_tr_b16 a[24:25], v119 offset:16896
    ds_read_b64_tr_b16 a[26:27], v119 offset:19008
    ds_read_b64_tr_b16 a[136:137], v119 offset:16960
    ds_read_b64_tr_b16 a[138:139], v119 offset:19072
    ds_read_b64_tr_b16 a[28:29], v119 offset:25344
    ds_read_b64_tr_b16 a[30:31], v119 offset:27456
    ds_read_b64_tr_b16 a[140:141], v119 offset:25408
    ds_read_b64_tr_b16 a[142:143], v119 offset:27520
    s_waitcnt vmcnt(16) lgkmcnt(0)
    s_barrier
    s_add_u32 m0, s33, 33792
    s_nop 0
    buffer_load_dwordx4 v115, s[24:27], s21 offen lds
    s_add_u32 s21, s21, 7168
    s_add_u32 m0, s33, 34848
    s_nop 0
    buffer_load_dwordx4 v115, s[24:27], s21 offen lds
    s_add_u32 s21, s21, 7168
    s_add_u32 m0, s33, 35904
    s_nop 0
    buffer_load_dwordx4 v115, s[24:27], s21 offen lds
    s_add_u32 s21, s21, 7168
    s_add_u32 m0, s33, 36960
    s_nop 0
    buffer_load_dwordx4 v115, s[24:27], s21 offen lds
    s_add_u32 s21, s21, 7168
    s_add_u32 m0, s33, 38016
    s_nop 0
    buffer_load_dwordx4 v115, s[24:27], s21 offen lds
    s_add_u32 s21, s21, 7168
    s_add_u32 m0, s33, 39072
    s_nop 0
    buffer_load_dwordx4 v115, s[24:27], s21 offen lds
    s_add_u32 s21, s21, 7168
    s_add_u32 m0, s33, 40128
    s_nop 0
    buffer_load_dwordx4 v115, s[24:27], s21 offen lds
    s_add_u32 s21, s21, 7168
    s_add_u32 m0, s33, 41184
    s_nop 0
    buffer_load_dwordx4 v115, s[24:27], s21 offen lds
    s_add_u32 s21, s21, 7168
    s_add_u32 s21, s21, 172032
    v_add_u32 v119, 67584, v116
    ds_read_b64_tr_b16 a[32:33], v119 offset:0
    ds_read_b64_tr_b16 a[34:35], v119 offset:2112
    ds_read_b64_tr_b16 a[144:145], v119 offset:64
    ds_read_b64_tr_b16 a[146:147], v119 offset:2176
    ds_read_b64_tr_b16 a[36:37], v119 offset:8448
    ds_read_b64_tr_b16 a[38:39], v119 offset:10560
    ds_read_b64_tr_b16 a[148:149], v119 offset:8512
    ds_read_b64_tr_b16 a[150:151], v119 offset:10624
    ds_read_b64_tr_b16 a[40:41], v119 offset:16896
    ds_read_b64_tr_b16 a[42:43], v119 offset:19008
    ds_read_b64_tr_b16 a[152:153], v119 offset:16960
    ds_read_b64_tr_b16 a[154:155], v119 offset:19072
    ds_read_b64_tr_b16 a[44:45], v119 offset:25344
    ds_read_b64_tr_b16 a[46:47], v119 offset:27456
    ds_read_b64_tr_b16 a[156:157], v119 offset:25408
    ds_read_b64_tr_b16 a[158:159], v119 offset:27520
    s_waitcnt vmcnt(16) lgkmcnt(0)
    s_barrier
    s_add_u32 m0, s33, 67584
    s_nop 0
    buffer_load_dwordx4 v115, s[24:27], s21 offen lds
    s_add_u32 s21, s21, 7168
    s_add_u32 m0, s33, 68640
    s_nop 0
    buffer_load_dwordx4 v115, s[24:27], s21 offen lds
    s_add_u32 s21, s21, 7168
    s_add_u32 m0, s33, 69696
    s_nop 0
    buffer_load_dwordx4 v115, s[24:27], s21 offen lds
    s_add_u32 s21, s21, 7168
    s_add_u32 m0, s33, 70752
    s_nop 0
    buffer_load_dwordx4 v115, s[24:27], s21 offen lds
    s_add_u32 s21, s21, 7168
    s_add_u32 m0, s33, 71808
    s_nop 0
    buffer_load_dwordx4 v115, s[24:27], s21 offen lds
    s_add_u32 s21, s21, 7168
    s_add_u32 m0, s33, 72864
    s_nop 0
    buffer_load_dwordx4 v115, s[24:27], s21 offen lds
    s_add_u32 s21, s21, 7168
    s_add_u32 m0, s33, 73920
    s_nop 0
    buffer_load_dwordx4 v115, s[24:27], s21 offen lds
    s_add_u32 s21, s21, 7168
    s_add_u32 m0, s33, 74976
    s_nop 0
    buffer_load_dwordx4 v115, s[24:27], s21 offen lds
    s_add_u32 s21, s21, 7168
    s_add_u32 s21, s21, 172032
    v_add_u32 v119, 101376, v116
    ds_read_b64_tr_b16 a[48:49], v119 offset:0
    ds_read_b64_tr_b16 a[50:51], v119 offset:2112
    ds_read_b64_tr_b16 a[160:161], v119 offset:64
    ds_read_b64_tr_b16 a[162:163], v119 offset:2176
    ds_read_b64_tr_b16 a[52:53], v119 offset:8448
    ds_read_b64_tr_b16 a[54:55], v119 offset:10560
    ds_read_b64_tr_b16 a[164:165], v119 offset:8512
    ds_read_b64_tr_b16 a[166:167], v119 offset:10624
    ds_read_b64_tr_b16 a[56:57], v119 offset:16896
    ds_read_b64_tr_b16 a[58:59], v119 offset:19008
    ds_read_b64_tr_b16 a[168:169], v119 offset:16960
    ds_read_b64_tr_b16 a[170:171], v119 offset:19072
    ds_read_b64_tr_b16 a[60:61], v119 offset:25344
    ds_read_b64_tr_b16 a[62:63], v119 offset:27456
    ds_read_b64_tr_b16 a[172:173], v119 offset:25408
    ds_read_b64_tr_b16 a[174:175], v119 offset:27520
    s_waitcnt vmcnt(16) lgkmcnt(0)
    s_barrier
    s_add_u32 m0, s34, 101376
    s_nop 0
    buffer_load_dwordx4 v4, s[28:31], s32 offen lds
    buffer_load_dwordx4 v4, s[28:31], s32 offen offset:1024 lds
    buffer_load_dwordx4 v4, s[28:31], s32 offen offset:2048 lds
    buffer_load_dwordx4 v4, s[28:31], s32 offen offset:3072 lds
    s_add_u32 s32, s32, 4096
    s_add_u32 m0, s34, 105472
    s_nop 0
    buffer_load_dwordx4 v4, s[28:31], s32 offen lds
    buffer_load_dwordx4 v4, s[28:31], s32 offen offset:1024 lds
    buffer_load_dwordx4 v4, s[28:31], s32 offen offset:2048 lds
    s_add_u32 s32, s32, 24576
    v_add_u32 v119, 0, v116
    ds_read_b64_tr_b16 a[64:65], v119 offset:0
    ds_read_b64_tr_b16 a[66:67], v119 offset:2112
    ds_read_b64_tr_b16 a[176:177], v119 offset:64
    ds_read_b64_tr_b16 a[178:179], v119 offset:2176
    ds_read_b64_tr_b16 a[68:69], v119 offset:8448
    ds_read_b64_tr_b16 a[70:71], v119 offset:10560
    ds_read_b64_tr_b16 a[180:181], v119 offset:8512
    ds_read_b64_tr_b16 a[182:183], v119 offset:10624
    ds_read_b64_tr_b16 a[72:73], v119 offset:16896
    ds_read_b64_tr_b16 a[74:75], v119 offset:19008
    ds_read_b64_tr_b16 a[184:185], v119 offset:16960
    ds_read_b64_tr_b16 a[186:187], v119 offset:19072
    ds_read_b64_tr_b16 a[76:77], v119 offset:25344
    ds_read_b64_tr_b16 a[78:79], v119 offset:27456
    ds_read_b64_tr_b16 a[188:189], v119 offset:25408
    ds_read_b64_tr_b16 a[190:191], v119 offset:27520
    s_waitcnt vmcnt(15) lgkmcnt(0)
    s_barrier
    s_add_u32 m0, s34, 0
    s_nop 0
    buffer_load_dwordx4 v4, s[28:31], s32 offen lds
    buffer_load_dwordx4 v4, s[28:31], s32 offen offset:1024 lds
    buffer_load_dwordx4 v4, s[28:31], s32 offen offset:2048 lds
    buffer_load_dwordx4 v4, s[28:31], s32 offen offset:3072 lds
    s_add_u32 s32, s32, 4096
    s_add_u32 m0, s34, 4096
    s_nop 0
    buffer_load_dwordx4 v4, s[28:31], s32 offen lds
    buffer_load_dwordx4 v4, s[28:31], s32 offen offset:1024 lds
    buffer_load_dwordx4 v4, s[28:31], s32 offen offset:2048 lds
    s_add_u32 s32, s32, 24576
    v_add_u32 v119, 33792, v116
    ds_read_b64_tr_b16 a[80:81], v119 offset:0
    ds_read_b64_tr_b16 a[82:83], v119 offset:2112
    ds_read_b64_tr_b16 a[192:193], v119 offset:64
    ds_read_b64_tr_b16 a[194:195], v119 offset:2176
    ds_read_b64_tr_b16 a[84:85], v119 offset:8448
    ds_read_b64_tr_b16 a[86:87], v119 offset:10560
    ds_read_b64_tr_b16 a[196:197], v119 offset:8512
    ds_read_b64_tr_b16 a[198:199], v119 offset:10624
    ds_read_b64_tr_b16 a[88:89], v119 offset:16896
    ds_read_b64_tr_b16 a[90:91], v119 offset:19008
    ds_read_b64_tr_b16 a[200:201], v119 offset:16960
    ds_read_b64_tr_b16 a[202:203], v119 offset:19072
    ds_read_b64_tr_b16 a[92:93], v119 offset:25344
    ds_read_b64_tr_b16 a[94:95], v119 offset:27456
    ds_read_b64_tr_b16 a[204:205], v119 offset:25408
    ds_read_b64_tr_b16 a[206:207], v119 offset:27520
    s_waitcnt vmcnt(14) lgkmcnt(0)
    s_barrier
    s_add_u32 m0, s34, 33792
    s_nop 0
    buffer_load_dwordx4 v4, s[28:31], s32 offen lds
    buffer_load_dwordx4 v4, s[28:31], s32 offen offset:1024 lds
    buffer_load_dwordx4 v4, s[28:31], s32 offen offset:2048 lds
    buffer_load_dwordx4 v4, s[28:31], s32 offen offset:3072 lds
    s_add_u32 s32, s32, 4096
    s_add_u32 m0, s34, 37888
    s_nop 0
    buffer_load_dwordx4 v4, s[28:31], s32 offen lds
    buffer_load_dwordx4 v4, s[28:31], s32 offen offset:1024 lds
    buffer_load_dwordx4 v4, s[28:31], s32 offen offset:2048 lds
    s_add_u32 s32, s32, 24576
    v_add_u32 v119, 67584, v116
    ds_read_b64_tr_b16 a[96:97], v119 offset:0
    ds_read_b64_tr_b16 a[98:99], v119 offset:2112
    ds_read_b64_tr_b16 a[208:209], v119 offset:64
    ds_read_b64_tr_b16 a[210:211], v119 offset:2176
    ds_read_b64_tr_b16 a[100:101], v119 offset:8448
    ds_read_b64_tr_b16 a[102:103], v119 offset:10560
    ds_read_b64_tr_b16 a[212:213], v119 offset:8512
    ds_read_b64_tr_b16 a[214:215], v119 offset:10624
    ds_read_b64_tr_b16 a[104:105], v119 offset:16896
    ds_read_b64_tr_b16 a[106:107], v119 offset:19008
    ds_read_b64_tr_b16 a[216:217], v119 offset:16960
    ds_read_b64_tr_b16 a[218:219], v119 offset:19072
    ds_read_b64_tr_b16 a[108:109], v119 offset:25344
    ds_read_b64_tr_b16 a[110:111], v119 offset:27456
    ds_read_b64_tr_b16 a[220:221], v119 offset:25408
    ds_read_b64_tr_b16 a[222:223], v119 offset:27520
    s_waitcnt vmcnt(14) lgkmcnt(0)
    s_barrier
    s_add_u32 m0, s34, 67584
    s_nop 0
    buffer_load_dwordx4 v4, s[28:31], s32 offen lds
    buffer_load_dwordx4 v4, s[28:31], s32 offen offset:1024 lds
    buffer_load_dwordx4 v4, s[28:31], s32 offen offset:2048 lds
    buffer_load_dwordx4 v4, s[28:31], s32 offen offset:3072 lds
    s_add_u32 s32, s32, 4096
    s_add_u32 m0, s34, 71680
    s_nop 0
    buffer_load_dwordx4 v4, s[28:31], s32 offen lds
    buffer_load_dwordx4 v4, s[28:31], s32 offen offset:1024 lds
    buffer_load_dwordx4 v4, s[28:31], s32 offen offset:2048 lds
    s_add_u32 s32, s32, 24576
    v_add_u32 v119, 101376, v117
    v_add_u32 v120, 101376, v118
    ds_read_b64_tr_b16 a[224:225], v119 offset:0
    ds_read_b64_tr_b16 a[226:227], v119 offset:3584
    ds_read_b64_tr_b16 v[122:123], v119 offset:64
    ds_read_b64_tr_b16 v[124:125], v119 offset:3648
    ds_read_b64_tr_b16 v[46:47], v119 offset:128
    ds_read_b64_tr_b16 v[48:49], v119 offset:3712
    ds_read_b64_tr_b16 v[126:127], v119 offset:14336
    ds_read_b64_tr_b16 v[128:129], v119 offset:17920
    ds_read_b64_tr_b16 v[10:11], v119 offset:14400
    ds_read_b64_tr_b16 v[12:13], v119 offset:17984
    ds_read_b64_tr_b16 v[130:131], v119 offset:14464
    ds_read_b64_tr_b16 v[132:133], v119 offset:18048
    ds_read_b64_tr_b16 v[82:83], v120 offset:0
    ds_read_b64_tr_b16 v[84:85], v120 offset:3584
    s_waitcnt vmcnt(14) lgkmcnt(0)
    s_barrier
    s_add_u32 m0, s34, 101376
    s_nop 0
    buffer_load_dwordx4 v4, s[28:31], s32 offen lds
    buffer_load_dwordx4 v4, s[28:31], s32 offen offset:1024 lds
    buffer_load_dwordx4 v4, s[28:31], s32 offen offset:2048 lds
    buffer_load_dwordx4 v4, s[28:31], s32 offen offset:3072 lds
    s_add_u32 s32, s32, 4096
    s_add_u32 m0, s34, 105472
    s_nop 0
    buffer_load_dwordx4 v4, s[28:31], s32 offen lds
    buffer_load_dwordx4 v4, s[28:31], s32 offen offset:1024 lds
    buffer_load_dwordx4 v4, s[28:31], s32 offen offset:2048 lds
    s_add_u32 s32, s32, 24576
    v_add_u32 v119, 0, v117
    v_add_u32 v120, 0, v118
    ds_read_b64_tr_b16 a[228:229], v119 offset:0
    ds_read_b64_tr_b16 a[230:231], v119 offset:3584
    ds_read_b64_tr_b16 v[134:135], v119 offset:64
    ds_read_b64_tr_b16 v[136:137], v119 offset:3648
    ds_read_b64_tr_b16 v[50:51], v119 offset:128
    ds_read_b64_tr_b16 v[52:53], v119 offset:3712
    ds_read_b64_tr_b16 v[138:139], v119 offset:14336
    ds_read_b64_tr_b16 v[140:141], v119 offset:17920
    ds_read_b64_tr_b16 v[14:15], v119 offset:14400
    ds_read_b64_tr_b16 v[16:17], v119 offset:17984
    ds_read_b64_tr_b16 v[142:143], v119 offset:14464
    ds_read_b64_tr_b16 v[144:145], v119 offset:18048
    ds_read_b64_tr_b16 v[86:87], v120 offset:0
    ds_read_b64_tr_b16 v[88:89], v120 offset:3584
    s_waitcnt vmcnt(14) lgkmcnt(0)
    s_barrier
    s_add_u32 m0, s34, 0
    s_nop 0
    buffer_load_dwordx4 v4, s[28:31], s32 offen lds
    buffer_load_dwordx4 v4, s[28:31], s32 offen offset:1024 lds
    buffer_load_dwordx4 v4, s[28:31], s32 offen offset:2048 lds
    buffer_load_dwordx4 v4, s[28:31], s32 offen offset:3072 lds
    s_add_u32 s32, s32, 4096
    s_add_u32 m0, s34, 4096
    s_nop 0
    buffer_load_dwordx4 v4, s[28:31], s32 offen lds
    buffer_load_dwordx4 v4, s[28:31], s32 offen offset:1024 lds
    buffer_load_dwordx4 v4, s[28:31], s32 offen offset:2048 lds
    s_add_u32 s32, s32, 24576
    v_add_u32 v119, 33792, v117
    v_add_u32 v120, 33792, v118
    ds_read_b64_tr_b16 a[232:233], v119 offset:0
    ds_read_b64_tr_b16 a[234:235], v119 offset:3584
    ds_read_b64_tr_b16 v[146:147], v119 offset:64
    ds_read_b64_tr_b16 v[148:149], v119 offset:3648
    ds_read_b64_tr_b16 v[54:55], v119 offset:128
    ds_read_b64_tr_b16 v[56:57], v119 offset:3712
    ds_read_b64_tr_b16 v[150:151], v119 offset:14336
    ds_read_b64_tr_b16 v[152:153], v119 offset:17920
    ds_read_b64_tr_b16 v[18:19], v119 offset:14400
    ds_read_b64_tr_b16 v[20:21], v119 offset:17984
    ds_read_b64_tr_b16 v[154:155], v119 offset:14464
    ds_read_b64_tr_b16 v[156:157], v119 offset:18048
    ds_read_b64_tr_b16 v[90:91], v120 offset:0
    ds_read_b64_tr_b16 v[92:93], v120 offset:3584
    s_waitcnt vmcnt(14) lgkmcnt(0)
    s_barrier
    s_add_u32 m0, s34, 33792
    s_nop 0
    buffer_load_dwordx4 v4, s[28:31], s32 offen lds
    buffer_load_dwordx4 v4, s[28:31], s32 offen offset:1024 lds
    buffer_load_dwordx4 v4, s[28:31], s32 offen offset:2048 lds
    buffer_load_dwordx4 v4, s[28:31], s32 offen offset:3072 lds
    s_add_u32 s32, s32, 4096
    s_add_u32 m0, s34, 37888
    s_nop 0
    buffer_load_dwordx4 v4, s[28:31], s32 offen lds
    buffer_load_dwordx4 v4, s[28:31], s32 offen offset:1024 lds
    buffer_load_dwordx4 v4, s[28:31], s32 offen offset:2048 lds
    s_add_u32 s32, s32, 24576
    v_add_u32 v119, 67584, v117
    v_add_u32 v120, 67584, v118
    ds_read_b64_tr_b16 a[236:237], v119 offset:0
    ds_read_b64_tr_b16 a[238:239], v119 offset:3584
    ds_read_b64_tr_b16 v[158:159], v119 offset:64
    ds_read_b64_tr_b16 v[160:161], v119 offset:3648
    ds_read_b64_tr_b16 v[58:59], v119 offset:128
    ds_read_b64_tr_b16 v[60:61], v119 offset:3712
    ds_read_b64_tr_b16 v[162:163], v119 offset:14336
    ds_read_b64_tr_b16 v[164:165], v119 offset:17920
    ds_read_b64_tr_b16 v[22:23], v119 offset:14400
    ds_read_b64_tr_b16 v[24:25], v119 offset:17984
    ds_read_b64_tr_b16 v[166:167], v119 offset:14464
    ds_read_b64_tr_b16 v[168:169], v119 offset:18048
    ds_read_b64_tr_b16 v[94:95], v120 offset:0
    ds_read_b64_tr_b16 v[96:97], v120 offset:3584
    s_waitcnt vmcnt(14) lgkmcnt(0)
    s_barrier
    s_add_u32 m0, s34, 67584
    s_nop 0
    buffer_load_dwordx4 v4, s[28:31], s32 offen lds
    buffer_load_dwordx4 v4, s[28:31], s32 offen offset:1024 lds
    buffer_load_dwordx4 v4, s[28:31], s32 offen offset:2048 lds
    buffer_load_dwordx4 v4, s[28:31], s32 offen offset:3072 lds
    s_add_u32 s32, s32, 4096
    s_add_u32 m0, s34, 71680
    s_nop 0
    buffer_load_dwordx4 v4, s[28:31], s32 offen lds
    buffer_load_dwordx4 v4, s[28:31], s32 offen offset:1024 lds
    buffer_load_dwordx4 v4, s[28:31], s32 offen offset:2048 lds
    s_add_u32 s32, s32, 24576
    v_add_u32 v119, 101376, v117
    v_add_u32 v120, 101376, v118
    ds_read_b64_tr_b16 a[240:241], v119 offset:0
    ds_read_b64_tr_b16 a[242:243], v119 offset:3584
    ds_read_b64_tr_b16 v[170:171], v119 offset:64
    ds_read_b64_tr_b16 v[172:173], v119 offset:3648
    ds_read_b64_tr_b16 v[62:63], v119 offset:128
    ds_read_b64_tr_b16 v[64:65], v119 offset:3712
    ds_read_b64_tr_b16 v[174:175], v119 offset:14336
    ds_read_b64_tr_b16 v[176:177], v119 offset:17920
    ds_read_b64_tr_b16 v[26:27], v119 offset:14400
    ds_read_b64_tr_b16 v[28:29], v119 offset:17984
    ds_read_b64_tr_b16 v[178:179], v119 offset:14464
    ds_read_b64_tr_b16 v[180:181], v119 offset:18048
    ds_read_b64_tr_b16 v[98:99], v120 offset:0
    ds_read_b64_tr_b16 v[100:101], v120 offset:3584
    s_waitcnt vmcnt(14) lgkmcnt(0)
    s_barrier
    v_add_u32 v119, 0, v117
    v_add_u32 v120, 0, v118
    ds_read_b64_tr_b16 a[244:245], v119 offset:0
    ds_read_b64_tr_b16 a[246:247], v119 offset:3584
    ds_read_b64_tr_b16 v[182:183], v119 offset:64
    ds_read_b64_tr_b16 v[184:185], v119 offset:3648
    ds_read_b64_tr_b16 v[66:67], v119 offset:128
    ds_read_b64_tr_b16 v[68:69], v119 offset:3712
    ds_read_b64_tr_b16 v[186:187], v119 offset:14336
    ds_read_b64_tr_b16 v[188:189], v119 offset:17920
    ds_read_b64_tr_b16 v[30:31], v119 offset:14400
    ds_read_b64_tr_b16 v[32:33], v119 offset:17984
    ds_read_b64_tr_b16 v[190:191], v119 offset:14464
    ds_read_b64_tr_b16 v[192:193], v119 offset:18048
    ds_read_b64_tr_b16 v[102:103], v120 offset:0
    ds_read_b64_tr_b16 v[104:105], v120 offset:3584
    s_waitcnt vmcnt(7) lgkmcnt(0)
    s_barrier
    v_add_u32 v119, 33792, v117
    v_add_u32 v120, 33792, v118
    ds_read_b64_tr_b16 a[248:249], v119 offset:0
    ds_read_b64_tr_b16 a[250:251], v119 offset:3584
    ds_read_b64_tr_b16 v[194:195], v119 offset:64
    ds_read_b64_tr_b16 v[196:197], v119 offset:3648
    ds_read_b64_tr_b16 v[70:71], v119 offset:128
    ds_read_b64_tr_b16 v[72:73], v119 offset:3712
    ds_read_b64_tr_b16 v[198:199], v119 offset:14336
    ds_read_b64_tr_b16 v[200:201], v119 offset:17920
    ds_read_b64_tr_b16 v[34:35], v119 offset:14400
    ds_read_b64_tr_b16 v[36:37], v119 offset:17984
    ds_read_b64_tr_b16 v[202:203], v119 offset:14464
    ds_read_b64_tr_b16 v[204:205], v119 offset:18048
    ds_read_b64_tr_b16 v[106:107], v120 offset:0
    ds_read_b64_tr_b16 v[108:109], v120 offset:3584
    s_waitcnt vmcnt(0) lgkmcnt(0)
    s_barrier
    v_add_u32 v119, 67584, v117
    v_add_u32 v120, 67584, v118
    ds_read_b64_tr_b16 a[252:253], v119 offset:0
    ds_read_b64_tr_b16 a[254:255], v119 offset:3584
    ds_read_b64_tr_b16 v[38:39], v119 offset:64
    ds_read_b64_tr_b16 v[40:41], v119 offset:3648
    ds_read_b64_tr_b16 v[74:75], v119 offset:128
    ds_read_b64_tr_b16 v[76:77], v119 offset:3712
    ds_read_b64_tr_b16 v[6:7], v119 offset:14336
    ds_read_b64_tr_b16 v[8:9], v119 offset:17920
    ds_read_b64_tr_b16 v[42:43], v119 offset:14400
    ds_read_b64_tr_b16 v[44:45], v119 offset:17984
    ds_read_b64_tr_b16 v[78:79], v119 offset:14464
    ds_read_b64_tr_b16 v[80:81], v119 offset:18048
    ds_read_b64_tr_b16 v[110:111], v120 offset:0
    ds_read_b64_tr_b16 v[112:113], v120 offset:3584
    s_waitcnt lgkmcnt(0)
    s_barrier
    s_mul_i32 s16, s10, 21504
    s_add_u32 s16, s16, 49152
    v_add_u32 v114, s16, v4
    ds_write_b128 v114, v[122:125] offset:0
    ds_write_b128 v114, v[126:129] offset:1024
    ds_write_b128 v114, v[130:133] offset:2048
    ds_write_b128 v114, v[134:137] offset:3072
    ds_write_b128 v114, v[138:141] offset:4096
    ds_write_b128 v114, v[142:145] offset:5120
    ds_write_b128 v114, v[146:149] offset:6144
    ds_write_b128 v114, v[150:153] offset:7168
    ds_write_b128 v114, v[154:157] offset:8192
    ds_write_b128 v114, v[158:161] offset:9216
    ds_write_b128 v114, v[162:165] offset:10240
    ds_write_b128 v114, v[166:169] offset:11264
    ds_write_b128 v114, v[170:173] offset:12288
    ds_write_b128 v114, v[174:177] offset:13312
    ds_write_b128 v114, v[178:181] offset:14336
    ds_write_b128 v114, v[182:185] offset:15360
    ds_write_b128 v114, v[186:189] offset:16384
    ds_write_b128 v114, v[190:193] offset:17408
    ds_write_b128 v114, v[194:197] offset:18432
    ds_write_b128 v114, v[198:201] offset:19456
    ds_write_b128 v114, v[202:205] offset:20480
    v_min_u32 v115, 27, v1
    v_lshlrev_b32 v115, 8, v115
    s_mul_i32 s35, s8, 229376
    s_add_u32 s35, s35, 21704704
    s_mul_i32 s38, s10, 7168
    s_add_u32 s35, s35, s38
    s_mov_b32 s41, s35
    s_mul_i32 s39, s11, 28672
    s_add_u32 s35, s35, s39
    s_add_u32 s38, s38, 0
    s_mul_i32 s37, s8, 69632
    s_add_u32 s37, s37, 51200
    s_lshl_b32 s39, s11, 2
    s_add_u32 s37, s37, s39
    s_mov_b32 s40, s11
    s_mov_b32 s39, 1
    v_add_u32 v118, 0, v4
    s_lshl_b32 s16, s9, 2
    s_add_u32 s16, s16, s10
    s_mul_i32 s42, s8, 69632
    s_add_u32 s42, s42, 58368
    s_lshl_b32 s43, s16, 8
    s_add_u32 s42, s42, s43
    s_lshl_b32 s43, s11, 2
    s_add_u32 s42, s42, s43
    v_mov_b32 v128, 1073741824
    v_cmp_eq_u32 vcc, 0, v1
    s_nop 1
    v_cndmask_b32 v129, v128, 0, vcc
    v_mov_b32 v130, 1
    s_lshl_b32 s16, s10, 12
    s_add_u32 s16, s16, 28672
    v_add_u32 v119, s16, v4
    v_lshrrev_b32 v242, 1, v3
    v_lshlrev_b32 v120, 10, v242
    v_and_b32 v243, 1, v3
    v_lshl_add_u32 v120, v243, 9, v120
    v_lshl_add_u32 v120, v2, 4, v120
    v_add_u32 v120, 28672, v120
    v_mul_u32_u24 v124, 14336, v243
    v_lshl_add_u32 v124, v242, 8, v124
    v_lshl_add_u32 v124, v2, 4, v124
    s_lshl_b32 s16, s18, 10
    v_add_u32 v125, s16, v124
    s_lshl_b32 s16, s19, 10
    s_lshl_b32 s17, s20, 9
    s_add_u32 s16, s16, s17
    v_add_u32 v126, s16, v124
    s_lshl_b32 s16, s10, 8
    s_add_u32 s16, s16, 47104
    v_lshl_add_u32 v127, v242, 6, s16
    v_lshlrev_b32 v122, 4, v2
    v_add_u32 v122, 45056, v122
    v_lshl_add_u32 v121, s10, 8, v122
    v_lshl_add_u32 v122, v243, 9, v122
    v_lshrrev_b32 v242, 2, v2
    v_mov_b32 v243, 46080
    v_cmp_eq_u32 vcc, v242, v3
    s_nop 1
    v_cndmask_b32 v121, v243, v121, vcc
    v_and_b32 v242, 3, v2
    v_cmp_eq_u32 s[44:45], 1, v242
    v_cmp_eq_u32 s[46:47], 2, v242
    v_cmp_eq_u32 s[48:49], 3, v242
    s_mul_i32 s16, s10, 7168
    v_add_u32 v123, s16, v118
    s_mul_i32 s52, s8, 1605632
    s_add_u32 s52, s52, 41168896
    s_mul_i32 s16, s9, 28672
    s_add_u32 s52, s52, s16
    s_mov_b32 s51, 0xbfb8aa3b
    v_mov_b32 v204, 0x3f803f80
    v_mov_b32 v205, 0x3f803f80
    v_mov_b32 v206, 0x3f803f80
    v_mov_b32 v207, 0x3f803f80
    s_nop 1
    v_mfma_f32_32x32x16_bf16 v[132:147], a[0:3], v[204:207], 0
    v_mfma_f32_32x32x16_bf16 v[148:163], a[112:115], v[204:207], 0
    v_mfma_f32_32x32x16_bf16 v[132:147], a[4:7], v[204:207], v[132:147]
    v_mfma_f32_32x32x16_bf16 v[148:163], a[116:119], v[204:207], v[148:163]
    v_mfma_f32_32x32x16_bf16 v[132:147], a[8:11], v[204:207], v[132:147]
    v_mfma_f32_32x32x16_bf16 v[148:163], a[120:123], v[204:207], v[148:163]
    v_mfma_f32_32x32x16_bf16 v[132:147], a[12:15], v[204:207], v[132:147]
    v_mfma_f32_32x32x16_bf16 v[148:163], a[124:127], v[204:207], v[148:163]
    v_mfma_f32_32x32x16_bf16 v[132:147], a[16:19], v[204:207], v[132:147]
    v_mfma_f32_32x32x16_bf16 v[148:163], a[128:131], v[204:207], v[148:163]
    v_mfma_f32_32x32x16_bf16 v[132:147], a[20:23], v[204:207], v[132:147]
    v_mfma_f32_32x32x16_bf16 v[148:163], a[132:135], v[204:207], v[148:163]
    v_mfma_f32_32x32x16_bf16 v[132:147], a[24:27], v[204:207], v[132:147]
    v_mfma_f32_32x32x16_bf16 v[148:163], a[136:139], v[204:207], v[148:163]
    v_mfma_f32_32x32x16_bf16 v[132:147], a[28:31], v[204:207], v[132:147]
    v_mfma_f32_32x32x16_bf16 v[148:163], a[140:143], v[204:207], v[148:163]
    v_mfma_f32_32x32x16_bf16 v[132:147], a[32:35], v[204:207], v[132:147]
    v_mfma_f32_32x32x16_bf16 v[148:163], a[144:147], v[204:207], v[148:163]
    v_mfma_f32_32x32x16_bf16 v[132:147], a[36:39], v[204:207], v[132:147]
    v_mfma_f32_32x32x16_bf16 v[148:163], a[148:151], v[204:207], v[148:163]
    v_mfma_f32_32x32x16_bf16 v[132:147], a[40:43], v[204:207], v[132:147]
    v_mfma_f32_32x32x16_bf16 v[148:163], a[152:155], v[204:207], v[148:163]
    v_mfma_f32_32x32x16_bf16 v[132:147], a[44:47], v[204:207], v[132:147]
    v_mfma_f32_32x32x16_bf16 v[148:163], a[156:159], v[204:207], v[148:163]
    v_mfma_f32_32x32x16_bf16 v[132:147], a[48:51], v[204:207], v[132:147]
    v_mfma_f32_32x32x16_bf16 v[148:163], a[160:163], v[204:207], v[148:163]
    v_mfma_f32_32x32x16_bf16 v[132:147], a[52:55], v[204:207], v[132:147]
    v_mfma_f32_32x32x16_bf16 v[148:163], a[164:167], v[204:207], v[148:163]
    v_mfma_f32_32x32x16_bf16 v[132:147], a[56:59], v[204:207], v[132:147]
    v_mfma_f32_32x32x16_bf16 v[148:163], a[168:171], v[204:207], v[148:163]
    v_mfma_f32_32x32x16_bf16 v[132:147], a[60:63], v[204:207], v[132:147]
    v_mfma_f32_32x32x16_bf16 v[148:163], a[172:175], v[204:207], v[148:163]
    v_mfma_f32_32x32x16_bf16 v[132:147], a[64:67], v[204:207], v[132:147]
    v_mfma_f32_32x32x16_bf16 v[148:163], a[176:179], v[204:207], v[148:163]
    v_mfma_f32_32x32x16_bf16 v[132:147], a[68:71], v[204:207], v[132:147]
    v_mfma_f32_32x32x16_bf16 v[148:163], a[180:183], v[204:207], v[148:163]
    v_mfma_f32_32x32x16_bf16 v[132:147], a[72:75], v[204:207], v[132:147]
    v_mfma_f32_32x32x16_bf16 v[148:163], a[184:187], v[204:207], v[148:163]
    v_mfma_f32_32x32x16_bf16 v[132:147], a[76:79], v[204:207], v[132:147]
    v_mfma_f32_32x32x16_bf16 v[148:163], a[188:191], v[204:207], v[148:163]
    v_mfma_f32_32x32x16_bf16 v[132:147], a[80:83], v[204:207], v[132:147]
    v_mfma_f32_32x32x16_bf16 v[148:163], a[192:195], v[204:207], v[148:163]
    v_mfma_f32_32x32x16_bf16 v[132:147], a[84:87], v[204:207], v[132:147]
    v_mfma_f32_32x32x16_bf16 v[148:163], a[196:199], v[204:207], v[148:163]
    v_mfma_f32_32x32x16_bf16 v[132:147], a[88:91], v[204:207], v[132:147]
    v_mfma_f32_32x32x16_bf16 v[148:163], a[200:203], v[204:207], v[148:163]
    v_mfma_f32_32x32x16_bf16 v[132:147], a[92:95], v[204:207], v[132:147]
    v_mfma_f32_32x32x16_bf16 v[148:163], a[204:207], v[204:207], v[148:163]
    v_mfma_f32_32x32x16_bf16 v[132:147], a[96:99], v[204:207], v[132:147]
    v_mfma_f32_32x32x16_bf16 v[148:163], a[208:211], v[204:207], v[148:163]
    v_mfma_f32_32x32x16_bf16 v[132:147], a[100:103], v[204:207], v[132:147]
    v_mfma_f32_32x32x16_bf16 v[148:163], a[212:215], v[204:207], v[148:163]
    v_mfma_f32_32x32x16_bf16 v[132:147], a[104:107], v[204:207], v[132:147]
    v_mfma_f32_32x32x16_bf16 v[148:163], a[216:219], v[204:207], v[148:163]
    v_mfma_f32_32x32x16_bf16 v[132:147], a[108:111], v[204:207], v[132:147]
    v_mfma_f32_32x32x16_bf16 v[148:163], a[220:223], v[204:207], v[148:163]
    s_nop 10
    ds_write_b128 v127, v[132:135] offset:0
    ds_write_b128 v127, v[136:139] offset:16
    ds_write_b128 v127, v[140:143] offset:32
    ds_write_b128 v127, v[144:147] offset:48
    ds_write_b128 v127, v[148:151] offset:128
    ds_write_b128 v127, v[152:155] offset:144
    ds_write_b128 v127, v[156:159] offset:160
    ds_write_b128 v127, v[160:163] offset:176
    v_lshlrev_b32 v242, 7, v0
    s_mov_b32 s53, 176132
ww_316:
    buffer_load_dword v243, v242, s[4:7], s53 offen sc1
    s_waitcnt vmcnt(0)
    v_cmp_eq_u32 vcc, 0, v243
    s_cbranch_vccz wwok_317
    s_sleep 4
    s_sub_u32 s13, s13, 1
    s_cbranch_scc0 ww_316
    s_mov_b32 s13, 0
wwok_317:
    s_barrier
    v_and_b32 v242, 63, v0
    v_min_u32 v242, 31, v242
    v_lshlrev_b32 v242, 10, v242
    s_and_b32 s53, s2, 7
    s_lshl_b32 s53, s53, 7
    s_add_u32 s53, s53, 176128
    buffer_load_dword v243, v242, s[4:7], s53 offen sc1
    s_waitcnt vmcnt(0)
    v_cmp_ne_u32 vcc, s15, v243
    s_cmp_lg_u64 vcc, 0
    s_cselect_b32 s12, 1, 0
    s_cmp_lg_u32 s12, 0
    s_cbranch_scc1 far_318
Floop_319:
    s_cmp_eq_u32 s39, 0
    s_cbranch_scc1 Tearly_320
    s_waitcnt vmcnt(0)
    buffer_store_dword v130, v128, s[4:7], 0 offen
    v_mov_b32 v128, 1073741824
Tpoll_322:
    buffer_load_dword v116, v115, s[4:7], s37 offen sc1
    s_waitcnt vmcnt(0)
    v_cmp_eq_u32 vcc, 0, v116
    s_cbranch_vccz Tok_323
    s_sleep 1
    s_sub_u32 s13, s13, 1
    s_cbranch_scc0 Tpoll_322
    s_mov_b32 s13, 0
Tok_323:
    s_mov_b32 m0, s38
    s_nop 0
    buffer_load_dwordx4 v4, s[4:7], s35 offen sc1 lds
    buffer_load_dwordx4 v4, s[4:7], s35 offen offset:1024 sc1 lds
    buffer_load_dwordx4 v4, s[4:7], s35 offen offset:2048 sc1 lds
    buffer_load_dwordx4 v4, s[4:7], s35 offen offset:3072 sc1 lds
    s_add_u32 s36, s35, 4096
    s_add_u32 m0, s38, 4096
    s_nop 0
    buffer_load_dwordx4 v4, s[4:7], s36 offen sc1 lds
    buffer_load_dwordx4 v4, s[4:7], s36 offen offset:1024 sc1 lds
    buffer_load_dwordx4 v4, s[4:7], s36 offen offset:2048 sc1 lds
    s_waitcnt vmcnt(0)
    s_branch Tjoin_321
Tearly_320:
    s_waitcnt vmcnt(7)
Tjoin_321:
    s_add_u32 s37, s37, 8
    s_add_u32 s40, s40, 2
    s_and_b32 s35, s40, 7
    s_mul_i32 s35, s35, 28672
    s_add_u32 s35, s35, s41
    s_barrier
    s_and_b32 s50, s11, 7
    s_mul_i32 s50, s50, 200704
    s_add_u32 s50, s50, s52
    ds_read_b128 v[148:151], v123 offset:0
    v_mov_b32 v220, 0x3f803f80
    v_mov_b32 v221, 0x3f803f80
    v_mov_b32 v222, 0x3f803f80
    ds_read_b128 v[152:155], v123 offset:1024
    v_mov_b32 v223, 0x3f803f80
    ds_read_b128 v[156:159], v123 offset:2048
    ds_read_b128 v[160:163], v123 offset:3072
    ds_read_b128 v[204:207], v124 offset:0
    ds_read_b128 v[208:211], v124 offset:512
    ds_read_b128 v[212:215], v124 offset:1024
    ds_read_b128 v[216:219], v124 offset:1536
    s_waitcnt lgkmcnt(6)
    v_mfma_f32_16x16x32_bf16 v[180:183], v[220:223], v[148:151], 0
    ds_read_b128 v[164:167], v124 offset:2048
    v_mfma_f32_16x16x32_bf16 v[184:187], v[148:151], v[148:151], 0
    ds_read_b128 v[148:151], v123 offset:4096
    v_mfma_f32_16x16x32_bf16 v[180:183], v[220:223], v[152:155], v[180:183]
    ds_read_b128 v[168:171], v124 offset:2560
    v_mfma_f32_16x16x32_bf16 v[184:187], v[152:155], v[152:155], v[184:187]
    ds_read_b128 v[152:155], v123 offset:5120
    s_waitcnt lgkmcnt(8)
    v_mfma_f32_16x16x32_bf16 v[180:183], v[220:223], v[156:159], v[180:183]
    ds_read_b128 v[172:175], v124 offset:3072
    v_mfma_f32_16x16x32_bf16 v[184:187], v[156:159], v[156:159], v[184:187]
    ds_read_b128 v[156:159], v123 offset:6144
    s_waitcnt vmcnt(0)
    buffer_store_dword v130, v128, s[4:7], 0 offen
    v_mfma_f32_16x16x32_bf16 v[180:183], v[220:223], v[160:163], v[180:183]
    ds_read_b128 v[176:179], v124 offset:3584
    v_mfma_f32_16x16x32_bf16 v[184:187], v[160:163], v[160:163], v[184:187]
    ds_read_b128 v[232:235], v127 offset:0
    s_waitcnt lgkmcnt(10)
    v_mfma_f32_32x32x16_bf16 v[132:147], a[0:3], v[204:207], 0
    ds_read_b128 v[204:207], v124 offset:4096
    ds_read_b128 v[236:239], v127 offset:16
    s_waitcnt lgkmcnt(7)
    v_mfma_f32_16x16x32_bf16 v[180:183], v[220:223], v[148:151], v[180:183]
    ds_read_b128 v[224:227], v114 offset:6144
    v_mfma_f32_16x16x32_bf16 v[184:187], v[148:151], v[148:151], v[184:187]
    ds_read_b128 v[228:231], v114 offset:12288
    s_waitcnt lgkmcnt(7)
    v_mfma_f32_16x16x32_bf16 v[180:183], v[220:223], v[152:155], v[180:183]
    v_mfma_f32_16x16x32_bf16 v[184:187], v[152:155], v[152:155], v[184:187]
    s_waitcnt lgkmcnt(5)
    v_mfma_f32_16x16x32_bf16 v[180:183], v[220:223], v[156:159], v[180:183]
    ds_read_b128 v[220:223], v114 offset:0
    v_mfma_f32_16x16x32_bf16 v[184:187], v[156:159], v[156:159], v[184:187]
    v_mfma_f32_32x32x16_bf16 v[132:147], a[4:7], v[208:211], v[132:147]
    ds_read_b128 v[208:211], v124 offset:4608
    v_mfma_f32_32x32x16_bf16 v[132:147], a[8:11], v[212:215], v[132:147]
    ds_read_b128 v[212:215], v124 offset:5120
    s_nop 3
    v_cndmask_b32 v184, v184, v185, s[44:45]
    v_mfma_f32_32x32x16_bf16 v[132:147], a[12:15], v[216:219], v[132:147]
    v_cndmask_b32 v184, v184, v186, s[46:47]
    ds_read_b128 v[216:219], v124 offset:5632
    v_cndmask_b32 v184, v184, v187, s[48:49]
    v_mov_b32 v181, v184
    v_mfma_f32_32x32x16_bf16 v[132:147], a[16:19], v[164:167], v[132:147]
    ds_write_b64 v121, v[180:181]
    ds_read_b128 v[164:167], v124 offset:6144
    v_mfma_f32_32x32x16_bf16 v[132:147], a[20:23], v[168:171], v[132:147]
    ds_read_b128 v[168:171], v124 offset:6656
    v_mfma_f32_32x32x16_bf16 v[132:147], a[24:27], v[172:175], v[132:147]
    ds_read_b128 v[172:175], v124 offset:7168
    v_mfma_f32_32x32x16_bf16 v[132:147], a[28:31], v[176:179], v[132:147]
    s_waitcnt lgkmcnt(3)
    s_barrier
    ds_read_b128 v[176:179], v124 offset:7680
    v_mfma_f32_32x32x16_bf16 v[132:147], a[32:35], v[204:207], v[132:147]
    ds_read_b64 v[148:149], v122 offset:0
    ds_read_b64 v[150:151], v122 offset:256
    ds_read_b128 v[204:207], v124 offset:8192
    v_mfma_f32_32x32x16_bf16 v[132:147], a[36:39], v[208:211], v[132:147]
    ds_read_b128 v[208:211], v124 offset:8704
    v_mfma_f32_32x32x16_bf16 v[132:147], a[40:43], v[212:215], v[132:147]
    ds_read_b128 v[212:215], v124 offset:9216
    v_mfma_f32_32x32x16_bf16 v[132:147], a[44:47], v[216:219], v[132:147]
    ds_read_b128 v[216:219], v124 offset:9728
    s_waitcnt lgkmcnt(8)
    v_mfma_f32_32x32x16_bf16 v[132:147], a[48:51], v[164:167], v[132:147]
    ds_read_b128 v[164:167], v124 offset:10240
    s_waitcnt lgkmcnt(4)
    v_add_f32 v240, v148, v150
    v_add_f32 v241, v149, v151
    v_mul_f32 v240, 0x3b124925, v240
    v_mfma_f32_32x32x16_bf16 v[132:147], a[52:55], v[168:171], v[132:147]
    ds_read_b128 v[168:171], v124 offset:10752
    v_mul_f32 v241, 0x3b124925, v241
    v_fma_f32 v241, -v240, v240, v241
    v_sub_f32 v240, 0, v240
    v_max_f32 v241, 0, v241
    v_mfma_f32_32x32x16_bf16 v[132:147], a[56:59], v[172:175], v[132:147]
    ds_read_b128 v[172:175], v124 offset:11264
    v_add_f32 v241, 0x3727c5ac, v241
    v_rsq_f32 v241, v241
    v_mfma_f32_32x32x16_bf16 v[132:147], a[60:63], v[176:179], v[132:147]
    ds_read_b128 v[176:179], v124 offset:11776
    v_mul_f32 v241, s51, v241
    v_mfma_f32_32x32x16_bf16 v[132:147], a[64:67], v[204:207], v[132:147]
    ds_read_b128 v[204:207], v124 offset:12288
    s_waitcnt lgkmcnt(6)
    v_mfma_f32_32x32x16_bf16 v[132:147], a[68:71], v[208:211], v[132:147]
    ds_read_b128 v[208:211], v124 offset:12800
    v_mfma_f32_32x32x16_bf16 v[132:147], a[72:75], v[212:215], v[132:147]
    ds_read_b128 v[212:215], v124 offset:13312
    s_waitcnt lgkmcnt(6)
    v_mfma_f32_32x32x16_bf16 v[132:147], a[76:79], v[216:219], v[132:147]
    ds_read_b128 v[216:219], v124 offset:13824
    v_mfma_f32_32x32x16_bf16 v[132:147], a[80:83], v[164:167], v[132:147]
    ds_read_b128 v[164:167], v124 offset:0
    s_waitcnt lgkmcnt(6)
    v_mfma_f32_32x32x16_bf16 v[132:147], a[84:87], v[168:171], v[132:147]
    ds_read_b128 v[168:171], v124 offset:512
    v_mfma_f32_32x32x16_bf16 v[132:147], a[88:91], v[172:175], v[132:147]
    ds_read_b128 v[172:175], v124 offset:1024
    s_waitcnt lgkmcnt(6)
    v_mfma_f32_32x32x16_bf16 v[132:147], a[92:95], v[176:179], v[132:147]
    ds_read_b128 v[176:179], v124 offset:1536
    v_mfma_f32_32x32x16_bf16 v[132:147], a[96:99], v[204:207], v[132:147]
    ds_read_b128 v[204:207], v124 offset:2048
    s_waitcnt lgkmcnt(6)
    v_mfma_f32_32x32x16_bf16 v[132:147], a[100:103], v[208:211], v[132:147]
    ds_read_b128 v[208:211], v124 offset:2560
    v_mfma_f32_32x32x16_bf16 v[132:147], a[104:107], v[212:215], v[132:147]
    ds_read_b128 v[212:215], v124 offset:3072
    s_waitcnt lgkmcnt(6)
    v_mfma_f32_32x32x16_bf16 v[132:147], a[108:111], v[216:219], v[132:147]
    ds_read_b128 v[216:219], v124 offset:3584
    v_mfma_f32_32x32x16_bf16 v[188:203], a[112:115], v[164:167], 0
    ds_read_b128 v[164:167], v124 offset:4096
    s_waitcnt lgkmcnt(6)
    v_mfma_f32_32x32x16_bf16 v[188:203], a[116:119], v[168:171], v[188:203]
    ds_read_b128 v[168:171], v124 offset:4608
    v_mfma_f32_32x32x16_bf16 v[188:203], a[120:123], v[172:175], v[188:203]
    ds_read_b128 v[172:175], v124 offset:5120
    s_waitcnt lgkmcnt(6)
    v_mfma_f32_32x32x16_bf16 v[188:203], a[124:127], v[176:179], v[188:203]
    ds_read_b128 v[176:179], v124 offset:5632
    s_nop 0
    v_fmac_f32 v132, v240, v232
    v_fmac_f32 v133, v240, v233
    v_mfma_f32_32x32x16_bf16 v[188:203], a[128:131], v[204:207], v[188:203]
    ds_read_b128 v[204:207], v124 offset:6144
    v_fmac_f32 v134, v240, v234
    v_fmac_f32 v135, v240, v235
    v_mul_f32 v132, v132, v241
    ds_read_b128 v[232:235], v127 offset:32
    v_mul_f32 v133, v133, v241
    s_waitcnt lgkmcnt(7)
    v_mfma_f32_32x32x16_bf16 v[188:203], a[132:135], v[208:211], v[188:203]
    ds_read_b128 v[208:211], v124 offset:6656
    v_mul_f32 v134, v134, v241
    v_mul_f32 v135, v135, v241
    v_exp_f32 v242, v132
    v_fmac_f32 v136, v240, v236
    v_mfma_f32_32x32x16_bf16 v[188:203], a[136:139], v[212:215], v[188:203]
    ds_read_b128 v[212:215], v124 offset:7168
    v_exp_f32 v243, v133
    v_exp_f32 v244, v134
    v_fma_f32 v242, v242, s51, s51
    s_waitcnt lgkmcnt(7)
    v_mfma_f32_32x32x16_bf16 v[188:203], a[140:143], v[216:219], v[188:203]
    ds_read_b128 v[216:219], v124 offset:7680
    v_exp_f32 v245, v135
    v_fma_f32 v243, v243, s51, s51
    v_fma_f32 v244, v244, s51, s51
    v_fma_f32 v245, v245, s51, s51
    v_mfma_f32_32x32x16_bf16 v[188:203], a[144:147], v[164:167], v[188:203]
    ds_read_b128 v[164:167], v124 offset:8192
    v_rcp_f32 v242, v242
    v_rcp_f32 v243, v243
    v_mul_f32 v132, v132, v242
    s_waitcnt lgkmcnt(7)
    v_mfma_f32_32x32x16_bf16 v[188:203], a[148:151], v[168:171], v[188:203]
    ds_read_b128 v[168:171], v124 offset:8704
    v_rcp_f32 v244, v244
    v_rcp_f32 v245, v245
    v_mul_f32 v133, v133, v243
    v_mfma_f32_32x32x16_bf16 v[188:203], a[152:155], v[172:175], v[188:203]
    ds_read_b128 v[172:175], v124 offset:9216
    v_mul_f32 v134, v134, v244
    v_mul_f32 v135, v135, v245
    v_fmac_f32 v137, v240, v237
    v_fmac_f32 v138, v240, v238
    v_fmac_f32 v139, v240, v239
    s_waitcnt lgkmcnt(7)
    v_mfma_f32_32x32x16_bf16 v[188:203], a[156:159], v[176:179], v[188:203]
    ds_read_b128 v[176:179], v124 offset:9728
    v_mul_f32 v136, v136, v241
    v_mul_f32 v137, v137, v241
    v_mul_f32 v138, v138, v241
    ds_read_b128 v[236:239], v127 offset:48
    v_mul_f32 v139, v139, v241
    v_mfma_f32_32x32x16_bf16 v[188:203], a[160:163], v[204:207], v[188:203]
    ds_read_b128 v[204:207], v124 offset:10240
    v_exp_f32 v246, v136
    v_exp_f32 v247, v137
    v_fma_f32 v246, v246, s51, s51
    s_waitcnt lgkmcnt(7)
    v_mfma_f32_32x32x16_bf16 v[188:203], a[164:167], v[208:211], v[188:203]
    ds_read_b128 v[208:211], v124 offset:10752
    v_exp_f32 v248, v138
    v_exp_f32 v249, v139
    v_fma_f32 v247, v247, s51, s51
    v_mfma_f32_32x32x16_bf16 v[188:203], a[168:171], v[212:215], v[188:203]
    ds_read_b128 v[212:215], v124 offset:11264
    v_fma_f32 v248, v248, s51, s51
    v_fma_f32 v249, v249, s51, s51
    v_rcp_f32 v246, v246
    v_cvt_pk_bf16_f32 v132, v132, v133
    s_waitcnt lgkmcnt(7)
    v_mfma_f32_32x32x16_bf16 v[188:203], a[172:175], v[216:219], v[188:203]
    ds_read_b128 v[216:219], v124 offset:11776
    v_rcp_f32 v247, v247
    v_rcp_f32 v248, v248
    v_mul_f32 v136, v136, v246
    v_mfma_f32_32x32x16_bf16 v[188:203], a[176:179], v[164:167], v[188:203]
    ds_read_b128 v[164:167], v124 offset:12288
    v_rcp_f32 v249, v249
    v_mul_f32 v137, v137, v247
    v_mul_f32 v138, v138, v248
    v_mul_f32 v139, v139, v249
    s_waitcnt lgkmcnt(7)
    v_mfma_f32_32x32x16_bf16 v[188:203], a[180:183], v[168:171], v[188:203]
    ds_read_b128 v[168:171], v124 offset:12800
    v_cvt_pk_bf16_f32 v133, v134, v135
    v_cvt_pk_bf16_f32 v134, v136, v137
    v_cvt_pk_bf16_f32 v135, v138, v139
    v_fmac_f32 v140, v240, v232
    ds_write_b128 v119, v[132:135] offset:0
    v_mfma_f32_32x32x16_bf16 v[188:203], a[184:187], v[172:175], v[188:203]
    v_fmac_f32 v141, v240, v233
    v_fmac_f32 v142, v240, v234
    v_fmac_f32 v143, v240, v235
    v_mul_f32 v140, v140, v241
    v_mul_f32 v141, v141, v241
    ds_read_b128 v[172:175], v124 offset:13312
    s_waitcnt lgkmcnt(8)
    v_mfma_f32_32x32x16_bf16 v[188:203], a[188:191], v[176:179], v[188:203]
    v_mul_f32 v142, v142, v241
    ds_read_b128 v[176:179], v124 offset:13824
    v_mul_f32 v143, v143, v241
    v_exp_f32 v242, v140
    ds_read_b128 v[232:235], v127 offset:128
    s_waitcnt lgkmcnt(8)
    v_mfma_f32_32x32x16_bf16 v[188:203], a[192:195], v[204:207], v[188:203]
    v_exp_f32 v243, v141
    v_exp_f32 v244, v142
    s_waitcnt lgkmcnt(3)
    s_barrier
    v_exp_f32 v245, v143
    v_mfma_f32_32x32x16_bf16 v[188:203], a[196:199], v[208:211], v[188:203]
    v_fma_f32 v242, v242, s51, s51
    v_fma_f32 v243, v243, s51, s51
    ds_read_b128 v[204:207], v4 offset:28672
    v_fma_f32 v244, v244, s51, s51
    v_fma_f32 v245, v245, s51, s51
    v_fmac_f32 v144, v240, v236
    v_mfma_f32_32x32x16_bf16 v[188:203], a[200:203], v[212:215], v[188:203]
    ds_read_b128 v[208:211], v4 offset:32768
    v_rcp_f32 v242, v242
    v_rcp_f32 v243, v243
    ds_read_b128 v[212:215], v4 offset:36864
    v_mfma_f32_32x32x16_bf16 v[188:203], a[204:207], v[216:219], v[188:203]
    v_rcp_f32 v244, v244
    ds_read_b128 v[216:219], v4 offset:40960
    v_rcp_f32 v245, v245
    v_mul_f32 v140, v140, v242
    v_mfma_f32_32x32x16_bf16 v[188:203], a[208:211], v[164:167], v[188:203]
    v_mul_f32 v141, v141, v243
    v_mul_f32 v142, v142, v244
    v_mul_f32 v143, v143, v245
    v_fmac_f32 v145, v240, v237
    v_fmac_f32 v146, v240, v238
    v_fmac_f32 v147, v240, v239
    v_mfma_f32_32x32x16_bf16 v[188:203], a[212:215], v[168:171], v[188:203]
    ds_read_b128 v[236:239], v127 offset:144
    v_mul_f32 v144, v144, v241
    v_mul_f32 v145, v145, v241
    v_mul_f32 v146, v146, v241
    v_mul_f32 v147, v147, v241
    v_cvt_pk_bf16_f32 v140, v140, v141
    s_waitcnt lgkmcnt(6)
    v_mfma_f32_32x32x16_bf16 v[188:203], a[216:219], v[172:175], v[188:203]
    v_exp_f32 v246, v144
    v_exp_f32 v247, v145
    v_exp_f32 v248, v146
    v_mfma_f32_32x32x16_bf16 v[188:203], a[220:223], v[176:179], v[188:203]
    v_exp_f32 v249, v147
    v_fma_f32 v246, v246, s51, s51
    v_fma_f32 v247, v247, s51, s51
    v_fma_f32 v248, v248, s51, s51
    v_fma_f32 v249, v249, s51, s51
    s_waitcnt lgkmcnt(3)
    v_mfma_f32_32x32x16_bf16 v[148:163], v[220:223], v[204:207], 0
    ds_read_b128 v[220:223], v114 offset:18432
    v_rcp_f32 v246, v246
    v_rcp_f32 v247, v247
    v_mul_f32 v144, v144, v246
    v_mfma_f32_32x32x16_bf16 v[164:179], v[46:49], v[204:207], 0
    v_rcp_f32 v248, v248
    v_rcp_f32 v249, v249
    v_mul_f32 v145, v145, v247
    v_mul_f32 v146, v146, v248
    v_mfma_f32_32x32x16_bf16 v[148:163], v[224:227], v[208:211], v[148:163]
    ds_read_b128 v[224:227], v114 offset:1024
    v_mul_f32 v147, v147, v249
    v_cvt_pk_bf16_f32 v141, v142, v143
    v_cvt_pk_bf16_f32 v142, v144, v145
    v_cvt_pk_bf16_f32 v143, v146, v147
    v_fmac_f32 v188, v240, v232
    v_mfma_f32_32x32x16_bf16 v[164:179], v[54:57], v[208:211], v[164:179]
    ds_write_b128 v119, v[140:143] offset:1024
    v_fmac_f32 v189, v240, v233
    v_fmac_f32 v190, v240, v234
    v_fmac_f32 v191, v240, v235
    v_mul_f32 v188, v188, v241
    v_mul_f32 v189, v189, v241
    v_mfma_f32_32x32x16_bf16 v[132:147], a[224:227], v[204:207], 0
    ds_read_b128 v[232:235], v127 offset:160
    v_mul_f32 v190, v190, v241
    v_mul_f32 v191, v191, v241
    v_exp_f32 v242, v188
    s_waitcnt lgkmcnt(3)
    v_fmac_f32 v192, v240, v236
    v_mfma_f32_32x32x16_bf16 v[132:147], a[232:235], v[208:211], v[132:147]
    v_exp_f32 v243, v189
    v_exp_f32 v244, v190
    v_exp_f32 v245, v191
    v_mfma_f32_32x32x16_bf16 v[132:147], a[240:243], v[212:215], v[132:147]
    s_waitcnt lgkmcnt(1)
    s_barrier
    v_fma_f32 v242, v242, s51, s51
    v_fma_f32 v243, v243, s51, s51
    v_fma_f32 v244, v244, s51, s51
    v_fma_f32 v245, v245, s51, s51
    v_rcp_f32 v242, v242
    v_mfma_f32_32x32x16_bf16 v[148:163], v[228:231], v[212:215], v[148:163]
    ds_read_b128 v[204:207], v4 offset:29696
    v_rcp_f32 v243, v243
    v_rcp_f32 v244, v244
    ds_read_b128 v[228:231], v114 offset:2048
    v_mfma_f32_32x32x16_bf16 v[164:179], v[62:65], v[212:215], v[164:179]
    v_rcp_f32 v245, v245
    ds_read_b128 v[208:211], v120 offset:0
    v_mul_f32 v188, v188, v242
    v_mul_f32 v189, v189, v243
    v_mul_f32 v190, v190, v244
    v_mfma_f32_32x32x16_bf16 v[132:147], a[248:251], v[216:219], v[132:147]
    ds_read_b128 v[212:215], v120 offset:256
    v_mul_f32 v191, v191, v245
    v_fmac_f32 v193, v240, v237
    v_fmac_f32 v194, v240, v238
    v_fmac_f32 v195, v240, v239
    ds_read_b128 v[236:239], v127 offset:176
    v_mfma_f32_32x32x16_bf16 v[148:163], v[220:223], v[216:219], v[148:163]
    v_mul_f32 v192, v192, v241
    ds_read_b128 v[220:223], v114 offset:7168
    v_mul_f32 v193, v193, v241
    v_mul_f32 v194, v194, v241
    v_mul_f32 v195, v195, v241
    v_cvt_pk_bf16_f32 v188, v188, v189
    v_mfma_f32_32x32x16_bf16 v[164:179], v[70:73], v[216:219], v[164:179]
    ds_read_b128 v[216:219], v4 offset:33792
    v_exp_f32 v246, v192
    v_exp_f32 v247, v193
    v_fma_f32 v246, v246, s51, s51
    s_waitcnt lgkmcnt(5)
    v_mfma_f32_32x32x16_bf16 v[132:147], v[224:227], v[204:207], v[132:147]
    ds_read_b128 v[224:227], v114 offset:8192
    v_exp_f32 v248, v194
    v_exp_f32 v249, v195
    v_fma_f32 v247, v247, s51, s51
    v_mfma_f32_32x32x16_bf16 v[148:163], v[10:13], v[204:207], v[148:163]
    v_fma_f32 v248, v248, s51, s51
    v_fma_f32 v249, v249, s51, s51
    v_rcp_f32 v246, v246
    v_rcp_f32 v247, v247
    v_mfma_f32_32x32x16_bf16 v[164:179], v[228:231], v[204:207], v[164:179]
    ds_read_b128 v[204:207], v120 offset:4096
    v_rcp_f32 v248, v248
    v_rcp_f32 v249, v249
    ds_read_b128 v[228:231], v114 offset:13312
    s_waitcnt lgkmcnt(6)
    v_mfma_f32_16x16x32_bf16 v[180:183], v[82:85], v[208:211], 0
    v_mul_f32 v192, v192, v246
    ds_read_b128 v[208:211], v120 offset:4352
    v_mfma_f32_16x16x32_bf16 v[184:187], v[82:85], v[212:215], 0
    v_mul_f32 v193, v193, v247
    ds_read_b128 v[212:215], v4 offset:37888
    s_waitcnt lgkmcnt(4)
    v_mfma_f32_32x32x16_bf16 v[132:147], v[220:223], v[216:219], v[132:147]
    v_mul_f32 v194, v194, v248
    ds_read_b128 v[220:223], v114 offset:14336
    v_mul_f32 v195, v195, v249
    v_cvt_pk_bf16_f32 v189, v190, v191
    v_cvt_pk_bf16_f32 v190, v192, v193
    v_cvt_pk_bf16_f32 v191, v194, v195
    v_mfma_f32_32x32x16_bf16 v[148:163], v[18:21], v[216:219], v[148:163]
    ds_write_b128 v119, v[188:191] offset:2048
    v_fmac_f32 v196, v240, v232
    v_fmac_f32 v197, v240, v233
    v_fmac_f32 v198, v240, v234
    v_fmac_f32 v199, v240, v235
    v_mul_f32 v196, v196, v241
    v_mfma_f32_32x32x16_bf16 v[164:179], v[224:227], v[216:219], v[164:179]
    ds_read_b128 v[216:219], v120 offset:8192
    v_mul_f32 v197, v197, v241
    v_mul_f32 v198, v198, v241
    v_mul_f32 v199, v199, v241
    ds_read_b128 v[224:227], v114 offset:19456
    v_fmac_f32 v200, v240, v236
    s_waitcnt lgkmcnt(6)
    v_mfma_f32_16x16x32_bf16 v[180:183], v[90:93], v[204:207], v[180:183]
    ds_read_b128 v[204:207], v120 offset:8448
    v_fmac_f32 v201, v240, v237
    s_waitcnt lgkmcnt(5)
    v_mfma_f32_16x16x32_bf16 v[184:187], v[90:93], v[208:211], v[184:187]
    ds_read_b128 v[208:211], v4 offset:41984
    v_fmac_f32 v202, v240, v238
    v_mfma_f32_32x32x16_bf16 v[132:147], v[228:231], v[212:215], v[132:147]
    s_waitcnt lgkmcnt(3)
    s_barrier
    ds_read_b128 v[228:231], v114 offset:20480
    v_exp_f32 v242, v196
    v_exp_f32 v243, v197
    v_fma_f32 v242, v242, s51, s51
    v_mfma_f32_32x32x16_bf16 v[148:163], v[26:29], v[212:215], v[148:163]
    v_exp_f32 v244, v198
    v_exp_f32 v245, v199
    v_fma_f32 v243, v243, s51, s51
    v_fma_f32 v244, v244, s51, s51
    v_mfma_f32_32x32x16_bf16 v[164:179], v[220:223], v[212:215], v[164:179]
    ds_read_b128 v[212:215], v120 offset:12288
    v_fma_f32 v245, v245, s51, s51
    v_rcp_f32 v242, v242
    ds_read_b128 v[220:223], v114 offset:3072
    v_fmac_f32 v203, v240, v239
    v_mfma_f32_16x16x32_bf16 v[180:183], v[98:101], v[216:219], v[180:183]
    ds_read_b128 v[216:219], v120 offset:12544
    v_mul_f32 v196, v196, v242
    s_waitcnt lgkmcnt(4)
    v_mfma_f32_16x16x32_bf16 v[184:187], v[98:101], v[204:207], v[184:187]
    ds_read_b128 v[204:207], v4 offset:30720
    v_mul_f32 v200, v200, v241
    v_mfma_f32_32x32x16_bf16 v[132:147], v[224:227], v[208:211], v[132:147]
    ds_read_b128 v[224:227], v114 offset:9216
    v_rcp_f32 v243, v243
    v_rcp_f32 v244, v244
    v_mul_f32 v197, v197, v243
    v_mfma_f32_32x32x16_bf16 v[148:163], v[34:37], v[208:211], v[148:163]
    v_rcp_f32 v245, v245
    v_mul_f32 v198, v198, v244
    v_mul_f32 v201, v201, v241
    v_mul_f32 v199, v199, v245
    v_mul_f32 v202, v202, v241
    s_waitcnt lgkmcnt(4)
    v_mfma_f32_32x32x16_bf16 v[164:179], v[228:231], v[208:211], v[164:179]
    ds_read_b128 v[208:211], v4 offset:34816
    v_mul_f32 v203, v203, v241
    v_exp_f32 v246, v200
    ds_read_b128 v[228:231], v114 offset:15360
    v_cvt_pk_bf16_f32 v196, v196, v197
    v_mfma_f32_16x16x32_bf16 v[180:183], v[106:109], v[212:215], v[180:183]
    ds_read_b128 v[212:215], v4 offset:38912
    v_fma_f32 v246, v246, s51, s51
    s_waitcnt lgkmcnt(4)
    v_mfma_f32_16x16x32_bf16 v[184:187], v[106:109], v[216:219], v[184:187]
    ds_read_b128 v[216:219], v4 offset:43008
    v_cvt_pk_bf16_f32 v197, v198, v199
    v_mfma_f32_32x32x16_bf16 v[132:147], a[228:231], v[204:207], v[132:147]
    v_exp_f32 v247, v201
    v_exp_f32 v248, v202
    v_exp_f32 v249, v203
    v_mfma_f32_32x32x16_bf16 v[148:163], v[220:223], v[204:207], v[148:163]
    ds_read_b128 v[220:223], v114 offset:4096
    v_fma_f32 v247, v247, s51, s51
    v_fma_f32 v248, v248, s51, s51
    v_fma_f32 v249, v249, s51, s51
    v_rcp_f32 v246, v246
    v_mfma_f32_32x32x16_bf16 v[164:179], v[50:53], v[204:207], v[164:179]
    buffer_load_dword v116, v115, s[4:7], s37 offen sc1
    v_rcp_f32 v247, v247
    v_rcp_f32 v248, v248
    v_mul_f32 v200, v200, v246
    s_waitcnt lgkmcnt(3)
    v_mfma_f32_32x32x16_bf16 v[132:147], a[236:239], v[208:211], v[132:147]
    v_rcp_f32 v249, v249
    v_mul_f32 v201, v201, v247
    v_mul_f32 v202, v202, v248
    v_mul_f32 v203, v203, v249
    v_cvt_pk_bf16_f32 v198, v200, v201
    v_mfma_f32_32x32x16_bf16 v[148:163], v[224:227], v[208:211], v[148:163]
    ds_read_b128 v[224:227], v114 offset:10240
    v_cvt_pk_bf16_f32 v199, v202, v203
    ds_write_b128 v119, v[196:199] offset:3072
    v_mfma_f32_32x32x16_bf16 v[164:179], v[58:61], v[208:211], v[164:179]
    s_waitcnt lgkmcnt(3)
    v_mfma_f32_32x32x16_bf16 v[132:147], a[244:247], v[212:215], v[132:147]
    v_mfma_f32_32x32x16_bf16 v[148:163], v[228:231], v[212:215], v[148:163]
    ds_read_b128 v[228:231], v114 offset:16384
    s_waitcnt lgkmcnt(1)
    s_barrier
    v_mfma_f32_32x32x16_bf16 v[164:179], v[66:69], v[212:215], v[164:179]
    ds_read_b128 v[188:191], v4 offset:31744
    ds_read_b128 v[192:195], v4 offset:35840
    v_mfma_f32_32x32x16_bf16 v[132:147], a[252:255], v[216:219], v[132:147]
    ds_read_b128 v[196:199], v4 offset:39936
    ds_read_b128 v[200:203], v4 offset:44032
    v_mfma_f32_32x32x16_bf16 v[148:163], v[38:41], v[216:219], v[148:163]
    ds_read_b128 v[204:207], v120 offset:2048
    ds_read_b128 v[208:211], v120 offset:2304
    s_waitcnt vmcnt(0)
    v_cmp_eq_u32 vcc, 0, v116
    v_mfma_f32_32x32x16_bf16 v[164:179], v[74:77], v[216:219], v[164:179]
    s_cmp_eq_u64 vcc, 0
    ds_read_b128 v[212:215], v120 offset:6144
    s_cselect_b32 s39, 0, 1
    s_cselect_b32 s36, 0, 1073741824
    s_cmp_ge_u32 s40, 64
    s_cselect_b32 s36, 1073741824, s36
    ds_read_b128 v[216:219], v120 offset:6400
    v_add_u32 v117, s36, v4
    s_mov_b32 m0, s38
    s_nop 0
    buffer_load_dwordx4 v117, s[4:7], s35 offen sc1 lds
    s_waitcnt lgkmcnt(6)
    v_mfma_f32_32x32x16_bf16 v[132:147], v[220:223], v[188:191], v[132:147]
    buffer_load_dwordx4 v117, s[4:7], s35 offen offset:1024 sc1 lds
    ds_read_b128 v[220:223], v114 offset:5120
    buffer_load_dwordx4 v117, s[4:7], s35 offen offset:2048 sc1 lds
    v_mfma_f32_32x32x16_bf16 v[132:147], v[224:227], v[192:195], v[132:147]
    buffer_load_dwordx4 v117, s[4:7], s35 offen offset:3072 sc1 lds
    ds_read_b128 v[224:227], v114 offset:11264
    s_add_u32 s36, s35, 4096
    s_add_u32 m0, s38, 4096
    s_waitcnt lgkmcnt(6)
    v_mfma_f32_32x32x16_bf16 v[132:147], v[228:231], v[196:199], v[132:147]
    buffer_load_dwordx4 v117, s[4:7], s36 offen sc1 lds
    buffer_load_dwordx4 v117, s[4:7], s36 offen offset:1024 sc1 lds
    ds_read_b128 v[228:231], v114 offset:17408
    buffer_load_dwordx4 v117, s[4:7], s36 offen offset:2048 sc1 lds
    v_mfma_f32_32x32x16_bf16 v[132:147], v[6:9], v[200:203], v[132:147]
    s_waitcnt lgkmcnt(5)
    v_mfma_f32_16x16x32_bf16 v[180:183], v[86:89], v[204:207], v[180:183]
    ds_read_b128 v[204:207], v120 offset:10240
    v_mfma_f32_16x16x32_bf16 v[184:187], v[86:89], v[208:211], v[184:187]
    ds_read_b128 v[208:211], v120 offset:10496
    s_waitcnt lgkmcnt(5)
    v_mfma_f32_16x16x32_bf16 v[180:183], v[94:97], v[212:215], v[180:183]
    ds_read_b128 v[212:215], v120 offset:14336
    v_mfma_f32_16x16x32_bf16 v[184:187], v[94:97], v[216:219], v[184:187]
    ds_read_b128 v[216:219], v120 offset:14592
    v_mfma_f32_32x32x16_bf16 v[148:163], v[14:17], v[188:191], v[148:163]
    s_nop 0
    v_cvt_pk_bf16_f32 v132, v132, v133
    v_cvt_pk_bf16_f32 v133, v134, v135
    v_cvt_pk_bf16_f32 v134, v136, v137
    v_mfma_f32_32x32x16_bf16 v[148:163], v[22:25], v[192:195], v[148:163]
    v_cvt_pk_bf16_f32 v135, v138, v139
    v_cvt_pk_bf16_f32 v140, v140, v141
    v_cvt_pk_bf16_f32 v141, v142, v143
    v_cvt_pk_bf16_f32 v142, v144, v145
    v_cvt_pk_bf16_f32 v143, v146, v147
    v_mfma_f32_32x32x16_bf16 v[148:163], v[30:33], v[196:199], v[148:163]
    s_waitcnt lgkmcnt(3)
    v_mfma_f32_16x16x32_bf16 v[180:183], v[102:105], v[204:207], v[180:183]
    s_waitcnt lgkmcnt(2)
    v_mfma_f32_16x16x32_bf16 v[184:187], v[102:105], v[208:211], v[184:187]
    s_waitcnt lgkmcnt(1)
    v_mfma_f32_16x16x32_bf16 v[180:183], v[110:113], v[212:215], v[180:183]
    s_waitcnt lgkmcnt(0)
    v_mfma_f32_16x16x32_bf16 v[184:187], v[110:113], v[216:219], v[184:187]
    v_mfma_f32_32x32x16_bf16 v[148:163], v[42:45], v[200:203], v[148:163]
    v_mfma_f32_32x32x16_bf16 v[164:179], v[220:223], v[188:191], v[164:179]
    s_nop 3
    v_cvt_pk_bf16_f32 v180, v180, v181
    v_mfma_f32_32x32x16_bf16 v[164:179], v[224:227], v[192:195], v[164:179]
    v_cvt_pk_bf16_f32 v181, v182, v183
    v_cvt_pk_bf16_f32 v182, v184, v185
    v_cvt_pk_bf16_f32 v183, v186, v187
    s_nop 0
    v_permlane16_swap_b32 v180, v182
    v_permlane16_swap_b32 v181, v183
    v_mfma_f32_32x32x16_bf16 v[164:179], v[228:231], v[196:199], v[164:179]
    buffer_store_dwordx4 v[180:183], v126, s[4:7], s50 offen
    buffer_store_dwordx4 v[132:135], v125, s[4:7], s50 offen offset:0
    buffer_store_dwordx4 v[140:143], v125, s[4:7], s50 offen offset:512
    v_cvt_pk_bf16_f32 v148, v148, v149
    v_cvt_pk_bf16_f32 v149, v150, v151
    v_cvt_pk_bf16_f32 v150, v152, v153
    v_mfma_f32_32x32x16_bf16 v[164:179], v[78:81], v[200:203], v[164:179]
    v_cvt_pk_bf16_f32 v151, v154, v155
    v_cvt_pk_bf16_f32 v156, v156, v157
    buffer_store_dwordx4 v[148:151], v125, s[4:7], s50 offen offset:1024
    v_cvt_pk_bf16_f32 v157, v158, v159
    v_cvt_pk_bf16_f32 v158, v160, v161
    v_cvt_pk_bf16_f32 v159, v162, v163
    buffer_store_dwordx4 v[156:159], v125, s[4:7], s50 offen offset:1536
    s_nop 4
    v_cvt_pk_bf16_f32 v164, v164, v165
    v_cvt_pk_bf16_f32 v165, v166, v167
    v_cvt_pk_bf16_f32 v166, v168, v169
    v_cvt_pk_bf16_f32 v167, v170, v171
    v_cvt_pk_bf16_f32 v172, v172, v173
    buffer_store_dwordx4 v[164:167], v125, s[4:7], s50 offen offset:2048
    v_cvt_pk_bf16_f32 v173, v174, v175
    v_cvt_pk_bf16_f32 v174, v176, v177
    v_cvt_pk_bf16_f32 v175, v178, v179
    buffer_store_dwordx4 v[172:175], v125, s[4:7], s50 offen offset:2560
    v_add_u32 v128, s42, v129
    s_add_u32 s42, s42, 8
    s_add_u32 s11, s11, 2
    s_cmp_lt_u32 s11, 64
    s_cbranch_scc1 Floop_319
    s_waitcnt vmcnt(0)
    buffer_store_dword v130, v128, s[4:7], 0 offen
    v_mov_b32 v128, 1073741824
    s_endpgm
.p2align 6
far_318:
Floop_324:
    s_cmp_eq_u32 s39, 0
    s_cbranch_scc1 Tearly_325
    s_waitcnt vmcnt(0)
    buffer_store_dword v130, v128, s[4:7], 0 offen sc1
    v_mov_b32 v128, 1073741824
Tpoll_327:
    buffer_load_dword v116, v115, s[4:7], s37 offen sc1
    s_waitcnt vmcnt(0)
    v_cmp_eq_u32 vcc, 0, v116
    s_cbranch_vccz Tok_328
    s_sleep 1
    s_sub_u32 s13, s13, 1
    s_cbranch_scc0 Tpoll_327
    s_mov_b32 s13, 0
Tok_328:
    s_mov_b32 m0, s38
    s_nop 0
    buffer_load_dwordx4 v4, s[4:7], s35 offen sc1 lds
    buffer_load_dwordx4 v4, s[4:7], s35 offen offset:1024 sc1 lds
    buffer_load_dwordx4 v4, s[4:7], s35 offen offset:2048 sc1 lds
    buffer_load_dwordx4 v4, s[4:7], s35 offen offset:3072 sc1 lds
    s_add_u32 s36, s35, 4096
    s_add_u32 m0, s38, 4096
    s_nop 0
    buffer_load_dwordx4 v4, s[4:7], s36 offen sc1 lds
    buffer_load_dwordx4 v4, s[4:7], s36 offen offset:1024 sc1 lds
    buffer_load_dwordx4 v4, s[4:7], s36 offen offset:2048 sc1 lds
    s_waitcnt vmcnt(0)
    s_branch Tjoin_326
Tearly_325:
    s_waitcnt vmcnt(7)
Tjoin_326:
    s_add_u32 s37, s37, 8
    s_add_u32 s40, s40, 2
    s_and_b32 s35, s40, 7
    s_mul_i32 s35, s35, 28672
    s_add_u32 s35, s35, s41
    s_barrier
    s_and_b32 s50, s11, 7
    s_mul_i32 s50, s50, 200704
    s_add_u32 s50, s50, s52
    ds_read_b128 v[148:151], v123 offset:0
    v_mov_b32 v220, 0x3f803f80
    v_mov_b32 v221, 0x3f803f80
    v_mov_b32 v222, 0x3f803f80
    ds_read_b128 v[152:155], v123 offset:1024
    v_mov_b32 v223, 0x3f803f80
    ds_read_b128 v[156:159], v123 offset:2048
    ds_read_b128 v[160:163], v123 offset:3072
    ds_read_b128 v[204:207], v124 offset:0
    ds_read_b128 v[208:211], v124 offset:512
    ds_read_b128 v[212:215], v124 offset:1024
    ds_read_b128 v[216:219], v124 offset:1536
    s_waitcnt lgkmcnt(6)
    v_mfma_f32_16x16x32_bf16 v[180:183], v[220:223], v[148:151], 0
    ds_read_b128 v[164:167], v124 offset:2048
    v_mfma_f32_16x16x32_bf16 v[184:187], v[148:151], v[148:151], 0
    ds_read_b128 v[148:151], v123 offset:4096
    v_mfma_f32_16x16x32_bf16 v[180:183], v[220:223], v[152:155], v[180:183]
    ds_read_b128 v[168:171], v124 offset:2560
    v_mfma_f32_16x16x32_bf16 v[184:187], v[152:155], v[152:155], v[184:187]
    ds_read_b128 v[152:155], v123 offset:5120
    s_waitcnt lgkmcnt(8)
    v_mfma_f32_16x16x32_bf16 v[180:183], v[220:223], v[156:159], v[180:183]
    ds_read_b128 v[172:175], v124 offset:3072
    v_mfma_f32_16x16x32_bf16 v[184:187], v[156:159], v[156:159], v[184:187]
    ds_read_b128 v[156:159], v123 offset:6144
    s_waitcnt vmcnt(0)
    buffer_store_dword v130, v128, s[4:7], 0 offen sc1
    v_mfma_f32_16x16x32_bf16 v[180:183], v[220:223], v[160:163], v[180:183]
    ds_read_b128 v[176:179], v124 offset:3584
    v_mfma_f32_16x16x32_bf16 v[184:187], v[160:163], v[160:163], v[184:187]
    ds_read_b128 v[232:235], v127 offset:0
    s_waitcnt lgkmcnt(10)
    v_mfma_f32_32x32x16_bf16 v[132:147], a[0:3], v[204:207], 0
    ds_read_b128 v[204:207], v124 offset:4096
    ds_read_b128 v[236:239], v127 offset:16
    s_waitcnt lgkmcnt(7)
    v_mfma_f32_16x16x32_bf16 v[180:183], v[220:223], v[148:151], v[180:183]
    ds_read_b128 v[224:227], v114 offset:6144
    v_mfma_f32_16x16x32_bf16 v[184:187], v[148:151], v[148:151], v[184:187]
    ds_read_b128 v[228:231], v114 offset:12288
    s_waitcnt lgkmcnt(7)
    v_mfma_f32_16x16x32_bf16 v[180:183], v[220:223], v[152:155], v[180:183]
    v_mfma_f32_16x16x32_bf16 v[184:187], v[152:155], v[152:155], v[184:187]
    s_waitcnt lgkmcnt(5)
    v_mfma_f32_16x16x32_bf16 v[180:183], v[220:223], v[156:159], v[180:183]
    ds_read_b128 v[220:223], v114 offset:0
    v_mfma_f32_16x16x32_bf16 v[184:187], v[156:159], v[156:159], v[184:187]
    v_mfma_f32_32x32x16_bf16 v[132:147], a[4:7], v[208:211], v[132:147]
    ds_read_b128 v[208:211], v124 offset:4608
    v_mfma_f32_32x32x16_bf16 v[132:147], a[8:11], v[212:215], v[132:147]
    ds_read_b128 v[212:215], v124 offset:5120
    s_nop 3
    v_cndmask_b32 v184, v184, v185, s[44:45]
    v_mfma_f32_32x32x16_bf16 v[132:147], a[12:15], v[216:219], v[132:147]
    v_cndmask_b32 v184, v184, v186, s[46:47]
    ds_read_b128 v[216:219], v124 offset:5632
    v_cndmask_b32 v184, v184, v187, s[48:49]
    v_mov_b32 v181, v184
    v_mfma_f32_32x32x16_bf16 v[132:147], a[16:19], v[164:167], v[132:147]
    ds_write_b64 v121, v[180:181]
    ds_read_b128 v[164:167], v124 offset:6144
    v_mfma_f32_32x32x16_bf16 v[132:147], a[20:23], v[168:171], v[132:147]
    ds_read_b128 v[168:171], v124 offset:6656
    v_mfma_f32_32x32x16_bf16 v[132:147], a[24:27], v[172:175], v[132:147]
    ds_read_b128 v[172:175], v124 offset:7168
    v_mfma_f32_32x32x16_bf16 v[132:147], a[28:31], v[176:179], v[132:147]
    s_waitcnt lgkmcnt(3)
    s_barrier
    ds_read_b128 v[176:179], v124 offset:7680
    v_mfma_f32_32x32x16_bf16 v[132:147], a[32:35], v[204:207], v[132:147]
    ds_read_b64 v[148:149], v122 offset:0
    ds_read_b64 v[150:151], v122 offset:256
    ds_read_b128 v[204:207], v124 offset:8192
    v_mfma_f32_32x32x16_bf16 v[132:147], a[36:39], v[208:211], v[132:147]
    ds_read_b128 v[208:211], v124 offset:8704
    v_mfma_f32_32x32x16_bf16 v[132:147], a[40:43], v[212:215], v[132:147]
    ds_read_b128 v[212:215], v124 offset:9216
    v_mfma_f32_32x32x16_bf16 v[132:147], a[44:47], v[216:219], v[132:147]
    ds_read_b128 v[216:219], v124 offset:9728
    s_waitcnt lgkmcnt(8)
    v_mfma_f32_32x32x16_bf16 v[132:147], a[48:51], v[164:167], v[132:147]
    ds_read_b128 v[164:167], v124 offset:10240
    s_waitcnt lgkmcnt(4)
    v_add_f32 v240, v148, v150
    v_add_f32 v241, v149, v151
    v_mul_f32 v240, 0x3b124925, v240
    v_mfma_f32_32x32x16_bf16 v[132:147], a[52:55], v[168:171], v[132:147]
    ds_read_b128 v[168:171], v124 offset:10752
    v_mul_f32 v241, 0x3b124925, v241
    v_fma_f32 v241, -v240, v240, v241
    v_sub_f32 v240, 0, v240
    v_max_f32 v241, 0, v241
    v_mfma_f32_32x32x16_bf16 v[132:147], a[56:59], v[172:175], v[132:147]
    ds_read_b128 v[172:175], v124 offset:11264
    v_add_f32 v241, 0x3727c5ac, v241
    v_rsq_f32 v241, v241
    v_mfma_f32_32x32x16_bf16 v[132:147], a[60:63], v[176:179], v[132:147]
    ds_read_b128 v[176:179], v124 offset:11776
    v_mul_f32 v241, s51, v241
    v_mfma_f32_32x32x16_bf16 v[132:147], a[64:67], v[204:207], v[132:147]
    ds_read_b128 v[204:207], v124 offset:12288
    s_waitcnt lgkmcnt(6)
    v_mfma_f32_32x32x16_bf16 v[132:147], a[68:71], v[208:211], v[132:147]
    ds_read_b128 v[208:211], v124 offset:12800
    v_mfma_f32_32x32x16_bf16 v[132:147], a[72:75], v[212:215], v[132:147]
    ds_read_b128 v[212:215], v124 offset:13312
    s_waitcnt lgkmcnt(6)
    v_mfma_f32_32x32x16_bf16 v[132:147], a[76:79], v[216:219], v[132:147]
    ds_read_b128 v[216:219], v124 offset:13824
    v_mfma_f32_32x32x16_bf16 v[132:147], a[80:83], v[164:167], v[132:147]
    ds_read_b128 v[164:167], v124 offset:0
    s_waitcnt lgkmcnt(6)
    v_mfma_f32_32x32x16_bf16 v[132:147], a[84:87], v[168:171], v[132:147]
    ds_read_b128 v[168:171], v124 offset:512
    v_mfma_f32_32x32x16_bf16 v[132:147], a[88:91], v[172:175], v[132:147]
    ds_read_b128 v[172:175], v124 offset:1024
    s_waitcnt lgkmcnt(6)
    v_mfma_f32_32x32x16_bf16 v[132:147], a[92:95], v[176:179], v[132:147]
    ds_read_b128 v[176:179], v124 offset:1536
    v_mfma_f32_32x32x16_bf16 v[132:147], a[96:99], v[204:207], v[132:147]
    ds_read_b128 v[204:207], v124 offset:2048
    s_waitcnt lgkmcnt(6)
    v_mfma_f32_32x32x16_bf16 v[132:147], a[100:103], v[208:211], v[132:147]
    ds_read_b128 v[208:211], v124 offset:2560
    v_mfma_f32_32x32x16_bf16 v[132:147], a[104:107], v[212:215], v[132:147]
    ds_read_b128 v[212:215], v124 offset:3072
    s_waitcnt lgkmcnt(6)
    v_mfma_f32_32x32x16_bf16 v[132:147], a[108:111], v[216:219], v[132:147]
    ds_read_b128 v[216:219], v124 offset:3584
    v_mfma_f32_32x32x16_bf16 v[188:203], a[112:115], v[164:167], 0
    ds_read_b128 v[164:167], v124 offset:4096
    s_waitcnt lgkmcnt(6)
    v_mfma_f32_32x32x16_bf16 v[188:203], a[116:119], v[168:171], v[188:203]
    ds_read_b128 v[168:171], v124 offset:4608
    v_mfma_f32_32x32x16_bf16 v[188:203], a[120:123], v[172:175], v[188:203]
    ds_read_b128 v[172:175], v124 offset:5120
    s_waitcnt lgkmcnt(6)
    v_mfma_f32_32x32x16_bf16 v[188:203], a[124:127], v[176:179], v[188:203]
    ds_read_b128 v[176:179], v124 offset:5632
    s_nop 0
    v_fmac_f32 v132, v240, v232
    v_fmac_f32 v133, v240, v233
    v_mfma_f32_32x32x16_bf16 v[188:203], a[128:131], v[204:207], v[188:203]
    ds_read_b128 v[204:207], v124 offset:6144
    v_fmac_f32 v134, v240, v234
    v_fmac_f32 v135, v240, v235
    v_mul_f32 v132, v132, v241
    ds_read_b128 v[232:235], v127 offset:32
    v_mul_f32 v133, v133, v241
    s_waitcnt lgkmcnt(7)
    v_mfma_f32_32x32x16_bf16 v[188:203], a[132:135], v[208:211], v[188:203]
    ds_read_b128 v[208:211], v124 offset:6656
    v_mul_f32 v134, v134, v241
    v_mul_f32 v135, v135, v241
    v_exp_f32 v242, v132
    v_fmac_f32 v136, v240, v236
    v_mfma_f32_32x32x16_bf16 v[188:203], a[136:139], v[212:215], v[188:203]
    ds_read_b128 v[212:215], v124 offset:7168
    v_exp_f32 v243, v133
    v_exp_f32 v244, v134
    v_fma_f32 v242, v242, s51, s51
    s_waitcnt lgkmcnt(7)
    v_mfma_f32_32x32x16_bf16 v[188:203], a[140:143], v[216:219], v[188:203]
    ds_read_b128 v[216:219], v124 offset:7680
    v_exp_f32 v245, v135
    v_fma_f32 v243, v243, s51, s51
    v_fma_f32 v244, v244, s51, s51
    v_fma_f32 v245, v245, s51, s51
    v_mfma_f32_32x32x16_bf16 v[188:203], a[144:147], v[164:167], v[188:203]
    ds_read_b128 v[164:167], v124 offset:8192
    v_rcp_f32 v242, v242
    v_rcp_f32 v243, v243
    v_mul_f32 v132, v132, v242
    s_waitcnt lgkmcnt(7)
    v_mfma_f32_32x32x16_bf16 v[188:203], a[148:151], v[168:171], v[188:203]
    ds_read_b128 v[168:171], v124 offset:8704
    v_rcp_f32 v244, v244
    v_rcp_f32 v245, v245
    v_mul_f32 v133, v133, v243
    v_mfma_f32_32x32x16_bf16 v[188:203], a[152:155], v[172:175], v[188:203]
    ds_read_b128 v[172:175], v124 offset:9216
    v_mul_f32 v134, v134, v244
    v_mul_f32 v135, v135, v245
    v_fmac_f32 v137, v240, v237
    v_fmac_f32 v138, v240, v238
    v_fmac_f32 v139, v240, v239
    s_waitcnt lgkmcnt(7)
    v_mfma_f32_32x32x16_bf16 v[188:203], a[156:159], v[176:179], v[188:203]
    ds_read_b128 v[176:179], v124 offset:9728
    v_mul_f32 v136, v136, v241
    v_mul_f32 v137, v137, v241
    v_mul_f32 v138, v138, v241
    ds_read_b128 v[236:239], v127 offset:48
    v_mul_f32 v139, v139, v241
    v_mfma_f32_32x32x16_bf16 v[188:203], a[160:163], v[204:207], v[188:203]
    ds_read_b128 v[204:207], v124 offset:10240
    v_exp_f32 v246, v136
    v_exp_f32 v247, v137
    v_fma_f32 v246, v246, s51, s51
    s_waitcnt lgkmcnt(7)
    v_mfma_f32_32x32x16_bf16 v[188:203], a[164:167], v[208:211], v[188:203]
    ds_read_b128 v[208:211], v124 offset:10752
    v_exp_f32 v248, v138
    v_exp_f32 v249, v139
    v_fma_f32 v247, v247, s51, s51
    v_mfma_f32_32x32x16_bf16 v[188:203], a[168:171], v[212:215], v[188:203]
    ds_read_b128 v[212:215], v124 offset:11264
    v_fma_f32 v248, v248, s51, s51
    v_fma_f32 v249, v249, s51, s51
    v_rcp_f32 v246, v246
    v_cvt_pk_bf16_f32 v132, v132, v133
    s_waitcnt lgkmcnt(7)
    v_mfma_f32_32x32x16_bf16 v[188:203], a[172:175], v[216:219], v[188:203]
    ds_read_b128 v[216:219], v124 offset:11776
    v_rcp_f32 v247, v247
    v_rcp_f32 v248, v248
    v_mul_f32 v136, v136, v246
    v_mfma_f32_32x32x16_bf16 v[188:203], a[176:179], v[164:167], v[188:203]
    ds_read_b128 v[164:167], v124 offset:12288
    v_rcp_f32 v249, v249
    v_mul_f32 v137, v137, v247
    v_mul_f32 v138, v138, v248
    v_mul_f32 v139, v139, v249
    s_waitcnt lgkmcnt(7)
    v_mfma_f32_32x32x16_bf16 v[188:203], a[180:183], v[168:171], v[188:203]
    ds_read_b128 v[168:171], v124 offset:12800
    v_cvt_pk_bf16_f32 v133, v134, v135
    v_cvt_pk_bf16_f32 v134, v136, v137
    v_cvt_pk_bf16_f32 v135, v138, v139
    v_fmac_f32 v140, v240, v232
    ds_write_b128 v119, v[132:135] offset:0
    v_mfma_f32_32x32x16_bf16 v[188:203], a[184:187], v[172:175], v[188:203]
    v_fmac_f32 v141, v240, v233
    v_fmac_f32 v142, v240, v234
    v_fmac_f32 v143, v240, v235
    v_mul_f32 v140, v140, v241
    v_mul_f32 v141, v141, v241
    ds_read_b128 v[172:175], v124 offset:13312
    s_waitcnt lgkmcnt(8)
    v_mfma_f32_32x32x16_bf16 v[188:203], a[188:191], v[176:179], v[188:203]
    v_mul_f32 v142, v142, v241
    ds_read_b128 v[176:179], v124 offset:13824
    v_mul_f32 v143, v143, v241
    v_exp_f32 v242, v140
    ds_read_b128 v[232:235], v127 offset:128
    s_waitcnt lgkmcnt(8)
    v_mfma_f32_32x32x16_bf16 v[188:203], a[192:195], v[204:207], v[188:203]
    v_exp_f32 v243, v141
    v_exp_f32 v244, v142
    s_waitcnt lgkmcnt(3)
    s_barrier
    v_exp_f32 v245, v143
    v_mfma_f32_32x32x16_bf16 v[188:203], a[196:199], v[208:211], v[188:203]
    v_fma_f32 v242, v242, s51, s51
    v_fma_f32 v243, v243, s51, s51
    ds_read_b128 v[204:207], v4 offset:28672
    v_fma_f32 v244, v244, s51, s51
    v_fma_f32 v245, v245, s51, s51
    v_fmac_f32 v144, v240, v236
    v_mfma_f32_32x32x16_bf16 v[188:203], a[200:203], v[212:215], v[188:203]
    ds_read_b128 v[208:211], v4 offset:32768
    v_rcp_f32 v242, v242
    v_rcp_f32 v243, v243
    ds_read_b128 v[212:215], v4 offset:36864
    v_mfma_f32_32x32x16_bf16 v[188:203], a[204:207], v[216:219], v[188:203]
    v_rcp_f32 v244, v244
    ds_read_b128 v[216:219], v4 offset:40960
    v_rcp_f32 v245, v245
    v_mul_f32 v140, v140, v242
    v_mfma_f32_32x32x16_bf16 v[188:203], a[208:211], v[164:167], v[188:203]
    v_mul_f32 v141, v141, v243
    v_mul_f32 v142, v142, v244
    v_mul_f32 v143, v143, v245
    v_fmac_f32 v145, v240, v237
    v_fmac_f32 v146, v240, v238
    v_fmac_f32 v147, v240, v239
    v_mfma_f32_32x32x16_bf16 v[188:203], a[212:215], v[168:171], v[188:203]
    ds_read_b128 v[236:239], v127 offset:144
    v_mul_f32 v144, v144, v241
    v_mul_f32 v145, v145, v241
    v_mul_f32 v146, v146, v241
    v_mul_f32 v147, v147, v241
    v_cvt_pk_bf16_f32 v140, v140, v141
    s_waitcnt lgkmcnt(6)
    v_mfma_f32_32x32x16_bf16 v[188:203], a[216:219], v[172:175], v[188:203]
    v_exp_f32 v246, v144
    v_exp_f32 v247, v145
    v_exp_f32 v248, v146
    v_mfma_f32_32x32x16_bf16 v[188:203], a[220:223], v[176:179], v[188:203]
    v_exp_f32 v249, v147
    v_fma_f32 v246, v246, s51, s51
    v_fma_f32 v247, v247, s51, s51
    v_fma_f32 v248, v248, s51, s51
    v_fma_f32 v249, v249, s51, s51
    s_waitcnt lgkmcnt(3)
    v_mfma_f32_32x32x16_bf16 v[148:163], v[220:223], v[204:207], 0
    ds_read_b128 v[220:223], v114 offset:18432
    v_rcp_f32 v246, v246
    v_rcp_f32 v247, v247
    v_mul_f32 v144, v144, v246
    v_mfma_f32_32x32x16_bf16 v[164:179], v[46:49], v[204:207], 0
    v_rcp_f32 v248, v248
    v_rcp_f32 v249, v249
    v_mul_f32 v145, v145, v247
    v_mul_f32 v146, v146, v248
    v_mfma_f32_32x32x16_bf16 v[148:163], v[224:227], v[208:211], v[148:163]
    ds_read_b128 v[224:227], v114 offset:1024
    v_mul_f32 v147, v147, v249
    v_cvt_pk_bf16_f32 v141, v142, v143
    v_cvt_pk_bf16_f32 v142, v144, v145
    v_cvt_pk_bf16_f32 v143, v146, v147
    v_fmac_f32 v188, v240, v232
    v_mfma_f32_32x32x16_bf16 v[164:179], v[54:57], v[208:211], v[164:179]
    ds_write_b128 v119, v[140:143] offset:1024
    v_fmac_f32 v189, v240, v233
    v_fmac_f32 v190, v240, v234
    v_fmac_f32 v191, v240, v235
    v_mul_f32 v188, v188, v241
    v_mul_f32 v189, v189, v241
    v_mfma_f32_32x32x16_bf16 v[132:147], a[224:227], v[204:207], 0
    ds_read_b128 v[232:235], v127 offset:160
    v_mul_f32 v190, v190, v241
    v_mul_f32 v191, v191, v241
    v_exp_f32 v242, v188
    s_waitcnt lgkmcnt(3)
    v_fmac_f32 v192, v240, v236
    v_mfma_f32_32x32x16_bf16 v[132:147], a[232:235], v[208:211], v[132:147]
    v_exp_f32 v243, v189
    v_exp_f32 v244, v190
    v_exp_f32 v245, v191
    v_mfma_f32_32x32x16_bf16 v[132:147], a[240:243], v[212:215], v[132:147]
    s_waitcnt lgkmcnt(1)
    s_barrier
    v_fma_f32 v242, v242, s51, s51
    v_fma_f32 v243, v243, s51, s51
    v_fma_f32 v244, v244, s51, s51
    v_fma_f32 v245, v245, s51, s51
    v_rcp_f32 v242, v242
    v_mfma_f32_32x32x16_bf16 v[148:163], v[228:231], v[212:215], v[148:163]
    ds_read_b128 v[204:207], v4 offset:29696
    v_rcp_f32 v243, v243
    v_rcp_f32 v244, v244
    ds_read_b128 v[228:231], v114 offset:2048
    v_mfma_f32_32x32x16_bf16 v[164:179], v[62:65], v[212:215], v[164:179]
    v_rcp_f32 v245, v245
    ds_read_b128 v[208:211], v120 offset:0
    v_mul_f32 v188, v188, v242
    v_mul_f32 v189, v189, v243
    v_mul_f32 v190, v190, v244
    v_mfma_f32_32x32x16_bf16 v[132:147], a[248:251], v[216:219], v[132:147]
    ds_read_b128 v[212:215], v120 offset:256
    v_mul_f32 v191, v191, v245
    v_fmac_f32 v193, v240, v237
    v_fmac_f32 v194, v240, v238
    v_fmac_f32 v195, v240, v239
    ds_read_b128 v[236:239], v127 offset:176
    v_mfma_f32_32x32x16_bf16 v[148:163], v[220:223], v[216:219], v[148:163]
    v_mul_f32 v192, v192, v241
    ds_read_b128 v[220:223], v114 offset:7168
    v_mul_f32 v193, v193, v241
    v_mul_f32 v194, v194, v241
    v_mul_f32 v195, v195, v241
    v_cvt_pk_bf16_f32 v188, v188, v189
    v_mfma_f32_32x32x16_bf16 v[164:179], v[70:73], v[216:219], v[164:179]
    ds_read_b128 v[216:219], v4 offset:33792
    v_exp_f32 v246, v192
    v_exp_f32 v247, v193
    v_fma_f32 v246, v246, s51, s51
    s_waitcnt lgkmcnt(5)
    v_mfma_f32_32x32x16_bf16 v[132:147], v[224:227], v[204:207], v[132:147]
    ds_read_b128 v[224:227], v114 offset:8192
    v_exp_f32 v248, v194
    v_exp_f32 v249, v195
    v_fma_f32 v247, v247, s51, s51
    v_mfma_f32_32x32x16_bf16 v[148:163], v[10:13], v[204:207], v[148:163]
    v_fma_f32 v248, v248, s51, s51
    v_fma_f32 v249, v249, s51, s51
    v_rcp_f32 v246, v246
    v_rcp_f32 v247, v247
    v_mfma_f32_32x32x16_bf16 v[164:179], v[228:231], v[204:207], v[164:179]
    ds_read_b128 v[204:207], v120 offset:4096
    v_rcp_f32 v248, v248
    v_rcp_f32 v249, v249
    ds_read_b128 v[228:231], v114 offset:13312
    s_waitcnt lgkmcnt(6)
    v_mfma_f32_16x16x32_bf16 v[180:183], v[82:85], v[208:211], 0
    v_mul_f32 v192, v192, v246
    ds_read_b128 v[208:211], v120 offset:4352
    v_mfma_f32_16x16x32_bf16 v[184:187], v[82:85], v[212:215], 0
    v_mul_f32 v193, v193, v247
    ds_read_b128 v[212:215], v4 offset:37888
    s_waitcnt lgkmcnt(4)
    v_mfma_f32_32x32x16_bf16 v[132:147], v[220:223], v[216:219], v[132:147]
    v_mul_f32 v194, v194, v248
    ds_read_b128 v[220:223], v114 offset:14336
    v_mul_f32 v195, v195, v249
    v_cvt_pk_bf16_f32 v189, v190, v191
    v_cvt_pk_bf16_f32 v190, v192, v193
    v_cvt_pk_bf16_f32 v191, v194, v195
    v_mfma_f32_32x32x16_bf16 v[148:163], v[18:21], v[216:219], v[148:163]
    ds_write_b128 v119, v[188:191] offset:2048
    v_fmac_f32 v196, v240, v232
    v_fmac_f32 v197, v240, v233
    v_fmac_f32 v198, v240, v234
    v_fmac_f32 v199, v240, v235
    v_mul_f32 v196, v196, v241
    v_mfma_f32_32x32x16_bf16 v[164:179], v[224:227], v[216:219], v[164:179]
    ds_read_b128 v[216:219], v120 offset:8192
    v_mul_f32 v197, v197, v241
    v_mul_f32 v198, v198, v241
    v_mul_f32 v199, v199, v241
    ds_read_b128 v[224:227], v114 offset:19456
    v_fmac_f32 v200, v240, v236
    s_waitcnt lgkmcnt(6)
    v_mfma_f32_16x16x32_bf16 v[180:183], v[90:93], v[204:207], v[180:183]
    ds_read_b128 v[204:207], v120 offset:8448
    v_fmac_f32 v201, v240, v237
    s_waitcnt lgkmcnt(5)
    v_mfma_f32_16x16x32_bf16 v[184:187], v[90:93], v[208:211], v[184:187]
    ds_read_b128 v[208:211], v4 offset:41984
    v_fmac_f32 v202, v240, v238
    v_mfma_f32_32x32x16_bf16 v[132:147], v[228:231], v[212:215], v[132:147]
    s_waitcnt lgkmcnt(3)
    s_barrier
    ds_read_b128 v[228:231], v114 offset:20480
    v_exp_f32 v242, v196
    v_exp_f32 v243, v197
    v_fma_f32 v242, v242, s51, s51
    v_mfma_f32_32x32x16_bf16 v[148:163], v[26:29], v[212:215], v[148:163]
    v_exp_f32 v244, v198
    v_exp_f32 v245, v199
    v_fma_f32 v243, v243, s51, s51
    v_fma_f32 v244, v244, s51, s51
    v_mfma_f32_32x32x16_bf16 v[164:179], v[220:223], v[212:215], v[164:179]
    ds_read_b128 v[212:215], v120 offset:12288
    v_fma_f32 v245, v245, s51, s51
    v_rcp_f32 v242, v242
    ds_read_b128 v[220:223], v114 offset:3072
    v_fmac_f32 v203, v240, v239
    v_mfma_f32_16x16x32_bf16 v[180:183], v[98:101], v[216:219], v[180:183]
    ds_read_b128 v[216:219], v120 offset:12544
    v_mul_f32 v196, v196, v242
    s_waitcnt lgkmcnt(4)
    v_mfma_f32_16x16x32_bf16 v[184:187], v[98:101], v[204:207], v[184:187]
    ds_read_b128 v[204:207], v4 offset:30720
    v_mul_f32 v200, v200, v241
    v_mfma_f32_32x32x16_bf16 v[132:147], v[224:227], v[208:211], v[132:147]
    ds_read_b128 v[224:227], v114 offset:9216
    v_rcp_f32 v243, v243
    v_rcp_f32 v244, v244
    v_mul_f32 v197, v197, v243
    v_mfma_f32_32x32x16_bf16 v[148:163], v[34:37], v[208:211], v[148:163]
    v_rcp_f32 v245, v245
    v_mul_f32 v198, v198, v244
    v_mul_f32 v201, v201, v241
    v_mul_f32 v199, v199, v245
    v_mul_f32 v202, v202, v241
    s_waitcnt lgkmcnt(4)
    v_mfma_f32_32x32x16_bf16 v[164:179], v[228:231], v[208:211], v[164:179]
    ds_read_b128 v[208:211], v4 offset:34816
    v_mul_f32 v203, v203, v241
    v_exp_f32 v246, v200
    ds_read_b128 v[228:231], v114 offset:15360
    v_cvt_pk_bf16_f32 v196, v196, v197
    v_mfma_f32_16x16x32_bf16 v[180:183], v[106:109], v[212:215], v[180:183]
    ds_read_b128 v[212:215], v4 offset:38912
    v_fma_f32 v246, v246, s51, s51
    s_waitcnt lgkmcnt(4)
    v_mfma_f32_16x16x32_bf16 v[184:187], v[106:109], v[216:219], v[184:187]
    ds_read_b128 v[216:219], v4 offset:43008
    v_cvt_pk_bf16_f32 v197, v198, v199
    v_mfma_f32_32x32x16_bf16 v[132:147], a[228:231], v[204:207], v[132:147]
    v_exp_f32 v247, v201
    v_exp_f32 v248, v202
    v_exp_f32 v249, v203
    v_mfma_f32_32x32x16_bf16 v[148:163], v[220:223], v[204:207], v[148:163]
    ds_read_b128 v[220:223], v114 offset:4096
    v_fma_f32 v247, v247, s51, s51
    v_fma_f32 v248, v248, s51, s51
    v_fma_f32 v249, v249, s51, s51
    v_rcp_f32 v246, v246
    v_mfma_f32_32x32x16_bf16 v[164:179], v[50:53], v[204:207], v[164:179]
    buffer_load_dword v116, v115, s[4:7], s37 offen sc1
    v_rcp_f32 v247, v247
    v_rcp_f32 v248, v248
    v_mul_f32 v200, v200, v246
    s_waitcnt lgkmcnt(3)
    v_mfma_f32_32x32x16_bf16 v[132:147], a[236:239], v[208:211], v[132:147]
    v_rcp_f32 v249, v249
    v_mul_f32 v201, v201, v247
    v_mul_f32 v202, v202, v248
    v_mul_f32 v203, v203, v249
    v_cvt_pk_bf16_f32 v198, v200, v201
    v_mfma_f32_32x32x16_bf16 v[148:163], v[224:227], v[208:211], v[148:163]
    ds_read_b128 v[224:227], v114 offset:10240
    v_cvt_pk_bf16_f32 v199, v202, v203
    ds_write_b128 v119, v[196:199] offset:3072
    v_mfma_f32_32x32x16_bf16 v[164:179], v[58:61], v[208:211], v[164:179]
    s_waitcnt lgkmcnt(3)
    v_mfma_f32_32x32x16_bf16 v[132:147], a[244:247], v[212:215], v[132:147]
    v_mfma_f32_32x32x16_bf16 v[148:163], v[228:231], v[212:215], v[148:163]
    ds_read_b128 v[228:231], v114 offset:16384
    s_waitcnt lgkmcnt(1)
    s_barrier
    v_mfma_f32_32x32x16_bf16 v[164:179], v[66:69], v[212:215], v[164:179]
    ds_read_b128 v[188:191], v4 offset:31744
    ds_read_b128 v[192:195], v4 offset:35840
    v_mfma_f32_32x32x16_bf16 v[132:147], a[252:255], v[216:219], v[132:147]
    ds_read_b128 v[196:199], v4 offset:39936
    ds_read_b128 v[200:203], v4 offset:44032
    v_mfma_f32_32x32x16_bf16 v[148:163], v[38:41], v[216:219], v[148:163]
    ds_read_b128 v[204:207], v120 offset:2048
    ds_read_b128 v[208:211], v120 offset:2304
    s_waitcnt vmcnt(0)
    v_cmp_eq_u32 vcc, 0, v116
    v_mfma_f32_32x32x16_bf16 v[164:179], v[74:77], v[216:219], v[164:179]
    s_cmp_eq_u64 vcc, 0
    ds_read_b128 v[212:215], v120 offset:6144
    s_cselect_b32 s39, 0, 1
    s_cselect_b32 s36, 0, 1073741824
    s_cmp_ge_u32 s40, 64
    s_cselect_b32 s36, 1073741824, s36
    ds_read_b128 v[216:219], v120 offset:6400
    v_add_u32 v117, s36, v4
    s_mov_b32 m0, s38
    s_nop 0
    buffer_load_dwordx4 v117, s[4:7], s35 offen sc1 lds
    s_waitcnt lgkmcnt(6)
    v_mfma_f32_32x32x16_bf16 v[132:147], v[220:223], v[188:191], v[132:147]
    buffer_load_dwordx4 v117, s[4:7], s35 offen offset:1024 sc1 lds
    ds_read_b128 v[220:223], v114 offset:5120
    buffer_load_dwordx4 v117, s[4:7], s35 offen offset:2048 sc1 lds
    v_mfma_f32_32x32x16_bf16 v[132:147], v[224:227], v[192:195], v[132:147]
    buffer_load_dwordx4 v117, s[4:7], s35 offen offset:3072 sc1 lds
    ds_read_b128 v[224:227], v114 offset:11264
    s_add_u32 s36, s35, 4096
    s_add_u32 m0, s38, 4096
    s_waitcnt lgkmcnt(6)
    v_mfma_f32_32x32x16_bf16 v[132:147], v[228:231], v[196:199], v[132:147]
    buffer_load_dwordx4 v117, s[4:7], s36 offen sc1 lds
    buffer_load_dwordx4 v117, s[4:7], s36 offen offset:1024 sc1 lds
    ds_read_b128 v[228:231], v114 offset:17408
    buffer_load_dwordx4 v117, s[4:7], s36 offen offset:2048 sc1 lds
    v_mfma_f32_32x32x16_bf16 v[132:147], v[6:9], v[200:203], v[132:147]
    s_waitcnt lgkmcnt(5)
    v_mfma_f32_16x16x32_bf16 v[180:183], v[86:89], v[204:207], v[180:183]
    ds_read_b128 v[204:207], v120 offset:10240
    v_mfma_f32_16x16x32_bf16 v[184:187], v[86:89], v[208:211], v[184:187]
    ds_read_b128 v[208:211], v120 offset:10496
    s_waitcnt lgkmcnt(5)
    v_mfma_f32_16x16x32_bf16 v[180:183], v[94:97], v[212:215], v[180:183]
    ds_read_b128 v[212:215], v120 offset:14336
    v_mfma_f32_16x16x32_bf16 v[184:187], v[94:97], v[216:219], v[184:187]
    ds_read_b128 v[216:219], v120 offset:14592
    v_mfma_f32_32x32x16_bf16 v[148:163], v[14:17], v[188:191], v[148:163]
    s_nop 0
    v_cvt_pk_bf16_f32 v132, v132, v133
    v_cvt_pk_bf16_f32 v133, v134, v135
    v_cvt_pk_bf16_f32 v134, v136, v137
    v_mfma_f32_32x32x16_bf16 v[148:163], v[22:25], v[192:195], v[148:163]
    v_cvt_pk_bf16_f32 v135, v138, v139
    v_cvt_pk_bf16_f32 v140, v140, v141
    v_cvt_pk_bf16_f32 v141, v142, v143
    v_cvt_pk_bf16_f32 v142, v144, v145
    v_cvt_pk_bf16_f32 v143, v146, v147
    v_mfma_f32_32x32x16_bf16 v[148:163], v[30:33], v[196:199], v[148:163]
    s_waitcnt lgkmcnt(3)
    v_mfma_f32_16x16x32_bf16 v[180:183], v[102:105], v[204:207], v[180:183]
    s_waitcnt lgkmcnt(2)
    v_mfma_f32_16x16x32_bf16 v[184:187], v[102:105], v[208:211], v[184:187]
    s_waitcnt lgkmcnt(1)
    v_mfma_f32_16x16x32_bf16 v[180:183], v[110:113], v[212:215], v[180:183]
    s_waitcnt lgkmcnt(0)
    v_mfma_f32_16x16x32_bf16 v[184:187], v[110:113], v[216:219], v[184:187]
    v_mfma_f32_32x32x16_bf16 v[148:163], v[42:45], v[200:203], v[148:163]
    v_mfma_f32_32x32x16_bf16 v[164:179], v[220:223], v[188:191], v[164:179]
    s_nop 3
    v_cvt_pk_bf16_f32 v180, v180, v181
    v_mfma_f32_32x32x16_bf16 v[164:179], v[224:227], v[192:195], v[164:179]
    v_cvt_pk_bf16_f32 v181, v182, v183
    v_cvt_pk_bf16_f32 v182, v184, v185
    v_cvt_pk_bf16_f32 v183, v186, v187
    s_nop 0
    v_permlane16_swap_b32 v180, v182
    v_permlane16_swap_b32 v181, v183
    v_mfma_f32_32x32x16_bf16 v[164:179], v[228:231], v[196:199], v[164:179]
    buffer_store_dwordx4 v[180:183], v126, s[4:7], s50 offen sc1
    buffer_store_dwordx4 v[132:135], v125, s[4:7], s50 offen offset:0 sc1
    buffer_store_dwordx4 v[140:143], v125, s[4:7], s50 offen offset:512 sc1
    v_cvt_pk_bf16_f32 v148, v148, v149
    v_cvt_pk_bf16_f32 v149, v150, v151
    v_cvt_pk_bf16_f32 v150, v152, v153
    v_mfma_f32_32x32x16_bf16 v[164:179], v[78:81], v[200:203], v[164:179]
    v_cvt_pk_bf16_f32 v151, v154, v155
    v_cvt_pk_bf16_f32 v156, v156, v157
    buffer_store_dwordx4 v[148:151], v125, s[4:7], s50 offen offset:1024 sc1
    v_cvt_pk_bf16_f32 v157, v158, v159
    v_cvt_pk_bf16_f32 v158, v160, v161
    v_cvt_pk_bf16_f32 v159, v162, v163
    buffer_store_dwordx4 v[156:159], v125, s[4:7], s50 offen offset:1536 sc1
    s_nop 4
    v_cvt_pk_bf16_f32 v164, v164, v165
    v_cvt_pk_bf16_f32 v165, v166, v167
    v_cvt_pk_bf16_f32 v166, v168, v169
    v_cvt_pk_bf16_f32 v167, v170, v171
    v_cvt_pk_bf16_f32 v172, v172, v173
    buffer_store_dwordx4 v[164:167], v125, s[4:7], s50 offen offset:2048 sc1
    v_cvt_pk_bf16_f32 v173, v174, v175
    v_cvt_pk_bf16_f32 v174, v176, v177
    v_cvt_pk_bf16_f32 v175, v178, v179
    buffer_store_dwordx4 v[172:175], v125, s[4:7], s50 offen offset:2560 sc1
    v_add_u32 v128, s42, v129
    s_add_u32 s42, s42, 8
    s_add_u32 s11, s11, 2
    s_cmp_lt_u32 s11, 64
    s_cbranch_scc1 Floop_324
    s_waitcnt vmcnt(0)
    buffer_store_dword v130, v128, s[4:7], 0 offen sc1
    v_mov_b32 v128, 1073741824
    s_endpgm
.p2align 6
role_RED:
    v_and_b32 v1, 63, v0
    v_and_b32 v2, 15, v0
    v_lshrrev_b32 v3, 4, v1
    s_load_dwordx2 s[16:17], s[0:1], 80
    s_mov_b32 s18, 1835008
    s_mov_b32 s19, 0x20000
    v_lshlrev_b32 v15, 4, v1
    s_add_u32 s20, s10, 0
    s_cmp_lt_u32 s20, 14
    s_cselect_b32 s26, 0, 1073741824
    s_lshl_b32 s20, s20, 10
    s_or_b32 s20, s20, s26
    v_add_u32 v4, s20, v15
    s_add_u32 s20, s10, 4
    s_cmp_lt_u32 s20, 14
    s_cselect_b32 s26, 0, 1073741824
    s_lshl_b32 s20, s20, 10
    s_or_b32 s20, s20, s26
    v_add_u32 v5, s20, v15
    s_add_u32 s20, s10, 8
    s_cmp_lt_u32 s20, 14
    s_cselect_b32 s26, 0, 1073741824
    s_lshl_b32 s20, s20, 10
    s_or_b32 s20, s20, s26
    v_add_u32 v6, s20, v15
    s_add_u32 s20, s10, 12
    s_cmp_lt_u32 s20, 14
    s_cselect_b32 s26, 0, 1073741824
    s_lshl_b32 s20, s20, 10
    s_or_b32 s20, s20, s26
    v_add_u32 v7, s20, v15
    s_mul_i32 s26, s9, 14336
    s_mul_i32 s29, s8, 1605632
    s_add_u32 s29, s29, 41168896
    s_add_u32 s29, s29, s26
    s_mul_i32 s30, s8, 229376
    s_add_u32 s30, s30, 21704704
    s_add_u32 s30, s30, s26
    s_mul_i32 s20, s11, 28672
    s_add_u32 s26, s26, s20
    s_add_u32 s22, s26, 19869696
    s_add_u32 s23, s26, 23998464
    s_lshl_b32 s20, s11, 2
    s_mul_i32 s24, s8, 69632
    s_add_u32 s24, s24, 58368
    s_add_u32 s24, s24, s20
    s_lshl_b32 s25, s9, 8
    s_add_u32 s25, s25, 135168
    s_add_u32 s25, s25, s20
    s_mul_i32 s31, s8, 69632
    s_add_u32 s31, s31, 66560
    s_add_u32 s31, s31, s20
    s_lshl_b32 s20, s9, 8
    s_add_u32 s31, s31, s20
    s_mov_b32 s27, 0x3f80
    s_mov_b32 s28, 0x3f800000
    v_min_u32 v8, 27, v1
    v_lshlrev_b32 v8, 8, v8
    v_mov_b32 v11, 1073741824
    v_cmp_eq_u32 vcc, 0, v0
    s_nop 1
    v_cndmask_b32 v10, v11, 0, vcc
    v_mov_b32 v11, 1
    v_lshlrev_b32 v13, 3, v2
    v_add_u32 v13, 0, v13
    v_lshl_add_u32 v12, s10, 7, v13
    v_mul_u32_u24 v14, 912, v2
    v_lshl_add_u32 v14, v3, 4, v14
    s_lshl_b32 s20, s10, 6
    s_add_u32 s20, s20, 4096
    v_add_u32 v14, s20, v14
    s_mul_i32 s20, s10, 3584
    v_add_u32 v16, s20, v15
    v_mov_b32 v17, 1073741824
    v_cmp_gt_u32 vcc, 56, v1
    s_nop 1
    v_cndmask_b32 v16, v17, v16, vcc
    s_mul_i32 s20, s10, 3648
    s_add_u32 s20, s20, 4096
    v_add_u32 v15, s20, v15
    s_mul_i32 s21, s8, 229376
    s_add_u32 s21, s21, 21704704
    s_mul_i32 s20, s11, 28672
    s_add_u32 s21, s21, s20
    s_mul_i32 s20, s9, 14336
    s_add_u32 s21, s21, s20
    v_lshlrev_b32 v194, 7, v0
    v_mov_b32 v195, 1073741824
    v_cmp_gt_u32 vcc, 14336, v194
    s_nop 1
    v_cndmask_b32 v194, v195, v194, vcc
    buffer_load_dword v196, v194, s[4:7], s21 offen sc1
    v_add_u32 v194, 32768, v194
    s_mul_i32 s21, s8, 327680
    s_add_u32 s21, s21, 40513536
    s_mul_i32 s20, s11, 40960
    s_add_u32 s21, s21, s20
    s_mul_i32 s20, s9, 20480
    s_add_u32 s21, s21, s20
    v_lshlrev_b32 v194, 7, v0
    v_mov_b32 v195, 1073741824
    v_cmp_gt_u32 vcc, 20480, v194
    s_nop 1
    v_cndmask_b32 v194, v195, v194, vcc
    buffer_load_dword v196, v194, s[4:7], s21 offen sc1
    v_add_u32 v194, 32768, v194
    s_mul_i32 s21, s8, 229376
    s_add_u32 s21, s21, 21762048
    s_mul_i32 s20, s11, 28672
    s_add_u32 s21, s21, s20
    s_mul_i32 s20, s9, 14336
    s_add_u32 s21, s21, s20
    v_lshlrev_b32 v194, 7, v0
    v_mov_b32 v195, 1073741824
    v_cmp_gt_u32 vcc, 14336, v194
    s_nop 1
    v_cndmask_b32 v194, v195, v194, vcc
    buffer_load_dword v196, v194, s[4:7], s21 offen sc1
    v_add_u32 v194, 32768, v194
    s_mul_i32 s21, s8, 327680
    s_add_u32 s21, s21, 40595456
    s_mul_i32 s20, s11, 40960
    s_add_u32 s21, s21, s20
    s_mul_i32 s20, s9, 20480
    s_add_u32 s21, s21, s20
    v_lshlrev_b32 v194, 7, v0
    v_mov_b32 v195, 1073741824
    v_cmp_gt_u32 vcc, 20480, v194
    s_nop 1
    v_cndmask_b32 v194, v195, v194, vcc
    buffer_load_dword v196, v194, s[4:7], s21 offen sc1
    v_add_u32 v194, 32768, v194
    s_mul_i32 s21, s8, 229376
    s_add_u32 s21, s21, 21819392
    s_mul_i32 s20, s11, 28672
    s_add_u32 s21, s21, s20
    s_mul_i32 s20, s9, 14336
    s_add_u32 s21, s21, s20
    v_lshlrev_b32 v194, 7, v0
    v_mov_b32 v195, 1073741824
    v_cmp_gt_u32 vcc, 14336, v194
    s_nop 1
    v_cndmask_b32 v194, v195, v194, vcc
    buffer_load_dword v196, v194, s[4:7], s21 offen sc1
    v_add_u32 v194, 32768, v194
    s_mul_i32 s21, s8, 327680
    s_add_u32 s21, s21, 40677376
    s_mul_i32 s20, s11, 40960
    s_add_u32 s21, s21, s20
    s_mul_i32 s20, s9, 20480
    s_add_u32 s21, s21, s20
    v_lshlrev_b32 v194, 7, v0
    v_mov_b32 v195, 1073741824
    v_cmp_gt_u32 vcc, 20480, v194
    s_nop 1
    v_cndmask_b32 v194, v195, v194, vcc
    buffer_load_dword v196, v194, s[4:7], s21 offen sc1
    v_add_u32 v194, 32768, v194
    s_mul_i32 s21, s8, 229376
    s_add_u32 s21, s21, 21876736
    s_mul_i32 s20, s11, 28672
    s_add_u32 s21, s21, s20
    s_mul_i32 s20, s9, 14336
    s_add_u32 s21, s21, s20
    v_lshlrev_b32 v194, 7, v0
    v_mov_b32 v195, 1073741824
    v_cmp_gt_u32 vcc, 14336, v194
    s_nop 1
    v_cndmask_b32 v194, v195, v194, vcc
    buffer_load_dword v196, v194, s[4:7], s21 offen sc1
    v_add_u32 v194, 32768, v194
    s_mul_i32 s21, s8, 327680
    s_add_u32 s21, s21, 40759296
    s_mul_i32 s20, s11, 40960
    s_add_u32 s21, s21, s20
    s_mul_i32 s20, s9, 20480
    s_add_u32 s21, s21, s20
    v_lshlrev_b32 v194, 7, v0
    v_mov_b32 v195, 1073741824
    v_cmp_gt_u32 vcc, 20480, v194
    s_nop 1
    v_cndmask_b32 v194, v195, v194, vcc
    buffer_load_dword v196, v194, s[4:7], s21 offen sc1
    v_add_u32 v194, 32768, v194
    v_lshlrev_b32 v194, 7, v0
    s_mov_b32 s39, 176132
ww_329:
    buffer_load_dword v195, v194, s[4:7], s39 offen sc1
    s_waitcnt vmcnt(0)
    v_cmp_eq_u32 vcc, 0, v195
    s_cbranch_vccz wwok_330
    s_sleep 4
    s_sub_u32 s13, s13, 1
    s_cbranch_scc0 ww_329
    s_mov_b32 s13, 0
wwok_330:
    s_barrier
    v_and_b32 v194, 63, v0
    v_min_u32 v194, 31, v194
    v_lshlrev_b32 v194, 10, v194
    s_and_b32 s39, s2, 7
    s_lshl_b32 s39, s39, 7
    s_add_u32 s39, s39, 176128
    buffer_load_dword v195, v194, s[4:7], s39 offen sc1
    s_waitcnt vmcnt(0)
    v_cmp_ne_u32 vcc, s15, v195
    s_cmp_lg_u64 vcc, 0
    s_cselect_b32 s12, 1, 0
    s_waitcnt lgkmcnt(0)
    v_mov_b32 v9, 0
Rloop_331:
    v_cmp_eq_u32 vcc, 0, v9
    s_cbranch_vccz ptok_335
ptp_334:
    s_sleep 1
    buffer_load_dword v9, v8, s[4:7], s24 offen sc1
    s_waitcnt vmcnt(0)
    v_cmp_eq_u32 vcc, 0, v9
    s_cbranch_vccz ptok_335
    s_sub_u32 s13, s13, 1
    s_cbranch_scc0 ptp_334
    s_mov_b32 s13, 0
ptok_335:
    s_and_b32 s32, s11, 7
    s_mul_i32 s32, s32, 200704
    s_add_u32 s32, s32, s29
    s_and_b32 s21, s11, 7
    s_mul_i32 s21, s21, 28672
    s_add_u32 s21, s21, s30
    s_add_u32 s33, s32, 28672
    s_add_u32 s34, s32, 57344
    s_add_u32 s35, s32, 86016
    s_add_u32 s36, s32, 114688
    s_add_u32 s37, s32, 143360
    s_add_u32 s38, s32, 172032
    s_cmp_lg_u32 s8, 0
    s_cbranch_scc1 Rlast_332
    s_cmp_ge_u32 s10, 2
    s_cbranch_scc1 R3_336
    buffer_load_dwordx4 v[18:21], v4, s[4:7], s32 offen sc1
    buffer_load_dwordx4 v[22:25], v4, s[4:7], s33 offen sc1
    buffer_load_dwordx4 v[26:29], v4, s[4:7], s34 offen sc1
    buffer_load_dwordx4 v[30:33], v4, s[4:7], s35 offen sc1
    buffer_load_dwordx4 v[34:37], v4, s[4:7], s36 offen sc1
    buffer_load_dwordx4 v[38:41], v4, s[4:7], s37 offen sc1
    buffer_load_dwordx4 v[42:45], v4, s[4:7], s38 offen sc1
    buffer_load_dwordx4 v[46:49], v4, s[4:7], s21 offen sc1
    buffer_load_dwordx4 v[50:53], v5, s[4:7], s32 offen sc1
    buffer_load_dwordx4 v[54:57], v5, s[4:7], s33 offen sc1
    buffer_load_dwordx4 v[58:61], v5, s[4:7], s34 offen sc1
    buffer_load_dwordx4 v[62:65], v5, s[4:7], s35 offen sc1
    buffer_load_dwordx4 v[66:69], v5, s[4:7], s36 offen sc1
    buffer_load_dwordx4 v[70:73], v5, s[4:7], s37 offen sc1
    buffer_load_dwordx4 v[74:77], v5, s[4:7], s38 offen sc1
    buffer_load_dwordx4 v[78:81], v5, s[4:7], s21 offen sc1
    buffer_load_dwordx4 v[82:85], v6, s[4:7], s32 offen sc1
    buffer_load_dwordx4 v[86:89], v6, s[4:7], s33 offen sc1
    buffer_load_dwordx4 v[90:93], v6, s[4:7], s34 offen sc1
    buffer_load_dwordx4 v[94:97], v6, s[4:7], s35 offen sc1
    buffer_load_dwordx4 v[98:101], v6, s[4:7], s36 offen sc1
    buffer_load_dwordx4 v[102:105], v6, s[4:7], s37 offen sc1
    buffer_load_dwordx4 v[106:109], v6, s[4:7], s38 offen sc1
    buffer_load_dwordx4 v[110:113], v6, s[4:7], s21 offen sc1
    buffer_load_dwordx4 v[114:117], v7, s[4:7], s32 offen sc1
    buffer_load_dwordx4 v[118:121], v7, s[4:7], s33 offen sc1
    buffer_load_dwordx4 v[122:125], v7, s[4:7], s34 offen sc1
    buffer_load_dwordx4 v[126:129], v7, s[4:7], s35 offen sc1
    buffer_load_dwordx4 v[130:133], v7, s[4:7], s36 offen sc1
    buffer_load_dwordx4 v[134:137], v7, s[4:7], s37 offen sc1
    buffer_load_dwordx4 v[138:141], v7, s[4:7], s38 offen sc1
    buffer_load_dwordx4 v[142:145], v7, s[4:7], s21 offen sc1
    buffer_load_dword v9, v8, s[4:7], s24 offen offset:8 sc1
    s_waitcnt vmcnt(32)
    v_and_b32 v147, 0xffff0000, v18
    v_lshlrev_b32 v146, 16, v18
    v_and_b32 v149, 0xffff0000, v19
    v_lshlrev_b32 v148, 16, v19
    v_and_b32 v151, 0xffff0000, v20
    v_lshlrev_b32 v150, 16, v20
    v_and_b32 v153, 0xffff0000, v21
    v_lshlrev_b32 v152, 16, v21
    s_waitcnt vmcnt(31)
    v_dot2c_f32_bf16 v146, s27, v22
    v_dot2c_f32_bf16 v147, s28, v22
    v_dot2c_f32_bf16 v148, s27, v23
    v_dot2c_f32_bf16 v149, s28, v23
    v_dot2c_f32_bf16 v150, s27, v24
    v_dot2c_f32_bf16 v151, s28, v24
    v_dot2c_f32_bf16 v152, s27, v25
    v_dot2c_f32_bf16 v153, s28, v25
    s_waitcnt vmcnt(30)
    v_dot2c_f32_bf16 v146, s27, v26
    v_dot2c_f32_bf16 v147, s28, v26
    v_dot2c_f32_bf16 v148, s27, v27
    v_dot2c_f32_bf16 v149, s28, v27
    v_dot2c_f32_bf16 v150, s27, v28
    v_dot2c_f32_bf16 v151, s28, v28
    v_dot2c_f32_bf16 v152, s27, v29
    v_dot2c_f32_bf16 v153, s28, v29
    s_waitcnt vmcnt(29)
    v_dot2c_f32_bf16 v146, s27, v30
    v_dot2c_f32_bf16 v147, s28, v30
    v_dot2c_f32_bf16 v148, s27, v31
    v_dot2c_f32_bf16 v149, s28, v31
    v_dot2c_f32_bf16 v150, s27, v32
    v_dot2c_f32_bf16 v151, s28, v32
    v_dot2c_f32_bf16 v152, s27, v33
    v_dot2c_f32_bf16 v153, s28, v33
    s_waitcnt vmcnt(28)
    v_dot2c_f32_bf16 v146, s27, v34
    v_dot2c_f32_bf16 v147, s28, v34
    v_dot2c_f32_bf16 v148, s27, v35
    v_dot2c_f32_bf16 v149, s28, v35
    v_dot2c_f32_bf16 v150, s27, v36
    v_dot2c_f32_bf16 v151, s28, v36
    v_dot2c_f32_bf16 v152, s27, v37
    v_dot2c_f32_bf16 v153, s28, v37
    s_waitcnt vmcnt(27)
    v_dot2c_f32_bf16 v146, s27, v38
    v_dot2c_f32_bf16 v147, s28, v38
    v_dot2c_f32_bf16 v148, s27, v39
    v_dot2c_f32_bf16 v149, s28, v39
    v_dot2c_f32_bf16 v150, s27, v40
    v_dot2c_f32_bf16 v151, s28, v40
    v_dot2c_f32_bf16 v152, s27, v41
    v_dot2c_f32_bf16 v153, s28, v41
    s_waitcnt vmcnt(26)
    v_dot2c_f32_bf16 v146, s27, v42
    v_dot2c_f32_bf16 v147, s28, v42
    v_dot2c_f32_bf16 v148, s27, v43
    v_dot2c_f32_bf16 v149, s28, v43
    v_dot2c_f32_bf16 v150, s27, v44
    v_dot2c_f32_bf16 v151, s28, v44
    v_dot2c_f32_bf16 v152, s27, v45
    v_dot2c_f32_bf16 v153, s28, v45
    s_waitcnt vmcnt(25)
    v_dot2c_f32_bf16 v146, s27, v46
    v_dot2c_f32_bf16 v147, s28, v46
    v_dot2c_f32_bf16 v148, s27, v47
    v_dot2c_f32_bf16 v149, s28, v47
    v_dot2c_f32_bf16 v150, s27, v48
    v_dot2c_f32_bf16 v151, s28, v48
    v_dot2c_f32_bf16 v152, s27, v49
    v_dot2c_f32_bf16 v153, s28, v49
    v_cvt_pk_bf16_f32 v178, v146, v147
    v_cvt_pk_bf16_f32 v179, v148, v149
    v_cvt_pk_bf16_f32 v180, v150, v151
    v_cvt_pk_bf16_f32 v181, v152, v153
    v_and_b32 v147, 0xffff0000, v178
    v_lshlrev_b32 v146, 16, v178
    v_and_b32 v149, 0xffff0000, v179
    v_lshlrev_b32 v148, 16, v179
    v_and_b32 v151, 0xffff0000, v180
    v_lshlrev_b32 v150, 16, v180
    v_and_b32 v153, 0xffff0000, v181
    v_lshlrev_b32 v152, 16, v181
    v_mov_b32 v194, v146
    v_mul_f32 v196, v146, v146
    v_mov_b32 v195, v147
    v_mul_f32 v197, v147, v147
    v_add_f32 v194, v194, v148
    v_fmac_f32 v196, v148, v148
    v_add_f32 v195, v195, v149
    v_fmac_f32 v197, v149, v149
    v_add_f32 v194, v194, v150
    v_fmac_f32 v196, v150, v150
    v_add_f32 v195, v195, v151
    v_fmac_f32 v197, v151, v151
    v_add_f32 v194, v194, v152
    v_fmac_f32 v196, v152, v152
    v_add_f32 v195, v195, v153
    v_fmac_f32 v197, v153, v153
    s_waitcnt vmcnt(24)
    v_and_b32 v155, 0xffff0000, v50
    v_lshlrev_b32 v154, 16, v50
    v_and_b32 v157, 0xffff0000, v51
    v_lshlrev_b32 v156, 16, v51
    v_and_b32 v159, 0xffff0000, v52
    v_lshlrev_b32 v158, 16, v52
    v_and_b32 v161, 0xffff0000, v53
    v_lshlrev_b32 v160, 16, v53
    s_waitcnt vmcnt(23)
    v_dot2c_f32_bf16 v154, s27, v54
    v_dot2c_f32_bf16 v155, s28, v54
    v_dot2c_f32_bf16 v156, s27, v55
    v_dot2c_f32_bf16 v157, s28, v55
    v_dot2c_f32_bf16 v158, s27, v56
    v_dot2c_f32_bf16 v159, s28, v56
    v_dot2c_f32_bf16 v160, s27, v57
    v_dot2c_f32_bf16 v161, s28, v57
    s_waitcnt vmcnt(22)
    v_dot2c_f32_bf16 v154, s27, v58
    v_dot2c_f32_bf16 v155, s28, v58
    v_dot2c_f32_bf16 v156, s27, v59
    v_dot2c_f32_bf16 v157, s28, v59
    v_dot2c_f32_bf16 v158, s27, v60
    v_dot2c_f32_bf16 v159, s28, v60
    v_dot2c_f32_bf16 v160, s27, v61
    v_dot2c_f32_bf16 v161, s28, v61
    buffer_store_dwordx4 v[178:181], v4, s[4:7], s23 offen sc1
    s_waitcnt vmcnt(22)
    v_dot2c_f32_bf16 v154, s27, v62
    v_dot2c_f32_bf16 v155, s28, v62
    v_dot2c_f32_bf16 v156, s27, v63
    v_dot2c_f32_bf16 v157, s28, v63
    v_dot2c_f32_bf16 v158, s27, v64
    v_dot2c_f32_bf16 v159, s28, v64
    v_dot2c_f32_bf16 v160, s27, v65
    v_dot2c_f32_bf16 v161, s28, v65
    s_waitcnt vmcnt(21)
    v_dot2c_f32_bf16 v154, s27, v66
    v_dot2c_f32_bf16 v155, s28, v66
    v_dot2c_f32_bf16 v156, s27, v67
    v_dot2c_f32_bf16 v157, s28, v67
    v_dot2c_f32_bf16 v158, s27, v68
    v_dot2c_f32_bf16 v159, s28, v68
    v_dot2c_f32_bf16 v160, s27, v69
    v_dot2c_f32_bf16 v161, s28, v69
    s_waitcnt vmcnt(20)
    v_dot2c_f32_bf16 v154, s27, v70
    v_dot2c_f32_bf16 v155, s28, v70
    v_dot2c_f32_bf16 v156, s27, v71
    v_dot2c_f32_bf16 v157, s28, v71
    v_dot2c_f32_bf16 v158, s27, v72
    v_dot2c_f32_bf16 v159, s28, v72
    v_dot2c_f32_bf16 v160, s27, v73
    v_dot2c_f32_bf16 v161, s28, v73
    s_waitcnt vmcnt(19)
    v_dot2c_f32_bf16 v154, s27, v74
    v_dot2c_f32_bf16 v155, s28, v74
    v_dot2c_f32_bf16 v156, s27, v75
    v_dot2c_f32_bf16 v157, s28, v75
    v_dot2c_f32_bf16 v158, s27, v76
    v_dot2c_f32_bf16 v159, s28, v76
    v_dot2c_f32_bf16 v160, s27, v77
    v_dot2c_f32_bf16 v161, s28, v77
    s_waitcnt vmcnt(18)
    v_dot2c_f32_bf16 v154, s27, v78
    v_dot2c_f32_bf16 v155, s28, v78
    v_dot2c_f32_bf16 v156, s27, v79
    v_dot2c_f32_bf16 v157, s28, v79
    v_dot2c_f32_bf16 v158, s27, v80
    v_dot2c_f32_bf16 v159, s28, v80
    v_dot2c_f32_bf16 v160, s27, v81
    v_dot2c_f32_bf16 v161, s28, v81
    v_cvt_pk_bf16_f32 v182, v154, v155
    v_cvt_pk_bf16_f32 v183, v156, v157
    v_cvt_pk_bf16_f32 v184, v158, v159
    v_cvt_pk_bf16_f32 v185, v160, v161
    v_and_b32 v155, 0xffff0000, v182
    v_lshlrev_b32 v154, 16, v182
    v_and_b32 v157, 0xffff0000, v183
    v_lshlrev_b32 v156, 16, v183
    v_and_b32 v159, 0xffff0000, v184
    v_lshlrev_b32 v158, 16, v184
    v_and_b32 v161, 0xffff0000, v185
    v_lshlrev_b32 v160, 16, v185
    v_add_f32 v194, v194, v154
    v_fmac_f32 v196, v154, v154
    v_add_f32 v195, v195, v155
    v_fmac_f32 v197, v155, v155
    v_add_f32 v194, v194, v156
    v_fmac_f32 v196, v156, v156
    v_add_f32 v195, v195, v157
    v_fmac_f32 v197, v157, v157
    v_add_f32 v194, v194, v158
    v_fmac_f32 v196, v158, v158
    v_add_f32 v195, v195, v159
    v_fmac_f32 v197, v159, v159
    v_add_f32 v194, v194, v160
    v_fmac_f32 v196, v160, v160
    v_add_f32 v195, v195, v161
    v_fmac_f32 v197, v161, v161
    s_waitcnt vmcnt(17)
    v_and_b32 v163, 0xffff0000, v82
    v_lshlrev_b32 v162, 16, v82
    v_and_b32 v165, 0xffff0000, v83
    v_lshlrev_b32 v164, 16, v83
    v_and_b32 v167, 0xffff0000, v84
    v_lshlrev_b32 v166, 16, v84
    v_and_b32 v169, 0xffff0000, v85
    v_lshlrev_b32 v168, 16, v85
    s_waitcnt vmcnt(16)
    v_dot2c_f32_bf16 v162, s27, v86
    v_dot2c_f32_bf16 v163, s28, v86
    v_dot2c_f32_bf16 v164, s27, v87
    v_dot2c_f32_bf16 v165, s28, v87
    v_dot2c_f32_bf16 v166, s27, v88
    v_dot2c_f32_bf16 v167, s28, v88
    v_dot2c_f32_bf16 v168, s27, v89
    v_dot2c_f32_bf16 v169, s28, v89
    s_waitcnt vmcnt(15)
    v_dot2c_f32_bf16 v162, s27, v90
    v_dot2c_f32_bf16 v163, s28, v90
    v_dot2c_f32_bf16 v164, s27, v91
    v_dot2c_f32_bf16 v165, s28, v91
    v_dot2c_f32_bf16 v166, s27, v92
    v_dot2c_f32_bf16 v167, s28, v92
    v_dot2c_f32_bf16 v168, s27, v93
    v_dot2c_f32_bf16 v169, s28, v93
    buffer_store_dwordx4 v[182:185], v5, s[4:7], s23 offen sc1
    s_waitcnt vmcnt(15)
    v_dot2c_f32_bf16 v162, s27, v94
    v_dot2c_f32_bf16 v163, s28, v94
    v_dot2c_f32_bf16 v164, s27, v95
    v_dot2c_f32_bf16 v165, s28, v95
    v_dot2c_f32_bf16 v166, s27, v96
    v_dot2c_f32_bf16 v167, s28, v96
    v_dot2c_f32_bf16 v168, s27, v97
    v_dot2c_f32_bf16 v169, s28, v97
    s_waitcnt vmcnt(14)
    v_dot2c_f32_bf16 v162, s27, v98
    v_dot2c_f32_bf16 v163, s28, v98
    v_dot2c_f32_bf16 v164, s27, v99
    v_dot2c_f32_bf16 v165, s28, v99
    v_dot2c_f32_bf16 v166, s27, v100
    v_dot2c_f32_bf16 v167, s28, v100
    v_dot2c_f32_bf16 v168, s27, v101
    v_dot2c_f32_bf16 v169, s28, v101
    s_waitcnt vmcnt(13)
    v_dot2c_f32_bf16 v162, s27, v102
    v_dot2c_f32_bf16 v163, s28, v102
    v_dot2c_f32_bf16 v164, s27, v103
    v_dot2c_f32_bf16 v165, s28, v103
    v_dot2c_f32_bf16 v166, s27, v104
    v_dot2c_f32_bf16 v167, s28, v104
    v_dot2c_f32_bf16 v168, s27, v105
    v_dot2c_f32_bf16 v169, s28, v105
    s_waitcnt vmcnt(12)
    v_dot2c_f32_bf16 v162, s27, v106
    v_dot2c_f32_bf16 v163, s28, v106
    v_dot2c_f32_bf16 v164, s27, v107
    v_dot2c_f32_bf16 v165, s28, v107
    v_dot2c_f32_bf16 v166, s27, v108
    v_dot2c_f32_bf16 v167, s28, v108
    v_dot2c_f32_bf16 v168, s27, v109
    v_dot2c_f32_bf16 v169, s28, v109
    s_waitcnt vmcnt(11)
    v_dot2c_f32_bf16 v162, s27, v110
    v_dot2c_f32_bf16 v163, s28, v110
    v_dot2c_f32_bf16 v164, s27, v111
    v_dot2c_f32_bf16 v165, s28, v111
    v_dot2c_f32_bf16 v166, s27, v112
    v_dot2c_f32_bf16 v167, s28, v112
    v_dot2c_f32_bf16 v168, s27, v113
    v_dot2c_f32_bf16 v169, s28, v113
    v_cvt_pk_bf16_f32 v186, v162, v163
    v_cvt_pk_bf16_f32 v187, v164, v165
    v_cvt_pk_bf16_f32 v188, v166, v167
    v_cvt_pk_bf16_f32 v189, v168, v169
    v_and_b32 v163, 0xffff0000, v186
    v_lshlrev_b32 v162, 16, v186
    v_and_b32 v165, 0xffff0000, v187
    v_lshlrev_b32 v164, 16, v187
    v_and_b32 v167, 0xffff0000, v188
    v_lshlrev_b32 v166, 16, v188
    v_and_b32 v169, 0xffff0000, v189
    v_lshlrev_b32 v168, 16, v189
    v_add_f32 v194, v194, v162
    v_fmac_f32 v196, v162, v162
    v_add_f32 v195, v195, v163
    v_fmac_f32 v197, v163, v163
    v_add_f32 v194, v194, v164
    v_fmac_f32 v196, v164, v164
    v_add_f32 v195, v195, v165
    v_fmac_f32 v197, v165, v165
    v_add_f32 v194, v194, v166
    v_fmac_f32 v196, v166, v166
    v_add_f32 v195, v195, v167
    v_fmac_f32 v197, v167, v167
    v_add_f32 v194, v194, v168
    v_fmac_f32 v196, v168, v168
    v_add_f32 v195, v195, v169
    v_fmac_f32 v197, v169, v169
    s_waitcnt vmcnt(10)
    v_and_b32 v171, 0xffff0000, v114
    v_lshlrev_b32 v170, 16, v114
    v_and_b32 v173, 0xffff0000, v115
    v_lshlrev_b32 v172, 16, v115
    v_and_b32 v175, 0xffff0000, v116
    v_lshlrev_b32 v174, 16, v116
    v_and_b32 v177, 0xffff0000, v117
    v_lshlrev_b32 v176, 16, v117
    s_waitcnt vmcnt(9)
    v_dot2c_f32_bf16 v170, s27, v118
    v_dot2c_f32_bf16 v171, s28, v118
    v_dot2c_f32_bf16 v172, s27, v119
    v_dot2c_f32_bf16 v173, s28, v119
    v_dot2c_f32_bf16 v174, s27, v120
    v_dot2c_f32_bf16 v175, s28, v120
    v_dot2c_f32_bf16 v176, s27, v121
    v_dot2c_f32_bf16 v177, s28, v121
    s_waitcnt vmcnt(8)
    v_dot2c_f32_bf16 v170, s27, v122
    v_dot2c_f32_bf16 v171, s28, v122
    v_dot2c_f32_bf16 v172, s27, v123
    v_dot2c_f32_bf16 v173, s28, v123
    v_dot2c_f32_bf16 v174, s27, v124
    v_dot2c_f32_bf16 v175, s28, v124
    v_dot2c_f32_bf16 v176, s27, v125
    v_dot2c_f32_bf16 v177, s28, v125
    buffer_store_dwordx4 v[186:189], v6, s[4:7], s23 offen sc1
    s_waitcnt vmcnt(8)
    v_dot2c_f32_bf16 v170, s27, v126
    v_dot2c_f32_bf16 v171, s28, v126
    v_dot2c_f32_bf16 v172, s27, v127
    v_dot2c_f32_bf16 v173, s28, v127
    v_dot2c_f32_bf16 v174, s27, v128
    v_dot2c_f32_bf16 v175, s28, v128
    v_dot2c_f32_bf16 v176, s27, v129
    v_dot2c_f32_bf16 v177, s28, v129
    s_waitcnt vmcnt(7)
    v_dot2c_f32_bf16 v170, s27, v130
    v_dot2c_f32_bf16 v171, s28, v130
    v_dot2c_f32_bf16 v172, s27, v131
    v_dot2c_f32_bf16 v173, s28, v131
    v_dot2c_f32_bf16 v174, s27, v132
    v_dot2c_f32_bf16 v175, s28, v132
    v_dot2c_f32_bf16 v176, s27, v133
    v_dot2c_f32_bf16 v177, s28, v133
    s_waitcnt vmcnt(6)
    v_dot2c_f32_bf16 v170, s27, v134
    v_dot2c_f32_bf16 v171, s28, v134
    v_dot2c_f32_bf16 v172, s27, v135
    v_dot2c_f32_bf16 v173, s28, v135
    v_dot2c_f32_bf16 v174, s27, v136
    v_dot2c_f32_bf16 v175, s28, v136
    v_dot2c_f32_bf16 v176, s27, v137
    v_dot2c_f32_bf16 v177, s28, v137
    s_waitcnt vmcnt(5)
    v_dot2c_f32_bf16 v170, s27, v138
    v_dot2c_f32_bf16 v171, s28, v138
    v_dot2c_f32_bf16 v172, s27, v139
    v_dot2c_f32_bf16 v173, s28, v139
    v_dot2c_f32_bf16 v174, s27, v140
    v_dot2c_f32_bf16 v175, s28, v140
    v_dot2c_f32_bf16 v176, s27, v141
    v_dot2c_f32_bf16 v177, s28, v141
    s_waitcnt vmcnt(4)
    v_dot2c_f32_bf16 v170, s27, v142
    v_dot2c_f32_bf16 v171, s28, v142
    v_dot2c_f32_bf16 v172, s27, v143
    v_dot2c_f32_bf16 v173, s28, v143
    v_dot2c_f32_bf16 v174, s27, v144
    v_dot2c_f32_bf16 v175, s28, v144
    v_dot2c_f32_bf16 v176, s27, v145
    v_dot2c_f32_bf16 v177, s28, v145
    v_cvt_pk_bf16_f32 v190, v170, v171
    v_cvt_pk_bf16_f32 v191, v172, v173
    v_cvt_pk_bf16_f32 v192, v174, v175
    v_cvt_pk_bf16_f32 v193, v176, v177
    v_and_b32 v171, 0xffff0000, v190
    v_lshlrev_b32 v170, 16, v190
    v_and_b32 v173, 0xffff0000, v191
    v_lshlrev_b32 v172, 16, v191
    v_and_b32 v175, 0xffff0000, v192
    v_lshlrev_b32 v174, 16, v192
    v_and_b32 v177, 0xffff0000, v193
    v_lshlrev_b32 v176, 16, v193
    v_add_f32 v194, v194, v170
    v_fmac_f32 v196, v170, v170
    v_add_f32 v195, v195, v171
    v_fmac_f32 v197, v171, v171
    v_add_f32 v194, v194, v172
    v_fmac_f32 v196, v172, v172
    v_add_f32 v195, v195, v173
    v_fmac_f32 v197, v173, v173
    v_add_f32 v194, v194, v174
    v_fmac_f32 v196, v174, v174
    v_add_f32 v195, v195, v175
    v_fmac_f32 v197, v175, v175
    v_add_f32 v194, v194, v176
    v_fmac_f32 v196, v176, v176
    v_add_f32 v195, v195, v177
    v_fmac_f32 v197, v177, v177
    v_add_f32 v194, v194, v195
    v_add_f32 v195, v196, v197
    v_mov_b32 v196, v194
    v_mov_b32 v197, v195
    buffer_store_dwordx4 v[190:193], v7, s[4:7], s23 offen sc1
    v_permlane16_swap_b32 v194, v196
    v_permlane16_swap_b32 v195, v197
    v_add_f32 v194, v194, v196
    v_add_f32 v195, v195, v197
    v_mov_b32 v196, v194
    v_mov_b32 v197, v195
    s_nop 0
    v_permlane32_swap_b32 v194, v196
    v_permlane32_swap_b32 v195, v197
    v_add_f32 v194, v194, v196
    v_add_f32 v195, v195, v197
    ds_write_b64 v12, v[194:195]
    s_waitcnt lgkmcnt(0)
    s_barrier
    ds_read_b64 v[198:199], v13 offset:0
    ds_read_b64 v[200:201], v13 offset:128
    ds_read_b64 v[202:203], v13 offset:256
    ds_read_b64 v[204:205], v13 offset:384
    s_waitcnt lgkmcnt(2)
    v_add_f32 v198, v198, v200
    v_add_f32 v199, v199, v201
    s_waitcnt lgkmcnt(0)
    v_add_f32 v202, v202, v204
    v_add_f32 v203, v203, v205
    v_add_f32 v194, v198, v202
    v_add_f32 v195, v199, v203
    v_mul_f32 v194, 0x3b124925, v194
    v_mul_f32 v195, 0x3b124925, v195
    v_fma_f32 v195, -v194, v194, v195
    v_max_f32 v195, 0, v195
    v_add_f32 v195, 0x3727c5ac, v195
    v_rsq_f32 v195, v195
    s_nop 0
    v_mul_f32 v194, v194, v195
    v_fma_f32 v146, v146, v195, -v194
    v_fma_f32 v147, v147, v195, -v194
    v_fma_f32 v148, v148, v195, -v194
    v_fma_f32 v149, v149, v195, -v194
    v_fma_f32 v150, v150, v195, -v194
    v_fma_f32 v151, v151, v195, -v194
    v_fma_f32 v152, v152, v195, -v194
    v_fma_f32 v153, v153, v195, -v194
    v_cvt_pk_bf16_f32 v146, v146, v147
    v_cvt_pk_bf16_f32 v147, v148, v149
    v_cvt_pk_bf16_f32 v148, v150, v151
    v_cvt_pk_bf16_f32 v149, v152, v153
    v_fma_f32 v154, v154, v195, -v194
    buffer_store_dwordx4 v[146:149], v4, s[4:7], s22 offen sc1
    v_fma_f32 v155, v155, v195, -v194
    v_fma_f32 v156, v156, v195, -v194
    v_fma_f32 v157, v157, v195, -v194
    v_fma_f32 v158, v158, v195, -v194
    v_fma_f32 v159, v159, v195, -v194
    v_fma_f32 v160, v160, v195, -v194
    v_fma_f32 v161, v161, v195, -v194
    v_cvt_pk_bf16_f32 v154, v154, v155
    v_cvt_pk_bf16_f32 v155, v156, v157
    v_cvt_pk_bf16_f32 v156, v158, v159
    v_cvt_pk_bf16_f32 v157, v160, v161
    v_fma_f32 v162, v162, v195, -v194
    buffer_store_dwordx4 v[154:157], v5, s[4:7], s22 offen sc1
    v_fma_f32 v163, v163, v195, -v194
    v_fma_f32 v164, v164, v195, -v194
    v_fma_f32 v165, v165, v195, -v194
    v_fma_f32 v166, v166, v195, -v194
    v_fma_f32 v167, v167, v195, -v194
    v_fma_f32 v168, v168, v195, -v194
    v_fma_f32 v169, v169, v195, -v194
    v_cvt_pk_bf16_f32 v162, v162, v163
    v_cvt_pk_bf16_f32 v163, v164, v165
    v_cvt_pk_bf16_f32 v164, v166, v167
    v_cvt_pk_bf16_f32 v165, v168, v169
    v_fma_f32 v170, v170, v195, -v194
    buffer_store_dwordx4 v[162:165], v6, s[4:7], s22 offen sc1
    v_fma_f32 v171, v171, v195, -v194
    v_fma_f32 v172, v172, v195, -v194
    v_fma_f32 v173, v173, v195, -v194
    v_fma_f32 v174, v174, v195, -v194
    v_fma_f32 v175, v175, v195, -v194
    v_fma_f32 v176, v176, v195, -v194
    v_fma_f32 v177, v177, v195, -v194
    v_cvt_pk_bf16_f32 v170, v170, v171
    v_cvt_pk_bf16_f32 v171, v172, v173
    v_cvt_pk_bf16_f32 v172, v174, v175
    v_cvt_pk_bf16_f32 v173, v176, v177
    buffer_store_dwordx4 v[170:173], v7, s[4:7], s22 offen sc1
    s_branch Rj_337
R3_336:
    buffer_load_dwordx4 v[18:21], v4, s[4:7], s32 offen sc1
    buffer_load_dwordx4 v[22:25], v4, s[4:7], s33 offen sc1
    buffer_load_dwordx4 v[26:29], v4, s[4:7], s34 offen sc1
    buffer_load_dwordx4 v[30:33], v4, s[4:7], s35 offen sc1
    buffer_load_dwordx4 v[34:37], v4, s[4:7], s36 offen sc1
    buffer_load_dwordx4 v[38:41], v4, s[4:7], s37 offen sc1
    buffer_load_dwordx4 v[42:45], v4, s[4:7], s38 offen sc1
    buffer_load_dwordx4 v[46:49], v4, s[4:7], s21 offen sc1
    buffer_load_dwordx4 v[50:53], v5, s[4:7], s32 offen sc1
    buffer_load_dwordx4 v[54:57], v5, s[4:7], s33 offen sc1
    buffer_load_dwordx4 v[58:61], v5, s[4:7], s34 offen sc1
    buffer_load_dwordx4 v[62:65], v5, s[4:7], s35 offen sc1
    buffer_load_dwordx4 v[66:69], v5, s[4:7], s36 offen sc1
    buffer_load_dwordx4 v[70:73], v5, s[4:7], s37 offen sc1
    buffer_load_dwordx4 v[74:77], v5, s[4:7], s38 offen sc1
    buffer_load_dwordx4 v[78:81], v5, s[4:7], s21 offen sc1
    buffer_load_dwordx4 v[82:85], v6, s[4:7], s32 offen sc1
    buffer_load_dwordx4 v[86:89], v6, s[4:7], s33 offen sc1
    buffer_load_dwordx4 v[90:93], v6, s[4:7], s34 offen sc1
    buffer_load_dwordx4 v[94:97], v6, s[4:7], s35 offen sc1
    buffer_load_dwordx4 v[98:101], v6, s[4:7], s36 offen sc1
    buffer_load_dwordx4 v[102:105], v6, s[4:7], s37 offen sc1
    buffer_load_dwordx4 v[106:109], v6, s[4:7], s38 offen sc1
    buffer_load_dwordx4 v[110:113], v6, s[4:7], s21 offen sc1
    buffer_load_dword v9, v8, s[4:7], s24 offen offset:8 sc1
    s_waitcnt vmcnt(24)
    v_and_b32 v147, 0xffff0000, v18
    v_lshlrev_b32 v146, 16, v18
    v_and_b32 v149, 0xffff0000, v19
    v_lshlrev_b32 v148, 16, v19
    v_and_b32 v151, 0xffff0000, v20
    v_lshlrev_b32 v150, 16, v20
    v_and_b32 v153, 0xffff0000, v21
    v_lshlrev_b32 v152, 16, v21
    s_waitcnt vmcnt(23)
    v_dot2c_f32_bf16 v146, s27, v22
    v_dot2c_f32_bf16 v147, s28, v22
    v_dot2c_f32_bf16 v148, s27, v23
    v_dot2c_f32_bf16 v149, s28, v23
    v_dot2c_f32_bf16 v150, s27, v24
    v_dot2c_f32_bf16 v151, s28, v24
    v_dot2c_f32_bf16 v152, s27, v25
    v_dot2c_f32_bf16 v153, s28, v25
    s_waitcnt vmcnt(22)
    v_dot2c_f32_bf16 v146, s27, v26
    v_dot2c_f32_bf16 v147, s28, v26
    v_dot2c_f32_bf16 v148, s27, v27
    v_dot2c_f32_bf16 v149, s28, v27
    v_dot2c_f32_bf16 v150, s27, v28
    v_dot2c_f32_bf16 v151, s28, v28
    v_dot2c_f32_bf16 v152, s27, v29
    v_dot2c_f32_bf16 v153, s28, v29
    s_waitcnt vmcnt(21)
    v_dot2c_f32_bf16 v146, s27, v30
    v_dot2c_f32_bf16 v147, s28, v30
    v_dot2c_f32_bf16 v148, s27, v31
    v_dot2c_f32_bf16 v149, s28, v31
    v_dot2c_f32_bf16 v150, s27, v32
    v_dot2c_f32_bf16 v151, s28, v32
    v_dot2c_f32_bf16 v152, s27, v33
    v_dot2c_f32_bf16 v153, s28, v33
    s_waitcnt vmcnt(20)
    v_dot2c_f32_bf16 v146, s27, v34
    v_dot2c_f32_bf16 v147, s28, v34
    v_dot2c_f32_bf16 v148, s27, v35
    v_dot2c_f32_bf16 v149, s28, v35
    v_dot2c_f32_bf16 v150, s27, v36
    v_dot2c_f32_bf16 v151, s28, v36
    v_dot2c_f32_bf16 v152, s27, v37
    v_dot2c_f32_bf16 v153, s28, v37
    s_waitcnt vmcnt(19)
    v_dot2c_f32_bf16 v146, s27, v38
    v_dot2c_f32_bf16 v147, s28, v38
    v_dot2c_f32_bf16 v148, s27, v39
    v_dot2c_f32_bf16 v149, s28, v39
    v_dot2c_f32_bf16 v150, s27, v40
    v_dot2c_f32_bf16 v151, s28, v40
    v_dot2c_f32_bf16 v152, s27, v41
    v_dot2c_f32_bf16 v153, s28, v41
    s_waitcnt vmcnt(18)
    v_dot2c_f32_bf16 v146, s27, v42
    v_dot2c_f32_bf16 v147, s28, v42
    v_dot2c_f32_bf16 v148, s27, v43
    v_dot2c_f32_bf16 v149, s28, v43
    v_dot2c_f32_bf16 v150, s27, v44
    v_dot2c_f32_bf16 v151, s28, v44
    v_dot2c_f32_bf16 v152, s27, v45
    v_dot2c_f32_bf16 v153, s28, v45
    s_waitcnt vmcnt(17)
    v_dot2c_f32_bf16 v146, s27, v46
    v_dot2c_f32_bf16 v147, s28, v46
    v_dot2c_f32_bf16 v148, s27, v47
    v_dot2c_f32_bf16 v149, s28, v47
    v_dot2c_f32_bf16 v150, s27, v48
    v_dot2c_f32_bf16 v151, s28, v48
    v_dot2c_f32_bf16 v152, s27, v49
    v_dot2c_f32_bf16 v153, s28, v49
    v_cvt_pk_bf16_f32 v178, v146, v147
    v_cvt_pk_bf16_f32 v179, v148, v149
    v_cvt_pk_bf16_f32 v180, v150, v151
    v_cvt_pk_bf16_f32 v181, v152, v153
    v_and_b32 v147, 0xffff0000, v178
    v_lshlrev_b32 v146, 16, v178
    v_and_b32 v149, 0xffff0000, v179
    v_lshlrev_b32 v148, 16, v179
    v_and_b32 v151, 0xffff0000, v180
    v_lshlrev_b32 v150, 16, v180
    v_and_b32 v153, 0xffff0000, v181
    v_lshlrev_b32 v152, 16, v181
    v_mov_b32 v194, v146
    v_mul_f32 v196, v146, v146
    v_mov_b32 v195, v147
    v_mul_f32 v197, v147, v147
    v_add_f32 v194, v194, v148
    v_fmac_f32 v196, v148, v148
    v_add_f32 v195, v195, v149
    v_fmac_f32 v197, v149, v149
    v_add_f32 v194, v194, v150
    v_fmac_f32 v196, v150, v150
    v_add_f32 v195, v195, v151
    v_fmac_f32 v197, v151, v151
    v_add_f32 v194, v194, v152
    v_fmac_f32 v196, v152, v152
    v_add_f32 v195, v195, v153
    v_fmac_f32 v197, v153, v153
    s_waitcnt vmcnt(16)
    v_and_b32 v155, 0xffff0000, v50
    v_lshlrev_b32 v154, 16, v50
    v_and_b32 v157, 0xffff0000, v51
    v_lshlrev_b32 v156, 16, v51
    v_and_b32 v159, 0xffff0000, v52
    v_lshlrev_b32 v158, 16, v52
    v_and_b32 v161, 0xffff0000, v53
    v_lshlrev_b32 v160, 16, v53
    s_waitcnt vmcnt(15)
    v_dot2c_f32_bf16 v154, s27, v54
    v_dot2c_f32_bf16 v155, s28, v54
    v_dot2c_f32_bf16 v156, s27, v55
    v_dot2c_f32_bf16 v157, s28, v55
    v_dot2c_f32_bf16 v158, s27, v56
    v_dot2c_f32_bf16 v159, s28, v56
    v_dot2c_f32_bf16 v160, s27, v57
    v_dot2c_f32_bf16 v161, s28, v57
    s_waitcnt vmcnt(14)
    v_dot2c_f32_bf16 v154, s27, v58
    v_dot2c_f32_bf16 v155, s28, v58
    v_dot2c_f32_bf16 v156, s27, v59
    v_dot2c_f32_bf16 v157, s28, v59
    v_dot2c_f32_bf16 v158, s27, v60
    v_dot2c_f32_bf16 v159, s28, v60
    v_dot2c_f32_bf16 v160, s27, v61
    v_dot2c_f32_bf16 v161, s28, v61
    buffer_store_dwordx4 v[178:181], v4, s[4:7], s23 offen sc1
    s_waitcnt vmcnt(14)
    v_dot2c_f32_bf16 v154, s27, v62
    v_dot2c_f32_bf16 v155, s28, v62
    v_dot2c_f32_bf16 v156, s27, v63
    v_dot2c_f32_bf16 v157, s28, v63
    v_dot2c_f32_bf16 v158, s27, v64
    v_dot2c_f32_bf16 v159, s28, v64
    v_dot2c_f32_bf16 v160, s27, v65
    v_dot2c_f32_bf16 v161, s28, v65
    s_waitcnt vmcnt(13)
    v_dot2c_f32_bf16 v154, s27, v66
    v_dot2c_f32_bf16 v155, s28, v66
    v_dot2c_f32_bf16 v156, s27, v67
    v_dot2c_f32_bf16 v157, s28, v67
    v_dot2c_f32_bf16 v158, s27, v68
    v_dot2c_f32_bf16 v159, s28, v68
    v_dot2c_f32_bf16 v160, s27, v69
    v_dot2c_f32_bf16 v161, s28, v69
    s_waitcnt vmcnt(12)
    v_dot2c_f32_bf16 v154, s27, v70
    v_dot2c_f32_bf16 v155, s28, v70
    v_dot2c_f32_bf16 v156, s27, v71
    v_dot2c_f32_bf16 v157, s28, v71
    v_dot2c_f32_bf16 v158, s27, v72
    v_dot2c_f32_bf16 v159, s28, v72
    v_dot2c_f32_bf16 v160, s27, v73
    v_dot2c_f32_bf16 v161, s28, v73
    s_waitcnt vmcnt(11)
    v_dot2c_f32_bf16 v154, s27, v74
    v_dot2c_f32_bf16 v155, s28, v74
    v_dot2c_f32_bf16 v156, s27, v75
    v_dot2c_f32_bf16 v157, s28, v75
    v_dot2c_f32_bf16 v158, s27, v76
    v_dot2c_f32_bf16 v159, s28, v76
    v_dot2c_f32_bf16 v160, s27, v77
    v_dot2c_f32_bf16 v161, s28, v77
    s_waitcnt vmcnt(10)
    v_dot2c_f32_bf16 v154, s27, v78
    v_dot2c_f32_bf16 v155, s28, v78
    v_dot2c_f32_bf16 v156, s27, v79
    v_dot2c_f32_bf16 v157, s28, v79
    v_dot2c_f32_bf16 v158, s27, v80
    v_dot2c_f32_bf16 v159, s28, v80
    v_dot2c_f32_bf16 v160, s27, v81
    v_dot2c_f32_bf16 v161, s28, v81
    v_cvt_pk_bf16_f32 v182, v154, v155
    v_cvt_pk_bf16_f32 v183, v156, v157
    v_cvt_pk_bf16_f32 v184, v158, v159
    v_cvt_pk_bf16_f32 v185, v160, v161
    v_and_b32 v155, 0xffff0000, v182
    v_lshlrev_b32 v154, 16, v182
    v_and_b32 v157, 0xffff0000, v183
    v_lshlrev_b32 v156, 16, v183
    v_and_b32 v159, 0xffff0000, v184
    v_lshlrev_b32 v158, 16, v184
    v_and_b32 v161, 0xffff0000, v185
    v_lshlrev_b32 v160, 16, v185
    v_add_f32 v194, v194, v154
    v_fmac_f32 v196, v154, v154
    v_add_f32 v195, v195, v155
    v_fmac_f32 v197, v155, v155
    v_add_f32 v194, v194, v156
    v_fmac_f32 v196, v156, v156
    v_add_f32 v195, v195, v157
    v_fmac_f32 v197, v157, v157
    v_add_f32 v194, v194, v158
    v_fmac_f32 v196, v158, v158
    v_add_f32 v195, v195, v159
    v_fmac_f32 v197, v159, v159
    v_add_f32 v194, v194, v160
    v_fmac_f32 v196, v160, v160
    v_add_f32 v195, v195, v161
    v_fmac_f32 v197, v161, v161
    s_waitcnt vmcnt(9)
    v_and_b32 v163, 0xffff0000, v82
    v_lshlrev_b32 v162, 16, v82
    v_and_b32 v165, 0xffff0000, v83
    v_lshlrev_b32 v164, 16, v83
    v_and_b32 v167, 0xffff0000, v84
    v_lshlrev_b32 v166, 16, v84
    v_and_b32 v169, 0xffff0000, v85
    v_lshlrev_b32 v168, 16, v85
    s_waitcnt vmcnt(8)
    v_dot2c_f32_bf16 v162, s27, v86
    v_dot2c_f32_bf16 v163, s28, v86
    v_dot2c_f32_bf16 v164, s27, v87
    v_dot2c_f32_bf16 v165, s28, v87
    v_dot2c_f32_bf16 v166, s27, v88
    v_dot2c_f32_bf16 v167, s28, v88
    v_dot2c_f32_bf16 v168, s27, v89
    v_dot2c_f32_bf16 v169, s28, v89
    s_waitcnt vmcnt(7)
    v_dot2c_f32_bf16 v162, s27, v90
    v_dot2c_f32_bf16 v163, s28, v90
    v_dot2c_f32_bf16 v164, s27, v91
    v_dot2c_f32_bf16 v165, s28, v91
    v_dot2c_f32_bf16 v166, s27, v92
    v_dot2c_f32_bf16 v167, s28, v92
    v_dot2c_f32_bf16 v168, s27, v93
    v_dot2c_f32_bf16 v169, s28, v93
    buffer_store_dwordx4 v[182:185], v5, s[4:7], s23 offen sc1
    s_waitcnt vmcnt(7)
    v_dot2c_f32_bf16 v162, s27, v94
    v_dot2c_f32_bf16 v163, s28, v94
    v_dot2c_f32_bf16 v164, s27, v95
    v_dot2c_f32_bf16 v165, s28, v95
    v_dot2c_f32_bf16 v166, s27, v96
    v_dot2c_f32_bf16 v167, s28, v96
    v_dot2c_f32_bf16 v168, s27, v97
    v_dot2c_f32_bf16 v169, s28, v97
    s_waitcnt vmcnt(6)
    v_dot2c_f32_bf16 v162, s27, v98
    v_dot2c_f32_bf16 v163, s28, v98
    v_dot2c_f32_bf16 v164, s27, v99
    v_dot2c_f32_bf16 v165, s28, v99
    v_dot2c_f32_bf16 v166, s27, v100
    v_dot2c_f32_bf16 v167, s28, v100
    v_dot2c_f32_bf16 v168, s27, v101
    v_dot2c_f32_bf16 v169, s28, v101
    s_waitcnt vmcnt(5)
    v_dot2c_f32_bf16 v162, s27, v102
    v_dot2c_f32_bf16 v163, s28, v102
    v_dot2c_f32_bf16 v164, s27, v103
    v_dot2c_f32_bf16 v165, s28, v103
    v_dot2c_f32_bf16 v166, s27, v104
    v_dot2c_f32_bf16 v167, s28, v104
    v_dot2c_f32_bf16 v168, s27, v105
    v_dot2c_f32_bf16 v169, s28, v105
    s_waitcnt vmcnt(4)
    v_dot2c_f32_bf16 v162, s27, v106
    v_dot2c_f32_bf16 v163, s28, v106
    v_dot2c_f32_bf16 v164, s27, v107
    v_dot2c_f32_bf16 v165, s28, v107
    v_dot2c_f32_bf16 v166, s27, v108
    v_dot2c_f32_bf16 v167, s28, v108
    v_dot2c_f32_bf16 v168, s27, v109
    v_dot2c_f32_bf16 v169, s28, v109
    s_waitcnt vmcnt(3)
    v_dot2c_f32_bf16 v162, s27, v110
    v_dot2c_f32_bf16 v163, s28, v110
    v_dot2c_f32_bf16 v164, s27, v111
    v_dot2c_f32_bf16 v165, s28, v111
    v_dot2c_f32_bf16 v166, s27, v112
    v_dot2c_f32_bf16 v167, s28, v112
    v_dot2c_f32_bf16 v168, s27, v113
    v_dot2c_f32_bf16 v169, s28, v113
    v_cvt_pk_bf16_f32 v186, v162, v163
    v_cvt_pk_bf16_f32 v187, v164, v165
    v_cvt_pk_bf16_f32 v188, v166, v167
    v_cvt_pk_bf16_f32 v189, v168, v169
    v_and_b32 v163, 0xffff0000, v186
    v_lshlrev_b32 v162, 16, v186
    v_and_b32 v165, 0xffff0000, v187
    v_lshlrev_b32 v164, 16, v187
    v_and_b32 v167, 0xffff0000, v188
    v_lshlrev_b32 v166, 16, v188
    v_and_b32 v169, 0xffff0000, v189
    v_lshlrev_b32 v168, 16, v189
    v_add_f32 v194, v194, v162
    v_fmac_f32 v196, v162, v162
    v_add_f32 v195, v195, v163
    v_fmac_f32 v197, v163, v163
    v_add_f32 v194, v194, v164
    v_fmac_f32 v196, v164, v164
    v_add_f32 v195, v195, v165
    v_fmac_f32 v197, v165, v165
    v_add_f32 v194, v194, v166
    v_fmac_f32 v196, v166, v166
    v_add_f32 v195, v195, v167
    v_fmac_f32 v197, v167, v167
    v_add_f32 v194, v194, v168
    v_fmac_f32 v196, v168, v168
    v_add_f32 v195, v195, v169
    v_fmac_f32 v197, v169, v169
    v_add_f32 v194, v194, v195
    v_add_f32 v195, v196, v197
    v_mov_b32 v196, v194
    v_mov_b32 v197, v195
    buffer_store_dwordx4 v[186:189], v6, s[4:7], s23 offen sc1
    v_permlane16_swap_b32 v194, v196
    v_permlane16_swap_b32 v195, v197
    v_add_f32 v194, v194, v196
    v_add_f32 v195, v195, v197
    v_mov_b32 v196, v194
    v_mov_b32 v197, v195
    s_nop 0
    v_permlane32_swap_b32 v194, v196
    v_permlane32_swap_b32 v195, v197
    v_add_f32 v194, v194, v196
    v_add_f32 v195, v195, v197
    ds_write_b64 v12, v[194:195]
    s_waitcnt lgkmcnt(0)
    s_barrier
    ds_read_b64 v[198:199], v13 offset:0
    ds_read_b64 v[200:201], v13 offset:128
    ds_read_b64 v[202:203], v13 offset:256
    ds_read_b64 v[204:205], v13 offset:384
    s_waitcnt lgkmcnt(2)
    v_add_f32 v198, v198, v200
    v_add_f32 v199, v199, v201
    s_waitcnt lgkmcnt(0)
    v_add_f32 v202, v202, v204
    v_add_f32 v203, v203, v205
    v_add_f32 v194, v198, v202
    v_add_f32 v195, v199, v203
    v_mul_f32 v194, 0x3b124925, v194
    v_mul_f32 v195, 0x3b124925, v195
    v_fma_f32 v195, -v194, v194, v195
    v_max_f32 v195, 0, v195
    v_add_f32 v195, 0x3727c5ac, v195
    v_rsq_f32 v195, v195
    s_nop 0
    v_mul_f32 v194, v194, v195
    v_fma_f32 v146, v146, v195, -v194
    v_fma_f32 v147, v147, v195, -v194
    v_fma_f32 v148, v148, v195, -v194
    v_fma_f32 v149, v149, v195, -v194
    v_fma_f32 v150, v150, v195, -v194
    v_fma_f32 v151, v151, v195, -v194
    v_fma_f32 v152, v152, v195, -v194
    v_fma_f32 v153, v153, v195, -v194
    v_cvt_pk_bf16_f32 v146, v146, v147
    v_cvt_pk_bf16_f32 v147, v148, v149
    v_cvt_pk_bf16_f32 v148, v150, v151
    v_cvt_pk_bf16_f32 v149, v152, v153
    v_fma_f32 v154, v154, v195, -v194
    buffer_store_dwordx4 v[146:149], v4, s[4:7], s22 offen sc1
    v_fma_f32 v155, v155, v195, -v194
    v_fma_f32 v156, v156, v195, -v194
    v_fma_f32 v157, v157, v195, -v194
    v_fma_f32 v158, v158, v195, -v194
    v_fma_f32 v159, v159, v195, -v194
    v_fma_f32 v160, v160, v195, -v194
    v_fma_f32 v161, v161, v195, -v194
    v_cvt_pk_bf16_f32 v154, v154, v155
    v_cvt_pk_bf16_f32 v155, v156, v157
    v_cvt_pk_bf16_f32 v156, v158, v159
    v_cvt_pk_bf16_f32 v157, v160, v161
    v_fma_f32 v162, v162, v195, -v194
    buffer_store_dwordx4 v[154:157], v5, s[4:7], s22 offen sc1
    v_fma_f32 v163, v163, v195, -v194
    v_fma_f32 v164, v164, v195, -v194
    v_fma_f32 v165, v165, v195, -v194
    v_fma_f32 v166, v166, v195, -v194
    v_fma_f32 v167, v167, v195, -v194
    v_fma_f32 v168, v168, v195, -v194
    v_fma_f32 v169, v169, v195, -v194
    v_cvt_pk_bf16_f32 v162, v162, v163
    v_cvt_pk_bf16_f32 v163, v164, v165
    v_cvt_pk_bf16_f32 v164, v166, v167
    v_cvt_pk_bf16_f32 v165, v168, v169
    buffer_store_dwordx4 v[162:165], v6, s[4:7], s22 offen sc1
Rj_337:
    s_waitcnt vmcnt(0)
    s_barrier
    buffer_store_dword v11, v10, s[4:7], s25 offen sc1
    s_branch Rnext_333
Rlast_332:
    s_cmp_ge_u32 s10, 2
    s_cbranch_scc1 R3_338
    buffer_load_dwordx4 v[18:21], v4, s[4:7], s32 offen sc1
    buffer_load_dwordx4 v[22:25], v4, s[4:7], s33 offen sc1
    buffer_load_dwordx4 v[26:29], v4, s[4:7], s34 offen sc1
    buffer_load_dwordx4 v[30:33], v4, s[4:7], s35 offen sc1
    buffer_load_dwordx4 v[34:37], v4, s[4:7], s36 offen sc1
    buffer_load_dwordx4 v[38:41], v4, s[4:7], s37 offen sc1
    buffer_load_dwordx4 v[42:45], v4, s[4:7], s38 offen sc1
    buffer_load_dwordx4 v[46:49], v4, s[4:7], s21 offen sc1
    buffer_load_dwordx4 v[50:53], v5, s[4:7], s32 offen sc1
    buffer_load_dwordx4 v[54:57], v5, s[4:7], s33 offen sc1
    buffer_load_dwordx4 v[58:61], v5, s[4:7], s34 offen sc1
    buffer_load_dwordx4 v[62:65], v5, s[4:7], s35 offen sc1
    buffer_load_dwordx4 v[66:69], v5, s[4:7], s36 offen sc1
    buffer_load_dwordx4 v[70:73], v5, s[4:7], s37 offen sc1
    buffer_load_dwordx4 v[74:77], v5, s[4:7], s38 offen sc1
    buffer_load_dwordx4 v[78:81], v5, s[4:7], s21 offen sc1
    buffer_load_dwordx4 v[82:85], v6, s[4:7], s32 offen sc1
    buffer_load_dwordx4 v[86:89], v6, s[4:7], s33 offen sc1
    buffer_load_dwordx4 v[90:93], v6, s[4:7], s34 offen sc1
    buffer_load_dwordx4 v[94:97], v6, s[4:7], s35 offen sc1
    buffer_load_dwordx4 v[98:101], v6, s[4:7], s36 offen sc1
    buffer_load_dwordx4 v[102:105], v6, s[4:7], s37 offen sc1
    buffer_load_dwordx4 v[106:109], v6, s[4:7], s38 offen sc1
    buffer_load_dwordx4 v[110:113], v6, s[4:7], s21 offen sc1
    buffer_load_dwordx4 v[114:117], v7, s[4:7], s32 offen sc1
    buffer_load_dwordx4 v[118:121], v7, s[4:7], s33 offen sc1
    buffer_load_dwordx4 v[122:125], v7, s[4:7], s34 offen sc1
    buffer_load_dwordx4 v[126:129], v7, s[4:7], s35 offen sc1
    buffer_load_dwordx4 v[130:133], v7, s[4:7], s36 offen sc1
    buffer_load_dwordx4 v[134:137], v7, s[4:7], s37 offen sc1
    buffer_load_dwordx4 v[138:141], v7, s[4:7], s38 offen sc1
    buffer_load_dwordx4 v[142:145], v7, s[4:7], s21 offen sc1
    buffer_load_dword v9, v8, s[4:7], s24 offen offset:8 sc1
    s_waitcnt vmcnt(32)
    v_and_b32 v147, 0xffff0000, v18
    v_lshlrev_b32 v146, 16, v18
    v_and_b32 v149, 0xffff0000, v19
    v_lshlrev_b32 v148, 16, v19
    v_and_b32 v151, 0xffff0000, v20
    v_lshlrev_b32 v150, 16, v20
    v_and_b32 v153, 0xffff0000, v21
    v_lshlrev_b32 v152, 16, v21
    s_waitcnt vmcnt(31)
    v_dot2c_f32_bf16 v146, s27, v22
    v_dot2c_f32_bf16 v147, s28, v22
    v_dot2c_f32_bf16 v148, s27, v23
    v_dot2c_f32_bf16 v149, s28, v23
    v_dot2c_f32_bf16 v150, s27, v24
    v_dot2c_f32_bf16 v151, s28, v24
    v_dot2c_f32_bf16 v152, s27, v25
    v_dot2c_f32_bf16 v153, s28, v25
    s_waitcnt vmcnt(30)
    v_dot2c_f32_bf16 v146, s27, v26
    v_dot2c_f32_bf16 v147, s28, v26
    v_dot2c_f32_bf16 v148, s27, v27
    v_dot2c_f32_bf16 v149, s28, v27
    v_dot2c_f32_bf16 v150, s27, v28
    v_dot2c_f32_bf16 v151, s28, v28
    v_dot2c_f32_bf16 v152, s27, v29
    v_dot2c_f32_bf16 v153, s28, v29
    s_waitcnt vmcnt(29)
    v_dot2c_f32_bf16 v146, s27, v30
    v_dot2c_f32_bf16 v147, s28, v30
    v_dot2c_f32_bf16 v148, s27, v31
    v_dot2c_f32_bf16 v149, s28, v31
    v_dot2c_f32_bf16 v150, s27, v32
    v_dot2c_f32_bf16 v151, s28, v32
    v_dot2c_f32_bf16 v152, s27, v33
    v_dot2c_f32_bf16 v153, s28, v33
    s_waitcnt vmcnt(28)
    v_dot2c_f32_bf16 v146, s27, v34
    v_dot2c_f32_bf16 v147, s28, v34
    v_dot2c_f32_bf16 v148, s27, v35
    v_dot2c_f32_bf16 v149, s28, v35
    v_dot2c_f32_bf16 v150, s27, v36
    v_dot2c_f32_bf16 v151, s28, v36
    v_dot2c_f32_bf16 v152, s27, v37
    v_dot2c_f32_bf16 v153, s28, v37
    s_waitcnt vmcnt(27)
    v_dot2c_f32_bf16 v146, s27, v38
    v_dot2c_f32_bf16 v147, s28, v38
    v_dot2c_f32_bf16 v148, s27, v39
    v_dot2c_f32_bf16 v149, s28, v39
    v_dot2c_f32_bf16 v150, s27, v40
    v_dot2c_f32_bf16 v151, s28, v40
    v_dot2c_f32_bf16 v152, s27, v41
    v_dot2c_f32_bf16 v153, s28, v41
    s_waitcnt vmcnt(26)
    v_dot2c_f32_bf16 v146, s27, v42
    v_dot2c_f32_bf16 v147, s28, v42
    v_dot2c_f32_bf16 v148, s27, v43
    v_dot2c_f32_bf16 v149, s28, v43
    v_dot2c_f32_bf16 v150, s27, v44
    v_dot2c_f32_bf16 v151, s28, v44
    v_dot2c_f32_bf16 v152, s27, v45
    v_dot2c_f32_bf16 v153, s28, v45
    s_waitcnt vmcnt(25)
    v_dot2c_f32_bf16 v146, s27, v46
    v_dot2c_f32_bf16 v147, s28, v46
    v_dot2c_f32_bf16 v148, s27, v47
    v_dot2c_f32_bf16 v149, s28, v47
    v_dot2c_f32_bf16 v150, s27, v48
    v_dot2c_f32_bf16 v151, s28, v48
    v_dot2c_f32_bf16 v152, s27, v49
    v_dot2c_f32_bf16 v153, s28, v49
    v_cvt_pk_bf16_f32 v178, v146, v147
    v_cvt_pk_bf16_f32 v179, v148, v149
    v_cvt_pk_bf16_f32 v180, v150, v151
    v_cvt_pk_bf16_f32 v181, v152, v153
    ds_write_b128 v14, v[178:181] offset:0
    s_waitcnt vmcnt(24)
    v_and_b32 v155, 0xffff0000, v50
    v_lshlrev_b32 v154, 16, v50
    v_and_b32 v157, 0xffff0000, v51
    v_lshlrev_b32 v156, 16, v51
    v_and_b32 v159, 0xffff0000, v52
    v_lshlrev_b32 v158, 16, v52
    v_and_b32 v161, 0xffff0000, v53
    v_lshlrev_b32 v160, 16, v53
    s_waitcnt vmcnt(23)
    v_dot2c_f32_bf16 v154, s27, v54
    v_dot2c_f32_bf16 v155, s28, v54
    v_dot2c_f32_bf16 v156, s27, v55
    v_dot2c_f32_bf16 v157, s28, v55
    v_dot2c_f32_bf16 v158, s27, v56
    v_dot2c_f32_bf16 v159, s28, v56
    v_dot2c_f32_bf16 v160, s27, v57
    v_dot2c_f32_bf16 v161, s28, v57
    s_waitcnt vmcnt(22)
    v_dot2c_f32_bf16 v154, s27, v58
    v_dot2c_f32_bf16 v155, s28, v58
    v_dot2c_f32_bf16 v156, s27, v59
    v_dot2c_f32_bf16 v157, s28, v59
    v_dot2c_f32_bf16 v158, s27, v60
    v_dot2c_f32_bf16 v159, s28, v60
    v_dot2c_f32_bf16 v160, s27, v61
    v_dot2c_f32_bf16 v161, s28, v61
    s_waitcnt vmcnt(21)
    v_dot2c_f32_bf16 v154, s27, v62
    v_dot2c_f32_bf16 v155, s28, v62
    v_dot2c_f32_bf16 v156, s27, v63
    v_dot2c_f32_bf16 v157, s28, v63
    v_dot2c_f32_bf16 v158, s27, v64
    v_dot2c_f32_bf16 v159, s28, v64
    v_dot2c_f32_bf16 v160, s27, v65
    v_dot2c_f32_bf16 v161, s28, v65
    s_waitcnt vmcnt(20)
    v_dot2c_f32_bf16 v154, s27, v66
    v_dot2c_f32_bf16 v155, s28, v66
    v_dot2c_f32_bf16 v156, s27, v67
    v_dot2c_f32_bf16 v157, s28, v67
    v_dot2c_f32_bf16 v158, s27, v68
    v_dot2c_f32_bf16 v159, s28, v68
    v_dot2c_f32_bf16 v160, s27, v69
    v_dot2c_f32_bf16 v161, s28, v69
    s_waitcnt vmcnt(19)
    v_dot2c_f32_bf16 v154, s27, v70
    v_dot2c_f32_bf16 v155, s28, v70
    v_dot2c_f32_bf16 v156, s27, v71
    v_dot2c_f32_bf16 v157, s28, v71
    v_dot2c_f32_bf16 v158, s27, v72
    v_dot2c_f32_bf16 v159, s28, v72
    v_dot2c_f32_bf16 v160, s27, v73
    v_dot2c_f32_bf16 v161, s28, v73
    s_waitcnt vmcnt(18)
    v_dot2c_f32_bf16 v154, s27, v74
    v_dot2c_f32_bf16 v155, s28, v74
    v_dot2c_f32_bf16 v156, s27, v75
    v_dot2c_f32_bf16 v157, s28, v75
    v_dot2c_f32_bf16 v158, s27, v76
    v_dot2c_f32_bf16 v159, s28, v76
    v_dot2c_f32_bf16 v160, s27, v77
    v_dot2c_f32_bf16 v161, s28, v77
    s_waitcnt vmcnt(17)
    v_dot2c_f32_bf16 v154, s27, v78
    v_dot2c_f32_bf16 v155, s28, v78
    v_dot2c_f32_bf16 v156, s27, v79
    v_dot2c_f32_bf16 v157, s28, v79
    v_dot2c_f32_bf16 v158, s27, v80
    v_dot2c_f32_bf16 v159, s28, v80
    v_dot2c_f32_bf16 v160, s27, v81
    v_dot2c_f32_bf16 v161, s28, v81
    v_cvt_pk_bf16_f32 v182, v154, v155
    v_cvt_pk_bf16_f32 v183, v156, v157
    v_cvt_pk_bf16_f32 v184, v158, v159
    v_cvt_pk_bf16_f32 v185, v160, v161
    ds_write_b128 v14, v[182:185] offset:256
    s_waitcnt vmcnt(16)
    v_and_b32 v163, 0xffff0000, v82
    v_lshlrev_b32 v162, 16, v82
    v_and_b32 v165, 0xffff0000, v83
    v_lshlrev_b32 v164, 16, v83
    v_and_b32 v167, 0xffff0000, v84
    v_lshlrev_b32 v166, 16, v84
    v_and_b32 v169, 0xffff0000, v85
    v_lshlrev_b32 v168, 16, v85
    s_waitcnt vmcnt(15)
    v_dot2c_f32_bf16 v162, s27, v86
    v_dot2c_f32_bf16 v163, s28, v86
    v_dot2c_f32_bf16 v164, s27, v87
    v_dot2c_f32_bf16 v165, s28, v87
    v_dot2c_f32_bf16 v166, s27, v88
    v_dot2c_f32_bf16 v167, s28, v88
    v_dot2c_f32_bf16 v168, s27, v89
    v_dot2c_f32_bf16 v169, s28, v89
    s_waitcnt vmcnt(14)
    v_dot2c_f32_bf16 v162, s27, v90
    v_dot2c_f32_bf16 v163, s28, v90
    v_dot2c_f32_bf16 v164, s27, v91
    v_dot2c_f32_bf16 v165, s28, v91
    v_dot2c_f32_bf16 v166, s27, v92
    v_dot2c_f32_bf16 v167, s28, v92
    v_dot2c_f32_bf16 v168, s27, v93
    v_dot2c_f32_bf16 v169, s28, v93
    s_waitcnt vmcnt(13)
    v_dot2c_f32_bf16 v162, s27, v94
    v_dot2c_f32_bf16 v163, s28, v94
    v_dot2c_f32_bf16 v164, s27, v95
    v_dot2c_f32_bf16 v165, s28, v95
    v_dot2c_f32_bf16 v166, s27, v96
    v_dot2c_f32_bf16 v167, s28, v96
    v_dot2c_f32_bf16 v168, s27, v97
    v_dot2c_f32_bf16 v169, s28, v97
    s_waitcnt vmcnt(12)
    v_dot2c_f32_bf16 v162, s27, v98
    v_dot2c_f32_bf16 v163, s28, v98
    v_dot2c_f32_bf16 v164, s27, v99
    v_dot2c_f32_bf16 v165, s28, v99
    v_dot2c_f32_bf16 v166, s27, v100
    v_dot2c_f32_bf16 v167, s28, v100
    v_dot2c_f32_bf16 v168, s27, v101
    v_dot2c_f32_bf16 v169, s28, v101
    s_waitcnt vmcnt(11)
    v_dot2c_f32_bf16 v162, s27, v102
    v_dot2c_f32_bf16 v163, s28, v102
    v_dot2c_f32_bf16 v164, s27, v103
    v_dot2c_f32_bf16 v165, s28, v103
    v_dot2c_f32_bf16 v166, s27, v104
    v_dot2c_f32_bf16 v167, s28, v104
    v_dot2c_f32_bf16 v168, s27, v105
    v_dot2c_f32_bf16 v169, s28, v105
    s_waitcnt vmcnt(10)
    v_dot2c_f32_bf16 v162, s27, v106
    v_dot2c_f32_bf16 v163, s28, v106
    v_dot2c_f32_bf16 v164, s27, v107
    v_dot2c_f32_bf16 v165, s28, v107
    v_dot2c_f32_bf16 v166, s27, v108
    v_dot2c_f32_bf16 v167, s28, v108
    v_dot2c_f32_bf16 v168, s27, v109
    v_dot2c_f32_bf16 v169, s28, v109
    s_waitcnt vmcnt(9)
    v_dot2c_f32_bf16 v162, s27, v110
    v_dot2c_f32_bf16 v163, s28, v110
    v_dot2c_f32_bf16 v164, s27, v111
    v_dot2c_f32_bf16 v165, s28, v111
    v_dot2c_f32_bf16 v166, s27, v112
    v_dot2c_f32_bf16 v167, s28, v112
    v_dot2c_f32_bf16 v168, s27, v113
    v_dot2c_f32_bf16 v169, s28, v113
    v_cvt_pk_bf16_f32 v186, v162, v163
    v_cvt_pk_bf16_f32 v187, v164, v165
    v_cvt_pk_bf16_f32 v188, v166, v167
    v_cvt_pk_bf16_f32 v189, v168, v169
    ds_write_b128 v14, v[186:189] offset:512
    s_waitcnt vmcnt(8)
    v_and_b32 v171, 0xffff0000, v114
    v_lshlrev_b32 v170, 16, v114
    v_and_b32 v173, 0xffff0000, v115
    v_lshlrev_b32 v172, 16, v115
    v_and_b32 v175, 0xffff0000, v116
    v_lshlrev_b32 v174, 16, v116
    v_and_b32 v177, 0xffff0000, v117
    v_lshlrev_b32 v176, 16, v117
    s_waitcnt vmcnt(7)
    v_dot2c_f32_bf16 v170, s27, v118
    v_dot2c_f32_bf16 v171, s28, v118
    v_dot2c_f32_bf16 v172, s27, v119
    v_dot2c_f32_bf16 v173, s28, v119
    v_dot2c_f32_bf16 v174, s27, v120
    v_dot2c_f32_bf16 v175, s28, v120
    v_dot2c_f32_bf16 v176, s27, v121
    v_dot2c_f32_bf16 v177, s28, v121
    s_waitcnt vmcnt(6)
    v_dot2c_f32_bf16 v170, s27, v122
    v_dot2c_f32_bf16 v171, s28, v122
    v_dot2c_f32_bf16 v172, s27, v123
    v_dot2c_f32_bf16 v173, s28, v123
    v_dot2c_f32_bf16 v174, s27, v124
    v_dot2c_f32_bf16 v175, s28, v124
    v_dot2c_f32_bf16 v176, s27, v125
    v_dot2c_f32_bf16 v177, s28, v125
    s_waitcnt vmcnt(5)
    v_dot2c_f32_bf16 v170, s27, v126
    v_dot2c_f32_bf16 v171, s28, v126
    v_dot2c_f32_bf16 v172, s27, v127
    v_dot2c_f32_bf16 v173, s28, v127
    v_dot2c_f32_bf16 v174, s27, v128
    v_dot2c_f32_bf16 v175, s28, v128
    v_dot2c_f32_bf16 v176, s27, v129
    v_dot2c_f32_bf16 v177, s28, v129
    s_waitcnt vmcnt(4)
    v_dot2c_f32_bf16 v170, s27, v130
    v_dot2c_f32_bf16 v171, s28, v130
    v_dot2c_f32_bf16 v172, s27, v131
    v_dot2c_f32_bf16 v173, s28, v131
    v_dot2c_f32_bf16 v174, s27, v132
    v_dot2c_f32_bf16 v175, s28, v132
    v_dot2c_f32_bf16 v176, s27, v133
    v_dot2c_f32_bf16 v177, s28, v133
    s_waitcnt vmcnt(3)
    v_dot2c_f32_bf16 v170, s27, v134
    v_dot2c_f32_bf16 v171, s28, v134
    v_dot2c_f32_bf16 v172, s27, v135
    v_dot2c_f32_bf16 v173, s28, v135
    v_dot2c_f32_bf16 v174, s27, v136
    v_dot2c_f32_bf16 v175, s28, v136
    v_dot2c_f32_bf16 v176, s27, v137
    v_dot2c_f32_bf16 v177, s28, v137
    s_waitcnt vmcnt(2)
    v_dot2c_f32_bf16 v170, s27, v138
    v_dot2c_f32_bf16 v171, s28, v138
    v_dot2c_f32_bf16 v172, s27, v139
    v_dot2c_f32_bf16 v173, s28, v139
    v_dot2c_f32_bf16 v174, s27, v140
    v_dot2c_f32_bf16 v175, s28, v140
    v_dot2c_f32_bf16 v176, s27, v141
    v_dot2c_f32_bf16 v177, s28, v141
    s_waitcnt vmcnt(1)
    v_dot2c_f32_bf16 v170, s27, v142
    v_dot2c_f32_bf16 v171, s28, v142
    v_dot2c_f32_bf16 v172, s27, v143
    v_dot2c_f32_bf16 v173, s28, v143
    v_dot2c_f32_bf16 v174, s27, v144
    v_dot2c_f32_bf16 v175, s28, v144
    v_dot2c_f32_bf16 v176, s27, v145
    v_dot2c_f32_bf16 v177, s28, v145
    v_cvt_pk_bf16_f32 v190, v170, v171
    v_cvt_pk_bf16_f32 v191, v172, v173
    v_cvt_pk_bf16_f32 v192, v174, v175
    v_cvt_pk_bf16_f32 v193, v176, v177
    ds_write_b128 v14, v[190:193] offset:768
    s_branch Rj_339
R3_338:
    buffer_load_dwordx4 v[18:21], v4, s[4:7], s32 offen sc1
    buffer_load_dwordx4 v[22:25], v4, s[4:7], s33 offen sc1
    buffer_load_dwordx4 v[26:29], v4, s[4:7], s34 offen sc1
    buffer_load_dwordx4 v[30:33], v4, s[4:7], s35 offen sc1
    buffer_load_dwordx4 v[34:37], v4, s[4:7], s36 offen sc1
    buffer_load_dwordx4 v[38:41], v4, s[4:7], s37 offen sc1
    buffer_load_dwordx4 v[42:45], v4, s[4:7], s38 offen sc1
    buffer_load_dwordx4 v[46:49], v4, s[4:7], s21 offen sc1
    buffer_load_dwordx4 v[50:53], v5, s[4:7], s32 offen sc1
    buffer_load_dwordx4 v[54:57], v5, s[4:7], s33 offen sc1
    buffer_load_dwordx4 v[58:61], v5, s[4:7], s34 offen sc1
    buffer_load_dwordx4 v[62:65], v5, s[4:7], s35 offen sc1
    buffer_load_dwordx4 v[66:69], v5, s[4:7], s36 offen sc1
    buffer_load_dwordx4 v[70:73], v5, s[4:7], s37 offen sc1
    buffer_load_dwordx4 v[74:77], v5, s[4:7], s38 offen sc1
    buffer_load_dwordx4 v[78:81], v5, s[4:7], s21 offen sc1
    buffer_load_dwordx4 v[82:85], v6, s[4:7], s32 offen sc1
    buffer_load_dwordx4 v[86:89], v6, s[4:7], s33 offen sc1
    buffer_load_dwordx4 v[90:93], v6, s[4:7], s34 offen sc1
    buffer_load_dwordx4 v[94:97], v6, s[4:7], s35 offen sc1
    buffer_load_dwordx4 v[98:101], v6, s[4:7], s36 offen sc1
    buffer_load_dwordx4 v[102:105], v6, s[4:7], s37 offen sc1
    buffer_load_dwordx4 v[106:109], v6, s[4:7], s38 offen sc1
    buffer_load_dwordx4 v[110:113], v6, s[4:7], s21 offen sc1
    buffer_load_dword v9, v8, s[4:7], s24 offen offset:8 sc1
    s_waitcnt vmcnt(24)
    v_and_b32 v147, 0xffff0000, v18
    v_lshlrev_b32 v146, 16, v18
    v_and_b32 v149, 0xffff0000, v19
    v_lshlrev_b32 v148, 16, v19
    v_and_b32 v151, 0xffff0000, v20
    v_lshlrev_b32 v150, 16, v20
    v_and_b32 v153, 0xffff0000, v21
    v_lshlrev_b32 v152, 16, v21
    s_waitcnt vmcnt(23)
    v_dot2c_f32_bf16 v146, s27, v22
    v_dot2c_f32_bf16 v147, s28, v22
    v_dot2c_f32_bf16 v148, s27, v23
    v_dot2c_f32_bf16 v149, s28, v23
    v_dot2c_f32_bf16 v150, s27, v24
    v_dot2c_f32_bf16 v151, s28, v24
    v_dot2c_f32_bf16 v152, s27, v25
    v_dot2c_f32_bf16 v153, s28, v25
    s_waitcnt vmcnt(22)
    v_dot2c_f32_bf16 v146, s27, v26
    v_dot2c_f32_bf16 v147, s28, v26
    v_dot2c_f32_bf16 v148, s27, v27
    v_dot2c_f32_bf16 v149, s28, v27
    v_dot2c_f32_bf16 v150, s27, v28
    v_dot2c_f32_bf16 v151, s28, v28
    v_dot2c_f32_bf16 v152, s27, v29
    v_dot2c_f32_bf16 v153, s28, v29
    s_waitcnt vmcnt(21)
    v_dot2c_f32_bf16 v146, s27, v30
    v_dot2c_f32_bf16 v147, s28, v30
    v_dot2c_f32_bf16 v148, s27, v31
    v_dot2c_f32_bf16 v149, s28, v31
    v_dot2c_f32_bf16 v150, s27, v32
    v_dot2c_f32_bf16 v151, s28, v32
    v_dot2c_f32_bf16 v152, s27, v33
    v_dot2c_f32_bf16 v153, s28, v33
    s_waitcnt vmcnt(20)
    v_dot2c_f32_bf16 v146, s27, v34
    v_dot2c_f32_bf16 v147, s28, v34
    v_dot2c_f32_bf16 v148, s27, v35
    v_dot2c_f32_bf16 v149, s28, v35
    v_dot2c_f32_bf16 v150, s27, v36
    v_dot2c_f32_bf16 v151, s28, v36
    v_dot2c_f32_bf16 v152, s27, v37
    v_dot2c_f32_bf16 v153, s28, v37
    s_waitcnt vmcnt(19)
    v_dot2c_f32_bf16 v146, s27, v38
    v_dot2c_f32_bf16 v147, s28, v38
    v_dot2c_f32_bf16 v148, s27, v39
    v_dot2c_f32_bf16 v149, s28, v39
    v_dot2c_f32_bf16 v150, s27, v40
    v_dot2c_f32_bf16 v151, s28, v40
    v_dot2c_f32_bf16 v152, s27, v41
    v_dot2c_f32_bf16 v153, s28, v41
    s_waitcnt vmcnt(18)
    v_dot2c_f32_bf16 v146, s27, v42
    v_dot2c_f32_bf16 v147, s28, v42
    v_dot2c_f32_bf16 v148, s27, v43
    v_dot2c_f32_bf16 v149, s28, v43
    v_dot2c_f32_bf16 v150, s27, v44
    v_dot2c_f32_bf16 v151, s28, v44
    v_dot2c_f32_bf16 v152, s27, v45
    v_dot2c_f32_bf16 v153, s28, v45
    s_waitcnt vmcnt(17)
    v_dot2c_f32_bf16 v146, s27, v46
    v_dot2c_f32_bf16 v147, s28, v46
    v_dot2c_f32_bf16 v148, s27, v47
    v_dot2c_f32_bf16 v149, s28, v47
    v_dot2c_f32_bf16 v150, s27, v48
    v_dot2c_f32_bf16 v151, s28, v48
    v_dot2c_f32_bf16 v152, s27, v49
    v_dot2c_f32_bf16 v153, s28, v49
    v_cvt_pk_bf16_f32 v178, v146, v147
    v_cvt_pk_bf16_f32 v179, v148, v149
    v_cvt_pk_bf16_f32 v180, v150, v151
    v_cvt_pk_bf16_f32 v181, v152, v153
    ds_write_b128 v14, v[178:181] offset:0
    s_waitcnt vmcnt(16)
    v_and_b32 v155, 0xffff0000, v50
    v_lshlrev_b32 v154, 16, v50
    v_and_b32 v157, 0xffff0000, v51
    v_lshlrev_b32 v156, 16, v51
    v_and_b32 v159, 0xffff0000, v52
    v_lshlrev_b32 v158, 16, v52
    v_and_b32 v161, 0xffff0000, v53
    v_lshlrev_b32 v160, 16, v53
    s_waitcnt vmcnt(15)
    v_dot2c_f32_bf16 v154, s27, v54
    v_dot2c_f32_bf16 v155, s28, v54
    v_dot2c_f32_bf16 v156, s27, v55
    v_dot2c_f32_bf16 v157, s28, v55
    v_dot2c_f32_bf16 v158, s27, v56
    v_dot2c_f32_bf16 v159, s28, v56
    v_dot2c_f32_bf16 v160, s27, v57
    v_dot2c_f32_bf16 v161, s28, v57
    s_waitcnt vmcnt(14)
    v_dot2c_f32_bf16 v154, s27, v58
    v_dot2c_f32_bf16 v155, s28, v58
    v_dot2c_f32_bf16 v156, s27, v59
    v_dot2c_f32_bf16 v157, s28, v59
    v_dot2c_f32_bf16 v158, s27, v60
    v_dot2c_f32_bf16 v159, s28, v60
    v_dot2c_f32_bf16 v160, s27, v61
    v_dot2c_f32_bf16 v161, s28, v61
    s_waitcnt vmcnt(13)
    v_dot2c_f32_bf16 v154, s27, v62
    v_dot2c_f32_bf16 v155, s28, v62
    v_dot2c_f32_bf16 v156, s27, v63
    v_dot2c_f32_bf16 v157, s28, v63
    v_dot2c_f32_bf16 v158, s27, v64
    v_dot2c_f32_bf16 v159, s28, v64
    v_dot2c_f32_bf16 v160, s27, v65
    v_dot2c_f32_bf16 v161, s28, v65
    s_waitcnt vmcnt(12)
    v_dot2c_f32_bf16 v154, s27, v66
    v_dot2c_f32_bf16 v155, s28, v66
    v_dot2c_f32_bf16 v156, s27, v67
    v_dot2c_f32_bf16 v157, s28, v67
    v_dot2c_f32_bf16 v158, s27, v68
    v_dot2c_f32_bf16 v159, s28, v68
    v_dot2c_f32_bf16 v160, s27, v69
    v_dot2c_f32_bf16 v161, s28, v69
    s_waitcnt vmcnt(11)
    v_dot2c_f32_bf16 v154, s27, v70
    v_dot2c_f32_bf16 v155, s28, v70
    v_dot2c_f32_bf16 v156, s27, v71
    v_dot2c_f32_bf16 v157, s28, v71
    v_dot2c_f32_bf16 v158, s27, v72
    v_dot2c_f32_bf16 v159, s28, v72
    v_dot2c_f32_bf16 v160, s27, v73
    v_dot2c_f32_bf16 v161, s28, v73
    s_waitcnt vmcnt(10)
    v_dot2c_f32_bf16 v154, s27, v74
    v_dot2c_f32_bf16 v155, s28, v74
    v_dot2c_f32_bf16 v156, s27, v75
    v_dot2c_f32_bf16 v157, s28, v75
    v_dot2c_f32_bf16 v158, s27, v76
    v_dot2c_f32_bf16 v159, s28, v76
    v_dot2c_f32_bf16 v160, s27, v77
    v_dot2c_f32_bf16 v161, s28, v77
    s_waitcnt vmcnt(9)
    v_dot2c_f32_bf16 v154, s27, v78
    v_dot2c_f32_bf16 v155, s28, v78
    v_dot2c_f32_bf16 v156, s27, v79
    v_dot2c_f32_bf16 v157, s28, v79
    v_dot2c_f32_bf16 v158, s27, v80
    v_dot2c_f32_bf16 v159, s28, v80
    v_dot2c_f32_bf16 v160, s27, v81
    v_dot2c_f32_bf16 v161, s28, v81
    v_cvt_pk_bf16_f32 v182, v154, v155
    v_cvt_pk_bf16_f32 v183, v156, v157
    v_cvt_pk_bf16_f32 v184, v158, v159
    v_cvt_pk_bf16_f32 v185, v160, v161
    ds_write_b128 v14, v[182:185] offset:256
    s_waitcnt vmcnt(8)
    v_and_b32 v163, 0xffff0000, v82
    v_lshlrev_b32 v162, 16, v82
    v_and_b32 v165, 0xffff0000, v83
    v_lshlrev_b32 v164, 16, v83
    v_and_b32 v167, 0xffff0000, v84
    v_lshlrev_b32 v166, 16, v84
    v_and_b32 v169, 0xffff0000, v85
    v_lshlrev_b32 v168, 16, v85
    s_waitcnt vmcnt(7)
    v_dot2c_f32_bf16 v162, s27, v86
    v_dot2c_f32_bf16 v163, s28, v86
    v_dot2c_f32_bf16 v164, s27, v87
    v_dot2c_f32_bf16 v165, s28, v87
    v_dot2c_f32_bf16 v166, s27, v88
    v_dot2c_f32_bf16 v167, s28, v88
    v_dot2c_f32_bf16 v168, s27, v89
    v_dot2c_f32_bf16 v169, s28, v89
    s_waitcnt vmcnt(6)
    v_dot2c_f32_bf16 v162, s27, v90
    v_dot2c_f32_bf16 v163, s28, v90
    v_dot2c_f32_bf16 v164, s27, v91
    v_dot2c_f32_bf16 v165, s28, v91
    v_dot2c_f32_bf16 v166, s27, v92
    v_dot2c_f32_bf16 v167, s28, v92
    v_dot2c_f32_bf16 v168, s27, v93
    v_dot2c_f32_bf16 v169, s28, v93
    s_waitcnt vmcnt(5)
    v_dot2c_f32_bf16 v162, s27, v94
    v_dot2c_f32_bf16 v163, s28, v94
    v_dot2c_f32_bf16 v164, s27, v95
    v_dot2c_f32_bf16 v165, s28, v95
    v_dot2c_f32_bf16 v166, s27, v96
    v_dot2c_f32_bf16 v167, s28, v96
    v_dot2c_f32_bf16 v168, s27, v97
    v_dot2c_f32_bf16 v169, s28, v97
    s_waitcnt vmcnt(4)
    v_dot2c_f32_bf16 v162, s27, v98
    v_dot2c_f32_bf16 v163, s28, v98
    v_dot2c_f32_bf16 v164, s27, v99
    v_dot2c_f32_bf16 v165, s28, v99
    v_dot2c_f32_bf16 v166, s27, v100
    v_dot2c_f32_bf16 v167, s28, v100
    v_dot2c_f32_bf16 v168, s27, v101
    v_dot2c_f32_bf16 v169, s28, v101
    s_waitcnt vmcnt(3)
    v_dot2c_f32_bf16 v162, s27, v102
    v_dot2c_f32_bf16 v163, s28, v102
    v_dot2c_f32_bf16 v164, s27, v103
    v_dot2c_f32_bf16 v165, s28, v103
    v_dot2c_f32_bf16 v166, s27, v104
    v_dot2c_f32_bf16 v167, s28, v104
    v_dot2c_f32_bf16 v168, s27, v105
    v_dot2c_f32_bf16 v169, s28, v105
    s_waitcnt vmcnt(2)
    v_dot2c_f32_bf16 v162, s27, v106
    v_dot2c_f32_bf16 v163, s28, v106
    v_dot2c_f32_bf16 v164, s27, v107
    v_dot2c_f32_bf16 v165, s28, v107
    v_dot2c_f32_bf16 v166, s27, v108
    v_dot2c_f32_bf16 v167, s28, v108
    v_dot2c_f32_bf16 v168, s27, v109
    v_dot2c_f32_bf16 v169, s28, v109
    s_waitcnt vmcnt(1)
    v_dot2c_f32_bf16 v162, s27, v110
    v_dot2c_f32_bf16 v163, s28, v110
    v_dot2c_f32_bf16 v164, s27, v111
    v_dot2c_f32_bf16 v165, s28, v111
    v_dot2c_f32_bf16 v166, s27, v112
    v_dot2c_f32_bf16 v167, s28, v112
    v_dot2c_f32_bf16 v168, s27, v113
    v_dot2c_f32_bf16 v169, s28, v113
    v_cvt_pk_bf16_f32 v186, v162, v163
    v_cvt_pk_bf16_f32 v187, v164, v165
    v_cvt_pk_bf16_f32 v188, v166, v167
    v_cvt_pk_bf16_f32 v189, v168, v169
    ds_write_b128 v14, v[186:189] offset:512
Rj_339:
    s_waitcnt lgkmcnt(0)
    s_barrier
    ds_read_b128 v[178:181], v15 offset:0
    ds_read_b128 v[182:185], v15 offset:912
    ds_read_b128 v[186:189], v15 offset:1824
    ds_read_b128 v[190:193], v15 offset:2736
    s_waitcnt lgkmcnt(3)
    buffer_store_dwordx4 v[178:181], v16, s[16:19], s26 offen offset:0
    s_waitcnt lgkmcnt(2)
    buffer_store_dwordx4 v[182:185], v16, s[16:19], s26 offen offset:896
    s_waitcnt lgkmcnt(1)
    buffer_store_dwordx4 v[186:189], v16, s[16:19], s26 offen offset:1792
    s_waitcnt lgkmcnt(0)
    buffer_store_dwordx4 v[190:193], v16, s[16:19], s26 offen offset:2688
    s_waitcnt vmcnt(4)
    s_barrier
Rnext_333:
    buffer_store_dword v11, v10, s[4:7], s31 offen sc1
    s_add_u32 s22, s22, 57344
    s_add_u32 s23, s23, 57344
    s_add_u32 s26, s26, 57344
    s_add_u32 s24, s24, 8
    s_add_u32 s25, s25, 8
    s_add_u32 s31, s31, 8
    s_add_u32 s11, s11, 2
    s_cmp_lt_u32 s11, 64
    s_cbranch_scc1 Rloop_331
    s_endpgm
.section .rodata,"a"
.p2align 6
.amdhsa_kernel interleave_layers__memory_aug_recurrent_mem_tr__dense_activation_silu__prompt_kernel
  .amdhsa_next_free_vgpr 512
  .amdhsa_next_free_sgpr 102
  .amdhsa_accum_offset 256
  .amdhsa_group_segment_fixed_size 0
  .amdhsa_kernarg_size 104
  .amdhsa_user_sgpr_count 2
  .amdhsa_user_sgpr_kernarg_segment_ptr 1
  .amdhsa_system_sgpr_workgroup_id_x 1
  .amdhsa_float_denorm_mode_32 3
.end_amdhsa_kernel
```
